```python
import torch

def _softmax(x, axis=-1):
    return torch.softmax(x, dim=axis)
def _gelu(x):
    return torch.nn.functional.gelu(x, approximate="tanh")
def _silu(x):
    return torch.nn.functional.silu(x)
def _sigmoid(x):
    return torch.sigmoid(x)
def _layernorm(x, axis=-1, eps=1e-5):
    m = x.mean(dim=axis, keepdim=True)
    v = x.var(dim=axis, keepdim=True, unbiased=False)
    return (x - m) / torch.sqrt(v + eps)
def _scatter_add(tgt, idx, src, axis=0):
    return tgt.clone().index_add_(axis, idx, src)
def _segment_sum(src, seg, n):
    out = torch.zeros((n,) + src.shape[1:], dtype=src.dtype)
    return out.index_add_(0, seg, src)
def _pad(x, pw):
    flat = tuple(v for pair in reversed(pw) for v in pair)
    return torch.nn.functional.pad(x, flat)

kernel_name = 'concat_heads__grouped_kv_mqa__compressed_kv_cla__prompt'

def setup_inputs():

    _w = (lambda a: (lambda t: t.to(torch.bfloat16) if t.is_floating_point() else t)(torch.as_tensor(a)))
    def _A_setup():
        B, S, D, H = 1, 2048, 576, 32
        Dh = D // H
        return {
            "x": _w((lambda *s: torch.randn(*s, dtype=torch.bfloat16) * 0.05)(B, S, D)),
            "wq": _w((lambda *s: torch.randn(*s, dtype=torch.bfloat16) * 0.8)(D, H * Dh)),
            "wk": _w((lambda *s: torch.randn(*s, dtype=torch.bfloat16) * 0.8)(D, Dh)),
            "wv": _w((lambda *s: torch.randn(*s, dtype=torch.bfloat16) * 0.05)(D, Dh)),
            "wo": _w((lambda *s: torch.randn(*s, dtype=torch.bfloat16) * 0.05)(H * Dh, D)),
        }
    _A_in = _A_setup()

    def _B_setup():
        B, H, Sq, Sk, D, M = 1, 32, 2048, 2048, 128, 576
        Dc = 4 * D
        return {
            "x": _w((lambda *s: torch.randn(*s, dtype=torch.bfloat16) * 3.2)(B, Sq, M)),
            "c_kv": _w((lambda *s: torch.randn(*s, dtype=torch.bfloat16) * 0.1)(B, Sk, Dc)),
            "w_q": _w((lambda *s: torch.randn(*s, dtype=torch.bfloat16) * 6.4)(M, H, D) * (M ** -0.5)),
            "w_uk": _w((lambda *s: torch.randn(*s, dtype=torch.bfloat16) * 6.4)(Dc, H, D) * (Dc ** -0.5)),
            "w_uv": _w((lambda *s: torch.randn(*s, dtype=torch.bfloat16) * 0.1)(Dc, H, D) * (Dc ** -0.5)),
            "w_o": _w((lambda *s: torch.randn(*s, dtype=torch.bfloat16) * 0.1)(H, D, M) * ((H * D) ** -0.5)),
        }
    _B_in = _B_setup()

    return {
        "A_x": _A_in["x"],
        "A_wq": _A_in["wq"],
        "A_wk": _A_in["wk"],
        "A_wv": _A_in["wv"],
        "A_wo": _A_in["wo"],
        "B_x": _B_in["x"],
        "B_c_kv": _B_in["c_kv"],
        "B_w_q": _B_in["w_q"],
        "B_w_uk": _B_in["w_uk"],
        "B_w_uv": _B_in["w_uv"],
        "B_w_o": _B_in["w_o"],
    }

def reference(A_x, A_wq, A_wk, A_wv, A_wo, B_x, B_c_kv, B_w_q, B_w_uk, B_w_uv, B_w_o):
    def _A_ref(x, wq, wk, wv, wo):
        B, S, D = x.shape
        H = 32
        Dh = D // H
        q = (lambda x, *d: x.permute(*d))((x @ wq).reshape(B, S, H, Dh), 0, 2, 1, 3)
        k = x @ wk
        v = x @ wv
        scores = torch.einsum("bhqd,bkd->bhqk", q, k) * (Dh ** -0.5)
        p = _softmax(scores, axis=-1)
        o = torch.einsum("bhqk,bkd->bhqd", p, v)
        return (lambda x, *d: x.permute(*d))(o, 0, 2, 1, 3).reshape(B, S, H * Dh) @ wo

    def _B_ref(x, c_kv, w_q, w_uk, w_uv, w_o):
        B, Sq, M = x.shape[0], x.shape[1], x.shape[2]
        Sk = c_kv.shape[1]
        H, D = w_q.shape[1], w_q.shape[2]
        q = torch.einsum("bqm,mhd->bhqd", x, w_q)
        k = torch.einsum("bkc,chd->bhkd", c_kv, w_uk)
        v = torch.einsum("bkc,chd->bhkd", c_kv, w_uv)
        scores = torch.einsum("bhqd,bhkd->bhqk", q, k) * (D ** -0.5)
        off = Sk - Sq
        qi = torch.arange(Sq)[:, None]
        kj = torch.arange(Sk)[None, :]
        cmask = kj <= (qi + off)
        scores = torch.where(cmask[None, None], scores, -1e9)
        p = _softmax(scores, axis=-1)
        ctx = torch.einsum("bhqk,bhkd->bhqd", p, v)
        return torch.einsum("bhqd,hdm->bqm", ctx, w_o)

    a = _A_ref(A_x, A_wq, A_wk, A_wv, A_wo)
    b = _B_ref(B_x, B_c_kv, B_w_q, B_w_uk, B_w_uv, B_w_o)
    return torch.concatenate([a, b], axis=-1)
```

```asm
; @launch kernel=k2b_kernel grid=(256,1,1) block=(256,1,1) lds=163840
; @launch kernel=k3_kernel grid=(496,1,1) block=(256,1,1) lds=81920
.amdgcn_target "amdgcn-amd-amdhsa--gfx950"
.text
.globl k2b_kernel
.p2align 8
.type k2b_kernel,@function
k2b_kernel:
    s_cmp_ge_u32 s2, 256
    s_cbranch_scc1 L_k2b_end
    s_load_dwordx2 s[4:5], s[0:1], 40
    s_load_dwordx2 s[8:9], s[0:1], 56
    s_load_dwordx2 s[6:7], s[0:1], 104
    s_and_b32 s38, s2, 7
    s_lshr_b32 s39, s2, 3
    s_and_b32 s33, s39, 7
    s_lshr_b32 s39, s39, 3
    s_lshl_b32 s38, s38, 2
    s_add_u32 s32, s38, s39
    v_lshrrev_b32 v1, 6, v0
    v_and_b32 v0, 63, v0
    v_readfirstlane_b32 s34, v1
    v_lshlrev_b32 v1, 4, v0
    s_load_dwordx2 s[56:57], s[0:1], 48
    s_load_dwordx4 s[60:63], s[0:1], 64
    s_load_dwordx2 s[68:69], s[0:1], 96
    s_load_dwordx4 s[84:87], s[0:1], 16
    s_waitcnt lgkmcnt(0)
    s_mov_b32 s12, s4
    s_mov_b32 s13, s5
    s_mov_b32 s14, 2359296
    s_mov_b32 s15, 0x00020000
    s_mov_b32 s16, s8
    s_mov_b32 s17, s9
    s_mov_b32 s18, 4718592
    s_mov_b32 s19, 0x00020000
    s_lshl_b32 s38, s32, 19
    s_add_u32 s39, s38, 0
    s_add_u32 s20, s6, s39
    s_addc_u32 s21, s7, 0
    s_mov_b32 s22, 524288
    s_mov_b32 s23, 0x00020000
    s_add_u32 s39, s38, 16777216
    s_add_u32 s24, s6, s39
    s_addc_u32 s25, s7, 0
    s_mov_b32 s26, 524288
    s_mov_b32 s27, 0x00020000
    s_add_u32 s28, s6, 33554432
    s_addc_u32 s29, s7, 0
    s_mov_b32 s30, 16777216
    s_mov_b32 s31, 0x00020000
    s_mov_b32 s58, 2097152
    s_mov_b32 s59, 0x00020000
    s_mov_b32 s64, s62
    s_mov_b32 s65, s63
    s_mov_b32 s62, 4194304
    s_mov_b32 s63, 0x00020000
    s_mov_b32 s66, 4194304
    s_mov_b32 s67, 0x00020000
    s_mov_b32 s70, 256
    s_mov_b32 s71, 0x00020000
    s_mov_b32 s74, 0x3e0293ee
    s_or_b32 s38, s2, s34
    s_cmp_lg_u32 s38, 0
    s_cbranch_scc1 L_z_1
    s_add_u32 s88, s6, 59768832
    s_addc_u32 s89, s7, 0
    s_mov_b32 s90, 8192
    s_mov_b32 s91, 0x00020000
    v_lshlrev_b32 v22, 7, v0
    v_mov_b32 v23, 0
    buffer_store_dword v23, v22, s[88:91], 0 offen
L_z_1:
    s_load_dwordx4 s[96:99], s[0:1], 0
    s_load_dwordx2 s[100:101], s[0:1], 32
    s_load_dwordx2 s[94:95], s[0:1], 80
    s_lshl_b32 s38, s2, 2
    s_add_u32 s38, s38, s34
    s_waitcnt lgkmcnt(0)
    s_mov_b32 s88, s94
    s_mov_b32 s89, s95
    s_mov_b32 s39, s38
    s_cmp_ge_u32 s38, 512
    s_cselect_b32 s88, s96, s88
    s_cselect_b32 s89, s97, s89
    s_sub_u32 s40, s38, 512
    s_cmp_ge_u32 s38, 512
    s_cselect_b32 s39, s40, s39
    s_cmp_ge_u32 s38, 768
    s_cselect_b32 s88, s98, s88
    s_cselect_b32 s89, s99, s89
    s_sub_u32 s40, s38, 768
    s_cmp_ge_u32 s38, 768
    s_cselect_b32 s39, s40, s39
    s_cmp_ge_u32 s38, 840
    s_cselect_b32 s88, s100, s88
    s_cselect_b32 s89, s101, s89
    s_sub_u32 s40, s38, 840
    s_cmp_ge_u32 s38, 840
    s_cselect_b32 s39, s40, s39
    s_mul_i32 s92, s39, 9216
    s_add_u32 s90, s92, 9216
    s_cmp_ge_u32 s38, 912
    s_cselect_b32 s90, 0, s90
    s_mov_b32 s91, 0x00020000
    s_lshl_b32 s48, s33, 2
    s_add_u32 s44, s48, 4
    s_sub_u32 s49, 60, s48
    s_add_u32 s45, s49, 4
    s_add_u32 s46, s48, s34
    s_add_u32 s47, s49, s34
    s_mov_b32 s51, 0
    s_movk_i32 s38, 1152
    v_lshrrev_b32 v22, 3, v0
    v_mul_lo_u32 v22, v22, s38
    v_lshrrev_b32 v23, 4, v0
    v_and_b32 v24, 7, v0
    v_xor_b32 v25, v23, v24
    v_lshl_add_u32 v2, v25, 4, v22
    v_xor_b32 v3, 64, v2
    v_xor_b32 v25, 4, v25
    v_lshl_add_u32 v3, v25, 4, v22
    v_lshlrev_b32 v24, 2, v23
    v_and_b32 v25, 15, v0
    v_xor_b32 v24, v24, v25
    v_lshlrev_b32 v24, 4, v24
    v_lshlrev_b32 v23, 13, v23
    v_add_u32 v4, v23, v24
    s_lshl_b32 s38, s48, 5
    s_lshl_b32 s39, s49, 5
    s_sub_u32 s39, s39, 128
    s_cmp_lt_u32 s34, 2
    s_cselect_b32 s38, s38, s39
    s_lshl_b32 s39, s34, 6
    s_add_u32 s38, s38, s39
    s_mul_i32 s35, s38, 1152
    s_lshl_b32 s38, s34, 17
    s_lshl_b32 s39, s32, 8
    s_add_u32 s36, s38, s39
    s_lshl_b32 s37, s34, 12
    s_lshl_b32 s54, s34, 13
    v_and_b32 v22, 31, v0
    v_lshrrev_b32 v23, 1, v22
    v_and_b32 v23, 7, v23
    v_lshrrev_b32 v24, 5, v0
    v_xor_b32 v23, v23, v24
    v_lshlrev_b32 v23, 4, v23
    s_lshl_b32 s38, s34, 5
    v_add_u32 v22, s38, v22
    v_lshlrev_b32 v22, 7, v22
    v_add_u32 v5, v22, v23
    v_lshrrev_b32 v22, 2, v0
    v_and_b32 v22, 3, v22
    v_lshrrev_b32 v23, 5, v0
    v_lshl_add_u32 v23, v23, 3, v22
    v_lshlrev_b32 v23, 8, v23
    v_lshrrev_b32 v24, 4, v0
    v_and_b32 v24, 1, v24
    v_lshlrev_b32 v24, 5, v24
    v_and_b32 v25, 3, v0
    v_lshlrev_b32 v25, 3, v25
    v_add3_u32 v23, v23, v24, v25
    v_lshlrev_b32 v22, 6, v22
    v_add_u32 v6, v23, v22
    v_lshrrev_b32 v22, 3, v0
    v_lshlrev_b32 v22, 10, v22
    v_lshrrev_b32 v23, 4, v0
    v_and_b32 v24, 7, v0
    v_xor_b32 v25, v23, v24
    v_lshl_add_u32 v26, v25, 4, v22
    v_xor_b32 v25, 4, v25
    v_lshl_add_u32 v27, v25, 4, v22
    s_lshl_b32 s38, s33, 8
    s_lshl_b32 s39, s34, 6
    s_add_u32 s38, s38, s39
    s_lshl_b32 s72, s38, 10
    s_lshl_b32 s38, s33, 3
    s_add_u32 s38, s38, s34
    s_lshl_b32 s73, s38, 13
    s_mov_b32 s41, s37
    s_add_u32 s42, s37, 65536
    s_cmp_lg_u32 s34, 0
    s_cbranch_scc1 L_fo_2
    s_lshl_b32 s75, 1, s33
    s_lshl_b32 s76, s32, 2
    v_mov_b32 v22, s75
    v_mov_b32 v23, 0
    s_mov_b64 exec, 1
    buffer_atomic_or v22, v23, s[68:71], s76 offen
    s_mov_b64 exec, -1
L_fo_2:
    s_add_u32 m0, s54, 0
    s_add_u32 s38, s72, 0
    buffer_load_dwordx4 v26, s[56:59], s38 offen lds
    s_add_u32 m0, s54, 1024
    s_add_u32 s38, s72, 8192
    buffer_load_dwordx4 v27, s[56:59], s38 offen lds
    s_add_u32 m0, s54, 2048
    s_add_u32 s38, s72, 16384
    buffer_load_dwordx4 v26, s[56:59], s38 offen lds
    s_add_u32 m0, s54, 3072
    s_add_u32 s38, s72, 24576
    buffer_load_dwordx4 v27, s[56:59], s38 offen lds
    s_add_u32 m0, s54, 4096
    s_add_u32 s38, s72, 32768
    buffer_load_dwordx4 v26, s[56:59], s38 offen lds
    s_add_u32 m0, s54, 5120
    s_add_u32 s38, s72, 40960
    buffer_load_dwordx4 v27, s[56:59], s38 offen lds
    s_add_u32 m0, s54, 6144
    s_add_u32 s38, s72, 49152
    buffer_load_dwordx4 v26, s[56:59], s38 offen lds
    s_add_u32 m0, s54, 7168
    s_add_u32 s38, s72, 57344
    buffer_load_dwordx4 v27, s[56:59], s38 offen lds
    s_add_u32 m0, s37, 32768
    s_add_u32 s38, s36, 0
    buffer_load_dwordx4 v4, s[60:63], s38 offen lds
    s_add_u32 m0, s37, 33792
    s_add_u32 s38, s36, 32768
    buffer_load_dwordx4 v4, s[60:63], s38 offen lds
    s_add_u32 m0, s37, 34816
    s_add_u32 s38, s36, 65536
    buffer_load_dwordx4 v4, s[60:63], s38 offen lds
    s_add_u32 m0, s37, 35840
    s_add_u32 s38, s36, 98304
    buffer_load_dwordx4 v4, s[60:63], s38 offen lds
    s_add_u32 m0, s54, 49152
    s_add_u32 s38, s72, 128
    buffer_load_dwordx4 v26, s[56:59], s38 offen lds
    s_add_u32 m0, s54, 50176
    s_add_u32 s38, s72, 8320
    buffer_load_dwordx4 v27, s[56:59], s38 offen lds
    s_add_u32 m0, s54, 51200
    s_add_u32 s38, s72, 16512
    buffer_load_dwordx4 v26, s[56:59], s38 offen lds
    s_add_u32 m0, s54, 52224
    s_add_u32 s38, s72, 24704
    buffer_load_dwordx4 v27, s[56:59], s38 offen lds
    s_add_u32 m0, s54, 53248
    s_add_u32 s38, s72, 32896
    buffer_load_dwordx4 v26, s[56:59], s38 offen lds
    s_add_u32 m0, s54, 54272
    s_add_u32 s38, s72, 41088
    buffer_load_dwordx4 v27, s[56:59], s38 offen lds
    s_add_u32 m0, s54, 55296
    s_add_u32 s38, s72, 49280
    buffer_load_dwordx4 v26, s[56:59], s38 offen lds
    s_add_u32 m0, s54, 56320
    s_add_u32 s38, s72, 57472
    buffer_load_dwordx4 v27, s[56:59], s38 offen lds
    s_add_u32 m0, s37, 81920
    s_add_u32 s38, s36, 524288
    buffer_load_dwordx4 v4, s[60:63], s38 offen lds
    s_add_u32 m0, s37, 82944
    s_add_u32 s38, s36, 557056
    buffer_load_dwordx4 v4, s[60:63], s38 offen lds
    s_add_u32 m0, s37, 83968
    s_add_u32 s38, s36, 589824
    buffer_load_dwordx4 v4, s[60:63], s38 offen lds
    s_add_u32 m0, s37, 84992
    s_add_u32 s38, s36, 622592
    buffer_load_dwordx4 v4, s[60:63], s38 offen lds
    s_add_u32 m0, s54, 98304
    s_add_u32 s38, s72, 256
    buffer_load_dwordx4 v26, s[56:59], s38 offen lds
    s_add_u32 m0, s54, 99328
    s_add_u32 s38, s72, 8448
    buffer_load_dwordx4 v27, s[56:59], s38 offen lds
    s_add_u32 m0, s54, 100352
    s_add_u32 s38, s72, 16640
    buffer_load_dwordx4 v26, s[56:59], s38 offen lds
    s_add_u32 m0, s54, 101376
    s_add_u32 s38, s72, 24832
    buffer_load_dwordx4 v27, s[56:59], s38 offen lds
    s_add_u32 m0, s54, 102400
    s_add_u32 s38, s72, 33024
    buffer_load_dwordx4 v26, s[56:59], s38 offen lds
    s_add_u32 m0, s54, 103424
    s_add_u32 s38, s72, 41216
    buffer_load_dwordx4 v27, s[56:59], s38 offen lds
    s_add_u32 m0, s54, 104448
    s_add_u32 s38, s72, 49408
    buffer_load_dwordx4 v26, s[56:59], s38 offen lds
    s_add_u32 m0, s54, 105472
    s_add_u32 s38, s72, 57600
    buffer_load_dwordx4 v27, s[56:59], s38 offen lds
    s_add_u32 m0, s37, 131072
    s_add_u32 s38, s36, 1048576
    buffer_load_dwordx4 v4, s[60:63], s38 offen lds
    s_add_u32 m0, s37, 132096
    s_add_u32 s38, s36, 1081344
    buffer_load_dwordx4 v4, s[60:63], s38 offen lds
    s_add_u32 m0, s37, 133120
    s_add_u32 s38, s36, 1114112
    buffer_load_dwordx4 v4, s[60:63], s38 offen lds
    s_add_u32 m0, s37, 134144
    s_add_u32 s38, s36, 1146880
    buffer_load_dwordx4 v4, s[60:63], s38 offen lds
    v_mov_b32 v125, 0x7fffffff
    s_lshl_b32 s75, s2, 2
    s_add_u32 s75, s75, s34
    s_cmp_ge_u32 s75, 162
    s_cbranch_scc1 L_pl_3
    s_cmp_ge_u32 s75, 81
    s_cselect_b32 s76, 81, 0
    s_cselect_b32 s80, s86, s84
    s_cselect_b32 s81, s87, s85
    s_cselect_b32 s77, 64, 0
    s_mov_b32 s82, 20736
    s_mov_b32 s83, 0x00020000
    s_sub_u32 s75, s75, s76
    s_lshl_b32 s75, s75, 6
    v_add_u32 v126, s75, v0
    s_mov_b32 s75, 7282
    v_mul_lo_u32 v125, v126, s75
    v_lshrrev_b32 v125, 16, v125
    v_mul_u32_u24 v127, 9, v125
    v_sub_u32 v127, v126, v127
    v_lshlrev_b32 v125, 7, v125
    v_lshl_add_u32 v125, v127, 2, v125
    v_add_u32 v125, s77, v125
    v_lshlrev_b32 v126, 2, v126
    buffer_load_dword v124, v126, s[80:83], 0 offen
L_pl_3:
    s_lshr_b32 s75, s2, 3
    s_lshl_b32 s75, s75, 2
    s_add_u32 s75, s75, s34
    s_and_b32 s76, s2, 7
    s_lshl_b32 s77, s75, 15
    s_lshl_b32 s78, s76, 10
    s_add_u32 s77, s77, s78
    s_add_u32 s78, s77, 0
    buffer_load_dwordx4 v[28:31], v1, s[60:63], s78 offen
    s_add_u32 s78, s77, 8192
    buffer_load_dwordx4 v[28:31], v1, s[60:63], s78 offen
    s_add_u32 s78, s77, 16384
    buffer_load_dwordx4 v[28:31], v1, s[60:63], s78 offen
    s_add_u32 s78, s77, 24576
    buffer_load_dwordx4 v[28:31], v1, s[60:63], s78 offen
    s_lshl_b32 s78, s76, 4
    s_add_u32 s78, s78, s75
    s_and_b32 s78, s78, 127
    s_lshl_b32 s78, s78, 14
    buffer_load_dwordx4 v[28:31], v1, s[56:59], s78 offen offset:0
    buffer_load_dwordx4 v[28:31], v1, s[56:59], s78 offen offset:1024
    buffer_load_dwordx4 v[28:31], v1, s[56:59], s78 offen offset:2048
    buffer_load_dwordx4 v[28:31], v1, s[56:59], s78 offen offset:3072
    s_add_u32 s78, s78, 4096
    buffer_load_dwordx4 v[28:31], v1, s[56:59], s78 offen offset:0
    buffer_load_dwordx4 v[28:31], v1, s[56:59], s78 offen offset:1024
    buffer_load_dwordx4 v[28:31], v1, s[56:59], s78 offen offset:2048
    buffer_load_dwordx4 v[28:31], v1, s[56:59], s78 offen offset:3072
    s_add_u32 s78, s78, 4096
    buffer_load_dwordx4 v[28:31], v1, s[56:59], s78 offen offset:0
    buffer_load_dwordx4 v[28:31], v1, s[56:59], s78 offen offset:1024
    buffer_load_dwordx4 v[28:31], v1, s[56:59], s78 offen offset:2048
    buffer_load_dwordx4 v[28:31], v1, s[56:59], s78 offen offset:3072
    s_add_u32 s78, s78, 4096
    buffer_load_dwordx4 v[28:31], v1, s[56:59], s78 offen offset:0
    buffer_load_dwordx4 v[28:31], v1, s[56:59], s78 offen offset:1024
    buffer_load_dwordx4 v[28:31], v1, s[56:59], s78 offen offset:2048
    buffer_load_dwordx4 v[28:31], v1, s[56:59], s78 offen offset:3072
    s_lshl_b32 s79, s2, 2
    s_add_u32 s79, s79, s34
    s_lshl_b32 s79, s79, 10
    v_add_u32 v8, 0, v5
    v_add_u32 v12, 32768, v6
    v_xor_b32 v9, 32, v8
    v_xor_b32 v10, 64, v8
    v_xor_b32 v11, 96, v8
    v_xor_b32 v13, 64, v12
    v_xor_b32 v14, 128, v12
    v_xor_b32 v15, 192, v12
    s_waitcnt vmcnt(44)
    s_barrier
    ds_read_b128 v[32:35], v8 offset:0
    ds_read_b64_tr_b16 v[40:41], v12 offset:0
    ds_read_b64_tr_b16 v[42:43], v12 offset:1024
    ds_read_b128 v[36:39], v8 offset:16384
    ds_read_b64_tr_b16 v[44:45], v13 offset:0
    ds_read_b64_tr_b16 v[46:47], v13 offset:1024
    ds_read_b64_tr_b16 v[48:49], v14 offset:0
    ds_read_b64_tr_b16 v[50:51], v14 offset:1024
    ds_read_b64_tr_b16 v[52:53], v15 offset:0
    ds_read_b64_tr_b16 v[54:55], v15 offset:1024
    s_waitcnt lgkmcnt(7)
    v_mfma_f32_32x32x16_bf16 v[128:143], v[40:43], v[32:35], 0
    ds_read_b128 v[56:59], v9 offset:0
    ds_read_b64_tr_b16 v[64:65], v12 offset:4096
    s_waitcnt lgkmcnt(8)
    v_mfma_f32_32x32x16_bf16 v[192:207], v[40:43], v[36:39], 0
    ds_read_b64_tr_b16 v[66:67], v12 offset:5120
    ds_read_b128 v[60:63], v9 offset:16384
    s_waitcnt lgkmcnt(8)
    v_mfma_f32_32x32x16_bf16 v[144:159], v[44:47], v[32:35], 0
    ds_read_b64_tr_b16 v[68:69], v13 offset:4096
    ds_read_b64_tr_b16 v[70:71], v13 offset:5120
    v_mfma_f32_32x32x16_bf16 v[208:223], v[44:47], v[36:39], 0
    ds_read_b64_tr_b16 v[72:73], v14 offset:4096
    ds_read_b64_tr_b16 v[74:75], v14 offset:5120
    s_waitcnt lgkmcnt(10)
    v_mfma_f32_32x32x16_bf16 v[160:175], v[48:51], v[32:35], 0
    ds_read_b64_tr_b16 v[76:77], v15 offset:4096
    ds_read_b64_tr_b16 v[78:79], v15 offset:5120
    v_mfma_f32_32x32x16_bf16 v[224:239], v[48:51], v[36:39], 0
    s_waitcnt lgkmcnt(10)
    v_mfma_f32_32x32x16_bf16 v[176:191], v[52:55], v[32:35], 0
    v_mfma_f32_32x32x16_bf16 v[240:255], v[52:55], v[36:39], 0
    s_waitcnt lgkmcnt(7)
    v_mfma_f32_32x32x16_bf16 v[128:143], v[64:67], v[56:59], v[128:143]
    ds_read_b128 v[32:35], v10 offset:0
    ds_read_b64_tr_b16 v[40:41], v12 offset:8192
    s_waitcnt lgkmcnt(8)
    v_mfma_f32_32x32x16_bf16 v[192:207], v[64:67], v[60:63], v[192:207]
    ds_read_b64_tr_b16 v[42:43], v12 offset:9216
    ds_read_b128 v[36:39], v10 offset:16384
    s_waitcnt lgkmcnt(8)
    v_mfma_f32_32x32x16_bf16 v[144:159], v[68:71], v[56:59], v[144:159]
    ds_read_b64_tr_b16 v[44:45], v13 offset:8192
    ds_read_b64_tr_b16 v[46:47], v13 offset:9216
    v_mfma_f32_32x32x16_bf16 v[208:223], v[68:71], v[60:63], v[208:223]
    ds_read_b64_tr_b16 v[48:49], v14 offset:8192
    ds_read_b64_tr_b16 v[50:51], v14 offset:9216
    s_waitcnt lgkmcnt(10)
    v_mfma_f32_32x32x16_bf16 v[160:175], v[72:75], v[56:59], v[160:175]
    ds_read_b64_tr_b16 v[52:53], v15 offset:8192
    ds_read_b64_tr_b16 v[54:55], v15 offset:9216
    v_mfma_f32_32x32x16_bf16 v[224:239], v[72:75], v[60:63], v[224:239]
    s_waitcnt lgkmcnt(10)
    v_mfma_f32_32x32x16_bf16 v[176:191], v[76:79], v[56:59], v[176:191]
    v_mfma_f32_32x32x16_bf16 v[240:255], v[76:79], v[60:63], v[240:255]
    s_waitcnt lgkmcnt(7)
    v_mfma_f32_32x32x16_bf16 v[128:143], v[40:43], v[32:35], v[128:143]
    ds_read_b128 v[56:59], v11 offset:0
    ds_read_b64_tr_b16 v[64:65], v12 offset:12288
    s_waitcnt lgkmcnt(8)
    v_mfma_f32_32x32x16_bf16 v[192:207], v[40:43], v[36:39], v[192:207]
    ds_read_b64_tr_b16 v[66:67], v12 offset:13312
    ds_read_b128 v[60:63], v11 offset:16384
    s_waitcnt lgkmcnt(8)
    v_mfma_f32_32x32x16_bf16 v[144:159], v[44:47], v[32:35], v[144:159]
    ds_read_b64_tr_b16 v[68:69], v13 offset:12288
    ds_read_b64_tr_b16 v[70:71], v13 offset:13312
    v_mfma_f32_32x32x16_bf16 v[208:223], v[44:47], v[36:39], v[208:223]
    ds_read_b64_tr_b16 v[72:73], v14 offset:12288
    ds_read_b64_tr_b16 v[74:75], v14 offset:13312
    s_waitcnt lgkmcnt(10)
    v_mfma_f32_32x32x16_bf16 v[160:175], v[48:51], v[32:35], v[160:175]
    ds_read_b64_tr_b16 v[76:77], v15 offset:12288
    ds_read_b64_tr_b16 v[78:79], v15 offset:13312
    v_mfma_f32_32x32x16_bf16 v[224:239], v[48:51], v[36:39], v[224:239]
    s_waitcnt lgkmcnt(10)
    v_mfma_f32_32x32x16_bf16 v[176:191], v[52:55], v[32:35], v[176:191]
    v_mfma_f32_32x32x16_bf16 v[240:255], v[52:55], v[36:39], v[240:255]
    s_waitcnt vmcnt(32) lgkmcnt(0)
    s_barrier
    v_add_u32 v8, 49152, v5
    v_add_u32 v12, 81920, v6
    v_xor_b32 v9, 32, v8
    v_xor_b32 v10, 64, v8
    v_xor_b32 v11, 96, v8
    v_xor_b32 v13, 64, v12
    v_xor_b32 v14, 128, v12
    v_xor_b32 v15, 192, v12
    s_waitcnt lgkmcnt(7)
    v_mfma_f32_32x32x16_bf16 v[128:143], v[64:67], v[56:59], v[128:143]
    ds_read_b128 v[32:35], v8 offset:0
    ds_read_b64_tr_b16 v[40:41], v12 offset:0
    s_waitcnt lgkmcnt(8)
    v_mfma_f32_32x32x16_bf16 v[192:207], v[64:67], v[60:63], v[192:207]
    ds_read_b64_tr_b16 v[42:43], v12 offset:1024
    ds_read_b128 v[36:39], v8 offset:16384
    s_waitcnt lgkmcnt(8)
    v_mfma_f32_32x32x16_bf16 v[144:159], v[68:71], v[56:59], v[144:159]
    ds_read_b64_tr_b16 v[44:45], v13 offset:0
    ds_read_b64_tr_b16 v[46:47], v13 offset:1024
    v_mfma_f32_32x32x16_bf16 v[208:223], v[68:71], v[60:63], v[208:223]
    ds_read_b64_tr_b16 v[48:49], v14 offset:0
    ds_read_b64_tr_b16 v[50:51], v14 offset:1024
    s_waitcnt lgkmcnt(10)
    v_mfma_f32_32x32x16_bf16 v[160:175], v[72:75], v[56:59], v[160:175]
    ds_read_b64_tr_b16 v[52:53], v15 offset:0
    ds_read_b64_tr_b16 v[54:55], v15 offset:1024
    v_mfma_f32_32x32x16_bf16 v[224:239], v[72:75], v[60:63], v[224:239]
    s_waitcnt lgkmcnt(10)
    v_mfma_f32_32x32x16_bf16 v[176:191], v[76:79], v[56:59], v[176:191]
    v_mfma_f32_32x32x16_bf16 v[240:255], v[76:79], v[60:63], v[240:255]
    s_waitcnt lgkmcnt(7)
    v_mfma_f32_32x32x16_bf16 v[128:143], v[40:43], v[32:35], v[128:143]
    ds_read_b128 v[56:59], v9 offset:0
    ds_read_b64_tr_b16 v[64:65], v12 offset:4096
    ds_read_b64_tr_b16 v[66:67], v12 offset:5120
    ds_read_b128 v[60:63], v9 offset:16384
    s_waitcnt lgkmcnt(10)
    v_mfma_f32_32x32x16_bf16 v[192:207], v[40:43], v[36:39], v[192:207]
    ds_read_b64_tr_b16 v[68:69], v13 offset:4096
    ds_read_b64_tr_b16 v[70:71], v13 offset:5120
    ds_read_b64_tr_b16 v[72:73], v14 offset:4096
    ds_read_b64_tr_b16 v[74:75], v14 offset:5120
    s_waitcnt lgkmcnt(12)
    v_mfma_f32_32x32x16_bf16 v[144:159], v[44:47], v[32:35], v[144:159]
    ds_read_b64_tr_b16 v[76:77], v15 offset:4096
    ds_read_b64_tr_b16 v[78:79], v15 offset:5120
    s_add_u32 m0, s54, 0
    s_add_u32 s38, s72, 384
    buffer_load_dwordx4 v26, s[56:59], s38 offen lds
    v_mfma_f32_32x32x16_bf16 v[208:223], v[44:47], v[36:39], v[208:223]
    s_add_u32 m0, s54, 1024
    s_add_u32 s38, s72, 8576
    buffer_load_dwordx4 v27, s[56:59], s38 offen lds
    s_waitcnt lgkmcnt(12)
    v_mfma_f32_32x32x16_bf16 v[160:175], v[48:51], v[32:35], v[160:175]
    s_add_u32 m0, s54, 2048
    s_add_u32 s38, s72, 16768
    buffer_load_dwordx4 v26, s[56:59], s38 offen lds
    v_mfma_f32_32x32x16_bf16 v[224:239], v[48:51], v[36:39], v[224:239]
    s_add_u32 m0, s54, 3072
    s_add_u32 s38, s72, 24960
    buffer_load_dwordx4 v27, s[56:59], s38 offen lds
    s_waitcnt lgkmcnt(10)
    v_mfma_f32_32x32x16_bf16 v[176:191], v[52:55], v[32:35], v[176:191]
    s_add_u32 m0, s54, 4096
    s_add_u32 s38, s72, 33152
    buffer_load_dwordx4 v26, s[56:59], s38 offen lds
    v_mfma_f32_32x32x16_bf16 v[240:255], v[52:55], v[36:39], v[240:255]
    s_add_u32 m0, s54, 5120
    s_add_u32 s38, s72, 41344
    buffer_load_dwordx4 v27, s[56:59], s38 offen lds
    s_waitcnt lgkmcnt(7)
    v_mfma_f32_32x32x16_bf16 v[128:143], v[64:67], v[56:59], v[128:143]
    ds_read_b128 v[32:35], v10 offset:0
    ds_read_b64_tr_b16 v[40:41], v12 offset:8192
    ds_read_b64_tr_b16 v[42:43], v12 offset:9216
    ds_read_b128 v[36:39], v10 offset:16384
    s_waitcnt lgkmcnt(10)
    v_mfma_f32_32x32x16_bf16 v[192:207], v[64:67], v[60:63], v[192:207]
    ds_read_b64_tr_b16 v[44:45], v13 offset:8192
    ds_read_b64_tr_b16 v[46:47], v13 offset:9216
    ds_read_b64_tr_b16 v[48:49], v14 offset:8192
    ds_read_b64_tr_b16 v[50:51], v14 offset:9216
    s_waitcnt lgkmcnt(12)
    v_mfma_f32_32x32x16_bf16 v[144:159], v[68:71], v[56:59], v[144:159]
    ds_read_b64_tr_b16 v[52:53], v15 offset:8192
    ds_read_b64_tr_b16 v[54:55], v15 offset:9216
    v_mfma_f32_32x32x16_bf16 v[208:223], v[68:71], v[60:63], v[208:223]
    s_add_u32 m0, s54, 6144
    s_add_u32 s38, s72, 49536
    buffer_load_dwordx4 v26, s[56:59], s38 offen lds
    s_waitcnt lgkmcnt(12)
    v_mfma_f32_32x32x16_bf16 v[160:175], v[72:75], v[56:59], v[160:175]
    s_add_u32 m0, s54, 7168
    s_add_u32 s38, s72, 57728
    buffer_load_dwordx4 v27, s[56:59], s38 offen lds
    v_mfma_f32_32x32x16_bf16 v[224:239], v[72:75], v[60:63], v[224:239]
    s_add_u32 m0, s37, 32768
    s_add_u32 s38, s36, 1572864
    buffer_load_dwordx4 v4, s[60:63], s38 offen lds
    s_waitcnt lgkmcnt(10)
    v_mfma_f32_32x32x16_bf16 v[176:191], v[76:79], v[56:59], v[176:191]
    s_add_u32 m0, s37, 33792
    s_add_u32 s38, s36, 1605632
    buffer_load_dwordx4 v4, s[60:63], s38 offen lds
    v_mfma_f32_32x32x16_bf16 v[240:255], v[76:79], v[60:63], v[240:255]
    s_add_u32 m0, s37, 34816
    s_add_u32 s38, s36, 1638400
    buffer_load_dwordx4 v4, s[60:63], s38 offen lds
    s_waitcnt lgkmcnt(7)
    v_mfma_f32_32x32x16_bf16 v[128:143], v[40:43], v[32:35], v[128:143]
    ds_read_b128 v[56:59], v11 offset:0
    ds_read_b64_tr_b16 v[64:65], v12 offset:12288
    ds_read_b64_tr_b16 v[66:67], v12 offset:13312
    ds_read_b128 v[60:63], v11 offset:16384
    s_waitcnt lgkmcnt(10)
    v_mfma_f32_32x32x16_bf16 v[192:207], v[40:43], v[36:39], v[192:207]
    ds_read_b64_tr_b16 v[68:69], v13 offset:12288
    ds_read_b64_tr_b16 v[70:71], v13 offset:13312
    ds_read_b64_tr_b16 v[72:73], v14 offset:12288
    ds_read_b64_tr_b16 v[74:75], v14 offset:13312
    s_waitcnt lgkmcnt(12)
    v_mfma_f32_32x32x16_bf16 v[144:159], v[44:47], v[32:35], v[144:159]
    ds_read_b64_tr_b16 v[76:77], v15 offset:12288
    ds_read_b64_tr_b16 v[78:79], v15 offset:13312
    v_mfma_f32_32x32x16_bf16 v[208:223], v[44:47], v[36:39], v[208:223]
    s_add_u32 m0, s37, 35840
    s_add_u32 s38, s36, 1671168
    buffer_load_dwordx4 v4, s[60:63], s38 offen lds
    s_waitcnt lgkmcnt(12)
    v_mfma_f32_32x32x16_bf16 v[160:175], v[48:51], v[32:35], v[160:175]
    s_add_u32 s78, s77, 0
    buffer_load_dwordx4 v[28:31], v1, s[64:67], s78 offen
    v_mfma_f32_32x32x16_bf16 v[224:239], v[48:51], v[36:39], v[224:239]
    s_add_u32 s78, s77, 8192
    buffer_load_dwordx4 v[28:31], v1, s[64:67], s78 offen
    s_waitcnt lgkmcnt(10)
    v_mfma_f32_32x32x16_bf16 v[176:191], v[52:55], v[32:35], v[176:191]
    s_add_u32 s78, s77, 16384
    buffer_load_dwordx4 v[28:31], v1, s[64:67], s78 offen
    v_mfma_f32_32x32x16_bf16 v[240:255], v[52:55], v[36:39], v[240:255]
    s_add_u32 s78, s77, 24576
    buffer_load_dwordx4 v[28:31], v1, s[64:67], s78 offen
    s_waitcnt vmcnt(36) lgkmcnt(0)
    s_barrier
    v_add_u32 v8, 98304, v5
    v_add_u32 v12, 131072, v6
    v_xor_b32 v9, 32, v8
    v_xor_b32 v10, 64, v8
    v_xor_b32 v11, 96, v8
    v_xor_b32 v13, 64, v12
    v_xor_b32 v14, 128, v12
    v_xor_b32 v15, 192, v12
    s_waitcnt lgkmcnt(7)
    v_mfma_f32_32x32x16_bf16 v[128:143], v[64:67], v[56:59], v[128:143]
    ds_read_b128 v[32:35], v8 offset:0
    ds_read_b64_tr_b16 v[40:41], v12 offset:0
    s_waitcnt lgkmcnt(8)
    v_mfma_f32_32x32x16_bf16 v[192:207], v[64:67], v[60:63], v[192:207]
    ds_read_b64_tr_b16 v[42:43], v12 offset:1024
    ds_read_b128 v[36:39], v8 offset:16384
    s_waitcnt lgkmcnt(8)
    v_mfma_f32_32x32x16_bf16 v[144:159], v[68:71], v[56:59], v[144:159]
    ds_read_b64_tr_b16 v[44:45], v13 offset:0
    ds_read_b64_tr_b16 v[46:47], v13 offset:1024
    v_mfma_f32_32x32x16_bf16 v[208:223], v[68:71], v[60:63], v[208:223]
    ds_read_b64_tr_b16 v[48:49], v14 offset:0
    ds_read_b64_tr_b16 v[50:51], v14 offset:1024
    s_waitcnt lgkmcnt(10)
    v_mfma_f32_32x32x16_bf16 v[160:175], v[72:75], v[56:59], v[160:175]
    ds_read_b64_tr_b16 v[52:53], v15 offset:0
    ds_read_b64_tr_b16 v[54:55], v15 offset:1024
    v_mfma_f32_32x32x16_bf16 v[224:239], v[72:75], v[60:63], v[224:239]
    s_waitcnt lgkmcnt(10)
    v_mfma_f32_32x32x16_bf16 v[176:191], v[76:79], v[56:59], v[176:191]
    v_mfma_f32_32x32x16_bf16 v[240:255], v[76:79], v[60:63], v[240:255]
    s_waitcnt lgkmcnt(7)
    v_mfma_f32_32x32x16_bf16 v[128:143], v[40:43], v[32:35], v[128:143]
    ds_read_b128 v[56:59], v9 offset:0
    ds_read_b64_tr_b16 v[64:65], v12 offset:4096
    ds_read_b64_tr_b16 v[66:67], v12 offset:5120
    ds_read_b128 v[60:63], v9 offset:16384
    s_waitcnt lgkmcnt(10)
    v_mfma_f32_32x32x16_bf16 v[192:207], v[40:43], v[36:39], v[192:207]
    ds_read_b64_tr_b16 v[68:69], v13 offset:4096
    ds_read_b64_tr_b16 v[70:71], v13 offset:5120
    s_waitcnt lgkmcnt(10)
    v_mfma_f32_32x32x16_bf16 v[144:159], v[44:47], v[32:35], v[144:159]
    ds_read_b64_tr_b16 v[72:73], v14 offset:4096
    ds_read_b64_tr_b16 v[74:75], v14 offset:5120
    v_mfma_f32_32x32x16_bf16 v[208:223], v[44:47], v[36:39], v[208:223]
    ds_read_b64_tr_b16 v[76:77], v15 offset:4096
    ds_read_b64_tr_b16 v[78:79], v15 offset:5120
    s_waitcnt lgkmcnt(12)
    v_mfma_f32_32x32x16_bf16 v[160:175], v[48:51], v[32:35], v[160:175]
    s_add_u32 m0, s54, 49152
    s_add_u32 s38, s72, 512
    buffer_load_dwordx4 v26, s[56:59], s38 offen lds
    v_mfma_f32_32x32x16_bf16 v[224:239], v[48:51], v[36:39], v[224:239]
    s_add_u32 m0, s54, 50176
    s_add_u32 s38, s72, 8704
    buffer_load_dwordx4 v27, s[56:59], s38 offen lds
    s_waitcnt lgkmcnt(10)
    v_mfma_f32_32x32x16_bf16 v[176:191], v[52:55], v[32:35], v[176:191]
    s_add_u32 m0, s54, 51200
    s_add_u32 s38, s72, 16896
    buffer_load_dwordx4 v26, s[56:59], s38 offen lds
    v_mfma_f32_32x32x16_bf16 v[240:255], v[52:55], v[36:39], v[240:255]
    s_add_u32 m0, s54, 52224
    s_add_u32 s38, s72, 25088
    buffer_load_dwordx4 v27, s[56:59], s38 offen lds
    s_waitcnt lgkmcnt(7)
    v_mfma_f32_32x32x16_bf16 v[128:143], v[64:67], v[56:59], v[128:143]
    ds_read_b128 v[32:35], v10 offset:0
    ds_read_b64_tr_b16 v[40:41], v12 offset:8192
    ds_read_b64_tr_b16 v[42:43], v12 offset:9216
    ds_read_b128 v[36:39], v10 offset:16384
    s_waitcnt lgkmcnt(10)
    v_mfma_f32_32x32x16_bf16 v[192:207], v[64:67], v[60:63], v[192:207]
    ds_read_b64_tr_b16 v[44:45], v13 offset:8192
    ds_read_b64_tr_b16 v[46:47], v13 offset:9216
    s_waitcnt lgkmcnt(10)
    v_mfma_f32_32x32x16_bf16 v[144:159], v[68:71], v[56:59], v[144:159]
    ds_read_b64_tr_b16 v[48:49], v14 offset:8192
    ds_read_b64_tr_b16 v[50:51], v14 offset:9216
    v_mfma_f32_32x32x16_bf16 v[208:223], v[68:71], v[60:63], v[208:223]
    ds_read_b64_tr_b16 v[52:53], v15 offset:8192
    ds_read_b64_tr_b16 v[54:55], v15 offset:9216
    s_waitcnt lgkmcnt(12)
    v_mfma_f32_32x32x16_bf16 v[160:175], v[72:75], v[56:59], v[160:175]
    s_add_u32 m0, s54, 53248
    s_add_u32 s38, s72, 33280
    buffer_load_dwordx4 v26, s[56:59], s38 offen lds
    v_mfma_f32_32x32x16_bf16 v[224:239], v[72:75], v[60:63], v[224:239]
    s_add_u32 m0, s54, 54272
    s_add_u32 s38, s72, 41472
    buffer_load_dwordx4 v27, s[56:59], s38 offen lds
    s_waitcnt lgkmcnt(10)
    v_mfma_f32_32x32x16_bf16 v[176:191], v[76:79], v[56:59], v[176:191]
    s_add_u32 m0, s54, 55296
    s_add_u32 s38, s72, 49664
    buffer_load_dwordx4 v26, s[56:59], s38 offen lds
    v_mfma_f32_32x32x16_bf16 v[240:255], v[76:79], v[60:63], v[240:255]
    s_add_u32 m0, s54, 56320
    s_add_u32 s38, s72, 57856
    buffer_load_dwordx4 v27, s[56:59], s38 offen lds
    s_waitcnt lgkmcnt(7)
    v_mfma_f32_32x32x16_bf16 v[128:143], v[40:43], v[32:35], v[128:143]
    ds_read_b128 v[56:59], v11 offset:0
    ds_read_b64_tr_b16 v[64:65], v12 offset:12288
    ds_read_b64_tr_b16 v[66:67], v12 offset:13312
    ds_read_b128 v[60:63], v11 offset:16384
    s_waitcnt lgkmcnt(10)
    v_mfma_f32_32x32x16_bf16 v[192:207], v[40:43], v[36:39], v[192:207]
    ds_read_b64_tr_b16 v[68:69], v13 offset:12288
    ds_read_b64_tr_b16 v[70:71], v13 offset:13312
    s_waitcnt lgkmcnt(10)
    v_mfma_f32_32x32x16_bf16 v[144:159], v[44:47], v[32:35], v[144:159]
    ds_read_b64_tr_b16 v[72:73], v14 offset:12288
    ds_read_b64_tr_b16 v[74:75], v14 offset:13312
    v_mfma_f32_32x32x16_bf16 v[208:223], v[44:47], v[36:39], v[208:223]
    ds_read_b64_tr_b16 v[76:77], v15 offset:12288
    ds_read_b64_tr_b16 v[78:79], v15 offset:13312
    s_waitcnt lgkmcnt(12)
    v_mfma_f32_32x32x16_bf16 v[160:175], v[48:51], v[32:35], v[160:175]
    s_add_u32 m0, s37, 81920
    s_add_u32 s38, s36, 2097152
    buffer_load_dwordx4 v4, s[60:63], s38 offen lds
    v_mfma_f32_32x32x16_bf16 v[224:239], v[48:51], v[36:39], v[224:239]
    s_add_u32 m0, s37, 82944
    s_add_u32 s38, s36, 2129920
    buffer_load_dwordx4 v4, s[60:63], s38 offen lds
    s_waitcnt lgkmcnt(10)
    v_mfma_f32_32x32x16_bf16 v[176:191], v[52:55], v[32:35], v[176:191]
    s_add_u32 m0, s37, 83968
    s_add_u32 s38, s36, 2162688
    buffer_load_dwordx4 v4, s[60:63], s38 offen lds
    v_mfma_f32_32x32x16_bf16 v[240:255], v[52:55], v[36:39], v[240:255]
    s_add_u32 m0, s37, 84992
    s_add_u32 s38, s36, 2195456
    buffer_load_dwordx4 v4, s[60:63], s38 offen lds
    s_waitcnt vmcnt(16) lgkmcnt(0)
    s_barrier
    v_add_u32 v8, 0, v5
    v_add_u32 v12, 32768, v6
    v_xor_b32 v9, 32, v8
    v_xor_b32 v10, 64, v8
    v_xor_b32 v11, 96, v8
    v_xor_b32 v13, 64, v12
    v_xor_b32 v14, 128, v12
    v_xor_b32 v15, 192, v12
    s_waitcnt lgkmcnt(7)
    v_mfma_f32_32x32x16_bf16 v[128:143], v[64:67], v[56:59], v[128:143]
    ds_read_b128 v[32:35], v8 offset:0
    ds_read_b64_tr_b16 v[40:41], v12 offset:0
    s_waitcnt lgkmcnt(8)
    v_mfma_f32_32x32x16_bf16 v[192:207], v[64:67], v[60:63], v[192:207]
    ds_read_b64_tr_b16 v[42:43], v12 offset:1024
    ds_read_b128 v[36:39], v8 offset:16384
    s_waitcnt lgkmcnt(8)
    v_mfma_f32_32x32x16_bf16 v[144:159], v[68:71], v[56:59], v[144:159]
    ds_read_b64_tr_b16 v[44:45], v13 offset:0
    ds_read_b64_tr_b16 v[46:47], v13 offset:1024
    v_mfma_f32_32x32x16_bf16 v[208:223], v[68:71], v[60:63], v[208:223]
    ds_read_b64_tr_b16 v[48:49], v14 offset:0
    ds_read_b64_tr_b16 v[50:51], v14 offset:1024
    s_waitcnt lgkmcnt(10)
    v_mfma_f32_32x32x16_bf16 v[160:175], v[72:75], v[56:59], v[160:175]
    ds_read_b64_tr_b16 v[52:53], v15 offset:0
    ds_read_b64_tr_b16 v[54:55], v15 offset:1024
    v_mfma_f32_32x32x16_bf16 v[224:239], v[72:75], v[60:63], v[224:239]
    s_waitcnt lgkmcnt(10)
    v_mfma_f32_32x32x16_bf16 v[176:191], v[76:79], v[56:59], v[176:191]
    v_mfma_f32_32x32x16_bf16 v[240:255], v[76:79], v[60:63], v[240:255]
    s_waitcnt lgkmcnt(7)
    v_mfma_f32_32x32x16_bf16 v[128:143], v[40:43], v[32:35], v[128:143]
    ds_read_b128 v[56:59], v9 offset:0
    ds_read_b64_tr_b16 v[64:65], v12 offset:4096
    ds_read_b64_tr_b16 v[66:67], v12 offset:5120
    ds_read_b128 v[60:63], v9 offset:16384
    s_waitcnt lgkmcnt(10)
    v_mfma_f32_32x32x16_bf16 v[192:207], v[40:43], v[36:39], v[192:207]
    ds_read_b64_tr_b16 v[68:69], v13 offset:4096
    ds_read_b64_tr_b16 v[70:71], v13 offset:5120
    ds_read_b64_tr_b16 v[72:73], v14 offset:4096
    ds_read_b64_tr_b16 v[74:75], v14 offset:5120
    s_waitcnt lgkmcnt(12)
    v_mfma_f32_32x32x16_bf16 v[144:159], v[44:47], v[32:35], v[144:159]
    ds_read_b64_tr_b16 v[76:77], v15 offset:4096
    ds_read_b64_tr_b16 v[78:79], v15 offset:5120
    v_mfma_f32_32x32x16_bf16 v[208:223], v[44:47], v[36:39], v[208:223]
    s_add_u32 m0, s54, 98304
    s_add_u32 s38, s72, 640
    buffer_load_dwordx4 v26, s[56:59], s38 offen lds
    s_waitcnt lgkmcnt(12)
    v_mfma_f32_32x32x16_bf16 v[160:175], v[48:51], v[32:35], v[160:175]
    s_add_u32 m0, s54, 99328
    s_add_u32 s38, s72, 8832
    buffer_load_dwordx4 v27, s[56:59], s38 offen lds
    v_mfma_f32_32x32x16_bf16 v[224:239], v[48:51], v[36:39], v[224:239]
    s_add_u32 m0, s54, 100352
    s_add_u32 s38, s72, 17024
    buffer_load_dwordx4 v26, s[56:59], s38 offen lds
    s_waitcnt lgkmcnt(10)
    v_mfma_f32_32x32x16_bf16 v[176:191], v[52:55], v[32:35], v[176:191]
    s_add_u32 m0, s54, 101376
    s_add_u32 s38, s72, 25216
    buffer_load_dwordx4 v27, s[56:59], s38 offen lds
    v_mfma_f32_32x32x16_bf16 v[240:255], v[52:55], v[36:39], v[240:255]
    s_add_u32 m0, s54, 102400
    s_add_u32 s38, s72, 33408
    buffer_load_dwordx4 v26, s[56:59], s38 offen lds
    s_waitcnt lgkmcnt(7)
    v_mfma_f32_32x32x16_bf16 v[128:143], v[64:67], v[56:59], v[128:143]
    ds_read_b128 v[32:35], v10 offset:0
    ds_read_b64_tr_b16 v[40:41], v12 offset:8192
    ds_read_b64_tr_b16 v[42:43], v12 offset:9216
    ds_read_b128 v[36:39], v10 offset:16384
    s_waitcnt lgkmcnt(10)
    v_mfma_f32_32x32x16_bf16 v[192:207], v[64:67], v[60:63], v[192:207]
    ds_read_b64_tr_b16 v[44:45], v13 offset:8192
    ds_read_b64_tr_b16 v[46:47], v13 offset:9216
    s_waitcnt lgkmcnt(10)
    v_mfma_f32_32x32x16_bf16 v[144:159], v[68:71], v[56:59], v[144:159]
    ds_read_b64_tr_b16 v[48:49], v14 offset:8192
    ds_read_b64_tr_b16 v[50:51], v14 offset:9216
    v_mfma_f32_32x32x16_bf16 v[208:223], v[68:71], v[60:63], v[208:223]
    ds_read_b64_tr_b16 v[52:53], v15 offset:8192
    ds_read_b64_tr_b16 v[54:55], v15 offset:9216
    s_waitcnt lgkmcnt(12)
    v_mfma_f32_32x32x16_bf16 v[160:175], v[72:75], v[56:59], v[160:175]
    s_add_u32 m0, s54, 103424
    s_add_u32 s38, s72, 41600
    buffer_load_dwordx4 v27, s[56:59], s38 offen lds
    v_mfma_f32_32x32x16_bf16 v[224:239], v[72:75], v[60:63], v[224:239]
    s_add_u32 m0, s54, 104448
    s_add_u32 s38, s72, 49792
    buffer_load_dwordx4 v26, s[56:59], s38 offen lds
    s_waitcnt lgkmcnt(10)
    v_mfma_f32_32x32x16_bf16 v[176:191], v[76:79], v[56:59], v[176:191]
    s_add_u32 m0, s54, 105472
    s_add_u32 s38, s72, 57984
    buffer_load_dwordx4 v27, s[56:59], s38 offen lds
    v_mfma_f32_32x32x16_bf16 v[240:255], v[76:79], v[60:63], v[240:255]
    s_add_u32 m0, s37, 131072
    s_add_u32 s38, s36, 2621440
    buffer_load_dwordx4 v4, s[60:63], s38 offen lds
    s_waitcnt lgkmcnt(7)
    v_mfma_f32_32x32x16_bf16 v[128:143], v[40:43], v[32:35], v[128:143]
    ds_read_b128 v[56:59], v11 offset:0
    ds_read_b64_tr_b16 v[64:65], v12 offset:12288
    ds_read_b64_tr_b16 v[66:67], v12 offset:13312
    ds_read_b128 v[60:63], v11 offset:16384
    s_waitcnt lgkmcnt(10)
    v_mfma_f32_32x32x16_bf16 v[192:207], v[40:43], v[36:39], v[192:207]
    ds_read_b64_tr_b16 v[68:69], v13 offset:12288
    ds_read_b64_tr_b16 v[70:71], v13 offset:13312
    s_waitcnt lgkmcnt(10)
    v_mfma_f32_32x32x16_bf16 v[144:159], v[44:47], v[32:35], v[144:159]
    ds_read_b64_tr_b16 v[72:73], v14 offset:12288
    ds_read_b64_tr_b16 v[74:75], v14 offset:13312
    v_mfma_f32_32x32x16_bf16 v[208:223], v[44:47], v[36:39], v[208:223]
    ds_read_b64_tr_b16 v[76:77], v15 offset:12288
    ds_read_b64_tr_b16 v[78:79], v15 offset:13312
    s_waitcnt lgkmcnt(12)
    v_mfma_f32_32x32x16_bf16 v[160:175], v[48:51], v[32:35], v[160:175]
    s_add_u32 m0, s37, 132096
    s_add_u32 s38, s36, 2654208
    buffer_load_dwordx4 v4, s[60:63], s38 offen lds
    v_mfma_f32_32x32x16_bf16 v[224:239], v[48:51], v[36:39], v[224:239]
    s_add_u32 m0, s37, 133120
    s_add_u32 s38, s36, 2686976
    buffer_load_dwordx4 v4, s[60:63], s38 offen lds
    s_waitcnt lgkmcnt(10)
    v_mfma_f32_32x32x16_bf16 v[176:191], v[52:55], v[32:35], v[176:191]
    s_add_u32 m0, s37, 134144
    s_add_u32 s38, s36, 2719744
    buffer_load_dwordx4 v4, s[60:63], s38 offen lds
    v_mfma_f32_32x32x16_bf16 v[240:255], v[52:55], v[36:39], v[240:255]
    s_add_u32 s78, s79, 0
    buffer_load_dwordx4 v[28:31], v1, s[12:15], s78 offen
    s_waitcnt vmcnt(13) lgkmcnt(0)
    s_barrier
    v_add_u32 v8, 49152, v5
    v_add_u32 v12, 81920, v6
    v_xor_b32 v9, 32, v8
    v_xor_b32 v10, 64, v8
    v_xor_b32 v11, 96, v8
    v_xor_b32 v13, 64, v12
    v_xor_b32 v14, 128, v12
    v_xor_b32 v15, 192, v12
    s_waitcnt lgkmcnt(7)
    v_mfma_f32_32x32x16_bf16 v[128:143], v[64:67], v[56:59], v[128:143]
    ds_read_b128 v[32:35], v8 offset:0
    ds_read_b64_tr_b16 v[40:41], v12 offset:0
    s_waitcnt lgkmcnt(8)
    v_mfma_f32_32x32x16_bf16 v[192:207], v[64:67], v[60:63], v[192:207]
    ds_read_b64_tr_b16 v[42:43], v12 offset:1024
    ds_read_b128 v[36:39], v8 offset:16384
    s_waitcnt lgkmcnt(8)
    v_mfma_f32_32x32x16_bf16 v[144:159], v[68:71], v[56:59], v[144:159]
    ds_read_b64_tr_b16 v[44:45], v13 offset:0
    ds_read_b64_tr_b16 v[46:47], v13 offset:1024
    v_mfma_f32_32x32x16_bf16 v[208:223], v[68:71], v[60:63], v[208:223]
    ds_read_b64_tr_b16 v[48:49], v14 offset:0
    ds_read_b64_tr_b16 v[50:51], v14 offset:1024
    s_waitcnt lgkmcnt(10)
    v_mfma_f32_32x32x16_bf16 v[160:175], v[72:75], v[56:59], v[160:175]
    ds_read_b64_tr_b16 v[52:53], v15 offset:0
    ds_read_b64_tr_b16 v[54:55], v15 offset:1024
    v_mfma_f32_32x32x16_bf16 v[224:239], v[72:75], v[60:63], v[224:239]
    s_waitcnt lgkmcnt(10)
    v_mfma_f32_32x32x16_bf16 v[176:191], v[76:79], v[56:59], v[176:191]
    v_mfma_f32_32x32x16_bf16 v[240:255], v[76:79], v[60:63], v[240:255]
    s_waitcnt lgkmcnt(7)
    v_mfma_f32_32x32x16_bf16 v[128:143], v[40:43], v[32:35], v[128:143]
    ds_read_b128 v[56:59], v9 offset:0
    ds_read_b64_tr_b16 v[64:65], v12 offset:4096
    ds_read_b64_tr_b16 v[66:67], v12 offset:5120
    ds_read_b128 v[60:63], v9 offset:16384
    s_waitcnt lgkmcnt(10)
    v_mfma_f32_32x32x16_bf16 v[192:207], v[40:43], v[36:39], v[192:207]
    ds_read_b64_tr_b16 v[68:69], v13 offset:4096
    ds_read_b64_tr_b16 v[70:71], v13 offset:5120
    ds_read_b64_tr_b16 v[72:73], v14 offset:4096
    ds_read_b64_tr_b16 v[74:75], v14 offset:5120
    s_waitcnt lgkmcnt(12)
    v_mfma_f32_32x32x16_bf16 v[144:159], v[44:47], v[32:35], v[144:159]
    ds_read_b64_tr_b16 v[76:77], v15 offset:4096
    ds_read_b64_tr_b16 v[78:79], v15 offset:5120
    v_mfma_f32_32x32x16_bf16 v[208:223], v[44:47], v[36:39], v[208:223]
    s_add_u32 m0, s54, 0
    s_add_u32 s38, s72, 768
    buffer_load_dwordx4 v26, s[56:59], s38 offen lds
    s_waitcnt lgkmcnt(12)
    v_mfma_f32_32x32x16_bf16 v[160:175], v[48:51], v[32:35], v[160:175]
    s_add_u32 m0, s54, 1024
    s_add_u32 s38, s72, 8960
    buffer_load_dwordx4 v27, s[56:59], s38 offen lds
    v_mfma_f32_32x32x16_bf16 v[224:239], v[48:51], v[36:39], v[224:239]
    s_add_u32 m0, s54, 2048
    s_add_u32 s38, s72, 17152
    buffer_load_dwordx4 v26, s[56:59], s38 offen lds
    s_waitcnt lgkmcnt(10)
    v_mfma_f32_32x32x16_bf16 v[176:191], v[52:55], v[32:35], v[176:191]
    s_add_u32 m0, s54, 3072
    s_add_u32 s38, s72, 25344
    buffer_load_dwordx4 v27, s[56:59], s38 offen lds
    v_mfma_f32_32x32x16_bf16 v[240:255], v[52:55], v[36:39], v[240:255]
    s_add_u32 m0, s54, 4096
    s_add_u32 s38, s72, 33536
    buffer_load_dwordx4 v26, s[56:59], s38 offen lds
    s_waitcnt lgkmcnt(7)
    v_mfma_f32_32x32x16_bf16 v[128:143], v[64:67], v[56:59], v[128:143]
    ds_read_b128 v[32:35], v10 offset:0
    ds_read_b64_tr_b16 v[40:41], v12 offset:8192
    ds_read_b64_tr_b16 v[42:43], v12 offset:9216
    ds_read_b128 v[36:39], v10 offset:16384
    s_waitcnt lgkmcnt(10)
    v_mfma_f32_32x32x16_bf16 v[192:207], v[64:67], v[60:63], v[192:207]
    ds_read_b64_tr_b16 v[44:45], v13 offset:8192
    ds_read_b64_tr_b16 v[46:47], v13 offset:9216
    s_waitcnt lgkmcnt(10)
    v_mfma_f32_32x32x16_bf16 v[144:159], v[68:71], v[56:59], v[144:159]
    ds_read_b64_tr_b16 v[48:49], v14 offset:8192
    ds_read_b64_tr_b16 v[50:51], v14 offset:9216
    v_mfma_f32_32x32x16_bf16 v[208:223], v[68:71], v[60:63], v[208:223]
    ds_read_b64_tr_b16 v[52:53], v15 offset:8192
    ds_read_b64_tr_b16 v[54:55], v15 offset:9216
    s_waitcnt lgkmcnt(12)
    v_mfma_f32_32x32x16_bf16 v[160:175], v[72:75], v[56:59], v[160:175]
    s_add_u32 m0, s54, 5120
    s_add_u32 s38, s72, 41728
    buffer_load_dwordx4 v27, s[56:59], s38 offen lds
    v_mfma_f32_32x32x16_bf16 v[224:239], v[72:75], v[60:63], v[224:239]
    s_add_u32 m0, s54, 6144
    s_add_u32 s38, s72, 49920
    buffer_load_dwordx4 v26, s[56:59], s38 offen lds
    s_waitcnt lgkmcnt(10)
    v_mfma_f32_32x32x16_bf16 v[176:191], v[76:79], v[56:59], v[176:191]
    s_add_u32 m0, s54, 7168
    s_add_u32 s38, s72, 58112
    buffer_load_dwordx4 v27, s[56:59], s38 offen lds
    v_mfma_f32_32x32x16_bf16 v[240:255], v[76:79], v[60:63], v[240:255]
    s_add_u32 m0, s37, 32768
    s_add_u32 s38, s36, 3145728
    buffer_load_dwordx4 v4, s[60:63], s38 offen lds
    s_waitcnt lgkmcnt(7)
    v_mfma_f32_32x32x16_bf16 v[128:143], v[40:43], v[32:35], v[128:143]
    ds_read_b128 v[56:59], v11 offset:0
    ds_read_b64_tr_b16 v[64:65], v12 offset:12288
    ds_read_b64_tr_b16 v[66:67], v12 offset:13312
    ds_read_b128 v[60:63], v11 offset:16384
    s_waitcnt lgkmcnt(10)
    v_mfma_f32_32x32x16_bf16 v[192:207], v[40:43], v[36:39], v[192:207]
    ds_read_b64_tr_b16 v[68:69], v13 offset:12288
    ds_read_b64_tr_b16 v[70:71], v13 offset:13312
    s_waitcnt lgkmcnt(10)
    v_mfma_f32_32x32x16_bf16 v[144:159], v[44:47], v[32:35], v[144:159]
    ds_read_b64_tr_b16 v[72:73], v14 offset:12288
    ds_read_b64_tr_b16 v[74:75], v14 offset:13312
    v_mfma_f32_32x32x16_bf16 v[208:223], v[44:47], v[36:39], v[208:223]
    ds_read_b64_tr_b16 v[76:77], v15 offset:12288
    ds_read_b64_tr_b16 v[78:79], v15 offset:13312
    s_waitcnt lgkmcnt(12)
    v_mfma_f32_32x32x16_bf16 v[160:175], v[48:51], v[32:35], v[160:175]
    s_add_u32 m0, s37, 33792
    s_add_u32 s38, s36, 3178496
    buffer_load_dwordx4 v4, s[60:63], s38 offen lds
    v_mfma_f32_32x32x16_bf16 v[224:239], v[48:51], v[36:39], v[224:239]
    s_add_u32 m0, s37, 34816
    s_add_u32 s38, s36, 3211264
    buffer_load_dwordx4 v4, s[60:63], s38 offen lds
    s_waitcnt lgkmcnt(10)
    v_mfma_f32_32x32x16_bf16 v[176:191], v[52:55], v[32:35], v[176:191]
    s_add_u32 m0, s37, 35840
    s_add_u32 s38, s36, 3244032
    buffer_load_dwordx4 v4, s[60:63], s38 offen lds
    v_mfma_f32_32x32x16_bf16 v[240:255], v[52:55], v[36:39], v[240:255]
    s_add_u32 s78, s79, 1048576
    buffer_load_dwordx4 v[28:31], v1, s[12:15], s78 offen
    s_waitcnt vmcnt(14) lgkmcnt(0)
    s_barrier
    v_add_u32 v8, 98304, v5
    v_add_u32 v12, 131072, v6
    v_xor_b32 v9, 32, v8
    v_xor_b32 v10, 64, v8
    v_xor_b32 v11, 96, v8
    v_xor_b32 v13, 64, v12
    v_xor_b32 v14, 128, v12
    v_xor_b32 v15, 192, v12
    s_waitcnt lgkmcnt(7)
    v_mfma_f32_32x32x16_bf16 v[128:143], v[64:67], v[56:59], v[128:143]
    ds_read_b128 v[32:35], v8 offset:0
    ds_read_b64_tr_b16 v[40:41], v12 offset:0
    s_waitcnt lgkmcnt(8)
    v_mfma_f32_32x32x16_bf16 v[192:207], v[64:67], v[60:63], v[192:207]
    ds_read_b64_tr_b16 v[42:43], v12 offset:1024
    ds_read_b128 v[36:39], v8 offset:16384
    s_waitcnt lgkmcnt(8)
    v_mfma_f32_32x32x16_bf16 v[144:159], v[68:71], v[56:59], v[144:159]
    ds_read_b64_tr_b16 v[44:45], v13 offset:0
    ds_read_b64_tr_b16 v[46:47], v13 offset:1024
    v_mfma_f32_32x32x16_bf16 v[208:223], v[68:71], v[60:63], v[208:223]
    ds_read_b64_tr_b16 v[48:49], v14 offset:0
    ds_read_b64_tr_b16 v[50:51], v14 offset:1024
    s_waitcnt lgkmcnt(10)
    v_mfma_f32_32x32x16_bf16 v[160:175], v[72:75], v[56:59], v[160:175]
    ds_read_b64_tr_b16 v[52:53], v15 offset:0
    ds_read_b64_tr_b16 v[54:55], v15 offset:1024
    v_mfma_f32_32x32x16_bf16 v[224:239], v[72:75], v[60:63], v[224:239]
    s_waitcnt lgkmcnt(10)
    v_mfma_f32_32x32x16_bf16 v[176:191], v[76:79], v[56:59], v[176:191]
    v_mfma_f32_32x32x16_bf16 v[240:255], v[76:79], v[60:63], v[240:255]
    s_waitcnt lgkmcnt(7)
    v_mfma_f32_32x32x16_bf16 v[128:143], v[40:43], v[32:35], v[128:143]
    ds_read_b128 v[56:59], v9 offset:0
    ds_read_b64_tr_b16 v[64:65], v12 offset:4096
    ds_read_b64_tr_b16 v[66:67], v12 offset:5120
    ds_read_b128 v[60:63], v9 offset:16384
    s_waitcnt lgkmcnt(10)
    v_mfma_f32_32x32x16_bf16 v[192:207], v[40:43], v[36:39], v[192:207]
    ds_read_b64_tr_b16 v[68:69], v13 offset:4096
    ds_read_b64_tr_b16 v[70:71], v13 offset:5120
    ds_read_b64_tr_b16 v[72:73], v14 offset:4096
    ds_read_b64_tr_b16 v[74:75], v14 offset:5120
    s_waitcnt lgkmcnt(12)
    v_mfma_f32_32x32x16_bf16 v[144:159], v[44:47], v[32:35], v[144:159]
    ds_read_b64_tr_b16 v[76:77], v15 offset:4096
    ds_read_b64_tr_b16 v[78:79], v15 offset:5120
    v_mfma_f32_32x32x16_bf16 v[208:223], v[44:47], v[36:39], v[208:223]
    s_add_u32 m0, s54, 49152
    s_add_u32 s38, s72, 896
    buffer_load_dwordx4 v26, s[56:59], s38 offen lds
    s_waitcnt lgkmcnt(12)
    v_mfma_f32_32x32x16_bf16 v[160:175], v[48:51], v[32:35], v[160:175]
    s_add_u32 m0, s54, 50176
    s_add_u32 s38, s72, 9088
    buffer_load_dwordx4 v27, s[56:59], s38 offen lds
    v_mfma_f32_32x32x16_bf16 v[224:239], v[48:51], v[36:39], v[224:239]
    s_add_u32 m0, s54, 51200
    s_add_u32 s38, s72, 17280
    buffer_load_dwordx4 v26, s[56:59], s38 offen lds
    s_waitcnt lgkmcnt(10)
    v_mfma_f32_32x32x16_bf16 v[176:191], v[52:55], v[32:35], v[176:191]
    s_add_u32 m0, s54, 52224
    s_add_u32 s38, s72, 25472
    buffer_load_dwordx4 v27, s[56:59], s38 offen lds
    v_mfma_f32_32x32x16_bf16 v[240:255], v[52:55], v[36:39], v[240:255]
    s_add_u32 m0, s54, 53248
    s_add_u32 s38, s72, 33664
    buffer_load_dwordx4 v26, s[56:59], s38 offen lds
    s_waitcnt lgkmcnt(7)
    v_mfma_f32_32x32x16_bf16 v[128:143], v[64:67], v[56:59], v[128:143]
    ds_read_b128 v[32:35], v10 offset:0
    ds_read_b64_tr_b16 v[40:41], v12 offset:8192
    ds_read_b64_tr_b16 v[42:43], v12 offset:9216
    ds_read_b128 v[36:39], v10 offset:16384
    s_waitcnt lgkmcnt(10)
    v_mfma_f32_32x32x16_bf16 v[192:207], v[64:67], v[60:63], v[192:207]
    ds_read_b64_tr_b16 v[44:45], v13 offset:8192
    ds_read_b64_tr_b16 v[46:47], v13 offset:9216
    s_waitcnt lgkmcnt(10)
    v_mfma_f32_32x32x16_bf16 v[144:159], v[68:71], v[56:59], v[144:159]
    ds_read_b64_tr_b16 v[48:49], v14 offset:8192
    ds_read_b64_tr_b16 v[50:51], v14 offset:9216
    v_mfma_f32_32x32x16_bf16 v[208:223], v[68:71], v[60:63], v[208:223]
    ds_read_b64_tr_b16 v[52:53], v15 offset:8192
    ds_read_b64_tr_b16 v[54:55], v15 offset:9216
    s_waitcnt lgkmcnt(12)
    v_mfma_f32_32x32x16_bf16 v[160:175], v[72:75], v[56:59], v[160:175]
    s_add_u32 m0, s54, 54272
    s_add_u32 s38, s72, 41856
    buffer_load_dwordx4 v27, s[56:59], s38 offen lds
    v_mfma_f32_32x32x16_bf16 v[224:239], v[72:75], v[60:63], v[224:239]
    s_add_u32 m0, s54, 55296
    s_add_u32 s38, s72, 50048
    buffer_load_dwordx4 v26, s[56:59], s38 offen lds
    s_waitcnt lgkmcnt(10)
    v_mfma_f32_32x32x16_bf16 v[176:191], v[76:79], v[56:59], v[176:191]
    s_add_u32 m0, s54, 56320
    s_add_u32 s38, s72, 58240
    buffer_load_dwordx4 v27, s[56:59], s38 offen lds
    v_mfma_f32_32x32x16_bf16 v[240:255], v[76:79], v[60:63], v[240:255]
    s_add_u32 m0, s37, 81920
    s_add_u32 s38, s36, 3670016
    buffer_load_dwordx4 v4, s[60:63], s38 offen lds
    s_waitcnt lgkmcnt(7)
    v_mfma_f32_32x32x16_bf16 v[128:143], v[40:43], v[32:35], v[128:143]
    ds_read_b128 v[56:59], v11 offset:0
    ds_read_b64_tr_b16 v[64:65], v12 offset:12288
    ds_read_b64_tr_b16 v[66:67], v12 offset:13312
    ds_read_b128 v[60:63], v11 offset:16384
    s_waitcnt lgkmcnt(10)
    v_mfma_f32_32x32x16_bf16 v[192:207], v[40:43], v[36:39], v[192:207]
    ds_read_b64_tr_b16 v[68:69], v13 offset:12288
    ds_read_b64_tr_b16 v[70:71], v13 offset:13312
    s_waitcnt lgkmcnt(10)
    v_mfma_f32_32x32x16_bf16 v[144:159], v[44:47], v[32:35], v[144:159]
    ds_read_b64_tr_b16 v[72:73], v14 offset:12288
    ds_read_b64_tr_b16 v[74:75], v14 offset:13312
    v_mfma_f32_32x32x16_bf16 v[208:223], v[44:47], v[36:39], v[208:223]
    ds_read_b64_tr_b16 v[76:77], v15 offset:12288
    ds_read_b64_tr_b16 v[78:79], v15 offset:13312
    s_waitcnt lgkmcnt(12)
    v_mfma_f32_32x32x16_bf16 v[160:175], v[48:51], v[32:35], v[160:175]
    s_add_u32 m0, s37, 82944
    s_add_u32 s38, s36, 3702784
    buffer_load_dwordx4 v4, s[60:63], s38 offen lds
    v_mfma_f32_32x32x16_bf16 v[224:239], v[48:51], v[36:39], v[224:239]
    s_add_u32 m0, s37, 83968
    s_add_u32 s38, s36, 3735552
    buffer_load_dwordx4 v4, s[60:63], s38 offen lds
    s_waitcnt lgkmcnt(10)
    v_mfma_f32_32x32x16_bf16 v[176:191], v[52:55], v[32:35], v[176:191]
    s_add_u32 m0, s37, 84992
    s_add_u32 s38, s36, 3768320
    buffer_load_dwordx4 v4, s[60:63], s38 offen lds
    v_mfma_f32_32x32x16_bf16 v[240:255], v[52:55], v[36:39], v[240:255]
    s_add_u32 s78, s79, 2097152
    buffer_load_dwordx4 v[28:31], v1, s[12:15], s78 offen
    s_waitcnt vmcnt(14) lgkmcnt(0)
    s_barrier
    v_add_u32 v8, 0, v5
    v_add_u32 v12, 32768, v6
    v_xor_b32 v9, 32, v8
    v_xor_b32 v10, 64, v8
    v_xor_b32 v11, 96, v8
    v_xor_b32 v13, 64, v12
    v_xor_b32 v14, 128, v12
    v_xor_b32 v15, 192, v12
    s_waitcnt lgkmcnt(7)
    v_mfma_f32_32x32x16_bf16 v[128:143], v[64:67], v[56:59], v[128:143]
    ds_read_b128 v[32:35], v8 offset:0
    ds_read_b64_tr_b16 v[40:41], v12 offset:0
    s_waitcnt lgkmcnt(8)
    v_mfma_f32_32x32x16_bf16 v[192:207], v[64:67], v[60:63], v[192:207]
    ds_read_b64_tr_b16 v[42:43], v12 offset:1024
    ds_read_b128 v[36:39], v8 offset:16384
    s_waitcnt lgkmcnt(8)
    v_mfma_f32_32x32x16_bf16 v[144:159], v[68:71], v[56:59], v[144:159]
    ds_read_b64_tr_b16 v[44:45], v13 offset:0
    ds_read_b64_tr_b16 v[46:47], v13 offset:1024
    v_mfma_f32_32x32x16_bf16 v[208:223], v[68:71], v[60:63], v[208:223]
    ds_read_b64_tr_b16 v[48:49], v14 offset:0
    ds_read_b64_tr_b16 v[50:51], v14 offset:1024
    s_waitcnt lgkmcnt(10)
    v_mfma_f32_32x32x16_bf16 v[160:175], v[72:75], v[56:59], v[160:175]
    ds_read_b64_tr_b16 v[52:53], v15 offset:0
    ds_read_b64_tr_b16 v[54:55], v15 offset:1024
    v_mfma_f32_32x32x16_bf16 v[224:239], v[72:75], v[60:63], v[224:239]
    s_waitcnt lgkmcnt(10)
    v_mfma_f32_32x32x16_bf16 v[176:191], v[76:79], v[56:59], v[176:191]
    v_mfma_f32_32x32x16_bf16 v[240:255], v[76:79], v[60:63], v[240:255]
    s_waitcnt lgkmcnt(7)
    v_mfma_f32_32x32x16_bf16 v[128:143], v[40:43], v[32:35], v[128:143]
    ds_read_b128 v[56:59], v9 offset:0
    ds_read_b64_tr_b16 v[64:65], v12 offset:4096
    ds_read_b64_tr_b16 v[66:67], v12 offset:5120
    ds_read_b128 v[60:63], v9 offset:16384
    s_waitcnt lgkmcnt(10)
    v_mfma_f32_32x32x16_bf16 v[192:207], v[40:43], v[36:39], v[192:207]
    ds_read_b64_tr_b16 v[68:69], v13 offset:4096
    ds_read_b64_tr_b16 v[70:71], v13 offset:5120
    ds_read_b64_tr_b16 v[72:73], v14 offset:4096
    ds_read_b64_tr_b16 v[74:75], v14 offset:5120
    s_waitcnt lgkmcnt(12)
    v_mfma_f32_32x32x16_bf16 v[144:159], v[44:47], v[32:35], v[144:159]
    ds_read_b64_tr_b16 v[76:77], v15 offset:4096
    ds_read_b64_tr_b16 v[78:79], v15 offset:5120
    v_mfma_f32_32x32x16_bf16 v[208:223], v[44:47], v[36:39], v[208:223]
    s_add_u32 m0, s54, 98304
    s_add_u32 s38, s72, 0
    buffer_load_dwordx4 v26, s[56:59], s38 offen lds
    s_waitcnt lgkmcnt(12)
    v_mfma_f32_32x32x16_bf16 v[160:175], v[48:51], v[32:35], v[160:175]
    s_add_u32 m0, s54, 99328
    s_add_u32 s38, s72, 8192
    buffer_load_dwordx4 v27, s[56:59], s38 offen lds
    v_mfma_f32_32x32x16_bf16 v[224:239], v[48:51], v[36:39], v[224:239]
    s_add_u32 m0, s54, 100352
    s_add_u32 s38, s72, 16384
    buffer_load_dwordx4 v26, s[56:59], s38 offen lds
    s_waitcnt lgkmcnt(10)
    v_mfma_f32_32x32x16_bf16 v[176:191], v[52:55], v[32:35], v[176:191]
    s_add_u32 m0, s54, 101376
    s_add_u32 s38, s72, 24576
    buffer_load_dwordx4 v27, s[56:59], s38 offen lds
    v_mfma_f32_32x32x16_bf16 v[240:255], v[52:55], v[36:39], v[240:255]
    s_add_u32 m0, s54, 102400
    s_add_u32 s38, s72, 32768
    buffer_load_dwordx4 v26, s[56:59], s38 offen lds
    s_waitcnt lgkmcnt(7)
    v_mfma_f32_32x32x16_bf16 v[128:143], v[64:67], v[56:59], v[128:143]
    ds_read_b128 v[32:35], v10 offset:0
    ds_read_b64_tr_b16 v[40:41], v12 offset:8192
    ds_read_b64_tr_b16 v[42:43], v12 offset:9216
    ds_read_b128 v[36:39], v10 offset:16384
    s_waitcnt lgkmcnt(10)
    v_mfma_f32_32x32x16_bf16 v[192:207], v[64:67], v[60:63], v[192:207]
    ds_read_b64_tr_b16 v[44:45], v13 offset:8192
    ds_read_b64_tr_b16 v[46:47], v13 offset:9216
    s_waitcnt lgkmcnt(10)
    v_mfma_f32_32x32x16_bf16 v[144:159], v[68:71], v[56:59], v[144:159]
    ds_read_b64_tr_b16 v[48:49], v14 offset:8192
    ds_read_b64_tr_b16 v[50:51], v14 offset:9216
    v_mfma_f32_32x32x16_bf16 v[208:223], v[68:71], v[60:63], v[208:223]
    ds_read_b64_tr_b16 v[52:53], v15 offset:8192
    ds_read_b64_tr_b16 v[54:55], v15 offset:9216
    s_waitcnt lgkmcnt(12)
    v_mfma_f32_32x32x16_bf16 v[160:175], v[72:75], v[56:59], v[160:175]
    s_add_u32 m0, s54, 103424
    s_add_u32 s38, s72, 40960
    buffer_load_dwordx4 v27, s[56:59], s38 offen lds
    v_mfma_f32_32x32x16_bf16 v[224:239], v[72:75], v[60:63], v[224:239]
    s_add_u32 m0, s54, 104448
    s_add_u32 s38, s72, 49152
    buffer_load_dwordx4 v26, s[56:59], s38 offen lds
    s_waitcnt lgkmcnt(10)
    v_mfma_f32_32x32x16_bf16 v[176:191], v[76:79], v[56:59], v[176:191]
    s_add_u32 m0, s54, 105472
    s_add_u32 s38, s72, 57344
    buffer_load_dwordx4 v27, s[56:59], s38 offen lds
    v_mfma_f32_32x32x16_bf16 v[240:255], v[76:79], v[60:63], v[240:255]
    s_add_u32 m0, s37, 131072
    s_add_u32 s38, s36, 0
    buffer_load_dwordx4 v4, s[64:67], s38 offen lds
    s_waitcnt lgkmcnt(7)
    v_mfma_f32_32x32x16_bf16 v[128:143], v[40:43], v[32:35], v[128:143]
    ds_read_b128 v[56:59], v11 offset:0
    ds_read_b64_tr_b16 v[64:65], v12 offset:12288
    ds_read_b64_tr_b16 v[66:67], v12 offset:13312
    ds_read_b128 v[60:63], v11 offset:16384
    s_waitcnt lgkmcnt(10)
    v_mfma_f32_32x32x16_bf16 v[192:207], v[40:43], v[36:39], v[192:207]
    ds_read_b64_tr_b16 v[68:69], v13 offset:12288
    ds_read_b64_tr_b16 v[70:71], v13 offset:13312
    s_waitcnt lgkmcnt(10)
    v_mfma_f32_32x32x16_bf16 v[144:159], v[44:47], v[32:35], v[144:159]
    ds_read_b64_tr_b16 v[72:73], v14 offset:12288
    ds_read_b64_tr_b16 v[74:75], v14 offset:13312
    v_mfma_f32_32x32x16_bf16 v[208:223], v[44:47], v[36:39], v[208:223]
    ds_read_b64_tr_b16 v[76:77], v15 offset:12288
    ds_read_b64_tr_b16 v[78:79], v15 offset:13312
    s_waitcnt lgkmcnt(12)
    v_mfma_f32_32x32x16_bf16 v[160:175], v[48:51], v[32:35], v[160:175]
    s_add_u32 m0, s37, 132096
    s_add_u32 s38, s36, 32768
    buffer_load_dwordx4 v4, s[64:67], s38 offen lds
    v_mfma_f32_32x32x16_bf16 v[224:239], v[48:51], v[36:39], v[224:239]
    s_add_u32 m0, s37, 133120
    s_add_u32 s38, s36, 65536
    buffer_load_dwordx4 v4, s[64:67], s38 offen lds
    s_waitcnt lgkmcnt(10)
    v_mfma_f32_32x32x16_bf16 v[176:191], v[52:55], v[32:35], v[176:191]
    s_add_u32 m0, s37, 134144
    s_add_u32 s38, s36, 98304
    buffer_load_dwordx4 v4, s[64:67], s38 offen lds
    v_mfma_f32_32x32x16_bf16 v[240:255], v[52:55], v[36:39], v[240:255]
    s_add_u32 s78, s79, 0
    buffer_load_dwordx4 v[28:31], v1, s[16:19], s78 offen
    s_waitcnt vmcnt(14) lgkmcnt(0)
    s_barrier
    v_add_u32 v8, 49152, v5
    v_add_u32 v12, 81920, v6
    v_xor_b32 v9, 32, v8
    v_xor_b32 v10, 64, v8
    v_xor_b32 v11, 96, v8
    v_xor_b32 v13, 64, v12
    v_xor_b32 v14, 128, v12
    v_xor_b32 v15, 192, v12
    s_waitcnt lgkmcnt(7)
    v_mfma_f32_32x32x16_bf16 v[128:143], v[64:67], v[56:59], v[128:143]
    ds_read_b128 v[32:35], v8 offset:0
    ds_read_b64_tr_b16 v[40:41], v12 offset:0
    s_waitcnt lgkmcnt(8)
    v_mfma_f32_32x32x16_bf16 v[192:207], v[64:67], v[60:63], v[192:207]
    ds_read_b64_tr_b16 v[42:43], v12 offset:1024
    ds_read_b128 v[36:39], v8 offset:16384
    s_waitcnt lgkmcnt(8)
    v_mfma_f32_32x32x16_bf16 v[144:159], v[68:71], v[56:59], v[144:159]
    ds_read_b64_tr_b16 v[44:45], v13 offset:0
    ds_read_b64_tr_b16 v[46:47], v13 offset:1024
    v_mfma_f32_32x32x16_bf16 v[208:223], v[68:71], v[60:63], v[208:223]
    ds_read_b64_tr_b16 v[48:49], v14 offset:0
    ds_read_b64_tr_b16 v[50:51], v14 offset:1024
    s_waitcnt lgkmcnt(10)
    v_mfma_f32_32x32x16_bf16 v[160:175], v[72:75], v[56:59], v[160:175]
    ds_read_b64_tr_b16 v[52:53], v15 offset:0
    ds_read_b64_tr_b16 v[54:55], v15 offset:1024
    v_mfma_f32_32x32x16_bf16 v[224:239], v[72:75], v[60:63], v[224:239]
    s_waitcnt lgkmcnt(10)
    v_mfma_f32_32x32x16_bf16 v[176:191], v[76:79], v[56:59], v[176:191]
    v_mfma_f32_32x32x16_bf16 v[240:255], v[76:79], v[60:63], v[240:255]
    s_waitcnt lgkmcnt(7)
    v_mfma_f32_32x32x16_bf16 v[128:143], v[40:43], v[32:35], v[128:143]
    ds_read_b128 v[56:59], v9 offset:0
    ds_read_b64_tr_b16 v[64:65], v12 offset:4096
    ds_read_b64_tr_b16 v[66:67], v12 offset:5120
    ds_read_b128 v[60:63], v9 offset:16384
    s_waitcnt lgkmcnt(10)
    v_mfma_f32_32x32x16_bf16 v[192:207], v[40:43], v[36:39], v[192:207]
    ds_read_b64_tr_b16 v[68:69], v13 offset:4096
    ds_read_b64_tr_b16 v[70:71], v13 offset:5120
    ds_read_b64_tr_b16 v[72:73], v14 offset:4096
    ds_read_b64_tr_b16 v[74:75], v14 offset:5120
    s_waitcnt lgkmcnt(12)
    v_mfma_f32_32x32x16_bf16 v[144:159], v[44:47], v[32:35], v[144:159]
    ds_read_b64_tr_b16 v[76:77], v15 offset:4096
    ds_read_b64_tr_b16 v[78:79], v15 offset:5120
    v_mfma_f32_32x32x16_bf16 v[208:223], v[44:47], v[36:39], v[208:223]
    s_add_u32 m0, s54, 0
    s_add_u32 s38, s72, 128
    buffer_load_dwordx4 v26, s[56:59], s38 offen lds
    s_waitcnt lgkmcnt(12)
    v_mfma_f32_32x32x16_bf16 v[160:175], v[48:51], v[32:35], v[160:175]
    s_add_u32 m0, s54, 1024
    s_add_u32 s38, s72, 8320
    buffer_load_dwordx4 v27, s[56:59], s38 offen lds
    v_mfma_f32_32x32x16_bf16 v[224:239], v[48:51], v[36:39], v[224:239]
    s_add_u32 m0, s54, 2048
    s_add_u32 s38, s72, 16512
    buffer_load_dwordx4 v26, s[56:59], s38 offen lds
    s_waitcnt lgkmcnt(10)
    v_mfma_f32_32x32x16_bf16 v[176:191], v[52:55], v[32:35], v[176:191]
    s_add_u32 m0, s54, 3072
    s_add_u32 s38, s72, 24704
    buffer_load_dwordx4 v27, s[56:59], s38 offen lds
    v_mfma_f32_32x32x16_bf16 v[240:255], v[52:55], v[36:39], v[240:255]
    s_add_u32 m0, s54, 4096
    s_add_u32 s38, s72, 32896
    buffer_load_dwordx4 v26, s[56:59], s38 offen lds
    s_waitcnt lgkmcnt(7)
    v_mfma_f32_32x32x16_bf16 v[128:143], v[64:67], v[56:59], v[128:143]
    ds_read_b128 v[32:35], v10 offset:0
    ds_read_b64_tr_b16 v[40:41], v12 offset:8192
    ds_read_b64_tr_b16 v[42:43], v12 offset:9216
    ds_read_b128 v[36:39], v10 offset:16384
    s_waitcnt lgkmcnt(10)
    v_mfma_f32_32x32x16_bf16 v[192:207], v[64:67], v[60:63], v[192:207]
    ds_read_b64_tr_b16 v[44:45], v13 offset:8192
    ds_read_b64_tr_b16 v[46:47], v13 offset:9216
    s_waitcnt lgkmcnt(10)
    v_mfma_f32_32x32x16_bf16 v[144:159], v[68:71], v[56:59], v[144:159]
    ds_read_b64_tr_b16 v[48:49], v14 offset:8192
    ds_read_b64_tr_b16 v[50:51], v14 offset:9216
    v_mfma_f32_32x32x16_bf16 v[208:223], v[68:71], v[60:63], v[208:223]
    ds_read_b64_tr_b16 v[52:53], v15 offset:8192
    ds_read_b64_tr_b16 v[54:55], v15 offset:9216
    s_waitcnt lgkmcnt(12)
    v_mfma_f32_32x32x16_bf16 v[160:175], v[72:75], v[56:59], v[160:175]
    s_add_u32 m0, s54, 5120
    s_add_u32 s38, s72, 41088
    buffer_load_dwordx4 v27, s[56:59], s38 offen lds
    v_mfma_f32_32x32x16_bf16 v[224:239], v[72:75], v[60:63], v[224:239]
    s_add_u32 m0, s54, 6144
    s_add_u32 s38, s72, 49280
    buffer_load_dwordx4 v26, s[56:59], s38 offen lds
    s_waitcnt lgkmcnt(10)
    v_mfma_f32_32x32x16_bf16 v[176:191], v[76:79], v[56:59], v[176:191]
    s_add_u32 m0, s54, 7168
    s_add_u32 s38, s72, 57472
    buffer_load_dwordx4 v27, s[56:59], s38 offen lds
    v_mfma_f32_32x32x16_bf16 v[240:255], v[76:79], v[60:63], v[240:255]
    s_add_u32 m0, s37, 32768
    s_add_u32 s38, s36, 524288
    buffer_load_dwordx4 v4, s[64:67], s38 offen lds
    s_waitcnt lgkmcnt(7)
    v_mfma_f32_32x32x16_bf16 v[128:143], v[40:43], v[32:35], v[128:143]
    ds_read_b128 v[56:59], v11 offset:0
    ds_read_b64_tr_b16 v[64:65], v12 offset:12288
    ds_read_b64_tr_b16 v[66:67], v12 offset:13312
    ds_read_b128 v[60:63], v11 offset:16384
    s_waitcnt lgkmcnt(10)
    v_mfma_f32_32x32x16_bf16 v[192:207], v[40:43], v[36:39], v[192:207]
    ds_read_b64_tr_b16 v[68:69], v13 offset:12288
    ds_read_b64_tr_b16 v[70:71], v13 offset:13312
    s_waitcnt lgkmcnt(10)
    v_mfma_f32_32x32x16_bf16 v[144:159], v[44:47], v[32:35], v[144:159]
    ds_read_b64_tr_b16 v[72:73], v14 offset:12288
    ds_read_b64_tr_b16 v[74:75], v14 offset:13312
    v_mfma_f32_32x32x16_bf16 v[208:223], v[44:47], v[36:39], v[208:223]
    ds_read_b64_tr_b16 v[76:77], v15 offset:12288
    ds_read_b64_tr_b16 v[78:79], v15 offset:13312
    s_waitcnt lgkmcnt(12)
    v_mfma_f32_32x32x16_bf16 v[160:175], v[48:51], v[32:35], v[160:175]
    s_add_u32 m0, s37, 33792
    s_add_u32 s38, s36, 557056
    buffer_load_dwordx4 v4, s[64:67], s38 offen lds
    v_mfma_f32_32x32x16_bf16 v[224:239], v[48:51], v[36:39], v[224:239]
    s_add_u32 m0, s37, 34816
    s_add_u32 s38, s36, 589824
    buffer_load_dwordx4 v4, s[64:67], s38 offen lds
    s_waitcnt lgkmcnt(10)
    v_mfma_f32_32x32x16_bf16 v[176:191], v[52:55], v[32:35], v[176:191]
    s_add_u32 m0, s37, 35840
    s_add_u32 s38, s36, 622592
    buffer_load_dwordx4 v4, s[64:67], s38 offen lds
    v_mfma_f32_32x32x16_bf16 v[240:255], v[52:55], v[36:39], v[240:255]
    s_add_u32 s78, s79, 1048576
    buffer_load_dwordx4 v[28:31], v1, s[16:19], s78 offen
    s_waitcnt vmcnt(14) lgkmcnt(0)
    s_barrier
    v_add_u32 v8, 98304, v5
    v_add_u32 v12, 131072, v6
    v_xor_b32 v9, 32, v8
    v_xor_b32 v10, 64, v8
    v_xor_b32 v11, 96, v8
    v_xor_b32 v13, 64, v12
    v_xor_b32 v14, 128, v12
    v_xor_b32 v15, 192, v12
    s_waitcnt lgkmcnt(7)
    v_mfma_f32_32x32x16_bf16 v[128:143], v[64:67], v[56:59], v[128:143]
    ds_read_b128 v[32:35], v8 offset:0
    ds_read_b64_tr_b16 v[40:41], v12 offset:0
    s_waitcnt lgkmcnt(8)
    v_mfma_f32_32x32x16_bf16 v[192:207], v[64:67], v[60:63], v[192:207]
    ds_read_b64_tr_b16 v[42:43], v12 offset:1024
    ds_read_b128 v[36:39], v8 offset:16384
    s_waitcnt lgkmcnt(8)
    v_mfma_f32_32x32x16_bf16 v[144:159], v[68:71], v[56:59], v[144:159]
    ds_read_b64_tr_b16 v[44:45], v13 offset:0
    ds_read_b64_tr_b16 v[46:47], v13 offset:1024
    v_mfma_f32_32x32x16_bf16 v[208:223], v[68:71], v[60:63], v[208:223]
    ds_read_b64_tr_b16 v[48:49], v14 offset:0
    ds_read_b64_tr_b16 v[50:51], v14 offset:1024
    s_waitcnt lgkmcnt(10)
    v_mfma_f32_32x32x16_bf16 v[160:175], v[72:75], v[56:59], v[160:175]
    ds_read_b64_tr_b16 v[52:53], v15 offset:0
    ds_read_b64_tr_b16 v[54:55], v15 offset:1024
    v_mfma_f32_32x32x16_bf16 v[224:239], v[72:75], v[60:63], v[224:239]
    s_waitcnt lgkmcnt(10)
    v_mfma_f32_32x32x16_bf16 v[176:191], v[76:79], v[56:59], v[176:191]
    v_mfma_f32_32x32x16_bf16 v[240:255], v[76:79], v[60:63], v[240:255]
    s_waitcnt lgkmcnt(7)
    v_mfma_f32_32x32x16_bf16 a[0:15], v[32:35], v[40:43], 0
    ds_read_b128 v[56:59], v9 offset:0
    ds_read_b64_tr_b16 v[64:65], v12 offset:4096
    ds_read_b64_tr_b16 v[66:67], v12 offset:5120
    ds_read_b128 v[60:63], v9 offset:16384
    s_waitcnt lgkmcnt(10)
    v_mfma_f32_32x32x16_bf16 a[64:79], v[36:39], v[40:43], 0
    ds_read_b64_tr_b16 v[68:69], v13 offset:4096
    ds_read_b64_tr_b16 v[70:71], v13 offset:5120
    ds_read_b64_tr_b16 v[72:73], v14 offset:4096
    ds_read_b64_tr_b16 v[74:75], v14 offset:5120
    s_waitcnt lgkmcnt(12)
    v_mfma_f32_32x32x16_bf16 a[16:31], v[32:35], v[44:47], 0
    ds_read_b64_tr_b16 v[76:77], v15 offset:4096
    ds_read_b64_tr_b16 v[78:79], v15 offset:5120
    v_mfma_f32_32x32x16_bf16 a[80:95], v[36:39], v[44:47], 0
    s_add_u32 m0, s54, 49152
    s_add_u32 s38, s72, 256
    buffer_load_dwordx4 v26, s[56:59], s38 offen lds
    s_waitcnt lgkmcnt(12)
    v_mfma_f32_32x32x16_bf16 a[32:47], v[32:35], v[48:51], 0
    s_add_u32 m0, s54, 50176
    s_add_u32 s38, s72, 8448
    buffer_load_dwordx4 v27, s[56:59], s38 offen lds
    v_mfma_f32_32x32x16_bf16 a[96:111], v[36:39], v[48:51], 0
    s_add_u32 m0, s54, 51200
    s_add_u32 s38, s72, 16640
    buffer_load_dwordx4 v26, s[56:59], s38 offen lds
    s_waitcnt lgkmcnt(10)
    v_mfma_f32_32x32x16_bf16 a[48:63], v[32:35], v[52:55], 0
    s_add_u32 m0, s54, 52224
    s_add_u32 s38, s72, 24832
    buffer_load_dwordx4 v27, s[56:59], s38 offen lds
    v_mfma_f32_32x32x16_bf16 a[112:127], v[36:39], v[52:55], 0
    s_add_u32 m0, s54, 53248
    s_add_u32 s38, s72, 33024
    buffer_load_dwordx4 v26, s[56:59], s38 offen lds
    s_waitcnt lgkmcnt(7)
    v_mfma_f32_32x32x16_bf16 a[0:15], v[56:59], v[64:67], a[0:15]
    ds_read_b128 v[32:35], v10 offset:0
    ds_read_b64_tr_b16 v[40:41], v12 offset:8192
    ds_read_b64_tr_b16 v[42:43], v12 offset:9216
    ds_read_b128 v[36:39], v10 offset:16384
    s_waitcnt lgkmcnt(10)
    v_mfma_f32_32x32x16_bf16 a[64:79], v[60:63], v[64:67], a[64:79]
    ds_read_b64_tr_b16 v[44:45], v13 offset:8192
    ds_read_b64_tr_b16 v[46:47], v13 offset:9216
    s_waitcnt lgkmcnt(10)
    v_mfma_f32_32x32x16_bf16 a[16:31], v[56:59], v[68:71], a[16:31]
    ds_read_b64_tr_b16 v[48:49], v14 offset:8192
    ds_read_b64_tr_b16 v[50:51], v14 offset:9216
    v_mfma_f32_32x32x16_bf16 a[80:95], v[60:63], v[68:71], a[80:95]
    ds_read_b64_tr_b16 v[52:53], v15 offset:8192
    ds_read_b64_tr_b16 v[54:55], v15 offset:9216
    s_waitcnt lgkmcnt(12)
    v_mfma_f32_32x32x16_bf16 a[32:47], v[56:59], v[72:75], a[32:47]
    s_add_u32 m0, s54, 54272
    s_add_u32 s38, s72, 41216
    buffer_load_dwordx4 v27, s[56:59], s38 offen lds
    v_mfma_f32_32x32x16_bf16 a[96:111], v[60:63], v[72:75], a[96:111]
    s_add_u32 m0, s54, 55296
    s_add_u32 s38, s72, 49408
    buffer_load_dwordx4 v26, s[56:59], s38 offen lds
    s_waitcnt lgkmcnt(10)
    v_mfma_f32_32x32x16_bf16 a[48:63], v[56:59], v[76:79], a[48:63]
    s_add_u32 m0, s54, 56320
    s_add_u32 s38, s72, 57600
    buffer_load_dwordx4 v27, s[56:59], s38 offen lds
    v_mfma_f32_32x32x16_bf16 a[112:127], v[60:63], v[76:79], a[112:127]
    s_add_u32 m0, s37, 81920
    s_add_u32 s38, s36, 1048576
    buffer_load_dwordx4 v4, s[64:67], s38 offen lds
    s_waitcnt lgkmcnt(7)
    v_mfma_f32_32x32x16_bf16 a[0:15], v[32:35], v[40:43], a[0:15]
    ds_read_b128 v[56:59], v11 offset:0
    ds_read_b64_tr_b16 v[64:65], v12 offset:12288
    ds_read_b64_tr_b16 v[66:67], v12 offset:13312
    ds_read_b128 v[60:63], v11 offset:16384
    s_waitcnt lgkmcnt(10)
    v_mfma_f32_32x32x16_bf16 a[64:79], v[36:39], v[40:43], a[64:79]
    ds_read_b64_tr_b16 v[68:69], v13 offset:12288
    ds_read_b64_tr_b16 v[70:71], v13 offset:13312
    s_waitcnt lgkmcnt(10)
    v_mfma_f32_32x32x16_bf16 a[16:31], v[32:35], v[44:47], a[16:31]
    ds_read_b64_tr_b16 v[72:73], v14 offset:12288
    ds_read_b64_tr_b16 v[74:75], v14 offset:13312
    v_mfma_f32_32x32x16_bf16 a[80:95], v[36:39], v[44:47], a[80:95]
    ds_read_b64_tr_b16 v[76:77], v15 offset:12288
    ds_read_b64_tr_b16 v[78:79], v15 offset:13312
    s_waitcnt lgkmcnt(12)
    v_mfma_f32_32x32x16_bf16 a[32:47], v[32:35], v[48:51], a[32:47]
    s_add_u32 m0, s37, 82944
    s_add_u32 s38, s36, 1081344
    buffer_load_dwordx4 v4, s[64:67], s38 offen lds
    v_mfma_f32_32x32x16_bf16 a[96:111], v[36:39], v[48:51], a[96:111]
    s_add_u32 m0, s37, 83968
    s_add_u32 s38, s36, 1114112
    buffer_load_dwordx4 v4, s[64:67], s38 offen lds
    s_waitcnt lgkmcnt(10)
    v_mfma_f32_32x32x16_bf16 a[48:63], v[32:35], v[52:55], a[48:63]
    s_add_u32 m0, s37, 84992
    s_add_u32 s38, s36, 1146880
    buffer_load_dwordx4 v4, s[64:67], s38 offen lds
    v_mfma_f32_32x32x16_bf16 a[112:127], v[36:39], v[52:55], a[112:127]
    s_add_u32 s78, s79, 2097152
    buffer_load_dwordx4 v[28:31], v1, s[16:19], s78 offen
    s_waitcnt vmcnt(14) lgkmcnt(0)
    s_barrier
    v_add_u32 v8, 0, v5
    v_add_u32 v12, 32768, v6
    v_xor_b32 v9, 32, v8
    v_xor_b32 v10, 64, v8
    v_xor_b32 v11, 96, v8
    v_xor_b32 v13, 64, v12
    v_xor_b32 v14, 128, v12
    v_xor_b32 v15, 192, v12
    s_waitcnt lgkmcnt(7)
    v_mfma_f32_32x32x16_bf16 a[0:15], v[56:59], v[64:67], a[0:15]
    ds_read_b128 v[32:35], v8 offset:0
    ds_read_b64_tr_b16 v[40:41], v12 offset:0
    s_waitcnt lgkmcnt(8)
    v_mfma_f32_32x32x16_bf16 a[64:79], v[60:63], v[64:67], a[64:79]
    ds_read_b64_tr_b16 v[42:43], v12 offset:1024
    ds_read_b128 v[36:39], v8 offset:16384
    s_waitcnt lgkmcnt(8)
    v_mfma_f32_32x32x16_bf16 a[16:31], v[56:59], v[68:71], a[16:31]
    ds_read_b64_tr_b16 v[44:45], v13 offset:0
    ds_read_b64_tr_b16 v[46:47], v13 offset:1024
    v_mfma_f32_32x32x16_bf16 a[80:95], v[60:63], v[68:71], a[80:95]
    ds_read_b64_tr_b16 v[48:49], v14 offset:0
    ds_read_b64_tr_b16 v[50:51], v14 offset:1024
    s_waitcnt lgkmcnt(10)
    v_mfma_f32_32x32x16_bf16 a[32:47], v[56:59], v[72:75], a[32:47]
    ds_read_b64_tr_b16 v[52:53], v15 offset:0
    ds_read_b64_tr_b16 v[54:55], v15 offset:1024
    v_mfma_f32_32x32x16_bf16 a[96:111], v[60:63], v[72:75], a[96:111]
    s_waitcnt lgkmcnt(10)
    v_mfma_f32_32x32x16_bf16 a[48:63], v[56:59], v[76:79], a[48:63]
    v_mfma_f32_32x32x16_bf16 a[112:127], v[60:63], v[76:79], a[112:127]
    s_waitcnt lgkmcnt(7)
    v_mfma_f32_32x32x16_bf16 a[0:15], v[32:35], v[40:43], a[0:15]
    ds_read_b128 v[56:59], v9 offset:0
    ds_read_b64_tr_b16 v[64:65], v12 offset:4096
    ds_read_b64_tr_b16 v[66:67], v12 offset:5120
    ds_read_b128 v[60:63], v9 offset:16384
    s_waitcnt lgkmcnt(10)
    v_mfma_f32_32x32x16_bf16 a[64:79], v[36:39], v[40:43], a[64:79]
    ds_read_b64_tr_b16 v[68:69], v13 offset:4096
    ds_read_b64_tr_b16 v[70:71], v13 offset:5120
    ds_read_b64_tr_b16 v[72:73], v14 offset:4096
    ds_read_b64_tr_b16 v[74:75], v14 offset:5120
    s_waitcnt lgkmcnt(12)
    v_mfma_f32_32x32x16_bf16 a[16:31], v[32:35], v[44:47], a[16:31]
    ds_read_b64_tr_b16 v[76:77], v15 offset:4096
    ds_read_b64_tr_b16 v[78:79], v15 offset:5120
    s_add_u32 m0, s54, 98304
    s_add_u32 s38, s72, 384
    buffer_load_dwordx4 v26, s[56:59], s38 offen lds
    v_mfma_f32_32x32x16_bf16 a[80:95], v[36:39], v[44:47], a[80:95]
    s_add_u32 m0, s54, 99328
    s_add_u32 s38, s72, 8576
    buffer_load_dwordx4 v27, s[56:59], s38 offen lds
    s_add_u32 m0, s54, 100352
    s_add_u32 s38, s72, 16768
    buffer_load_dwordx4 v26, s[56:59], s38 offen lds
    s_waitcnt lgkmcnt(12)
    v_mfma_f32_32x32x16_bf16 a[32:47], v[32:35], v[48:51], a[32:47]
    s_add_u32 m0, s54, 101376
    s_add_u32 s38, s72, 24960
    buffer_load_dwordx4 v27, s[56:59], s38 offen lds
    v_mfma_f32_32x32x16_bf16 a[96:111], v[36:39], v[48:51], a[96:111]
    s_add_u32 m0, s54, 102400
    s_add_u32 s38, s72, 33152
    buffer_load_dwordx4 v26, s[56:59], s38 offen lds
    s_waitcnt lgkmcnt(10)
    v_mfma_f32_32x32x16_bf16 a[48:63], v[32:35], v[52:55], a[48:63]
    s_add_u32 m0, s54, 103424
    s_add_u32 s38, s72, 41344
    buffer_load_dwordx4 v27, s[56:59], s38 offen lds
    v_mfma_f32_32x32x16_bf16 a[112:127], v[36:39], v[52:55], a[112:127]
    s_add_u32 m0, s54, 104448
    s_add_u32 s38, s72, 49536
    buffer_load_dwordx4 v26, s[56:59], s38 offen lds
    s_waitcnt lgkmcnt(7)
    v_mfma_f32_32x32x16_bf16 a[0:15], v[56:59], v[64:67], a[0:15]
    ds_read_b128 v[32:35], v10 offset:0
    ds_read_b64_tr_b16 v[40:41], v12 offset:8192
    ds_read_b64_tr_b16 v[42:43], v12 offset:9216
    ds_read_b128 v[36:39], v10 offset:16384
    s_waitcnt lgkmcnt(10)
    v_mfma_f32_32x32x16_bf16 a[64:79], v[60:63], v[64:67], a[64:79]
    ds_read_b64_tr_b16 v[44:45], v13 offset:8192
    ds_read_b64_tr_b16 v[46:47], v13 offset:9216
    ds_read_b64_tr_b16 v[48:49], v14 offset:8192
    ds_read_b64_tr_b16 v[50:51], v14 offset:9216
    s_waitcnt lgkmcnt(12)
    v_mfma_f32_32x32x16_bf16 a[16:31], v[56:59], v[68:71], a[16:31]
    ds_read_b64_tr_b16 v[52:53], v15 offset:8192
    ds_read_b64_tr_b16 v[54:55], v15 offset:9216
    s_add_u32 m0, s54, 105472
    s_add_u32 s38, s72, 57728
    buffer_load_dwordx4 v27, s[56:59], s38 offen lds
    v_mfma_f32_32x32x16_bf16 a[80:95], v[60:63], v[68:71], a[80:95]
    s_add_u32 m0, s37, 131072
    s_add_u32 s38, s36, 1572864
    buffer_load_dwordx4 v4, s[64:67], s38 offen lds
    s_waitcnt lgkmcnt(12)
    v_mfma_f32_32x32x16_bf16 a[32:47], v[56:59], v[72:75], a[32:47]
    s_add_u32 m0, s37, 132096
    s_add_u32 s38, s36, 1605632
    buffer_load_dwordx4 v4, s[64:67], s38 offen lds
    v_mfma_f32_32x32x16_bf16 a[96:111], v[60:63], v[72:75], a[96:111]
    s_add_u32 m0, s37, 133120
    s_add_u32 s38, s36, 1638400
    buffer_load_dwordx4 v4, s[64:67], s38 offen lds
    s_waitcnt lgkmcnt(10)
    v_mfma_f32_32x32x16_bf16 a[48:63], v[56:59], v[76:79], a[48:63]
    s_add_u32 m0, s37, 134144
    s_add_u32 s38, s36, 1671168
    buffer_load_dwordx4 v4, s[64:67], s38 offen lds
    v_mfma_f32_32x32x16_bf16 a[112:127], v[60:63], v[76:79], a[112:127]
    s_add_u32 s78, s79, 3145728
    buffer_load_dwordx4 v[28:31], v1, s[16:19], s78 offen
    s_waitcnt lgkmcnt(7)
    v_mfma_f32_32x32x16_bf16 a[0:15], v[32:35], v[40:43], a[0:15]
    ds_read_b128 v[56:59], v11 offset:0
    ds_read_b64_tr_b16 v[64:65], v12 offset:12288
    ds_read_b64_tr_b16 v[66:67], v12 offset:13312
    ds_read_b128 v[60:63], v11 offset:16384
    s_waitcnt lgkmcnt(10)
    v_mfma_f32_32x32x16_bf16 a[64:79], v[36:39], v[40:43], a[64:79]
    ds_read_b64_tr_b16 v[68:69], v13 offset:12288
    ds_read_b64_tr_b16 v[70:71], v13 offset:13312
    ds_read_b64_tr_b16 v[72:73], v14 offset:12288
    ds_read_b64_tr_b16 v[74:75], v14 offset:13312
    s_waitcnt lgkmcnt(12)
    v_mfma_f32_32x32x16_bf16 a[16:31], v[32:35], v[44:47], a[16:31]
    ds_read_b64_tr_b16 v[76:77], v15 offset:12288
    ds_read_b64_tr_b16 v[78:79], v15 offset:13312
    v_mul_f32 v128, s74, v128
    v_mul_f32 v129, s74, v129
    v_mul_f32 v130, s74, v130
    v_mul_f32 v131, s74, v131
    v_mfma_f32_32x32x16_bf16 a[80:95], v[36:39], v[44:47], a[80:95]
    v_mul_f32 v132, s74, v132
    v_mul_f32 v133, s74, v133
    v_mul_f32 v134, s74, v134
    v_mul_f32 v135, s74, v135
    s_waitcnt lgkmcnt(12)
    v_mfma_f32_32x32x16_bf16 a[32:47], v[32:35], v[48:51], a[32:47]
    v_cvt_pk_bf16_f32 v96, v128, v129
    v_cvt_pk_bf16_f32 v97, v130, v131
    v_cvt_pk_bf16_f32 v98, v132, v133
    v_cvt_pk_bf16_f32 v99, v134, v135
    s_add_u32 s39, s73, 0
    buffer_store_dwordx4 v[96:99], v1, s[20:23], s39 offen offset:0 sc1
    v_mfma_f32_32x32x16_bf16 a[96:111], v[36:39], v[48:51], a[96:111]
    v_mul_f32 v136, s74, v136
    v_mul_f32 v137, s74, v137
    v_mul_f32 v138, s74, v138
    v_mul_f32 v139, s74, v139
    s_waitcnt lgkmcnt(10)
    v_mfma_f32_32x32x16_bf16 a[48:63], v[32:35], v[52:55], a[48:63]
    v_mul_f32 v140, s74, v140
    v_mul_f32 v141, s74, v141
    v_mul_f32 v142, s74, v142
    v_mul_f32 v143, s74, v143
    v_mfma_f32_32x32x16_bf16 a[112:127], v[36:39], v[52:55], a[112:127]
    v_cvt_pk_bf16_f32 v100, v136, v137
    v_cvt_pk_bf16_f32 v101, v138, v139
    v_cvt_pk_bf16_f32 v102, v140, v141
    v_cvt_pk_bf16_f32 v103, v142, v143
    s_add_u32 s39, s73, 0
    buffer_store_dwordx4 v[100:103], v1, s[20:23], s39 offen offset:1024 sc1
    s_waitcnt vmcnt(16) lgkmcnt(0)
    s_barrier
    v_add_u32 v8, 49152, v5
    v_add_u32 v12, 81920, v6
    v_xor_b32 v9, 32, v8
    v_xor_b32 v10, 64, v8
    v_xor_b32 v11, 96, v8
    v_xor_b32 v13, 64, v12
    v_xor_b32 v14, 128, v12
    v_xor_b32 v15, 192, v12
    s_waitcnt lgkmcnt(7)
    v_mfma_f32_32x32x16_bf16 a[0:15], v[56:59], v[64:67], a[0:15]
    ds_read_b128 v[32:35], v8 offset:0
    ds_read_b64_tr_b16 v[40:41], v12 offset:0
    s_waitcnt lgkmcnt(8)
    v_mfma_f32_32x32x16_bf16 a[64:79], v[60:63], v[64:67], a[64:79]
    ds_read_b64_tr_b16 v[42:43], v12 offset:1024
    ds_read_b128 v[36:39], v8 offset:16384
    s_waitcnt lgkmcnt(8)
    v_mfma_f32_32x32x16_bf16 a[16:31], v[56:59], v[68:71], a[16:31]
    ds_read_b64_tr_b16 v[44:45], v13 offset:0
    ds_read_b64_tr_b16 v[46:47], v13 offset:1024
    v_mfma_f32_32x32x16_bf16 a[80:95], v[60:63], v[68:71], a[80:95]
    ds_read_b64_tr_b16 v[48:49], v14 offset:0
    ds_read_b64_tr_b16 v[50:51], v14 offset:1024
    s_waitcnt lgkmcnt(10)
    v_mfma_f32_32x32x16_bf16 a[32:47], v[56:59], v[72:75], a[32:47]
    ds_read_b64_tr_b16 v[52:53], v15 offset:0
    ds_read_b64_tr_b16 v[54:55], v15 offset:1024
    v_mfma_f32_32x32x16_bf16 a[96:111], v[60:63], v[72:75], a[96:111]
    s_waitcnt lgkmcnt(10)
    v_mfma_f32_32x32x16_bf16 a[48:63], v[56:59], v[76:79], a[48:63]
    v_mfma_f32_32x32x16_bf16 a[112:127], v[60:63], v[76:79], a[112:127]
    s_waitcnt lgkmcnt(7)
    v_mfma_f32_32x32x16_bf16 a[0:15], v[32:35], v[40:43], a[0:15]
    ds_read_b128 v[56:59], v9 offset:0
    ds_read_b64_tr_b16 v[64:65], v12 offset:4096
    ds_read_b64_tr_b16 v[66:67], v12 offset:5120
    ds_read_b128 v[60:63], v9 offset:16384
    s_waitcnt lgkmcnt(10)
    v_mfma_f32_32x32x16_bf16 a[64:79], v[36:39], v[40:43], a[64:79]
    ds_read_b64_tr_b16 v[68:69], v13 offset:4096
    ds_read_b64_tr_b16 v[70:71], v13 offset:5120
    ds_read_b64_tr_b16 v[72:73], v14 offset:4096
    ds_read_b64_tr_b16 v[74:75], v14 offset:5120
    s_waitcnt lgkmcnt(12)
    v_mfma_f32_32x32x16_bf16 a[16:31], v[32:35], v[44:47], a[16:31]
    ds_read_b64_tr_b16 v[76:77], v15 offset:4096
    ds_read_b64_tr_b16 v[78:79], v15 offset:5120
    s_add_u32 m0, s54, 0
    s_add_u32 s38, s72, 512
    buffer_load_dwordx4 v26, s[56:59], s38 offen lds
    v_mfma_f32_32x32x16_bf16 a[80:95], v[36:39], v[44:47], a[80:95]
    s_add_u32 m0, s54, 1024
    s_add_u32 s38, s72, 8704
    buffer_load_dwordx4 v27, s[56:59], s38 offen lds
    s_add_u32 m0, s54, 2048
    s_add_u32 s38, s72, 16896
    buffer_load_dwordx4 v26, s[56:59], s38 offen lds
    s_waitcnt lgkmcnt(12)
    v_mfma_f32_32x32x16_bf16 a[32:47], v[32:35], v[48:51], a[32:47]
    s_add_u32 m0, s54, 3072
    s_add_u32 s38, s72, 25088
    buffer_load_dwordx4 v27, s[56:59], s38 offen lds
    v_mfma_f32_32x32x16_bf16 a[96:111], v[36:39], v[48:51], a[96:111]
    s_add_u32 m0, s54, 4096
    s_add_u32 s38, s72, 33280
    buffer_load_dwordx4 v26, s[56:59], s38 offen lds
    s_waitcnt lgkmcnt(10)
    v_mfma_f32_32x32x16_bf16 a[48:63], v[32:35], v[52:55], a[48:63]
    s_add_u32 m0, s54, 5120
    s_add_u32 s38, s72, 41472
    buffer_load_dwordx4 v27, s[56:59], s38 offen lds
    v_mfma_f32_32x32x16_bf16 a[112:127], v[36:39], v[52:55], a[112:127]
    s_add_u32 m0, s54, 6144
    s_add_u32 s38, s72, 49664
    buffer_load_dwordx4 v26, s[56:59], s38 offen lds
    s_waitcnt lgkmcnt(7)
    v_mfma_f32_32x32x16_bf16 a[0:15], v[56:59], v[64:67], a[0:15]
    ds_read_b128 v[32:35], v10 offset:0
    ds_read_b64_tr_b16 v[40:41], v12 offset:8192
    ds_read_b64_tr_b16 v[42:43], v12 offset:9216
    ds_read_b128 v[36:39], v10 offset:16384
    s_waitcnt lgkmcnt(10)
    v_mfma_f32_32x32x16_bf16 a[64:79], v[60:63], v[64:67], a[64:79]
    ds_read_b64_tr_b16 v[44:45], v13 offset:8192
    ds_read_b64_tr_b16 v[46:47], v13 offset:9216
    ds_read_b64_tr_b16 v[48:49], v14 offset:8192
    ds_read_b64_tr_b16 v[50:51], v14 offset:9216
    s_waitcnt lgkmcnt(12)
    v_mfma_f32_32x32x16_bf16 a[16:31], v[56:59], v[68:71], a[16:31]
    ds_read_b64_tr_b16 v[52:53], v15 offset:8192
    ds_read_b64_tr_b16 v[54:55], v15 offset:9216
    s_add_u32 m0, s54, 7168
    s_add_u32 s38, s72, 57856
    buffer_load_dwordx4 v27, s[56:59], s38 offen lds
    v_mfma_f32_32x32x16_bf16 a[80:95], v[60:63], v[68:71], a[80:95]
    s_add_u32 m0, s37, 32768
    s_add_u32 s38, s36, 2097152
    buffer_load_dwordx4 v4, s[64:67], s38 offen lds
    s_add_u32 m0, s37, 33792
    s_add_u32 s38, s36, 2129920
    buffer_load_dwordx4 v4, s[64:67], s38 offen lds
    s_waitcnt lgkmcnt(12)
    v_mfma_f32_32x32x16_bf16 a[32:47], v[56:59], v[72:75], a[32:47]
    s_add_u32 m0, s37, 34816
    s_add_u32 s38, s36, 2162688
    buffer_load_dwordx4 v4, s[64:67], s38 offen lds
    v_mfma_f32_32x32x16_bf16 a[96:111], v[60:63], v[72:75], a[96:111]
    s_add_u32 m0, s37, 35840
    s_add_u32 s38, s36, 2195456
    buffer_load_dwordx4 v4, s[64:67], s38 offen lds
    s_waitcnt lgkmcnt(10)
    v_mfma_f32_32x32x16_bf16 a[48:63], v[56:59], v[76:79], a[48:63]
    s_add_u32 s78, s79, 4194304
    buffer_load_dwordx4 v[28:31], v1, s[16:19], s78 offen
    v_mfma_f32_32x32x16_bf16 a[112:127], v[60:63], v[76:79], a[112:127]
    v_mul_f32 v144, s74, v144
    v_mul_f32 v145, s74, v145
    v_mul_f32 v146, s74, v146
    v_mul_f32 v147, s74, v147
    s_waitcnt lgkmcnt(7)
    v_mfma_f32_32x32x16_bf16 a[0:15], v[32:35], v[40:43], a[0:15]
    ds_read_b128 v[56:59], v11 offset:0
    ds_read_b64_tr_b16 v[64:65], v12 offset:12288
    ds_read_b64_tr_b16 v[66:67], v12 offset:13312
    ds_read_b128 v[60:63], v11 offset:16384
    s_waitcnt lgkmcnt(10)
    v_mfma_f32_32x32x16_bf16 a[64:79], v[36:39], v[40:43], a[64:79]
    ds_read_b64_tr_b16 v[68:69], v13 offset:12288
    ds_read_b64_tr_b16 v[70:71], v13 offset:13312
    ds_read_b64_tr_b16 v[72:73], v14 offset:12288
    ds_read_b64_tr_b16 v[74:75], v14 offset:13312
    s_waitcnt lgkmcnt(12)
    v_mfma_f32_32x32x16_bf16 a[16:31], v[32:35], v[44:47], a[16:31]
    ds_read_b64_tr_b16 v[76:77], v15 offset:12288
    ds_read_b64_tr_b16 v[78:79], v15 offset:13312
    v_mul_f32 v148, s74, v148
    v_mul_f32 v149, s74, v149
    v_mul_f32 v150, s74, v150
    v_mul_f32 v151, s74, v151
    v_mfma_f32_32x32x16_bf16 a[80:95], v[36:39], v[44:47], a[80:95]
    v_cvt_pk_bf16_f32 v104, v144, v145
    v_cvt_pk_bf16_f32 v105, v146, v147
    v_cvt_pk_bf16_f32 v106, v148, v149
    v_cvt_pk_bf16_f32 v107, v150, v151
    s_add_u32 s39, s73, 0
    buffer_store_dwordx4 v[104:107], v1, s[20:23], s39 offen offset:2048 sc1
    s_waitcnt lgkmcnt(12)
    v_mfma_f32_32x32x16_bf16 a[32:47], v[32:35], v[48:51], a[32:47]
    v_mul_f32 v152, s74, v152
    v_mul_f32 v153, s74, v153
    v_mul_f32 v154, s74, v154
    v_mul_f32 v155, s74, v155
    v_mfma_f32_32x32x16_bf16 a[96:111], v[36:39], v[48:51], a[96:111]
    v_mul_f32 v156, s74, v156
    v_mul_f32 v157, s74, v157
    v_mul_f32 v158, s74, v158
    v_mul_f32 v159, s74, v159
    s_waitcnt lgkmcnt(10)
    v_mfma_f32_32x32x16_bf16 a[48:63], v[32:35], v[52:55], a[48:63]
    v_cvt_pk_bf16_f32 v108, v152, v153
    v_cvt_pk_bf16_f32 v109, v154, v155
    v_cvt_pk_bf16_f32 v110, v156, v157
    v_cvt_pk_bf16_f32 v111, v158, v159
    s_add_u32 s39, s73, 0
    buffer_store_dwordx4 v[108:111], v1, s[20:23], s39 offen offset:3072 sc1
    v_mfma_f32_32x32x16_bf16 a[112:127], v[36:39], v[52:55], a[112:127]
    v_mul_f32 v160, s74, v160
    v_mul_f32 v161, s74, v161
    v_mul_f32 v162, s74, v162
    v_mul_f32 v163, s74, v163
    s_waitcnt vmcnt(18) lgkmcnt(0)
    s_barrier
    v_add_u32 v8, 98304, v5
    v_add_u32 v12, 131072, v6
    v_xor_b32 v9, 32, v8
    v_xor_b32 v10, 64, v8
    v_xor_b32 v11, 96, v8
    v_xor_b32 v13, 64, v12
    v_xor_b32 v14, 128, v12
    v_xor_b32 v15, 192, v12
    s_waitcnt lgkmcnt(7)
    v_mfma_f32_32x32x16_bf16 a[0:15], v[56:59], v[64:67], a[0:15]
    ds_read_b128 v[32:35], v8 offset:0
    ds_read_b64_tr_b16 v[40:41], v12 offset:0
    s_waitcnt lgkmcnt(8)
    v_mfma_f32_32x32x16_bf16 a[64:79], v[60:63], v[64:67], a[64:79]
    ds_read_b64_tr_b16 v[42:43], v12 offset:1024
    ds_read_b128 v[36:39], v8 offset:16384
    s_waitcnt lgkmcnt(8)
    v_mfma_f32_32x32x16_bf16 a[16:31], v[56:59], v[68:71], a[16:31]
    ds_read_b64_tr_b16 v[44:45], v13 offset:0
    ds_read_b64_tr_b16 v[46:47], v13 offset:1024
    v_mfma_f32_32x32x16_bf16 a[80:95], v[60:63], v[68:71], a[80:95]
    ds_read_b64_tr_b16 v[48:49], v14 offset:0
    ds_read_b64_tr_b16 v[50:51], v14 offset:1024
    s_waitcnt lgkmcnt(10)
    v_mfma_f32_32x32x16_bf16 a[32:47], v[56:59], v[72:75], a[32:47]
    ds_read_b64_tr_b16 v[52:53], v15 offset:0
    ds_read_b64_tr_b16 v[54:55], v15 offset:1024
    v_mfma_f32_32x32x16_bf16 a[96:111], v[60:63], v[72:75], a[96:111]
    s_waitcnt lgkmcnt(10)
    v_mfma_f32_32x32x16_bf16 a[48:63], v[56:59], v[76:79], a[48:63]
    v_mfma_f32_32x32x16_bf16 a[112:127], v[60:63], v[76:79], a[112:127]
    s_waitcnt lgkmcnt(7)
    v_mfma_f32_32x32x16_bf16 a[0:15], v[32:35], v[40:43], a[0:15]
    ds_read_b128 v[56:59], v9 offset:0
    ds_read_b64_tr_b16 v[64:65], v12 offset:4096
    ds_read_b64_tr_b16 v[66:67], v12 offset:5120
    ds_read_b128 v[60:63], v9 offset:16384
    s_waitcnt lgkmcnt(10)
    v_mfma_f32_32x32x16_bf16 a[64:79], v[36:39], v[40:43], a[64:79]
    ds_read_b64_tr_b16 v[68:69], v13 offset:4096
    ds_read_b64_tr_b16 v[70:71], v13 offset:5120
    ds_read_b64_tr_b16 v[72:73], v14 offset:4096
    ds_read_b64_tr_b16 v[74:75], v14 offset:5120
    s_waitcnt lgkmcnt(12)
    v_mfma_f32_32x32x16_bf16 a[16:31], v[32:35], v[44:47], a[16:31]
    ds_read_b64_tr_b16 v[76:77], v15 offset:4096
    ds_read_b64_tr_b16 v[78:79], v15 offset:5120
    s_add_u32 m0, s54, 49152
    s_add_u32 s38, s72, 640
    buffer_load_dwordx4 v26, s[56:59], s38 offen lds
    v_mfma_f32_32x32x16_bf16 a[80:95], v[36:39], v[44:47], a[80:95]
    s_add_u32 m0, s54, 50176
    s_add_u32 s38, s72, 8832
    buffer_load_dwordx4 v27, s[56:59], s38 offen lds
    s_add_u32 m0, s54, 51200
    s_add_u32 s38, s72, 17024
    buffer_load_dwordx4 v26, s[56:59], s38 offen lds
    s_waitcnt lgkmcnt(12)
    v_mfma_f32_32x32x16_bf16 a[32:47], v[32:35], v[48:51], a[32:47]
    s_add_u32 m0, s54, 52224
    s_add_u32 s38, s72, 25216
    buffer_load_dwordx4 v27, s[56:59], s38 offen lds
    v_mfma_f32_32x32x16_bf16 a[96:111], v[36:39], v[48:51], a[96:111]
    s_add_u32 m0, s54, 53248
    s_add_u32 s38, s72, 33408
    buffer_load_dwordx4 v26, s[56:59], s38 offen lds
    s_waitcnt lgkmcnt(10)
    v_mfma_f32_32x32x16_bf16 a[48:63], v[32:35], v[52:55], a[48:63]
    s_add_u32 m0, s54, 54272
    s_add_u32 s38, s72, 41600
    buffer_load_dwordx4 v27, s[56:59], s38 offen lds
    v_mfma_f32_32x32x16_bf16 a[112:127], v[36:39], v[52:55], a[112:127]
    s_add_u32 m0, s54, 55296
    s_add_u32 s38, s72, 49792
    buffer_load_dwordx4 v26, s[56:59], s38 offen lds
    s_waitcnt lgkmcnt(7)
    v_mfma_f32_32x32x16_bf16 a[0:15], v[56:59], v[64:67], a[0:15]
    ds_read_b128 v[32:35], v10 offset:0
    ds_read_b64_tr_b16 v[40:41], v12 offset:8192
    ds_read_b64_tr_b16 v[42:43], v12 offset:9216
    ds_read_b128 v[36:39], v10 offset:16384
    s_waitcnt lgkmcnt(10)
    v_mfma_f32_32x32x16_bf16 a[64:79], v[60:63], v[64:67], a[64:79]
    ds_read_b64_tr_b16 v[44:45], v13 offset:8192
    ds_read_b64_tr_b16 v[46:47], v13 offset:9216
    ds_read_b64_tr_b16 v[48:49], v14 offset:8192
    ds_read_b64_tr_b16 v[50:51], v14 offset:9216
    s_waitcnt lgkmcnt(12)
    v_mfma_f32_32x32x16_bf16 a[16:31], v[56:59], v[68:71], a[16:31]
    ds_read_b64_tr_b16 v[52:53], v15 offset:8192
    ds_read_b64_tr_b16 v[54:55], v15 offset:9216
    s_add_u32 m0, s54, 56320
    s_add_u32 s38, s72, 57984
    buffer_load_dwordx4 v27, s[56:59], s38 offen lds
    v_mfma_f32_32x32x16_bf16 a[80:95], v[60:63], v[68:71], a[80:95]
    s_add_u32 m0, s37, 81920
    s_add_u32 s38, s36, 2621440
    buffer_load_dwordx4 v4, s[64:67], s38 offen lds
    s_waitcnt lgkmcnt(12)
    v_mfma_f32_32x32x16_bf16 a[32:47], v[56:59], v[72:75], a[32:47]
    s_add_u32 m0, s37, 82944
    s_add_u32 s38, s36, 2654208
    buffer_load_dwordx4 v4, s[64:67], s38 offen lds
    v_mfma_f32_32x32x16_bf16 a[96:111], v[60:63], v[72:75], a[96:111]
    s_add_u32 m0, s37, 83968
    s_add_u32 s38, s36, 2686976
    buffer_load_dwordx4 v4, s[64:67], s38 offen lds
    s_waitcnt lgkmcnt(10)
    v_mfma_f32_32x32x16_bf16 a[48:63], v[56:59], v[76:79], a[48:63]
    s_add_u32 m0, s37, 84992
    s_add_u32 s38, s36, 2719744
    buffer_load_dwordx4 v4, s[64:67], s38 offen lds
    v_mfma_f32_32x32x16_bf16 a[112:127], v[60:63], v[76:79], a[112:127]
    v_mul_f32 v164, s74, v164
    v_mul_f32 v165, s74, v165
    v_mul_f32 v166, s74, v166
    v_mul_f32 v167, s74, v167
    s_waitcnt lgkmcnt(7)
    v_mfma_f32_32x32x16_bf16 a[0:15], v[32:35], v[40:43], a[0:15]
    ds_read_b128 v[56:59], v11 offset:0
    ds_read_b64_tr_b16 v[64:65], v12 offset:12288
    ds_read_b64_tr_b16 v[66:67], v12 offset:13312
    ds_read_b128 v[60:63], v11 offset:16384
    s_waitcnt lgkmcnt(10)
    v_mfma_f32_32x32x16_bf16 a[64:79], v[36:39], v[40:43], a[64:79]
    ds_read_b64_tr_b16 v[68:69], v13 offset:12288
    ds_read_b64_tr_b16 v[70:71], v13 offset:13312
    ds_read_b64_tr_b16 v[72:73], v14 offset:12288
    ds_read_b64_tr_b16 v[74:75], v14 offset:13312
    s_waitcnt lgkmcnt(12)
    v_mfma_f32_32x32x16_bf16 a[16:31], v[32:35], v[44:47], a[16:31]
    ds_read_b64_tr_b16 v[76:77], v15 offset:12288
    ds_read_b64_tr_b16 v[78:79], v15 offset:13312
    v_cvt_pk_bf16_f32 v96, v160, v161
    v_cvt_pk_bf16_f32 v97, v162, v163
    v_cvt_pk_bf16_f32 v98, v164, v165
    v_cvt_pk_bf16_f32 v99, v166, v167
    s_add_u32 s39, s73, 4096
    buffer_store_dwordx4 v[96:99], v1, s[20:23], s39 offen offset:0 sc1
    v_mfma_f32_32x32x16_bf16 a[80:95], v[36:39], v[44:47], a[80:95]
    v_mul_f32 v168, s74, v168
    v_mul_f32 v169, s74, v169
    v_mul_f32 v170, s74, v170
    v_mul_f32 v171, s74, v171
    s_waitcnt lgkmcnt(12)
    v_mfma_f32_32x32x16_bf16 a[32:47], v[32:35], v[48:51], a[32:47]
    v_mul_f32 v172, s74, v172
    v_mul_f32 v173, s74, v173
    v_mul_f32 v174, s74, v174
    v_mul_f32 v175, s74, v175
    v_mfma_f32_32x32x16_bf16 a[96:111], v[36:39], v[48:51], a[96:111]
    v_cvt_pk_bf16_f32 v100, v168, v169
    v_cvt_pk_bf16_f32 v101, v170, v171
    v_cvt_pk_bf16_f32 v102, v172, v173
    v_cvt_pk_bf16_f32 v103, v174, v175
    s_add_u32 s39, s73, 4096
    buffer_store_dwordx4 v[100:103], v1, s[20:23], s39 offen offset:1024 sc1
    s_waitcnt lgkmcnt(10)
    v_mfma_f32_32x32x16_bf16 a[48:63], v[32:35], v[52:55], a[48:63]
    v_mul_f32 v176, s74, v176
    v_mul_f32 v177, s74, v177
    v_mul_f32 v178, s74, v178
    v_mul_f32 v179, s74, v179
    v_mfma_f32_32x32x16_bf16 a[112:127], v[36:39], v[52:55], a[112:127]
    v_mul_f32 v180, s74, v180
    v_mul_f32 v181, s74, v181
    v_mul_f32 v182, s74, v182
    v_mul_f32 v183, s74, v183
    s_waitcnt vmcnt(17) lgkmcnt(0)
    s_barrier
    v_add_u32 v8, 0, v5
    v_add_u32 v12, 32768, v6
    v_xor_b32 v9, 32, v8
    v_xor_b32 v10, 64, v8
    v_xor_b32 v11, 96, v8
    v_xor_b32 v13, 64, v12
    v_xor_b32 v14, 128, v12
    v_xor_b32 v15, 192, v12
    s_waitcnt lgkmcnt(7)
    v_mfma_f32_32x32x16_bf16 a[0:15], v[56:59], v[64:67], a[0:15]
    ds_read_b128 v[32:35], v8 offset:0
    ds_read_b64_tr_b16 v[40:41], v12 offset:0
    s_waitcnt lgkmcnt(8)
    v_mfma_f32_32x32x16_bf16 a[64:79], v[60:63], v[64:67], a[64:79]
    ds_read_b64_tr_b16 v[42:43], v12 offset:1024
    ds_read_b128 v[36:39], v8 offset:16384
    s_waitcnt lgkmcnt(8)
    v_mfma_f32_32x32x16_bf16 a[16:31], v[56:59], v[68:71], a[16:31]
    ds_read_b64_tr_b16 v[44:45], v13 offset:0
    ds_read_b64_tr_b16 v[46:47], v13 offset:1024
    v_mfma_f32_32x32x16_bf16 a[80:95], v[60:63], v[68:71], a[80:95]
    ds_read_b64_tr_b16 v[48:49], v14 offset:0
    ds_read_b64_tr_b16 v[50:51], v14 offset:1024
    s_waitcnt lgkmcnt(10)
    v_mfma_f32_32x32x16_bf16 a[32:47], v[56:59], v[72:75], a[32:47]
    ds_read_b64_tr_b16 v[52:53], v15 offset:0
    ds_read_b64_tr_b16 v[54:55], v15 offset:1024
    v_mfma_f32_32x32x16_bf16 a[96:111], v[60:63], v[72:75], a[96:111]
    s_waitcnt lgkmcnt(10)
    v_mfma_f32_32x32x16_bf16 a[48:63], v[56:59], v[76:79], a[48:63]
    v_mfma_f32_32x32x16_bf16 a[112:127], v[60:63], v[76:79], a[112:127]
    s_waitcnt lgkmcnt(7)
    v_mfma_f32_32x32x16_bf16 a[0:15], v[32:35], v[40:43], a[0:15]
    ds_read_b128 v[56:59], v9 offset:0
    ds_read_b64_tr_b16 v[64:65], v12 offset:4096
    ds_read_b64_tr_b16 v[66:67], v12 offset:5120
    ds_read_b128 v[60:63], v9 offset:16384
    s_waitcnt lgkmcnt(10)
    v_mfma_f32_32x32x16_bf16 a[64:79], v[36:39], v[40:43], a[64:79]
    ds_read_b64_tr_b16 v[68:69], v13 offset:4096
    ds_read_b64_tr_b16 v[70:71], v13 offset:5120
    ds_read_b64_tr_b16 v[72:73], v14 offset:4096
    ds_read_b64_tr_b16 v[74:75], v14 offset:5120
    s_waitcnt lgkmcnt(12)
    v_mfma_f32_32x32x16_bf16 a[16:31], v[32:35], v[44:47], a[16:31]
    ds_read_b64_tr_b16 v[76:77], v15 offset:4096
    ds_read_b64_tr_b16 v[78:79], v15 offset:5120
    s_add_u32 m0, s54, 98304
    s_add_u32 s38, s72, 768
    buffer_load_dwordx4 v26, s[56:59], s38 offen lds
    v_mfma_f32_32x32x16_bf16 a[80:95], v[36:39], v[44:47], a[80:95]
    s_add_u32 m0, s54, 99328
    s_add_u32 s38, s72, 8960
    buffer_load_dwordx4 v27, s[56:59], s38 offen lds
    s_add_u32 m0, s54, 100352
    s_add_u32 s38, s72, 17152
    buffer_load_dwordx4 v26, s[56:59], s38 offen lds
    s_waitcnt lgkmcnt(12)
    v_mfma_f32_32x32x16_bf16 a[32:47], v[32:35], v[48:51], a[32:47]
    s_add_u32 m0, s54, 101376
    s_add_u32 s38, s72, 25344
    buffer_load_dwordx4 v27, s[56:59], s38 offen lds
    v_mfma_f32_32x32x16_bf16 a[96:111], v[36:39], v[48:51], a[96:111]
    s_add_u32 m0, s54, 102400
    s_add_u32 s38, s72, 33536
    buffer_load_dwordx4 v26, s[56:59], s38 offen lds
    s_waitcnt lgkmcnt(10)
    v_mfma_f32_32x32x16_bf16 a[48:63], v[32:35], v[52:55], a[48:63]
    s_add_u32 m0, s54, 103424
    s_add_u32 s38, s72, 41728
    buffer_load_dwordx4 v27, s[56:59], s38 offen lds
    v_mfma_f32_32x32x16_bf16 a[112:127], v[36:39], v[52:55], a[112:127]
    s_add_u32 m0, s54, 104448
    s_add_u32 s38, s72, 49920
    buffer_load_dwordx4 v26, s[56:59], s38 offen lds
    s_waitcnt lgkmcnt(7)
    v_mfma_f32_32x32x16_bf16 a[0:15], v[56:59], v[64:67], a[0:15]
    ds_read_b128 v[32:35], v10 offset:0
    ds_read_b64_tr_b16 v[40:41], v12 offset:8192
    ds_read_b64_tr_b16 v[42:43], v12 offset:9216
    ds_read_b128 v[36:39], v10 offset:16384
    s_waitcnt lgkmcnt(10)
    v_mfma_f32_32x32x16_bf16 a[64:79], v[60:63], v[64:67], a[64:79]
    ds_read_b64_tr_b16 v[44:45], v13 offset:8192
    ds_read_b64_tr_b16 v[46:47], v13 offset:9216
    ds_read_b64_tr_b16 v[48:49], v14 offset:8192
    ds_read_b64_tr_b16 v[50:51], v14 offset:9216
    s_waitcnt lgkmcnt(12)
    v_mfma_f32_32x32x16_bf16 a[16:31], v[56:59], v[68:71], a[16:31]
    ds_read_b64_tr_b16 v[52:53], v15 offset:8192
    ds_read_b64_tr_b16 v[54:55], v15 offset:9216
    s_add_u32 m0, s54, 105472
    s_add_u32 s38, s72, 58112
    buffer_load_dwordx4 v27, s[56:59], s38 offen lds
    v_mfma_f32_32x32x16_bf16 a[80:95], v[60:63], v[68:71], a[80:95]
    s_add_u32 m0, s37, 131072
    s_add_u32 s38, s36, 3145728
    buffer_load_dwordx4 v4, s[64:67], s38 offen lds
    s_waitcnt lgkmcnt(12)
    v_mfma_f32_32x32x16_bf16 a[32:47], v[56:59], v[72:75], a[32:47]
    s_add_u32 m0, s37, 132096
    s_add_u32 s38, s36, 3178496
    buffer_load_dwordx4 v4, s[64:67], s38 offen lds
    v_mfma_f32_32x32x16_bf16 a[96:111], v[60:63], v[72:75], a[96:111]
    s_add_u32 m0, s37, 133120
    s_add_u32 s38, s36, 3211264
    buffer_load_dwordx4 v4, s[64:67], s38 offen lds
    s_waitcnt lgkmcnt(10)
    v_mfma_f32_32x32x16_bf16 a[48:63], v[56:59], v[76:79], a[48:63]
    s_add_u32 m0, s37, 134144
    s_add_u32 s38, s36, 3244032
    buffer_load_dwordx4 v4, s[64:67], s38 offen lds
    v_mfma_f32_32x32x16_bf16 a[112:127], v[60:63], v[76:79], a[112:127]
    v_cvt_pk_bf16_f32 v104, v176, v177
    v_cvt_pk_bf16_f32 v105, v178, v179
    v_cvt_pk_bf16_f32 v106, v180, v181
    v_cvt_pk_bf16_f32 v107, v182, v183
    s_add_u32 s39, s73, 4096
    buffer_store_dwordx4 v[104:107], v1, s[20:23], s39 offen offset:2048 sc1
    s_waitcnt lgkmcnt(7)
    v_mfma_f32_32x32x16_bf16 a[0:15], v[32:35], v[40:43], a[0:15]
    ds_read_b128 v[56:59], v11 offset:0
    ds_read_b64_tr_b16 v[64:65], v12 offset:12288
    ds_read_b64_tr_b16 v[66:67], v12 offset:13312
    ds_read_b128 v[60:63], v11 offset:16384
    s_waitcnt lgkmcnt(10)
    v_mfma_f32_32x32x16_bf16 a[64:79], v[36:39], v[40:43], a[64:79]
    ds_read_b64_tr_b16 v[68:69], v13 offset:12288
    ds_read_b64_tr_b16 v[70:71], v13 offset:13312
    ds_read_b64_tr_b16 v[72:73], v14 offset:12288
    ds_read_b64_tr_b16 v[74:75], v14 offset:13312
    s_waitcnt lgkmcnt(12)
    v_mfma_f32_32x32x16_bf16 a[16:31], v[32:35], v[44:47], a[16:31]
    ds_read_b64_tr_b16 v[76:77], v15 offset:12288
    ds_read_b64_tr_b16 v[78:79], v15 offset:13312
    v_mul_f32 v184, s74, v184
    v_mul_f32 v185, s74, v185
    v_mul_f32 v186, s74, v186
    v_mul_f32 v187, s74, v187
    v_mfma_f32_32x32x16_bf16 a[80:95], v[36:39], v[44:47], a[80:95]
    v_mul_f32 v188, s74, v188
    v_mul_f32 v189, s74, v189
    v_mul_f32 v190, s74, v190
    v_mul_f32 v191, s74, v191
    s_waitcnt lgkmcnt(12)
    v_mfma_f32_32x32x16_bf16 a[32:47], v[32:35], v[48:51], a[32:47]
    v_cvt_pk_bf16_f32 v108, v184, v185
    v_cvt_pk_bf16_f32 v109, v186, v187
    v_cvt_pk_bf16_f32 v110, v188, v189
    v_cvt_pk_bf16_f32 v111, v190, v191
    s_add_u32 s39, s73, 4096
    buffer_store_dwordx4 v[108:111], v1, s[20:23], s39 offen offset:3072 sc1
    v_mfma_f32_32x32x16_bf16 a[96:111], v[36:39], v[48:51], a[96:111]
    v_mul_f32 v192, s74, v192
    v_mul_f32 v193, s74, v193
    v_mul_f32 v194, s74, v194
    v_mul_f32 v195, s74, v195
    s_waitcnt lgkmcnt(10)
    v_mfma_f32_32x32x16_bf16 a[48:63], v[32:35], v[52:55], a[48:63]
    v_mul_f32 v196, s74, v196
    v_mul_f32 v197, s74, v197
    v_mul_f32 v198, s74, v198
    v_mul_f32 v199, s74, v199
    v_mfma_f32_32x32x16_bf16 a[112:127], v[36:39], v[52:55], a[112:127]
    v_cvt_pk_bf16_f32 v96, v192, v193
    v_cvt_pk_bf16_f32 v97, v194, v195
    v_cvt_pk_bf16_f32 v98, v196, v197
    v_cvt_pk_bf16_f32 v99, v198, v199
    s_add_u32 s39, s73, 32768
    buffer_store_dwordx4 v[96:99], v1, s[20:23], s39 offen offset:0 sc1
    s_waitcnt vmcnt(17) lgkmcnt(0)
    s_barrier
    v_add_u32 v8, 49152, v5
    v_add_u32 v12, 81920, v6
    v_xor_b32 v9, 32, v8
    v_xor_b32 v10, 64, v8
    v_xor_b32 v11, 96, v8
    v_xor_b32 v13, 64, v12
    v_xor_b32 v14, 128, v12
    v_xor_b32 v15, 192, v12
    s_waitcnt lgkmcnt(7)
    v_mfma_f32_32x32x16_bf16 a[0:15], v[56:59], v[64:67], a[0:15]
    ds_read_b128 v[32:35], v8 offset:0
    ds_read_b64_tr_b16 v[40:41], v12 offset:0
    s_waitcnt lgkmcnt(8)
    v_mfma_f32_32x32x16_bf16 a[64:79], v[60:63], v[64:67], a[64:79]
    ds_read_b64_tr_b16 v[42:43], v12 offset:1024
    ds_read_b128 v[36:39], v8 offset:16384
    s_waitcnt lgkmcnt(8)
    v_mfma_f32_32x32x16_bf16 a[16:31], v[56:59], v[68:71], a[16:31]
    ds_read_b64_tr_b16 v[44:45], v13 offset:0
    ds_read_b64_tr_b16 v[46:47], v13 offset:1024
    v_mfma_f32_32x32x16_bf16 a[80:95], v[60:63], v[68:71], a[80:95]
    ds_read_b64_tr_b16 v[48:49], v14 offset:0
    ds_read_b64_tr_b16 v[50:51], v14 offset:1024
    s_waitcnt lgkmcnt(10)
    v_mfma_f32_32x32x16_bf16 a[32:47], v[56:59], v[72:75], a[32:47]
    ds_read_b64_tr_b16 v[52:53], v15 offset:0
    ds_read_b64_tr_b16 v[54:55], v15 offset:1024
    v_mfma_f32_32x32x16_bf16 a[96:111], v[60:63], v[72:75], a[96:111]
    s_waitcnt lgkmcnt(10)
    v_mfma_f32_32x32x16_bf16 a[48:63], v[56:59], v[76:79], a[48:63]
    v_mfma_f32_32x32x16_bf16 a[112:127], v[60:63], v[76:79], a[112:127]
    s_waitcnt lgkmcnt(7)
    v_mfma_f32_32x32x16_bf16 a[0:15], v[32:35], v[40:43], a[0:15]
    ds_read_b128 v[56:59], v9 offset:0
    ds_read_b64_tr_b16 v[64:65], v12 offset:4096
    ds_read_b64_tr_b16 v[66:67], v12 offset:5120
    ds_read_b128 v[60:63], v9 offset:16384
    s_waitcnt lgkmcnt(10)
    v_mfma_f32_32x32x16_bf16 a[64:79], v[36:39], v[40:43], a[64:79]
    ds_read_b64_tr_b16 v[68:69], v13 offset:4096
    ds_read_b64_tr_b16 v[70:71], v13 offset:5120
    ds_read_b64_tr_b16 v[72:73], v14 offset:4096
    ds_read_b64_tr_b16 v[74:75], v14 offset:5120
    s_waitcnt lgkmcnt(12)
    v_mfma_f32_32x32x16_bf16 a[16:31], v[32:35], v[44:47], a[16:31]
    ds_read_b64_tr_b16 v[76:77], v15 offset:4096
    ds_read_b64_tr_b16 v[78:79], v15 offset:5120
    s_add_u32 m0, s54, 0
    s_add_u32 s38, s72, 896
    buffer_load_dwordx4 v26, s[56:59], s38 offen lds
    v_mfma_f32_32x32x16_bf16 a[80:95], v[36:39], v[44:47], a[80:95]
    s_add_u32 m0, s54, 1024
    s_add_u32 s38, s72, 9088
    buffer_load_dwordx4 v27, s[56:59], s38 offen lds
    s_add_u32 m0, s54, 2048
    s_add_u32 s38, s72, 17280
    buffer_load_dwordx4 v26, s[56:59], s38 offen lds
    s_waitcnt lgkmcnt(12)
    v_mfma_f32_32x32x16_bf16 a[32:47], v[32:35], v[48:51], a[32:47]
    s_add_u32 m0, s54, 3072
    s_add_u32 s38, s72, 25472
    buffer_load_dwordx4 v27, s[56:59], s38 offen lds
    v_mfma_f32_32x32x16_bf16 a[96:111], v[36:39], v[48:51], a[96:111]
    s_add_u32 m0, s54, 4096
    s_add_u32 s38, s72, 33664
    buffer_load_dwordx4 v26, s[56:59], s38 offen lds
    s_waitcnt lgkmcnt(10)
    v_mfma_f32_32x32x16_bf16 a[48:63], v[32:35], v[52:55], a[48:63]
    s_add_u32 m0, s54, 5120
    s_add_u32 s38, s72, 41856
    buffer_load_dwordx4 v27, s[56:59], s38 offen lds
    v_mfma_f32_32x32x16_bf16 a[112:127], v[36:39], v[52:55], a[112:127]
    s_add_u32 m0, s54, 6144
    s_add_u32 s38, s72, 50048
    buffer_load_dwordx4 v26, s[56:59], s38 offen lds
    s_waitcnt lgkmcnt(7)
    v_mfma_f32_32x32x16_bf16 a[0:15], v[56:59], v[64:67], a[0:15]
    ds_read_b128 v[32:35], v10 offset:0
    ds_read_b64_tr_b16 v[40:41], v12 offset:8192
    ds_read_b64_tr_b16 v[42:43], v12 offset:9216
    ds_read_b128 v[36:39], v10 offset:16384
    s_waitcnt lgkmcnt(10)
    v_mfma_f32_32x32x16_bf16 a[64:79], v[60:63], v[64:67], a[64:79]
    ds_read_b64_tr_b16 v[44:45], v13 offset:8192
    ds_read_b64_tr_b16 v[46:47], v13 offset:9216
    ds_read_b64_tr_b16 v[48:49], v14 offset:8192
    ds_read_b64_tr_b16 v[50:51], v14 offset:9216
    s_waitcnt lgkmcnt(12)
    v_mfma_f32_32x32x16_bf16 a[16:31], v[56:59], v[68:71], a[16:31]
    ds_read_b64_tr_b16 v[52:53], v15 offset:8192
    ds_read_b64_tr_b16 v[54:55], v15 offset:9216
    s_add_u32 m0, s54, 7168
    s_add_u32 s38, s72, 58240
    buffer_load_dwordx4 v27, s[56:59], s38 offen lds
    v_mfma_f32_32x32x16_bf16 a[80:95], v[60:63], v[68:71], a[80:95]
    s_add_u32 m0, s37, 32768
    s_add_u32 s38, s36, 3670016
    buffer_load_dwordx4 v4, s[64:67], s38 offen lds
    s_add_u32 m0, s37, 33792
    s_add_u32 s38, s36, 3702784
    buffer_load_dwordx4 v4, s[64:67], s38 offen lds
    s_waitcnt lgkmcnt(12)
    v_mfma_f32_32x32x16_bf16 a[32:47], v[56:59], v[72:75], a[32:47]
    s_add_u32 m0, s37, 34816
    s_add_u32 s38, s36, 3735552
    buffer_load_dwordx4 v4, s[64:67], s38 offen lds
    v_mfma_f32_32x32x16_bf16 a[96:111], v[60:63], v[72:75], a[96:111]
    s_add_u32 m0, s37, 35840
    s_add_u32 s38, s36, 3768320
    buffer_load_dwordx4 v4, s[64:67], s38 offen lds
    s_waitcnt lgkmcnt(10)
    v_mfma_f32_32x32x16_bf16 a[48:63], v[56:59], v[76:79], a[48:63]
    v_mul_f32 v200, s74, v200
    v_mul_f32 v201, s74, v201
    v_mul_f32 v202, s74, v202
    v_mul_f32 v203, s74, v203
    v_mfma_f32_32x32x16_bf16 a[112:127], v[60:63], v[76:79], a[112:127]
    v_mul_f32 v204, s74, v204
    v_mul_f32 v205, s74, v205
    v_mul_f32 v206, s74, v206
    v_mul_f32 v207, s74, v207
    s_waitcnt lgkmcnt(7)
    v_mfma_f32_32x32x16_bf16 a[0:15], v[32:35], v[40:43], a[0:15]
    ds_read_b128 v[56:59], v11 offset:0
    ds_read_b64_tr_b16 v[64:65], v12 offset:12288
    ds_read_b64_tr_b16 v[66:67], v12 offset:13312
    ds_read_b128 v[60:63], v11 offset:16384
    s_waitcnt lgkmcnt(10)
    v_mfma_f32_32x32x16_bf16 a[64:79], v[36:39], v[40:43], a[64:79]
    ds_read_b64_tr_b16 v[68:69], v13 offset:12288
    ds_read_b64_tr_b16 v[70:71], v13 offset:13312
    ds_read_b64_tr_b16 v[72:73], v14 offset:12288
    ds_read_b64_tr_b16 v[74:75], v14 offset:13312
    s_waitcnt lgkmcnt(12)
    v_mfma_f32_32x32x16_bf16 a[16:31], v[32:35], v[44:47], a[16:31]
    ds_read_b64_tr_b16 v[76:77], v15 offset:12288
    ds_read_b64_tr_b16 v[78:79], v15 offset:13312
    v_cvt_pk_bf16_f32 v100, v200, v201
    v_cvt_pk_bf16_f32 v101, v202, v203
    v_cvt_pk_bf16_f32 v102, v204, v205
    v_cvt_pk_bf16_f32 v103, v206, v207
    s_add_u32 s39, s73, 32768
    buffer_store_dwordx4 v[100:103], v1, s[20:23], s39 offen offset:1024 sc1
    v_mfma_f32_32x32x16_bf16 a[80:95], v[36:39], v[44:47], a[80:95]
    v_mul_f32 v208, s74, v208
    v_mul_f32 v209, s74, v209
    v_mul_f32 v210, s74, v210
    v_mul_f32 v211, s74, v211
    s_waitcnt lgkmcnt(12)
    v_mfma_f32_32x32x16_bf16 a[32:47], v[32:35], v[48:51], a[32:47]
    v_mul_f32 v212, s74, v212
    v_mul_f32 v213, s74, v213
    v_mul_f32 v214, s74, v214
    v_mul_f32 v215, s74, v215
    v_mfma_f32_32x32x16_bf16 a[96:111], v[36:39], v[48:51], a[96:111]
    v_cvt_pk_bf16_f32 v104, v208, v209
    v_cvt_pk_bf16_f32 v105, v210, v211
    v_cvt_pk_bf16_f32 v106, v212, v213
    v_cvt_pk_bf16_f32 v107, v214, v215
    s_add_u32 s39, s73, 32768
    buffer_store_dwordx4 v[104:107], v1, s[20:23], s39 offen offset:2048 sc1
    s_waitcnt lgkmcnt(10)
    v_mfma_f32_32x32x16_bf16 a[48:63], v[32:35], v[52:55], a[48:63]
    v_mul_f32 v216, s74, v216
    v_mul_f32 v217, s74, v217
    v_mul_f32 v218, s74, v218
    v_mul_f32 v219, s74, v219
    v_mfma_f32_32x32x16_bf16 a[112:127], v[36:39], v[52:55], a[112:127]
    s_add_u32 s80, s6, 58720256
    s_addc_u32 s81, s7, 0
    s_mov_b32 s82, 73728
    s_mov_b32 s83, 0x00020000
    buffer_store_dword v124, v125, s[80:83], 0 offen sc1
    s_waitcnt vmcnt(18) lgkmcnt(0)
    s_barrier
    v_add_u32 v8, 98304, v5
    v_add_u32 v12, 131072, v6
    v_xor_b32 v9, 32, v8
    v_xor_b32 v10, 64, v8
    v_xor_b32 v11, 96, v8
    v_xor_b32 v13, 64, v12
    v_xor_b32 v14, 128, v12
    v_xor_b32 v15, 192, v12
    s_waitcnt lgkmcnt(7)
    v_mfma_f32_32x32x16_bf16 a[0:15], v[56:59], v[64:67], a[0:15]
    ds_read_b128 v[32:35], v8 offset:0
    ds_read_b64_tr_b16 v[40:41], v12 offset:0
    s_waitcnt lgkmcnt(8)
    v_mfma_f32_32x32x16_bf16 a[64:79], v[60:63], v[64:67], a[64:79]
    ds_read_b64_tr_b16 v[42:43], v12 offset:1024
    ds_read_b128 v[36:39], v8 offset:16384
    s_waitcnt lgkmcnt(8)
    v_mfma_f32_32x32x16_bf16 a[16:31], v[56:59], v[68:71], a[16:31]
    ds_read_b64_tr_b16 v[44:45], v13 offset:0
    ds_read_b64_tr_b16 v[46:47], v13 offset:1024
    v_mfma_f32_32x32x16_bf16 a[80:95], v[60:63], v[68:71], a[80:95]
    ds_read_b64_tr_b16 v[48:49], v14 offset:0
    ds_read_b64_tr_b16 v[50:51], v14 offset:1024
    s_waitcnt lgkmcnt(10)
    v_mfma_f32_32x32x16_bf16 a[32:47], v[56:59], v[72:75], a[32:47]
    ds_read_b64_tr_b16 v[52:53], v15 offset:0
    ds_read_b64_tr_b16 v[54:55], v15 offset:1024
    v_mfma_f32_32x32x16_bf16 a[96:111], v[60:63], v[72:75], a[96:111]
    s_waitcnt lgkmcnt(10)
    v_mfma_f32_32x32x16_bf16 a[48:63], v[56:59], v[76:79], a[48:63]
    v_mfma_f32_32x32x16_bf16 a[112:127], v[60:63], v[76:79], a[112:127]
    s_waitcnt lgkmcnt(7)
    v_mfma_f32_32x32x16_bf16 a[0:15], v[32:35], v[40:43], a[0:15]
    ds_read_b128 v[56:59], v9 offset:0
    ds_read_b64_tr_b16 v[64:65], v12 offset:4096
    ds_read_b64_tr_b16 v[66:67], v12 offset:5120
    ds_read_b128 v[60:63], v9 offset:16384
    s_waitcnt lgkmcnt(10)
    v_mfma_f32_32x32x16_bf16 a[64:79], v[36:39], v[40:43], a[64:79]
    ds_read_b64_tr_b16 v[68:69], v13 offset:4096
    ds_read_b64_tr_b16 v[70:71], v13 offset:5120
    ds_read_b64_tr_b16 v[72:73], v14 offset:4096
    ds_read_b64_tr_b16 v[74:75], v14 offset:5120
    s_waitcnt lgkmcnt(12)
    v_mfma_f32_32x32x16_bf16 a[16:31], v[32:35], v[44:47], a[16:31]
    ds_read_b64_tr_b16 v[76:77], v15 offset:4096
    ds_read_b64_tr_b16 v[78:79], v15 offset:5120
    s_add_u32 m0, s54, 49152
    s_add_u32 s38, s35, 0
    buffer_load_dwordx4 v2, s[12:15], s38 offen lds
    v_mfma_f32_32x32x16_bf16 a[80:95], v[36:39], v[44:47], a[80:95]
    s_add_u32 m0, s54, 50176
    s_add_u32 s38, s35, 9216
    buffer_load_dwordx4 v3, s[12:15], s38 offen lds
    s_add_u32 m0, s54, 51200
    s_add_u32 s38, s35, 18432
    buffer_load_dwordx4 v2, s[12:15], s38 offen lds
    s_waitcnt lgkmcnt(12)
    v_mfma_f32_32x32x16_bf16 a[32:47], v[32:35], v[48:51], a[32:47]
    s_add_u32 m0, s54, 52224
    s_add_u32 s38, s35, 27648
    buffer_load_dwordx4 v3, s[12:15], s38 offen lds
    v_mfma_f32_32x32x16_bf16 a[96:111], v[36:39], v[48:51], a[96:111]
    s_add_u32 m0, s54, 53248
    s_add_u32 s38, s35, 36864
    buffer_load_dwordx4 v2, s[12:15], s38 offen lds
    s_waitcnt lgkmcnt(10)
    v_mfma_f32_32x32x16_bf16 a[48:63], v[32:35], v[52:55], a[48:63]
    s_add_u32 m0, s54, 54272
    s_add_u32 s38, s35, 46080
    buffer_load_dwordx4 v3, s[12:15], s38 offen lds
    v_mfma_f32_32x32x16_bf16 a[112:127], v[36:39], v[52:55], a[112:127]
    s_add_u32 m0, s54, 55296
    s_add_u32 s38, s35, 55296
    buffer_load_dwordx4 v2, s[12:15], s38 offen lds
    s_waitcnt lgkmcnt(7)
    v_mfma_f32_32x32x16_bf16 a[0:15], v[56:59], v[64:67], a[0:15]
    ds_read_b128 v[32:35], v10 offset:0
    ds_read_b64_tr_b16 v[40:41], v12 offset:8192
    ds_read_b64_tr_b16 v[42:43], v12 offset:9216
    ds_read_b128 v[36:39], v10 offset:16384
    s_waitcnt lgkmcnt(10)
    v_mfma_f32_32x32x16_bf16 a[64:79], v[60:63], v[64:67], a[64:79]
    ds_read_b64_tr_b16 v[44:45], v13 offset:8192
    ds_read_b64_tr_b16 v[46:47], v13 offset:9216
    ds_read_b64_tr_b16 v[48:49], v14 offset:8192
    ds_read_b64_tr_b16 v[50:51], v14 offset:9216
    s_waitcnt lgkmcnt(12)
    v_mfma_f32_32x32x16_bf16 a[16:31], v[56:59], v[68:71], a[16:31]
    ds_read_b64_tr_b16 v[52:53], v15 offset:8192
    ds_read_b64_tr_b16 v[54:55], v15 offset:9216
    s_add_u32 m0, s54, 56320
    s_add_u32 s38, s35, 64512
    buffer_load_dwordx4 v3, s[12:15], s38 offen lds
    v_mfma_f32_32x32x16_bf16 a[80:95], v[60:63], v[68:71], a[80:95]
    s_add_u32 m0, s37, 81920
    s_add_u32 s38, s36, 0
    buffer_load_dwordx4 v4, s[16:19], s38 offen lds
    s_waitcnt lgkmcnt(12)
    v_mfma_f32_32x32x16_bf16 a[32:47], v[56:59], v[72:75], a[32:47]
    s_add_u32 m0, s37, 82944
    s_add_u32 s38, s36, 32768
    buffer_load_dwordx4 v4, s[16:19], s38 offen lds
    v_mfma_f32_32x32x16_bf16 a[96:111], v[60:63], v[72:75], a[96:111]
    s_add_u32 m0, s37, 83968
    s_add_u32 s38, s36, 65536
    buffer_load_dwordx4 v4, s[16:19], s38 offen lds
    s_waitcnt lgkmcnt(10)
    v_mfma_f32_32x32x16_bf16 a[48:63], v[56:59], v[76:79], a[48:63]
    s_add_u32 m0, s37, 84992
    s_add_u32 s38, s36, 98304
    buffer_load_dwordx4 v4, s[16:19], s38 offen lds
    v_mfma_f32_32x32x16_bf16 a[112:127], v[60:63], v[76:79], a[112:127]
    v_mul_f32 v220, s74, v220
    v_mul_f32 v221, s74, v221
    v_mul_f32 v222, s74, v222
    v_mul_f32 v223, s74, v223
    s_waitcnt lgkmcnt(7)
    v_mfma_f32_32x32x16_bf16 a[0:15], v[32:35], v[40:43], a[0:15]
    ds_read_b128 v[56:59], v11 offset:0
    ds_read_b64_tr_b16 v[64:65], v12 offset:12288
    ds_read_b64_tr_b16 v[66:67], v12 offset:13312
    ds_read_b128 v[60:63], v11 offset:16384
    s_waitcnt lgkmcnt(10)
    v_mfma_f32_32x32x16_bf16 a[64:79], v[36:39], v[40:43], a[64:79]
    ds_read_b64_tr_b16 v[68:69], v13 offset:12288
    ds_read_b64_tr_b16 v[70:71], v13 offset:13312
    ds_read_b64_tr_b16 v[72:73], v14 offset:12288
    ds_read_b64_tr_b16 v[74:75], v14 offset:13312
    s_waitcnt lgkmcnt(12)
    v_mfma_f32_32x32x16_bf16 a[16:31], v[32:35], v[44:47], a[16:31]
    ds_read_b64_tr_b16 v[76:77], v15 offset:12288
    ds_read_b64_tr_b16 v[78:79], v15 offset:13312
    v_cvt_pk_bf16_f32 v108, v216, v217
    v_cvt_pk_bf16_f32 v109, v218, v219
    v_cvt_pk_bf16_f32 v110, v220, v221
    v_cvt_pk_bf16_f32 v111, v222, v223
    s_add_u32 s39, s73, 32768
    buffer_store_dwordx4 v[108:111], v1, s[20:23], s39 offen offset:3072 sc1
    v_mfma_f32_32x32x16_bf16 a[80:95], v[36:39], v[44:47], a[80:95]
    v_mul_f32 v224, s74, v224
    v_mul_f32 v225, s74, v225
    v_mul_f32 v226, s74, v226
    v_mul_f32 v227, s74, v227
    s_waitcnt lgkmcnt(12)
    v_mfma_f32_32x32x16_bf16 a[32:47], v[32:35], v[48:51], a[32:47]
    v_mul_f32 v228, s74, v228
    v_mul_f32 v229, s74, v229
    v_mul_f32 v230, s74, v230
    v_mul_f32 v231, s74, v231
    v_mfma_f32_32x32x16_bf16 a[96:111], v[36:39], v[48:51], a[96:111]
    v_cvt_pk_bf16_f32 v96, v224, v225
    v_cvt_pk_bf16_f32 v97, v226, v227
    v_cvt_pk_bf16_f32 v98, v228, v229
    v_cvt_pk_bf16_f32 v99, v230, v231
    s_add_u32 s39, s73, 36864
    buffer_store_dwordx4 v[96:99], v1, s[20:23], s39 offen offset:0 sc1
    s_waitcnt lgkmcnt(10)
    v_mfma_f32_32x32x16_bf16 a[48:63], v[32:35], v[52:55], a[48:63]
    v_mul_f32 v232, s74, v232
    v_mul_f32 v233, s74, v233
    v_mul_f32 v234, s74, v234
    v_mul_f32 v235, s74, v235
    v_mfma_f32_32x32x16_bf16 a[112:127], v[36:39], v[52:55], a[112:127]
    v_mul_f32 v236, s74, v236
    v_mul_f32 v237, s74, v237
    v_mul_f32 v238, s74, v238
    v_mul_f32 v239, s74, v239
    s_waitcnt vmcnt(17) lgkmcnt(0)
    s_barrier
    v_add_u32 v8, 0, v5
    v_add_u32 v12, 32768, v6
    v_xor_b32 v9, 32, v8
    v_xor_b32 v10, 64, v8
    v_xor_b32 v11, 96, v8
    v_xor_b32 v13, 64, v12
    v_xor_b32 v14, 128, v12
    v_xor_b32 v15, 192, v12
    s_waitcnt lgkmcnt(7)
    v_mfma_f32_32x32x16_bf16 a[0:15], v[56:59], v[64:67], a[0:15]
    ds_read_b128 v[32:35], v8 offset:0
    ds_read_b64_tr_b16 v[40:41], v12 offset:0
    s_waitcnt lgkmcnt(8)
    v_mfma_f32_32x32x16_bf16 a[64:79], v[60:63], v[64:67], a[64:79]
    ds_read_b64_tr_b16 v[42:43], v12 offset:1024
    ds_read_b128 v[36:39], v8 offset:16384
    s_waitcnt lgkmcnt(8)
    v_mfma_f32_32x32x16_bf16 a[16:31], v[56:59], v[68:71], a[16:31]
    ds_read_b64_tr_b16 v[44:45], v13 offset:0
    ds_read_b64_tr_b16 v[46:47], v13 offset:1024
    v_mfma_f32_32x32x16_bf16 a[80:95], v[60:63], v[68:71], a[80:95]
    ds_read_b64_tr_b16 v[48:49], v14 offset:0
    ds_read_b64_tr_b16 v[50:51], v14 offset:1024
    s_waitcnt lgkmcnt(10)
    v_mfma_f32_32x32x16_bf16 a[32:47], v[56:59], v[72:75], a[32:47]
    ds_read_b64_tr_b16 v[52:53], v15 offset:0
    ds_read_b64_tr_b16 v[54:55], v15 offset:1024
    v_mfma_f32_32x32x16_bf16 a[96:111], v[60:63], v[72:75], a[96:111]
    s_waitcnt lgkmcnt(10)
    v_mfma_f32_32x32x16_bf16 a[48:63], v[56:59], v[76:79], a[48:63]
    v_mfma_f32_32x32x16_bf16 a[112:127], v[60:63], v[76:79], a[112:127]
    s_waitcnt lgkmcnt(7)
    v_mfma_f32_32x32x16_bf16 a[0:15], v[32:35], v[40:43], a[0:15]
    ds_read_b128 v[56:59], v9 offset:0
    ds_read_b64_tr_b16 v[64:65], v12 offset:4096
    ds_read_b64_tr_b16 v[66:67], v12 offset:5120
    ds_read_b128 v[60:63], v9 offset:16384
    s_waitcnt lgkmcnt(10)
    v_mfma_f32_32x32x16_bf16 a[64:79], v[36:39], v[40:43], a[64:79]
    ds_read_b64_tr_b16 v[68:69], v13 offset:4096
    ds_read_b64_tr_b16 v[70:71], v13 offset:5120
    ds_read_b64_tr_b16 v[72:73], v14 offset:4096
    ds_read_b64_tr_b16 v[74:75], v14 offset:5120
    s_waitcnt lgkmcnt(12)
    v_mfma_f32_32x32x16_bf16 a[16:31], v[32:35], v[44:47], a[16:31]
    ds_read_b64_tr_b16 v[76:77], v15 offset:4096
    ds_read_b64_tr_b16 v[78:79], v15 offset:5120
    s_add_u32 m0, s54, 98304
    s_add_u32 s38, s35, 128
    buffer_load_dwordx4 v2, s[12:15], s38 offen lds
    v_mfma_f32_32x32x16_bf16 a[80:95], v[36:39], v[44:47], a[80:95]
    s_add_u32 m0, s54, 99328
    s_add_u32 s38, s35, 9344
    buffer_load_dwordx4 v3, s[12:15], s38 offen lds
    s_add_u32 m0, s54, 100352
    s_add_u32 s38, s35, 18560
    buffer_load_dwordx4 v2, s[12:15], s38 offen lds
    s_waitcnt lgkmcnt(12)
    v_mfma_f32_32x32x16_bf16 a[32:47], v[32:35], v[48:51], a[32:47]
    s_add_u32 m0, s54, 101376
    s_add_u32 s38, s35, 27776
    buffer_load_dwordx4 v3, s[12:15], s38 offen lds
    v_mfma_f32_32x32x16_bf16 a[96:111], v[36:39], v[48:51], a[96:111]
    s_add_u32 m0, s54, 102400
    s_add_u32 s38, s35, 36992
    buffer_load_dwordx4 v2, s[12:15], s38 offen lds
    s_waitcnt lgkmcnt(10)
    v_mfma_f32_32x32x16_bf16 a[48:63], v[32:35], v[52:55], a[48:63]
    s_add_u32 m0, s54, 103424
    s_add_u32 s38, s35, 46208
    buffer_load_dwordx4 v3, s[12:15], s38 offen lds
    v_mfma_f32_32x32x16_bf16 a[112:127], v[36:39], v[52:55], a[112:127]
    s_add_u32 m0, s54, 104448
    s_add_u32 s38, s35, 55424
    buffer_load_dwordx4 v2, s[12:15], s38 offen lds
    s_waitcnt lgkmcnt(7)
    v_mfma_f32_32x32x16_bf16 a[0:15], v[56:59], v[64:67], a[0:15]
    ds_read_b128 v[32:35], v10 offset:0
    ds_read_b64_tr_b16 v[40:41], v12 offset:8192
    ds_read_b64_tr_b16 v[42:43], v12 offset:9216
    ds_read_b128 v[36:39], v10 offset:16384
    s_waitcnt lgkmcnt(10)
    v_mfma_f32_32x32x16_bf16 a[64:79], v[60:63], v[64:67], a[64:79]
    ds_read_b64_tr_b16 v[44:45], v13 offset:8192
    ds_read_b64_tr_b16 v[46:47], v13 offset:9216
    ds_read_b64_tr_b16 v[48:49], v14 offset:8192
    ds_read_b64_tr_b16 v[50:51], v14 offset:9216
    s_waitcnt lgkmcnt(12)
    v_mfma_f32_32x32x16_bf16 a[16:31], v[56:59], v[68:71], a[16:31]
    ds_read_b64_tr_b16 v[52:53], v15 offset:8192
    ds_read_b64_tr_b16 v[54:55], v15 offset:9216
    s_add_u32 m0, s54, 105472
    s_add_u32 s38, s35, 64640
    buffer_load_dwordx4 v3, s[12:15], s38 offen lds
    v_mfma_f32_32x32x16_bf16 a[80:95], v[60:63], v[68:71], a[80:95]
    s_add_u32 m0, s37, 131072
    s_add_u32 s38, s36, 524288
    buffer_load_dwordx4 v4, s[16:19], s38 offen lds
    s_waitcnt lgkmcnt(12)
    v_mfma_f32_32x32x16_bf16 a[32:47], v[56:59], v[72:75], a[32:47]
    s_add_u32 m0, s37, 132096
    s_add_u32 s38, s36, 557056
    buffer_load_dwordx4 v4, s[16:19], s38 offen lds
    v_mfma_f32_32x32x16_bf16 a[96:111], v[60:63], v[72:75], a[96:111]
    s_add_u32 m0, s37, 133120
    s_add_u32 s38, s36, 589824
    buffer_load_dwordx4 v4, s[16:19], s38 offen lds
    s_waitcnt lgkmcnt(10)
    v_mfma_f32_32x32x16_bf16 a[48:63], v[56:59], v[76:79], a[48:63]
    s_add_u32 m0, s37, 134144
    s_add_u32 s38, s36, 622592
    buffer_load_dwordx4 v4, s[16:19], s38 offen lds
    v_mfma_f32_32x32x16_bf16 a[112:127], v[60:63], v[76:79], a[112:127]
    v_cvt_pk_bf16_f32 v100, v232, v233
    v_cvt_pk_bf16_f32 v101, v234, v235
    v_cvt_pk_bf16_f32 v102, v236, v237
    v_cvt_pk_bf16_f32 v103, v238, v239
    s_add_u32 s39, s73, 36864
    buffer_store_dwordx4 v[100:103], v1, s[20:23], s39 offen offset:1024 sc1
    s_waitcnt lgkmcnt(7)
    v_mfma_f32_32x32x16_bf16 a[0:15], v[32:35], v[40:43], a[0:15]
    ds_read_b128 v[56:59], v11 offset:0
    ds_read_b64_tr_b16 v[64:65], v12 offset:12288
    ds_read_b64_tr_b16 v[66:67], v12 offset:13312
    ds_read_b128 v[60:63], v11 offset:16384
    s_waitcnt lgkmcnt(10)
    v_mfma_f32_32x32x16_bf16 a[64:79], v[36:39], v[40:43], a[64:79]
    ds_read_b64_tr_b16 v[68:69], v13 offset:12288
    ds_read_b64_tr_b16 v[70:71], v13 offset:13312
    ds_read_b64_tr_b16 v[72:73], v14 offset:12288
    ds_read_b64_tr_b16 v[74:75], v14 offset:13312
    s_waitcnt lgkmcnt(12)
    v_mfma_f32_32x32x16_bf16 a[16:31], v[32:35], v[44:47], a[16:31]
    ds_read_b64_tr_b16 v[76:77], v15 offset:12288
    ds_read_b64_tr_b16 v[78:79], v15 offset:13312
    v_mul_f32 v240, s74, v240
    v_mul_f32 v241, s74, v241
    v_mul_f32 v242, s74, v242
    v_mul_f32 v243, s74, v243
    v_mfma_f32_32x32x16_bf16 a[80:95], v[36:39], v[44:47], a[80:95]
    v_mul_f32 v244, s74, v244
    v_mul_f32 v245, s74, v245
    v_mul_f32 v246, s74, v246
    v_mul_f32 v247, s74, v247
    s_waitcnt lgkmcnt(12)
    v_mfma_f32_32x32x16_bf16 a[32:47], v[32:35], v[48:51], a[32:47]
    v_cvt_pk_bf16_f32 v104, v240, v241
    v_cvt_pk_bf16_f32 v105, v242, v243
    v_cvt_pk_bf16_f32 v106, v244, v245
    v_cvt_pk_bf16_f32 v107, v246, v247
    s_add_u32 s39, s73, 36864
    buffer_store_dwordx4 v[104:107], v1, s[20:23], s39 offen offset:2048 sc1
    v_mfma_f32_32x32x16_bf16 a[96:111], v[36:39], v[48:51], a[96:111]
    v_mul_f32 v248, s74, v248
    v_mul_f32 v249, s74, v249
    v_mul_f32 v250, s74, v250
    v_mul_f32 v251, s74, v251
    s_waitcnt lgkmcnt(10)
    v_mfma_f32_32x32x16_bf16 a[48:63], v[32:35], v[52:55], a[48:63]
    v_mul_f32 v252, s74, v252
    v_mul_f32 v253, s74, v253
    v_mul_f32 v254, s74, v254
    v_mul_f32 v255, s74, v255
    v_mfma_f32_32x32x16_bf16 a[112:127], v[36:39], v[52:55], a[112:127]
    v_cvt_pk_bf16_f32 v108, v248, v249
    v_cvt_pk_bf16_f32 v109, v250, v251
    v_cvt_pk_bf16_f32 v110, v252, v253
    v_cvt_pk_bf16_f32 v111, v254, v255
    s_add_u32 s39, s73, 36864
    buffer_store_dwordx4 v[108:111], v1, s[20:23], s39 offen offset:3072 sc1
    s_waitcnt vmcnt(17) lgkmcnt(0)
    s_barrier
    v_add_u32 v8, 49152, v5
    v_add_u32 v12, 81920, v6
    v_xor_b32 v9, 32, v8
    v_xor_b32 v10, 64, v8
    v_xor_b32 v11, 96, v8
    v_xor_b32 v13, 64, v12
    v_xor_b32 v14, 128, v12
    v_xor_b32 v15, 192, v12
    s_waitcnt lgkmcnt(7)
    v_mfma_f32_32x32x16_bf16 a[0:15], v[56:59], v[64:67], a[0:15]
    ds_read_b128 v[32:35], v8 offset:0
    ds_read_b64_tr_b16 v[40:41], v12 offset:0
    s_waitcnt lgkmcnt(8)
    v_mfma_f32_32x32x16_bf16 a[64:79], v[60:63], v[64:67], a[64:79]
    ds_read_b64_tr_b16 v[42:43], v12 offset:1024
    ds_read_b128 v[36:39], v8 offset:16384
    s_waitcnt lgkmcnt(8)
    v_mfma_f32_32x32x16_bf16 a[16:31], v[56:59], v[68:71], a[16:31]
    ds_read_b64_tr_b16 v[44:45], v13 offset:0
    ds_read_b64_tr_b16 v[46:47], v13 offset:1024
    v_mfma_f32_32x32x16_bf16 a[80:95], v[60:63], v[68:71], a[80:95]
    ds_read_b64_tr_b16 v[48:49], v14 offset:0
    ds_read_b64_tr_b16 v[50:51], v14 offset:1024
    s_waitcnt lgkmcnt(10)
    v_mfma_f32_32x32x16_bf16 a[32:47], v[56:59], v[72:75], a[32:47]
    ds_read_b64_tr_b16 v[52:53], v15 offset:0
    ds_read_b64_tr_b16 v[54:55], v15 offset:1024
    v_mfma_f32_32x32x16_bf16 a[96:111], v[60:63], v[72:75], a[96:111]
    s_waitcnt lgkmcnt(10)
    v_mfma_f32_32x32x16_bf16 a[48:63], v[56:59], v[76:79], a[48:63]
    v_mfma_f32_32x32x16_bf16 a[112:127], v[60:63], v[76:79], a[112:127]
    s_waitcnt lgkmcnt(7)
    v_mfma_f32_32x32x16_bf16 v[128:143], v[40:43], v[32:35], 0
    ds_read_b128 v[56:59], v9 offset:0
    ds_read_b64_tr_b16 v[64:65], v12 offset:4096
    ds_read_b64_tr_b16 v[66:67], v12 offset:5120
    ds_read_b128 v[60:63], v9 offset:16384
    s_waitcnt lgkmcnt(10)
    v_mfma_f32_32x32x16_bf16 v[192:207], v[40:43], v[36:39], 0
    ds_read_b64_tr_b16 v[68:69], v13 offset:4096
    ds_read_b64_tr_b16 v[70:71], v13 offset:5120
    s_waitcnt lgkmcnt(10)
    v_mfma_f32_32x32x16_bf16 v[144:159], v[44:47], v[32:35], 0
    ds_read_b64_tr_b16 v[72:73], v14 offset:4096
    ds_read_b64_tr_b16 v[74:75], v14 offset:5120
    v_mfma_f32_32x32x16_bf16 v[208:223], v[44:47], v[36:39], 0
    ds_read_b64_tr_b16 v[76:77], v15 offset:4096
    ds_read_b64_tr_b16 v[78:79], v15 offset:5120
    s_waitcnt lgkmcnt(12)
    v_mfma_f32_32x32x16_bf16 v[160:175], v[48:51], v[32:35], 0
    s_add_u32 m0, s54, 0
    s_add_u32 s38, s35, 256
    buffer_load_dwordx4 v2, s[12:15], s38 offen lds
    v_mfma_f32_32x32x16_bf16 v[224:239], v[48:51], v[36:39], 0
    s_add_u32 m0, s54, 1024
    s_add_u32 s38, s35, 9472
    buffer_load_dwordx4 v3, s[12:15], s38 offen lds
    s_waitcnt lgkmcnt(10)
    v_mfma_f32_32x32x16_bf16 v[176:191], v[52:55], v[32:35], 0
    s_add_u32 m0, s54, 2048
    s_add_u32 s38, s35, 18688
    buffer_load_dwordx4 v2, s[12:15], s38 offen lds
    v_mfma_f32_32x32x16_bf16 v[240:255], v[52:55], v[36:39], 0
    s_add_u32 m0, s54, 3072
    s_add_u32 s38, s35, 27904
    buffer_load_dwordx4 v3, s[12:15], s38 offen lds
    s_waitcnt lgkmcnt(7)
    v_mfma_f32_32x32x16_bf16 v[128:143], v[64:67], v[56:59], v[128:143]
    ds_read_b128 v[32:35], v10 offset:0
    ds_read_b64_tr_b16 v[40:41], v12 offset:8192
    ds_read_b64_tr_b16 v[42:43], v12 offset:9216
    ds_read_b128 v[36:39], v10 offset:16384
    s_waitcnt lgkmcnt(10)
    v_mfma_f32_32x32x16_bf16 v[192:207], v[64:67], v[60:63], v[192:207]
    ds_read_b64_tr_b16 v[44:45], v13 offset:8192
    ds_read_b64_tr_b16 v[46:47], v13 offset:9216
    s_waitcnt lgkmcnt(10)
    v_mfma_f32_32x32x16_bf16 v[144:159], v[68:71], v[56:59], v[144:159]
    ds_read_b64_tr_b16 v[48:49], v14 offset:8192
    ds_read_b64_tr_b16 v[50:51], v14 offset:9216
    v_mfma_f32_32x32x16_bf16 v[208:223], v[68:71], v[60:63], v[208:223]
    ds_read_b64_tr_b16 v[52:53], v15 offset:8192
    ds_read_b64_tr_b16 v[54:55], v15 offset:9216
    s_waitcnt lgkmcnt(12)
    v_mfma_f32_32x32x16_bf16 v[160:175], v[72:75], v[56:59], v[160:175]
    s_add_u32 m0, s54, 4096
    s_add_u32 s38, s35, 37120
    buffer_load_dwordx4 v2, s[12:15], s38 offen lds
    v_mfma_f32_32x32x16_bf16 v[224:239], v[72:75], v[60:63], v[224:239]
    s_add_u32 m0, s54, 5120
    s_add_u32 s38, s35, 46336
    buffer_load_dwordx4 v3, s[12:15], s38 offen lds
    s_waitcnt lgkmcnt(10)
    v_mfma_f32_32x32x16_bf16 v[176:191], v[76:79], v[56:59], v[176:191]
    s_add_u32 m0, s54, 6144
    s_add_u32 s38, s35, 55552
    buffer_load_dwordx4 v2, s[12:15], s38 offen lds
    v_mfma_f32_32x32x16_bf16 v[240:255], v[76:79], v[60:63], v[240:255]
    s_add_u32 m0, s54, 7168
    s_add_u32 s38, s35, 64768
    buffer_load_dwordx4 v3, s[12:15], s38 offen lds
    s_waitcnt lgkmcnt(7)
    v_mfma_f32_32x32x16_bf16 v[128:143], v[40:43], v[32:35], v[128:143]
    ds_read_b128 v[56:59], v11 offset:0
    ds_read_b64_tr_b16 v[64:65], v12 offset:12288
    ds_read_b64_tr_b16 v[66:67], v12 offset:13312
    ds_read_b128 v[60:63], v11 offset:16384
    s_waitcnt lgkmcnt(10)
    v_mfma_f32_32x32x16_bf16 v[192:207], v[40:43], v[36:39], v[192:207]
    ds_read_b64_tr_b16 v[68:69], v13 offset:12288
    ds_read_b64_tr_b16 v[70:71], v13 offset:13312
    s_waitcnt lgkmcnt(10)
    v_mfma_f32_32x32x16_bf16 v[144:159], v[44:47], v[32:35], v[144:159]
    ds_read_b64_tr_b16 v[72:73], v14 offset:12288
    ds_read_b64_tr_b16 v[74:75], v14 offset:13312
    v_mfma_f32_32x32x16_bf16 v[208:223], v[44:47], v[36:39], v[208:223]
    ds_read_b64_tr_b16 v[76:77], v15 offset:12288
    ds_read_b64_tr_b16 v[78:79], v15 offset:13312
    s_waitcnt lgkmcnt(12)
    v_mfma_f32_32x32x16_bf16 v[160:175], v[48:51], v[32:35], v[160:175]
    s_add_u32 m0, s37, 32768
    s_add_u32 s38, s36, 1048576
    buffer_load_dwordx4 v4, s[16:19], s38 offen lds
    v_mfma_f32_32x32x16_bf16 v[224:239], v[48:51], v[36:39], v[224:239]
    s_add_u32 m0, s37, 33792
    s_add_u32 s38, s36, 1081344
    buffer_load_dwordx4 v4, s[16:19], s38 offen lds
    s_waitcnt lgkmcnt(10)
    v_mfma_f32_32x32x16_bf16 v[176:191], v[52:55], v[32:35], v[176:191]
    s_add_u32 m0, s37, 34816
    s_add_u32 s38, s36, 1114112
    buffer_load_dwordx4 v4, s[16:19], s38 offen lds
    v_mfma_f32_32x32x16_bf16 v[240:255], v[52:55], v[36:39], v[240:255]
    s_add_u32 m0, s37, 35840
    s_add_u32 s38, s36, 1146880
    buffer_load_dwordx4 v4, s[16:19], s38 offen lds
    s_waitcnt vmcnt(15) lgkmcnt(0)
    s_barrier
    v_add_u32 v8, 98304, v5
    v_add_u32 v12, 131072, v6
    v_xor_b32 v9, 32, v8
    v_xor_b32 v10, 64, v8
    v_xor_b32 v11, 96, v8
    v_xor_b32 v13, 64, v12
    v_xor_b32 v14, 128, v12
    v_xor_b32 v15, 192, v12
    s_waitcnt lgkmcnt(7)
    v_mfma_f32_32x32x16_bf16 v[128:143], v[64:67], v[56:59], v[128:143]
    ds_read_b128 v[32:35], v8 offset:0
    ds_read_b64_tr_b16 v[40:41], v12 offset:0
    s_waitcnt lgkmcnt(8)
    v_mfma_f32_32x32x16_bf16 v[192:207], v[64:67], v[60:63], v[192:207]
    ds_read_b64_tr_b16 v[42:43], v12 offset:1024
    ds_read_b128 v[36:39], v8 offset:16384
    s_waitcnt lgkmcnt(8)
    v_mfma_f32_32x32x16_bf16 v[144:159], v[68:71], v[56:59], v[144:159]
    ds_read_b64_tr_b16 v[44:45], v13 offset:0
    ds_read_b64_tr_b16 v[46:47], v13 offset:1024
    v_mfma_f32_32x32x16_bf16 v[208:223], v[68:71], v[60:63], v[208:223]
    ds_read_b64_tr_b16 v[48:49], v14 offset:0
    ds_read_b64_tr_b16 v[50:51], v14 offset:1024
    s_waitcnt lgkmcnt(10)
    v_mfma_f32_32x32x16_bf16 v[160:175], v[72:75], v[56:59], v[160:175]
    ds_read_b64_tr_b16 v[52:53], v15 offset:0
    ds_read_b64_tr_b16 v[54:55], v15 offset:1024
    v_mfma_f32_32x32x16_bf16 v[224:239], v[72:75], v[60:63], v[224:239]
    s_waitcnt lgkmcnt(10)
    v_mfma_f32_32x32x16_bf16 v[176:191], v[76:79], v[56:59], v[176:191]
    v_mfma_f32_32x32x16_bf16 v[240:255], v[76:79], v[60:63], v[240:255]
    s_waitcnt lgkmcnt(7)
    v_mfma_f32_32x32x16_bf16 v[128:143], v[40:43], v[32:35], v[128:143]
    ds_read_b128 v[56:59], v9 offset:0
    ds_read_b64_tr_b16 v[64:65], v12 offset:4096
    ds_read_b64_tr_b16 v[66:67], v12 offset:5120
    ds_read_b128 v[60:63], v9 offset:16384
    s_waitcnt lgkmcnt(10)
    v_mfma_f32_32x32x16_bf16 v[192:207], v[40:43], v[36:39], v[192:207]
    ds_read_b64_tr_b16 v[68:69], v13 offset:4096
    ds_read_b64_tr_b16 v[70:71], v13 offset:5120
    ds_read_b64_tr_b16 v[72:73], v14 offset:4096
    ds_read_b64_tr_b16 v[74:75], v14 offset:5120
    s_waitcnt lgkmcnt(12)
    v_mfma_f32_32x32x16_bf16 v[144:159], v[44:47], v[32:35], v[144:159]
    ds_read_b64_tr_b16 v[76:77], v15 offset:4096
    ds_read_b64_tr_b16 v[78:79], v15 offset:5120
    s_add_u32 m0, s54, 49152
    s_add_u32 s38, s35, 384
    buffer_load_dwordx4 v2, s[12:15], s38 offen lds
    v_mfma_f32_32x32x16_bf16 v[208:223], v[44:47], v[36:39], v[208:223]
    s_add_u32 m0, s54, 50176
    s_add_u32 s38, s35, 9600
    buffer_load_dwordx4 v3, s[12:15], s38 offen lds
    s_add_u32 m0, s54, 51200
    s_add_u32 s38, s35, 18816
    buffer_load_dwordx4 v2, s[12:15], s38 offen lds
    s_waitcnt lgkmcnt(12)
    v_mfma_f32_32x32x16_bf16 v[160:175], v[48:51], v[32:35], v[160:175]
    s_add_u32 m0, s54, 52224
    s_add_u32 s38, s35, 28032
    buffer_load_dwordx4 v3, s[12:15], s38 offen lds
    s_add_u32 m0, s54, 53248
    s_add_u32 s38, s35, 37248
    buffer_load_dwordx4 v2, s[12:15], s38 offen lds
    v_mfma_f32_32x32x16_bf16 v[224:239], v[48:51], v[36:39], v[224:239]
    s_add_u32 m0, s54, 54272
    s_add_u32 s38, s35, 46464
    buffer_load_dwordx4 v3, s[12:15], s38 offen lds
    s_add_u32 m0, s54, 55296
    s_add_u32 s38, s35, 55680
    buffer_load_dwordx4 v2, s[12:15], s38 offen lds
    s_waitcnt lgkmcnt(10)
    v_mfma_f32_32x32x16_bf16 v[176:191], v[52:55], v[32:35], v[176:191]
    s_add_u32 m0, s54, 56320
    s_add_u32 s38, s35, 64896
    buffer_load_dwordx4 v3, s[12:15], s38 offen lds
    s_add_u32 m0, s37, 81920
    s_add_u32 s38, s36, 1572864
    buffer_load_dwordx4 v4, s[16:19], s38 offen lds
    v_mfma_f32_32x32x16_bf16 v[240:255], v[52:55], v[36:39], v[240:255]
    s_add_u32 m0, s37, 82944
    s_add_u32 s38, s36, 1605632
    buffer_load_dwordx4 v4, s[16:19], s38 offen lds
    s_waitcnt lgkmcnt(7)
    v_mfma_f32_32x32x16_bf16 v[128:143], v[64:67], v[56:59], v[128:143]
    ds_read_b128 v[32:35], v10 offset:0
    ds_read_b64_tr_b16 v[40:41], v12 offset:8192
    ds_read_b64_tr_b16 v[42:43], v12 offset:9216
    ds_read_b128 v[36:39], v10 offset:16384
    s_waitcnt lgkmcnt(10)
    v_mfma_f32_32x32x16_bf16 v[192:207], v[64:67], v[60:63], v[192:207]
    ds_read_b64_tr_b16 v[44:45], v13 offset:8192
    ds_read_b64_tr_b16 v[46:47], v13 offset:9216
    ds_read_b64_tr_b16 v[48:49], v14 offset:8192
    ds_read_b64_tr_b16 v[50:51], v14 offset:9216
    s_waitcnt lgkmcnt(12)
    v_mfma_f32_32x32x16_bf16 v[144:159], v[68:71], v[56:59], v[144:159]
    ds_read_b64_tr_b16 v[52:53], v15 offset:8192
    ds_read_b64_tr_b16 v[54:55], v15 offset:9216
    s_add_u32 m0, s37, 83968
    s_add_u32 s38, s36, 1638400
    buffer_load_dwordx4 v4, s[16:19], s38 offen lds
    v_mfma_f32_32x32x16_bf16 v[208:223], v[68:71], v[60:63], v[208:223]
    s_add_u32 m0, s37, 84992
    s_add_u32 s38, s36, 1671168
    buffer_load_dwordx4 v4, s[16:19], s38 offen lds
    v_accvgpr_read_b32 v80, a0
    v_accvgpr_read_b32 v81, a1
    v_accvgpr_read_b32 v82, a2
    v_accvgpr_read_b32 v83, a3
    s_waitcnt lgkmcnt(12)
    v_mfma_f32_32x32x16_bf16 v[160:175], v[72:75], v[56:59], v[160:175]
    v_accvgpr_read_b32 v84, a4
    v_accvgpr_read_b32 v85, a5
    v_accvgpr_read_b32 v86, a6
    v_accvgpr_read_b32 v87, a7
    v_cvt_pk_bf16_f32 v96, v80, v81
    v_cvt_pk_bf16_f32 v97, v82, v83
    v_cvt_pk_bf16_f32 v98, v84, v85
    v_cvt_pk_bf16_f32 v99, v86, v87
    s_add_u32 s39, s73, 0
    buffer_store_dwordx4 v[96:99], v1, s[24:27], s39 offen offset:0 sc1
    v_mfma_f32_32x32x16_bf16 v[224:239], v[72:75], v[60:63], v[224:239]
    v_accvgpr_read_b32 v88, a8
    v_accvgpr_read_b32 v89, a9
    v_accvgpr_read_b32 v90, a10
    v_accvgpr_read_b32 v91, a11
    v_accvgpr_read_b32 v92, a12
    v_accvgpr_read_b32 v93, a13
    v_accvgpr_read_b32 v94, a14
    v_accvgpr_read_b32 v95, a15
    s_waitcnt lgkmcnt(10)
    v_mfma_f32_32x32x16_bf16 v[176:191], v[76:79], v[56:59], v[176:191]
    v_cvt_pk_bf16_f32 v100, v88, v89
    v_cvt_pk_bf16_f32 v101, v90, v91
    v_cvt_pk_bf16_f32 v102, v92, v93
    v_cvt_pk_bf16_f32 v103, v94, v95
    s_add_u32 s39, s73, 4096
    buffer_store_dwordx4 v[100:103], v1, s[24:27], s39 offen offset:0 sc1
    v_mfma_f32_32x32x16_bf16 v[240:255], v[76:79], v[60:63], v[240:255]
    v_accvgpr_read_b32 v80, a16
    v_accvgpr_read_b32 v81, a17
    v_accvgpr_read_b32 v82, a18
    v_accvgpr_read_b32 v83, a19
    s_waitcnt lgkmcnt(7)
    v_mfma_f32_32x32x16_bf16 v[128:143], v[40:43], v[32:35], v[128:143]
    ds_read_b128 v[56:59], v11 offset:0
    ds_read_b64_tr_b16 v[64:65], v12 offset:12288
    ds_read_b64_tr_b16 v[66:67], v12 offset:13312
    ds_read_b128 v[60:63], v11 offset:16384
    s_waitcnt lgkmcnt(10)
    v_mfma_f32_32x32x16_bf16 v[192:207], v[40:43], v[36:39], v[192:207]
    ds_read_b64_tr_b16 v[68:69], v13 offset:12288
    ds_read_b64_tr_b16 v[70:71], v13 offset:13312
    ds_read_b64_tr_b16 v[72:73], v14 offset:12288
    ds_read_b64_tr_b16 v[74:75], v14 offset:13312
    s_waitcnt lgkmcnt(12)
    v_mfma_f32_32x32x16_bf16 v[144:159], v[44:47], v[32:35], v[144:159]
    ds_read_b64_tr_b16 v[76:77], v15 offset:12288
    ds_read_b64_tr_b16 v[78:79], v15 offset:13312
    v_accvgpr_read_b32 v84, a20
    v_accvgpr_read_b32 v85, a21
    v_accvgpr_read_b32 v86, a22
    v_accvgpr_read_b32 v87, a23
    v_mfma_f32_32x32x16_bf16 v[208:223], v[44:47], v[36:39], v[208:223]
    v_cvt_pk_bf16_f32 v104, v80, v81
    v_cvt_pk_bf16_f32 v105, v82, v83
    v_cvt_pk_bf16_f32 v106, v84, v85
    v_cvt_pk_bf16_f32 v107, v86, v87
    s_add_u32 s39, s73, 0
    buffer_store_dwordx4 v[104:107], v1, s[24:27], s39 offen offset:1024 sc1
    v_accvgpr_read_b32 v88, a24
    v_accvgpr_read_b32 v89, a25
    v_accvgpr_read_b32 v90, a26
    v_accvgpr_read_b32 v91, a27
    s_waitcnt lgkmcnt(12)
    v_mfma_f32_32x32x16_bf16 v[160:175], v[48:51], v[32:35], v[160:175]
    v_accvgpr_read_b32 v92, a28
    v_accvgpr_read_b32 v93, a29
    v_accvgpr_read_b32 v94, a30
    v_accvgpr_read_b32 v95, a31
    v_cvt_pk_bf16_f32 v108, v88, v89
    v_cvt_pk_bf16_f32 v109, v90, v91
    v_cvt_pk_bf16_f32 v110, v92, v93
    v_cvt_pk_bf16_f32 v111, v94, v95
    s_add_u32 s39, s73, 4096
    buffer_store_dwordx4 v[108:111], v1, s[24:27], s39 offen offset:1024 sc1
    v_mfma_f32_32x32x16_bf16 v[224:239], v[48:51], v[36:39], v[224:239]
    v_accvgpr_read_b32 v80, a32
    v_accvgpr_read_b32 v81, a33
    v_accvgpr_read_b32 v82, a34
    v_accvgpr_read_b32 v83, a35
    v_accvgpr_read_b32 v84, a36
    v_accvgpr_read_b32 v85, a37
    v_accvgpr_read_b32 v86, a38
    v_accvgpr_read_b32 v87, a39
    s_waitcnt lgkmcnt(10)
    v_mfma_f32_32x32x16_bf16 v[176:191], v[52:55], v[32:35], v[176:191]
    v_cvt_pk_bf16_f32 v96, v80, v81
    v_cvt_pk_bf16_f32 v97, v82, v83
    v_cvt_pk_bf16_f32 v98, v84, v85
    v_cvt_pk_bf16_f32 v99, v86, v87
    s_add_u32 s39, s73, 0
    buffer_store_dwordx4 v[96:99], v1, s[24:27], s39 offen offset:2048 sc1
    v_mfma_f32_32x32x16_bf16 v[240:255], v[52:55], v[36:39], v[240:255]
    v_accvgpr_read_b32 v88, a40
    v_accvgpr_read_b32 v89, a41
    v_accvgpr_read_b32 v90, a42
    v_accvgpr_read_b32 v91, a43
    s_waitcnt vmcnt(17) lgkmcnt(0)
    s_barrier
    v_add_u32 v8, 0, v5
    v_add_u32 v12, 32768, v6
    v_xor_b32 v9, 32, v8
    v_xor_b32 v10, 64, v8
    v_xor_b32 v11, 96, v8
    v_xor_b32 v13, 64, v12
    v_xor_b32 v14, 128, v12
    v_xor_b32 v15, 192, v12
    s_waitcnt lgkmcnt(7)
    v_mfma_f32_32x32x16_bf16 v[128:143], v[64:67], v[56:59], v[128:143]
    ds_read_b128 v[32:35], v8 offset:0
    ds_read_b64_tr_b16 v[40:41], v12 offset:0
    s_waitcnt lgkmcnt(8)
    v_mfma_f32_32x32x16_bf16 v[192:207], v[64:67], v[60:63], v[192:207]
    ds_read_b64_tr_b16 v[42:43], v12 offset:1024
    ds_read_b128 v[36:39], v8 offset:16384
    s_waitcnt lgkmcnt(8)
    v_mfma_f32_32x32x16_bf16 v[144:159], v[68:71], v[56:59], v[144:159]
    ds_read_b64_tr_b16 v[44:45], v13 offset:0
    ds_read_b64_tr_b16 v[46:47], v13 offset:1024
    v_mfma_f32_32x32x16_bf16 v[208:223], v[68:71], v[60:63], v[208:223]
    ds_read_b64_tr_b16 v[48:49], v14 offset:0
    ds_read_b64_tr_b16 v[50:51], v14 offset:1024
    s_waitcnt lgkmcnt(10)
    v_mfma_f32_32x32x16_bf16 v[160:175], v[72:75], v[56:59], v[160:175]
    ds_read_b64_tr_b16 v[52:53], v15 offset:0
    ds_read_b64_tr_b16 v[54:55], v15 offset:1024
    v_mfma_f32_32x32x16_bf16 v[224:239], v[72:75], v[60:63], v[224:239]
    s_waitcnt lgkmcnt(10)
    v_mfma_f32_32x32x16_bf16 v[176:191], v[76:79], v[56:59], v[176:191]
    v_mfma_f32_32x32x16_bf16 v[240:255], v[76:79], v[60:63], v[240:255]
    s_waitcnt lgkmcnt(7)
    v_mfma_f32_32x32x16_bf16 v[128:143], v[40:43], v[32:35], v[128:143]
    ds_read_b128 v[56:59], v9 offset:0
    ds_read_b64_tr_b16 v[64:65], v12 offset:4096
    ds_read_b64_tr_b16 v[66:67], v12 offset:5120
    ds_read_b128 v[60:63], v9 offset:16384
    s_waitcnt lgkmcnt(10)
    v_mfma_f32_32x32x16_bf16 v[192:207], v[40:43], v[36:39], v[192:207]
    ds_read_b64_tr_b16 v[68:69], v13 offset:4096
    ds_read_b64_tr_b16 v[70:71], v13 offset:5120
    ds_read_b64_tr_b16 v[72:73], v14 offset:4096
    ds_read_b64_tr_b16 v[74:75], v14 offset:5120
    s_waitcnt lgkmcnt(12)
    v_mfma_f32_32x32x16_bf16 v[144:159], v[44:47], v[32:35], v[144:159]
    ds_read_b64_tr_b16 v[76:77], v15 offset:4096
    ds_read_b64_tr_b16 v[78:79], v15 offset:5120
    s_add_u32 m0, s54, 98304
    s_add_u32 s38, s35, 512
    buffer_load_dwordx4 v2, s[12:15], s38 offen lds
    v_mfma_f32_32x32x16_bf16 v[208:223], v[44:47], v[36:39], v[208:223]
    s_add_u32 m0, s54, 99328
    s_add_u32 s38, s35, 9728
    buffer_load_dwordx4 v3, s[12:15], s38 offen lds
    s_add_u32 m0, s54, 100352
    s_add_u32 s38, s35, 18944
    buffer_load_dwordx4 v2, s[12:15], s38 offen lds
    s_waitcnt lgkmcnt(12)
    v_mfma_f32_32x32x16_bf16 v[160:175], v[48:51], v[32:35], v[160:175]
    s_add_u32 m0, s54, 101376
    s_add_u32 s38, s35, 28160
    buffer_load_dwordx4 v3, s[12:15], s38 offen lds
    s_add_u32 m0, s54, 102400
    s_add_u32 s38, s35, 37376
    buffer_load_dwordx4 v2, s[12:15], s38 offen lds
    v_mfma_f32_32x32x16_bf16 v[224:239], v[48:51], v[36:39], v[224:239]
    s_add_u32 m0, s54, 103424
    s_add_u32 s38, s35, 46592
    buffer_load_dwordx4 v3, s[12:15], s38 offen lds
    s_add_u32 m0, s54, 104448
    s_add_u32 s38, s35, 55808
    buffer_load_dwordx4 v2, s[12:15], s38 offen lds
    s_waitcnt lgkmcnt(10)
    v_mfma_f32_32x32x16_bf16 v[176:191], v[52:55], v[32:35], v[176:191]
    s_add_u32 m0, s54, 105472
    s_add_u32 s38, s35, 65024
    buffer_load_dwordx4 v3, s[12:15], s38 offen lds
    s_add_u32 m0, s37, 131072
    s_add_u32 s38, s36, 2097152
    buffer_load_dwordx4 v4, s[16:19], s38 offen lds
    v_mfma_f32_32x32x16_bf16 v[240:255], v[52:55], v[36:39], v[240:255]
    s_add_u32 m0, s37, 132096
    s_add_u32 s38, s36, 2129920
    buffer_load_dwordx4 v4, s[16:19], s38 offen lds
    s_waitcnt lgkmcnt(7)
    v_mfma_f32_32x32x16_bf16 v[128:143], v[64:67], v[56:59], v[128:143]
    ds_read_b128 v[32:35], v10 offset:0
    ds_read_b64_tr_b16 v[40:41], v12 offset:8192
    ds_read_b64_tr_b16 v[42:43], v12 offset:9216
    ds_read_b128 v[36:39], v10 offset:16384
    s_waitcnt lgkmcnt(10)
    v_mfma_f32_32x32x16_bf16 v[192:207], v[64:67], v[60:63], v[192:207]
    ds_read_b64_tr_b16 v[44:45], v13 offset:8192
    ds_read_b64_tr_b16 v[46:47], v13 offset:9216
    ds_read_b64_tr_b16 v[48:49], v14 offset:8192
    ds_read_b64_tr_b16 v[50:51], v14 offset:9216
    s_waitcnt lgkmcnt(12)
    v_mfma_f32_32x32x16_bf16 v[144:159], v[68:71], v[56:59], v[144:159]
    ds_read_b64_tr_b16 v[52:53], v15 offset:8192
    ds_read_b64_tr_b16 v[54:55], v15 offset:9216
    s_add_u32 m0, s37, 133120
    s_add_u32 s38, s36, 2162688
    buffer_load_dwordx4 v4, s[16:19], s38 offen lds
    v_mfma_f32_32x32x16_bf16 v[208:223], v[68:71], v[60:63], v[208:223]
    s_add_u32 m0, s37, 134144
    s_add_u32 s38, s36, 2195456
    buffer_load_dwordx4 v4, s[16:19], s38 offen lds
    v_accvgpr_read_b32 v92, a44
    v_accvgpr_read_b32 v93, a45
    v_accvgpr_read_b32 v94, a46
    v_accvgpr_read_b32 v95, a47
    s_waitcnt lgkmcnt(12)
    v_mfma_f32_32x32x16_bf16 v[160:175], v[72:75], v[56:59], v[160:175]
    v_cvt_pk_bf16_f32 v100, v88, v89
    v_cvt_pk_bf16_f32 v101, v90, v91
    v_cvt_pk_bf16_f32 v102, v92, v93
    v_cvt_pk_bf16_f32 v103, v94, v95
    s_add_u32 s39, s73, 4096
    buffer_store_dwordx4 v[100:103], v1, s[24:27], s39 offen offset:2048 sc1
    v_accvgpr_read_b32 v80, a48
    v_accvgpr_read_b32 v81, a49
    v_accvgpr_read_b32 v82, a50
    v_accvgpr_read_b32 v83, a51
    v_mfma_f32_32x32x16_bf16 v[224:239], v[72:75], v[60:63], v[224:239]
    v_accvgpr_read_b32 v84, a52
    v_accvgpr_read_b32 v85, a53
    v_accvgpr_read_b32 v86, a54
    v_accvgpr_read_b32 v87, a55
    v_cvt_pk_bf16_f32 v104, v80, v81
    v_cvt_pk_bf16_f32 v105, v82, v83
    v_cvt_pk_bf16_f32 v106, v84, v85
    v_cvt_pk_bf16_f32 v107, v86, v87
    s_add_u32 s39, s73, 0
    buffer_store_dwordx4 v[104:107], v1, s[24:27], s39 offen offset:3072 sc1
    s_waitcnt lgkmcnt(10)
    v_mfma_f32_32x32x16_bf16 v[176:191], v[76:79], v[56:59], v[176:191]
    v_accvgpr_read_b32 v88, a56
    v_accvgpr_read_b32 v89, a57
    v_accvgpr_read_b32 v90, a58
    v_accvgpr_read_b32 v91, a59
    v_mfma_f32_32x32x16_bf16 v[240:255], v[76:79], v[60:63], v[240:255]
    v_accvgpr_read_b32 v92, a60
    v_accvgpr_read_b32 v93, a61
    v_accvgpr_read_b32 v94, a62
    v_accvgpr_read_b32 v95, a63
    s_waitcnt lgkmcnt(7)
    v_mfma_f32_32x32x16_bf16 v[128:143], v[40:43], v[32:35], v[128:143]
    ds_read_b128 v[56:59], v11 offset:0
    ds_read_b64_tr_b16 v[64:65], v12 offset:12288
    ds_read_b64_tr_b16 v[66:67], v12 offset:13312
    ds_read_b128 v[60:63], v11 offset:16384
    s_waitcnt lgkmcnt(10)
    v_mfma_f32_32x32x16_bf16 v[192:207], v[40:43], v[36:39], v[192:207]
    ds_read_b64_tr_b16 v[68:69], v13 offset:12288
    ds_read_b64_tr_b16 v[70:71], v13 offset:13312
    ds_read_b64_tr_b16 v[72:73], v14 offset:12288
    ds_read_b64_tr_b16 v[74:75], v14 offset:13312
    s_waitcnt lgkmcnt(12)
    v_mfma_f32_32x32x16_bf16 v[144:159], v[44:47], v[32:35], v[144:159]
    ds_read_b64_tr_b16 v[76:77], v15 offset:12288
    ds_read_b64_tr_b16 v[78:79], v15 offset:13312
    v_cvt_pk_bf16_f32 v108, v88, v89
    v_cvt_pk_bf16_f32 v109, v90, v91
    v_cvt_pk_bf16_f32 v110, v92, v93
    v_cvt_pk_bf16_f32 v111, v94, v95
    s_add_u32 s39, s73, 4096
    buffer_store_dwordx4 v[108:111], v1, s[24:27], s39 offen offset:3072 sc1
    v_mfma_f32_32x32x16_bf16 v[208:223], v[44:47], v[36:39], v[208:223]
    v_accvgpr_read_b32 v80, a64
    v_accvgpr_read_b32 v81, a65
    v_accvgpr_read_b32 v82, a66
    v_accvgpr_read_b32 v83, a67
    v_accvgpr_read_b32 v84, a68
    v_accvgpr_read_b32 v85, a69
    v_accvgpr_read_b32 v86, a70
    v_accvgpr_read_b32 v87, a71
    s_waitcnt lgkmcnt(12)
    v_mfma_f32_32x32x16_bf16 v[160:175], v[48:51], v[32:35], v[160:175]
    v_cvt_pk_bf16_f32 v96, v80, v81
    v_cvt_pk_bf16_f32 v97, v82, v83
    v_cvt_pk_bf16_f32 v98, v84, v85
    v_cvt_pk_bf16_f32 v99, v86, v87
    s_add_u32 s39, s73, 32768
    buffer_store_dwordx4 v[96:99], v1, s[24:27], s39 offen offset:0 sc1
    v_accvgpr_read_b32 v88, a72
    v_accvgpr_read_b32 v89, a73
    v_accvgpr_read_b32 v90, a74
    v_accvgpr_read_b32 v91, a75
    v_mfma_f32_32x32x16_bf16 v[224:239], v[48:51], v[36:39], v[224:239]
    v_accvgpr_read_b32 v92, a76
    v_accvgpr_read_b32 v93, a77
    v_accvgpr_read_b32 v94, a78
    v_accvgpr_read_b32 v95, a79
    v_cvt_pk_bf16_f32 v100, v88, v89
    v_cvt_pk_bf16_f32 v101, v90, v91
    v_cvt_pk_bf16_f32 v102, v92, v93
    v_cvt_pk_bf16_f32 v103, v94, v95
    s_add_u32 s39, s73, 36864
    buffer_store_dwordx4 v[100:103], v1, s[24:27], s39 offen offset:0 sc1
    s_waitcnt lgkmcnt(10)
    v_mfma_f32_32x32x16_bf16 v[176:191], v[52:55], v[32:35], v[176:191]
    v_accvgpr_read_b32 v80, a80
    v_accvgpr_read_b32 v81, a81
    v_accvgpr_read_b32 v82, a82
    v_accvgpr_read_b32 v83, a83
    v_mfma_f32_32x32x16_bf16 v[240:255], v[52:55], v[36:39], v[240:255]
    v_accvgpr_read_b32 v84, a84
    v_accvgpr_read_b32 v85, a85
    v_accvgpr_read_b32 v86, a86
    v_accvgpr_read_b32 v87, a87
    s_waitcnt vmcnt(22) lgkmcnt(0)
    s_barrier
    v_add_u32 v8, 49152, v5
    v_add_u32 v12, 81920, v6
    v_xor_b32 v9, 32, v8
    v_xor_b32 v10, 64, v8
    v_xor_b32 v11, 96, v8
    v_xor_b32 v13, 64, v12
    v_xor_b32 v14, 128, v12
    v_xor_b32 v15, 192, v12
    s_waitcnt lgkmcnt(7)
    v_mfma_f32_32x32x16_bf16 v[128:143], v[64:67], v[56:59], v[128:143]
    ds_read_b128 v[32:35], v8 offset:0
    ds_read_b64_tr_b16 v[40:41], v12 offset:0
    s_waitcnt lgkmcnt(8)
    v_mfma_f32_32x32x16_bf16 v[192:207], v[64:67], v[60:63], v[192:207]
    ds_read_b64_tr_b16 v[42:43], v12 offset:1024
    ds_read_b128 v[36:39], v8 offset:16384
    s_waitcnt lgkmcnt(8)
    v_mfma_f32_32x32x16_bf16 v[144:159], v[68:71], v[56:59], v[144:159]
    ds_read_b64_tr_b16 v[44:45], v13 offset:0
    ds_read_b64_tr_b16 v[46:47], v13 offset:1024
    v_mfma_f32_32x32x16_bf16 v[208:223], v[68:71], v[60:63], v[208:223]
    ds_read_b64_tr_b16 v[48:49], v14 offset:0
    ds_read_b64_tr_b16 v[50:51], v14 offset:1024
    s_waitcnt lgkmcnt(10)
    v_mfma_f32_32x32x16_bf16 v[160:175], v[72:75], v[56:59], v[160:175]
    ds_read_b64_tr_b16 v[52:53], v15 offset:0
    ds_read_b64_tr_b16 v[54:55], v15 offset:1024
    v_mfma_f32_32x32x16_bf16 v[224:239], v[72:75], v[60:63], v[224:239]
    s_waitcnt lgkmcnt(10)
    v_mfma_f32_32x32x16_bf16 v[176:191], v[76:79], v[56:59], v[176:191]
    v_mfma_f32_32x32x16_bf16 v[240:255], v[76:79], v[60:63], v[240:255]
    s_waitcnt lgkmcnt(7)
    v_mfma_f32_32x32x16_bf16 v[128:143], v[40:43], v[32:35], v[128:143]
    ds_read_b128 v[56:59], v9 offset:0
    ds_read_b64_tr_b16 v[64:65], v12 offset:4096
    ds_read_b64_tr_b16 v[66:67], v12 offset:5120
    ds_read_b128 v[60:63], v9 offset:16384
    s_waitcnt lgkmcnt(10)
    v_mfma_f32_32x32x16_bf16 v[192:207], v[40:43], v[36:39], v[192:207]
    ds_read_b64_tr_b16 v[68:69], v13 offset:4096
    ds_read_b64_tr_b16 v[70:71], v13 offset:5120
    ds_read_b64_tr_b16 v[72:73], v14 offset:4096
    ds_read_b64_tr_b16 v[74:75], v14 offset:5120
    s_waitcnt lgkmcnt(12)
    v_mfma_f32_32x32x16_bf16 v[144:159], v[44:47], v[32:35], v[144:159]
    ds_read_b64_tr_b16 v[76:77], v15 offset:4096
    ds_read_b64_tr_b16 v[78:79], v15 offset:5120
    s_add_u32 m0, s54, 0
    s_add_u32 s38, s35, 640
    buffer_load_dwordx4 v2, s[12:15], s38 offen lds
    v_mfma_f32_32x32x16_bf16 v[208:223], v[44:47], v[36:39], v[208:223]
    s_add_u32 m0, s54, 1024
    s_add_u32 s38, s35, 9856
    buffer_load_dwordx4 v3, s[12:15], s38 offen lds
    s_add_u32 m0, s54, 2048
    s_add_u32 s38, s35, 19072
    buffer_load_dwordx4 v2, s[12:15], s38 offen lds
    s_waitcnt lgkmcnt(12)
    v_mfma_f32_32x32x16_bf16 v[160:175], v[48:51], v[32:35], v[160:175]
    s_add_u32 m0, s54, 3072
    s_add_u32 s38, s35, 28288
    buffer_load_dwordx4 v3, s[12:15], s38 offen lds
    s_add_u32 m0, s54, 4096
    s_add_u32 s38, s35, 37504
    buffer_load_dwordx4 v2, s[12:15], s38 offen lds
    v_mfma_f32_32x32x16_bf16 v[224:239], v[48:51], v[36:39], v[224:239]
    s_add_u32 m0, s54, 5120
    s_add_u32 s38, s35, 46720
    buffer_load_dwordx4 v3, s[12:15], s38 offen lds
    s_add_u32 m0, s54, 6144
    s_add_u32 s38, s35, 55936
    buffer_load_dwordx4 v2, s[12:15], s38 offen lds
    s_waitcnt lgkmcnt(10)
    v_mfma_f32_32x32x16_bf16 v[176:191], v[52:55], v[32:35], v[176:191]
    s_add_u32 m0, s54, 7168
    s_add_u32 s38, s35, 65152
    buffer_load_dwordx4 v3, s[12:15], s38 offen lds
    s_add_u32 m0, s37, 32768
    s_add_u32 s38, s36, 2621440
    buffer_load_dwordx4 v4, s[16:19], s38 offen lds
    v_mfma_f32_32x32x16_bf16 v[240:255], v[52:55], v[36:39], v[240:255]
    s_add_u32 m0, s37, 33792
    s_add_u32 s38, s36, 2654208
    buffer_load_dwordx4 v4, s[16:19], s38 offen lds
    s_waitcnt lgkmcnt(7)
    v_mfma_f32_32x32x16_bf16 v[128:143], v[64:67], v[56:59], v[128:143]
    ds_read_b128 v[32:35], v10 offset:0
    ds_read_b64_tr_b16 v[40:41], v12 offset:8192
    ds_read_b64_tr_b16 v[42:43], v12 offset:9216
    ds_read_b128 v[36:39], v10 offset:16384
    s_waitcnt lgkmcnt(10)
    v_mfma_f32_32x32x16_bf16 v[192:207], v[64:67], v[60:63], v[192:207]
    ds_read_b64_tr_b16 v[44:45], v13 offset:8192
    ds_read_b64_tr_b16 v[46:47], v13 offset:9216
    ds_read_b64_tr_b16 v[48:49], v14 offset:8192
    ds_read_b64_tr_b16 v[50:51], v14 offset:9216
    s_waitcnt lgkmcnt(12)
    v_mfma_f32_32x32x16_bf16 v[144:159], v[68:71], v[56:59], v[144:159]
    ds_read_b64_tr_b16 v[52:53], v15 offset:8192
    ds_read_b64_tr_b16 v[54:55], v15 offset:9216
    s_add_u32 m0, s37, 34816
    s_add_u32 s38, s36, 2686976
    buffer_load_dwordx4 v4, s[16:19], s38 offen lds
    v_mfma_f32_32x32x16_bf16 v[208:223], v[68:71], v[60:63], v[208:223]
    s_add_u32 m0, s37, 35840
    s_add_u32 s38, s36, 2719744
    buffer_load_dwordx4 v4, s[16:19], s38 offen lds
    v_cvt_pk_bf16_f32 v104, v80, v81
    v_cvt_pk_bf16_f32 v105, v82, v83
    v_cvt_pk_bf16_f32 v106, v84, v85
    v_cvt_pk_bf16_f32 v107, v86, v87
    s_add_u32 s39, s73, 32768
    buffer_store_dwordx4 v[104:107], v1, s[24:27], s39 offen offset:1024 sc1
    s_waitcnt lgkmcnt(12)
    v_mfma_f32_32x32x16_bf16 v[160:175], v[72:75], v[56:59], v[160:175]
    v_accvgpr_read_b32 v88, a88
    v_accvgpr_read_b32 v89, a89
    v_accvgpr_read_b32 v90, a90
    v_accvgpr_read_b32 v91, a91
    v_accvgpr_read_b32 v92, a92
    v_accvgpr_read_b32 v93, a93
    v_accvgpr_read_b32 v94, a94
    v_accvgpr_read_b32 v95, a95
    v_mfma_f32_32x32x16_bf16 v[224:239], v[72:75], v[60:63], v[224:239]
    v_cvt_pk_bf16_f32 v108, v88, v89
    v_cvt_pk_bf16_f32 v109, v90, v91
    v_cvt_pk_bf16_f32 v110, v92, v93
    v_cvt_pk_bf16_f32 v111, v94, v95
    s_add_u32 s39, s73, 36864
    buffer_store_dwordx4 v[108:111], v1, s[24:27], s39 offen offset:1024 sc1
    v_accvgpr_read_b32 v80, a96
    v_accvgpr_read_b32 v81, a97
    v_accvgpr_read_b32 v82, a98
    v_accvgpr_read_b32 v83, a99
    s_waitcnt lgkmcnt(10)
    v_mfma_f32_32x32x16_bf16 v[176:191], v[76:79], v[56:59], v[176:191]
    v_accvgpr_read_b32 v84, a100
    v_accvgpr_read_b32 v85, a101
    v_accvgpr_read_b32 v86, a102
    v_accvgpr_read_b32 v87, a103
    v_mfma_f32_32x32x16_bf16 v[240:255], v[76:79], v[60:63], v[240:255]
    v_cvt_pk_bf16_f32 v96, v80, v81
    v_cvt_pk_bf16_f32 v97, v82, v83
    v_cvt_pk_bf16_f32 v98, v84, v85
    v_cvt_pk_bf16_f32 v99, v86, v87
    s_add_u32 s39, s73, 32768
    buffer_store_dwordx4 v[96:99], v1, s[24:27], s39 offen offset:2048 sc1
    s_waitcnt lgkmcnt(7)
    v_mfma_f32_32x32x16_bf16 v[128:143], v[40:43], v[32:35], v[128:143]
    ds_read_b128 v[56:59], v11 offset:0
    ds_read_b64_tr_b16 v[64:65], v12 offset:12288
    ds_read_b64_tr_b16 v[66:67], v12 offset:13312
    ds_read_b128 v[60:63], v11 offset:16384
    s_waitcnt lgkmcnt(10)
    v_mfma_f32_32x32x16_bf16 v[192:207], v[40:43], v[36:39], v[192:207]
    ds_read_b64_tr_b16 v[68:69], v13 offset:12288
    ds_read_b64_tr_b16 v[70:71], v13 offset:13312
    ds_read_b64_tr_b16 v[72:73], v14 offset:12288
    ds_read_b64_tr_b16 v[74:75], v14 offset:13312
    s_waitcnt lgkmcnt(12)
    v_mfma_f32_32x32x16_bf16 v[144:159], v[44:47], v[32:35], v[144:159]
    ds_read_b64_tr_b16 v[76:77], v15 offset:12288
    ds_read_b64_tr_b16 v[78:79], v15 offset:13312
    v_accvgpr_read_b32 v88, a104
    v_accvgpr_read_b32 v89, a105
    v_accvgpr_read_b32 v90, a106
    v_accvgpr_read_b32 v91, a107
    v_mfma_f32_32x32x16_bf16 v[208:223], v[44:47], v[36:39], v[208:223]
    v_accvgpr_read_b32 v92, a108
    v_accvgpr_read_b32 v93, a109
    v_accvgpr_read_b32 v94, a110
    v_accvgpr_read_b32 v95, a111
    v_cvt_pk_bf16_f32 v100, v88, v89
    v_cvt_pk_bf16_f32 v101, v90, v91
    v_cvt_pk_bf16_f32 v102, v92, v93
    v_cvt_pk_bf16_f32 v103, v94, v95
    s_add_u32 s39, s73, 36864
    buffer_store_dwordx4 v[100:103], v1, s[24:27], s39 offen offset:2048 sc1
    s_waitcnt lgkmcnt(12)
    v_mfma_f32_32x32x16_bf16 v[160:175], v[48:51], v[32:35], v[160:175]
    v_accvgpr_read_b32 v80, a112
    v_accvgpr_read_b32 v81, a113
    v_accvgpr_read_b32 v82, a114
    v_accvgpr_read_b32 v83, a115
    v_accvgpr_read_b32 v84, a116
    v_accvgpr_read_b32 v85, a117
    v_accvgpr_read_b32 v86, a118
    v_accvgpr_read_b32 v87, a119
    v_mfma_f32_32x32x16_bf16 v[224:239], v[48:51], v[36:39], v[224:239]
    v_cvt_pk_bf16_f32 v104, v80, v81
    v_cvt_pk_bf16_f32 v105, v82, v83
    v_cvt_pk_bf16_f32 v106, v84, v85
    v_cvt_pk_bf16_f32 v107, v86, v87
    s_add_u32 s39, s73, 32768
    buffer_store_dwordx4 v[104:107], v1, s[24:27], s39 offen offset:3072 sc1
    v_accvgpr_read_b32 v88, a120
    v_accvgpr_read_b32 v89, a121
    v_accvgpr_read_b32 v90, a122
    v_accvgpr_read_b32 v91, a123
    s_waitcnt lgkmcnt(10)
    v_mfma_f32_32x32x16_bf16 v[176:191], v[52:55], v[32:35], v[176:191]
    v_accvgpr_read_b32 v92, a124
    v_accvgpr_read_b32 v93, a125
    v_accvgpr_read_b32 v94, a126
    v_accvgpr_read_b32 v95, a127
    v_mfma_f32_32x32x16_bf16 v[240:255], v[52:55], v[36:39], v[240:255]
    v_cvt_pk_bf16_f32 v108, v88, v89
    v_cvt_pk_bf16_f32 v109, v90, v91
    v_cvt_pk_bf16_f32 v110, v92, v93
    v_cvt_pk_bf16_f32 v111, v94, v95
    s_add_u32 s39, s73, 36864
    buffer_store_dwordx4 v[108:111], v1, s[24:27], s39 offen offset:3072 sc1
    s_waitcnt vmcnt(23) lgkmcnt(0)
    s_barrier
    v_add_u32 v8, 98304, v5
    v_add_u32 v12, 131072, v6
    v_xor_b32 v9, 32, v8
    v_xor_b32 v10, 64, v8
    v_xor_b32 v11, 96, v8
    v_xor_b32 v13, 64, v12
    v_xor_b32 v14, 128, v12
    v_xor_b32 v15, 192, v12
    s_waitcnt lgkmcnt(7)
    v_mfma_f32_32x32x16_bf16 v[128:143], v[64:67], v[56:59], v[128:143]
    ds_read_b128 v[32:35], v8 offset:0
    ds_read_b64_tr_b16 v[40:41], v12 offset:0
    s_waitcnt lgkmcnt(8)
    v_mfma_f32_32x32x16_bf16 v[192:207], v[64:67], v[60:63], v[192:207]
    ds_read_b64_tr_b16 v[42:43], v12 offset:1024
    ds_read_b128 v[36:39], v8 offset:16384
    s_waitcnt lgkmcnt(8)
    v_mfma_f32_32x32x16_bf16 v[144:159], v[68:71], v[56:59], v[144:159]
    ds_read_b64_tr_b16 v[44:45], v13 offset:0
    ds_read_b64_tr_b16 v[46:47], v13 offset:1024
    v_mfma_f32_32x32x16_bf16 v[208:223], v[68:71], v[60:63], v[208:223]
    ds_read_b64_tr_b16 v[48:49], v14 offset:0
    ds_read_b64_tr_b16 v[50:51], v14 offset:1024
    s_waitcnt lgkmcnt(10)
    v_mfma_f32_32x32x16_bf16 v[160:175], v[72:75], v[56:59], v[160:175]
    ds_read_b64_tr_b16 v[52:53], v15 offset:0
    ds_read_b64_tr_b16 v[54:55], v15 offset:1024
    v_mfma_f32_32x32x16_bf16 v[224:239], v[72:75], v[60:63], v[224:239]
    s_waitcnt lgkmcnt(10)
    v_mfma_f32_32x32x16_bf16 v[176:191], v[76:79], v[56:59], v[176:191]
    v_mfma_f32_32x32x16_bf16 v[240:255], v[76:79], v[60:63], v[240:255]
    s_waitcnt lgkmcnt(7)
    v_mfma_f32_32x32x16_bf16 v[128:143], v[40:43], v[32:35], v[128:143]
    ds_read_b128 v[56:59], v9 offset:0
    ds_read_b64_tr_b16 v[64:65], v12 offset:4096
    ds_read_b64_tr_b16 v[66:67], v12 offset:5120
    ds_read_b128 v[60:63], v9 offset:16384
    s_waitcnt lgkmcnt(10)
    v_mfma_f32_32x32x16_bf16 v[192:207], v[40:43], v[36:39], v[192:207]
    ds_read_b64_tr_b16 v[68:69], v13 offset:4096
    ds_read_b64_tr_b16 v[70:71], v13 offset:5120
    s_waitcnt lgkmcnt(10)
    v_mfma_f32_32x32x16_bf16 v[144:159], v[44:47], v[32:35], v[144:159]
    ds_read_b64_tr_b16 v[72:73], v14 offset:4096
    ds_read_b64_tr_b16 v[74:75], v14 offset:5120
    v_mfma_f32_32x32x16_bf16 v[208:223], v[44:47], v[36:39], v[208:223]
    ds_read_b64_tr_b16 v[76:77], v15 offset:4096
    ds_read_b64_tr_b16 v[78:79], v15 offset:5120
    s_waitcnt lgkmcnt(12)
    v_mfma_f32_32x32x16_bf16 v[160:175], v[48:51], v[32:35], v[160:175]
    s_add_u32 m0, s54, 49152
    s_add_u32 s38, s35, 768
    buffer_load_dwordx4 v2, s[12:15], s38 offen lds
    v_mfma_f32_32x32x16_bf16 v[224:239], v[48:51], v[36:39], v[224:239]
    s_add_u32 m0, s54, 50176
    s_add_u32 s38, s35, 9984
    buffer_load_dwordx4 v3, s[12:15], s38 offen lds
    s_waitcnt lgkmcnt(10)
    v_mfma_f32_32x32x16_bf16 v[176:191], v[52:55], v[32:35], v[176:191]
    s_add_u32 m0, s54, 51200
    s_add_u32 s38, s35, 19200
    buffer_load_dwordx4 v2, s[12:15], s38 offen lds
    v_mfma_f32_32x32x16_bf16 v[240:255], v[52:55], v[36:39], v[240:255]
    s_add_u32 m0, s54, 52224
    s_add_u32 s38, s35, 28416
    buffer_load_dwordx4 v3, s[12:15], s38 offen lds
    s_waitcnt lgkmcnt(7)
    v_mfma_f32_32x32x16_bf16 v[128:143], v[64:67], v[56:59], v[128:143]
    ds_read_b128 v[32:35], v10 offset:0
    ds_read_b64_tr_b16 v[40:41], v12 offset:8192
    ds_read_b64_tr_b16 v[42:43], v12 offset:9216
    ds_read_b128 v[36:39], v10 offset:16384
    s_waitcnt lgkmcnt(10)
    v_mfma_f32_32x32x16_bf16 v[192:207], v[64:67], v[60:63], v[192:207]
    ds_read_b64_tr_b16 v[44:45], v13 offset:8192
    ds_read_b64_tr_b16 v[46:47], v13 offset:9216
    s_waitcnt lgkmcnt(10)
    v_mfma_f32_32x32x16_bf16 v[144:159], v[68:71], v[56:59], v[144:159]
    ds_read_b64_tr_b16 v[48:49], v14 offset:8192
    ds_read_b64_tr_b16 v[50:51], v14 offset:9216
    v_mfma_f32_32x32x16_bf16 v[208:223], v[68:71], v[60:63], v[208:223]
    ds_read_b64_tr_b16 v[52:53], v15 offset:8192
    ds_read_b64_tr_b16 v[54:55], v15 offset:9216
    s_waitcnt lgkmcnt(12)
    v_mfma_f32_32x32x16_bf16 v[160:175], v[72:75], v[56:59], v[160:175]
    s_add_u32 m0, s54, 53248
    s_add_u32 s38, s35, 37632
    buffer_load_dwordx4 v2, s[12:15], s38 offen lds
    v_mfma_f32_32x32x16_bf16 v[224:239], v[72:75], v[60:63], v[224:239]
    s_add_u32 m0, s54, 54272
    s_add_u32 s38, s35, 46848
    buffer_load_dwordx4 v3, s[12:15], s38 offen lds
    s_waitcnt lgkmcnt(10)
    v_mfma_f32_32x32x16_bf16 v[176:191], v[76:79], v[56:59], v[176:191]
    s_add_u32 m0, s54, 55296
    s_add_u32 s38, s35, 56064
    buffer_load_dwordx4 v2, s[12:15], s38 offen lds
    v_mfma_f32_32x32x16_bf16 v[240:255], v[76:79], v[60:63], v[240:255]
    s_add_u32 m0, s54, 56320
    s_add_u32 s38, s35, 65280
    buffer_load_dwordx4 v3, s[12:15], s38 offen lds
    s_waitcnt lgkmcnt(7)
    v_mfma_f32_32x32x16_bf16 v[128:143], v[40:43], v[32:35], v[128:143]
    ds_read_b128 v[56:59], v11 offset:0
    ds_read_b64_tr_b16 v[64:65], v12 offset:12288
    ds_read_b64_tr_b16 v[66:67], v12 offset:13312
    ds_read_b128 v[60:63], v11 offset:16384
    s_waitcnt lgkmcnt(10)
    v_mfma_f32_32x32x16_bf16 v[192:207], v[40:43], v[36:39], v[192:207]
    ds_read_b64_tr_b16 v[68:69], v13 offset:12288
    ds_read_b64_tr_b16 v[70:71], v13 offset:13312
    s_waitcnt lgkmcnt(10)
    v_mfma_f32_32x32x16_bf16 v[144:159], v[44:47], v[32:35], v[144:159]
    ds_read_b64_tr_b16 v[72:73], v14 offset:12288
    ds_read_b64_tr_b16 v[74:75], v14 offset:13312
    v_mfma_f32_32x32x16_bf16 v[208:223], v[44:47], v[36:39], v[208:223]
    ds_read_b64_tr_b16 v[76:77], v15 offset:12288
    ds_read_b64_tr_b16 v[78:79], v15 offset:13312
    s_waitcnt lgkmcnt(12)
    v_mfma_f32_32x32x16_bf16 v[160:175], v[48:51], v[32:35], v[160:175]
    s_add_u32 m0, s37, 81920
    s_add_u32 s38, s36, 3145728
    buffer_load_dwordx4 v4, s[16:19], s38 offen lds
    v_mfma_f32_32x32x16_bf16 v[224:239], v[48:51], v[36:39], v[224:239]
    s_add_u32 m0, s37, 82944
    s_add_u32 s38, s36, 3178496
    buffer_load_dwordx4 v4, s[16:19], s38 offen lds
    s_waitcnt lgkmcnt(10)
    v_mfma_f32_32x32x16_bf16 v[176:191], v[52:55], v[32:35], v[176:191]
    s_add_u32 m0, s37, 83968
    s_add_u32 s38, s36, 3211264
    buffer_load_dwordx4 v4, s[16:19], s38 offen lds
    v_mfma_f32_32x32x16_bf16 v[240:255], v[52:55], v[36:39], v[240:255]
    s_add_u32 m0, s37, 84992
    s_add_u32 s38, s36, 3244032
    buffer_load_dwordx4 v4, s[16:19], s38 offen lds
    s_waitcnt vmcnt(12) lgkmcnt(0)
    s_barrier
    s_cmp_lg_u32 s34, 0
    s_cbranch_scc1 L_fo_4
    s_lshl_b32 s75, 256, s33
    s_lshl_b32 s76, s32, 2
    v_mov_b32 v22, s75
    v_mov_b32 v23, 0
    s_mov_b64 exec, 1
    buffer_atomic_or v22, v23, s[68:71], s76 offen
    s_mov_b64 exec, -1
L_fo_4:
    v_add_u32 v8, 0, v5
    v_add_u32 v12, 32768, v6
    v_xor_b32 v9, 32, v8
    v_xor_b32 v10, 64, v8
    v_xor_b32 v11, 96, v8
    v_xor_b32 v13, 64, v12
    v_xor_b32 v14, 128, v12
    v_xor_b32 v15, 192, v12
    s_waitcnt lgkmcnt(7)
    v_mfma_f32_32x32x16_bf16 v[128:143], v[64:67], v[56:59], v[128:143]
    ds_read_b128 v[32:35], v8 offset:0
    ds_read_b64_tr_b16 v[40:41], v12 offset:0
    s_waitcnt lgkmcnt(8)
    v_mfma_f32_32x32x16_bf16 v[192:207], v[64:67], v[60:63], v[192:207]
    ds_read_b64_tr_b16 v[42:43], v12 offset:1024
    ds_read_b128 v[36:39], v8 offset:16384
    s_waitcnt lgkmcnt(8)
    v_mfma_f32_32x32x16_bf16 v[144:159], v[68:71], v[56:59], v[144:159]
    ds_read_b64_tr_b16 v[44:45], v13 offset:0
    ds_read_b64_tr_b16 v[46:47], v13 offset:1024
    v_mfma_f32_32x32x16_bf16 v[208:223], v[68:71], v[60:63], v[208:223]
    ds_read_b64_tr_b16 v[48:49], v14 offset:0
    ds_read_b64_tr_b16 v[50:51], v14 offset:1024
    s_waitcnt lgkmcnt(10)
    v_mfma_f32_32x32x16_bf16 v[160:175], v[72:75], v[56:59], v[160:175]
    ds_read_b64_tr_b16 v[52:53], v15 offset:0
    ds_read_b64_tr_b16 v[54:55], v15 offset:1024
    v_mfma_f32_32x32x16_bf16 v[224:239], v[72:75], v[60:63], v[224:239]
    s_waitcnt lgkmcnt(10)
    v_mfma_f32_32x32x16_bf16 v[176:191], v[76:79], v[56:59], v[176:191]
    v_mfma_f32_32x32x16_bf16 v[240:255], v[76:79], v[60:63], v[240:255]
    s_waitcnt lgkmcnt(7)
    v_mfma_f32_32x32x16_bf16 v[128:143], v[40:43], v[32:35], v[128:143]
    ds_read_b128 v[56:59], v9 offset:0
    ds_read_b64_tr_b16 v[64:65], v12 offset:4096
    ds_read_b64_tr_b16 v[66:67], v12 offset:5120
    ds_read_b128 v[60:63], v9 offset:16384
    s_waitcnt lgkmcnt(10)
    v_mfma_f32_32x32x16_bf16 v[192:207], v[40:43], v[36:39], v[192:207]
    ds_read_b64_tr_b16 v[68:69], v13 offset:4096
    ds_read_b64_tr_b16 v[70:71], v13 offset:5120
    s_waitcnt lgkmcnt(10)
    v_mfma_f32_32x32x16_bf16 v[144:159], v[44:47], v[32:35], v[144:159]
    ds_read_b64_tr_b16 v[72:73], v14 offset:4096
    ds_read_b64_tr_b16 v[74:75], v14 offset:5120
    v_mfma_f32_32x32x16_bf16 v[208:223], v[44:47], v[36:39], v[208:223]
    ds_read_b64_tr_b16 v[76:77], v15 offset:4096
    ds_read_b64_tr_b16 v[78:79], v15 offset:5120
    s_waitcnt lgkmcnt(12)
    v_mfma_f32_32x32x16_bf16 v[160:175], v[48:51], v[32:35], v[160:175]
    s_add_u32 m0, s54, 98304
    s_add_u32 s38, s35, 896
    buffer_load_dwordx4 v2, s[12:15], s38 offen lds
    v_mfma_f32_32x32x16_bf16 v[224:239], v[48:51], v[36:39], v[224:239]
    s_add_u32 m0, s54, 99328
    s_add_u32 s38, s35, 10112
    buffer_load_dwordx4 v3, s[12:15], s38 offen lds
    s_waitcnt lgkmcnt(10)
    v_mfma_f32_32x32x16_bf16 v[176:191], v[52:55], v[32:35], v[176:191]
    s_add_u32 m0, s54, 100352
    s_add_u32 s38, s35, 19328
    buffer_load_dwordx4 v2, s[12:15], s38 offen lds
    v_mfma_f32_32x32x16_bf16 v[240:255], v[52:55], v[36:39], v[240:255]
    s_add_u32 m0, s54, 101376
    s_add_u32 s38, s35, 28544
    buffer_load_dwordx4 v3, s[12:15], s38 offen lds
    s_waitcnt lgkmcnt(7)
    v_mfma_f32_32x32x16_bf16 v[128:143], v[64:67], v[56:59], v[128:143]
    ds_read_b128 v[32:35], v10 offset:0
    ds_read_b64_tr_b16 v[40:41], v12 offset:8192
    ds_read_b64_tr_b16 v[42:43], v12 offset:9216
    ds_read_b128 v[36:39], v10 offset:16384
    s_waitcnt lgkmcnt(10)
    v_mfma_f32_32x32x16_bf16 v[192:207], v[64:67], v[60:63], v[192:207]
    ds_read_b64_tr_b16 v[44:45], v13 offset:8192
    ds_read_b64_tr_b16 v[46:47], v13 offset:9216
    s_waitcnt lgkmcnt(10)
    v_mfma_f32_32x32x16_bf16 v[144:159], v[68:71], v[56:59], v[144:159]
    ds_read_b64_tr_b16 v[48:49], v14 offset:8192
    ds_read_b64_tr_b16 v[50:51], v14 offset:9216
    v_mfma_f32_32x32x16_bf16 v[208:223], v[68:71], v[60:63], v[208:223]
    ds_read_b64_tr_b16 v[52:53], v15 offset:8192
    ds_read_b64_tr_b16 v[54:55], v15 offset:9216
    s_waitcnt lgkmcnt(12)
    v_mfma_f32_32x32x16_bf16 v[160:175], v[72:75], v[56:59], v[160:175]
    s_add_u32 m0, s54, 102400
    s_add_u32 s38, s35, 37760
    buffer_load_dwordx4 v2, s[12:15], s38 offen lds
    v_mfma_f32_32x32x16_bf16 v[224:239], v[72:75], v[60:63], v[224:239]
    s_add_u32 m0, s54, 103424
    s_add_u32 s38, s35, 46976
    buffer_load_dwordx4 v3, s[12:15], s38 offen lds
    s_waitcnt lgkmcnt(10)
    v_mfma_f32_32x32x16_bf16 v[176:191], v[76:79], v[56:59], v[176:191]
    s_add_u32 m0, s54, 104448
    s_add_u32 s38, s35, 56192
    buffer_load_dwordx4 v2, s[12:15], s38 offen lds
    v_mfma_f32_32x32x16_bf16 v[240:255], v[76:79], v[60:63], v[240:255]
    s_add_u32 m0, s54, 105472
    s_add_u32 s38, s35, 65408
    buffer_load_dwordx4 v3, s[12:15], s38 offen lds
    s_waitcnt lgkmcnt(7)
    v_mfma_f32_32x32x16_bf16 v[128:143], v[40:43], v[32:35], v[128:143]
    ds_read_b128 v[56:59], v11 offset:0
    ds_read_b64_tr_b16 v[64:65], v12 offset:12288
    ds_read_b64_tr_b16 v[66:67], v12 offset:13312
    ds_read_b128 v[60:63], v11 offset:16384
    s_waitcnt lgkmcnt(10)
    v_mfma_f32_32x32x16_bf16 v[192:207], v[40:43], v[36:39], v[192:207]
    ds_read_b64_tr_b16 v[68:69], v13 offset:12288
    ds_read_b64_tr_b16 v[70:71], v13 offset:13312
    s_waitcnt lgkmcnt(10)
    v_mfma_f32_32x32x16_bf16 v[144:159], v[44:47], v[32:35], v[144:159]
    ds_read_b64_tr_b16 v[72:73], v14 offset:12288
    ds_read_b64_tr_b16 v[74:75], v14 offset:13312
    v_mfma_f32_32x32x16_bf16 v[208:223], v[44:47], v[36:39], v[208:223]
    ds_read_b64_tr_b16 v[76:77], v15 offset:12288
    ds_read_b64_tr_b16 v[78:79], v15 offset:13312
    s_waitcnt lgkmcnt(12)
    v_mfma_f32_32x32x16_bf16 v[160:175], v[48:51], v[32:35], v[160:175]
    s_add_u32 m0, s37, 131072
    s_add_u32 s38, s36, 3670016
    buffer_load_dwordx4 v4, s[16:19], s38 offen lds
    v_mfma_f32_32x32x16_bf16 v[224:239], v[48:51], v[36:39], v[224:239]
    s_add_u32 m0, s37, 132096
    s_add_u32 s38, s36, 3702784
    buffer_load_dwordx4 v4, s[16:19], s38 offen lds
    s_waitcnt lgkmcnt(10)
    v_mfma_f32_32x32x16_bf16 v[176:191], v[52:55], v[32:35], v[176:191]
    s_add_u32 m0, s37, 133120
    s_add_u32 s38, s36, 3735552
    buffer_load_dwordx4 v4, s[16:19], s38 offen lds
    v_mfma_f32_32x32x16_bf16 v[240:255], v[52:55], v[36:39], v[240:255]
    s_add_u32 m0, s37, 134144
    s_add_u32 s38, s36, 3768320
    buffer_load_dwordx4 v4, s[16:19], s38 offen lds
    s_waitcnt vmcnt(12) lgkmcnt(0)
    s_barrier
    v_add_u32 v8, 49152, v5
    v_add_u32 v12, 81920, v6
    v_xor_b32 v9, 32, v8
    v_xor_b32 v10, 64, v8
    v_xor_b32 v11, 96, v8
    v_xor_b32 v13, 64, v12
    v_xor_b32 v14, 128, v12
    v_xor_b32 v15, 192, v12
    s_waitcnt lgkmcnt(7)
    v_mfma_f32_32x32x16_bf16 v[128:143], v[64:67], v[56:59], v[128:143]
    ds_read_b128 v[32:35], v8 offset:0
    ds_read_b64_tr_b16 v[40:41], v12 offset:0
    s_waitcnt lgkmcnt(8)
    v_mfma_f32_32x32x16_bf16 v[192:207], v[64:67], v[60:63], v[192:207]
    ds_read_b64_tr_b16 v[42:43], v12 offset:1024
    ds_read_b128 v[36:39], v8 offset:16384
    s_waitcnt lgkmcnt(8)
    v_mfma_f32_32x32x16_bf16 v[144:159], v[68:71], v[56:59], v[144:159]
    ds_read_b64_tr_b16 v[44:45], v13 offset:0
    ds_read_b64_tr_b16 v[46:47], v13 offset:1024
    v_mfma_f32_32x32x16_bf16 v[208:223], v[68:71], v[60:63], v[208:223]
    ds_read_b64_tr_b16 v[48:49], v14 offset:0
    ds_read_b64_tr_b16 v[50:51], v14 offset:1024
    s_waitcnt lgkmcnt(10)
    v_mfma_f32_32x32x16_bf16 v[160:175], v[72:75], v[56:59], v[160:175]
    ds_read_b64_tr_b16 v[52:53], v15 offset:0
    ds_read_b64_tr_b16 v[54:55], v15 offset:1024
    v_mfma_f32_32x32x16_bf16 v[224:239], v[72:75], v[60:63], v[224:239]
    s_waitcnt lgkmcnt(10)
    v_mfma_f32_32x32x16_bf16 v[176:191], v[76:79], v[56:59], v[176:191]
    v_mfma_f32_32x32x16_bf16 v[240:255], v[76:79], v[60:63], v[240:255]
    s_waitcnt lgkmcnt(7)
    v_mfma_f32_32x32x16_bf16 v[128:143], v[40:43], v[32:35], v[128:143]
    ds_read_b128 v[56:59], v9 offset:0
    ds_read_b64_tr_b16 v[64:65], v12 offset:4096
    ds_read_b64_tr_b16 v[66:67], v12 offset:5120
    ds_read_b128 v[60:63], v9 offset:16384
    s_waitcnt lgkmcnt(10)
    v_mfma_f32_32x32x16_bf16 v[192:207], v[40:43], v[36:39], v[192:207]
    ds_read_b64_tr_b16 v[68:69], v13 offset:4096
    ds_read_b64_tr_b16 v[70:71], v13 offset:5120
    s_waitcnt lgkmcnt(10)
    v_mfma_f32_32x32x16_bf16 v[144:159], v[44:47], v[32:35], v[144:159]
    ds_read_b64_tr_b16 v[72:73], v14 offset:4096
    ds_read_b64_tr_b16 v[74:75], v14 offset:5120
    v_mfma_f32_32x32x16_bf16 v[208:223], v[44:47], v[36:39], v[208:223]
    ds_read_b64_tr_b16 v[76:77], v15 offset:4096
    ds_read_b64_tr_b16 v[78:79], v15 offset:5120
    s_waitcnt lgkmcnt(12)
    v_mfma_f32_32x32x16_bf16 v[160:175], v[48:51], v[32:35], v[160:175]
    s_add_u32 m0, s54, 0
    s_add_u32 s38, s35, 1024
    buffer_load_dwordx4 v2, s[12:15], s38 offen lds
    v_mfma_f32_32x32x16_bf16 v[224:239], v[48:51], v[36:39], v[224:239]
    s_add_u32 m0, s54, 1024
    s_add_u32 s38, s35, 10240
    buffer_load_dwordx4 v3, s[12:15], s38 offen lds
    s_waitcnt lgkmcnt(10)
    v_mfma_f32_32x32x16_bf16 v[176:191], v[52:55], v[32:35], v[176:191]
    s_add_u32 m0, s54, 2048
    s_add_u32 s38, s35, 19456
    buffer_load_dwordx4 v2, s[12:15], s38 offen lds
    v_mfma_f32_32x32x16_bf16 v[240:255], v[52:55], v[36:39], v[240:255]
    s_add_u32 m0, s54, 3072
    s_add_u32 s38, s35, 28672
    buffer_load_dwordx4 v3, s[12:15], s38 offen lds
    s_waitcnt lgkmcnt(7)
    v_mfma_f32_32x32x16_bf16 v[128:143], v[64:67], v[56:59], v[128:143]
    ds_read_b128 v[32:35], v10 offset:0
    ds_read_b64_tr_b16 v[40:41], v12 offset:8192
    ds_read_b64_tr_b16 v[42:43], v12 offset:9216
    ds_read_b128 v[36:39], v10 offset:16384
    s_waitcnt lgkmcnt(10)
    v_mfma_f32_32x32x16_bf16 v[192:207], v[64:67], v[60:63], v[192:207]
    ds_read_b64_tr_b16 v[44:45], v13 offset:8192
    ds_read_b64_tr_b16 v[46:47], v13 offset:9216
    s_waitcnt lgkmcnt(10)
    v_mfma_f32_32x32x16_bf16 v[144:159], v[68:71], v[56:59], v[144:159]
    ds_read_b64_tr_b16 v[48:49], v14 offset:8192
    ds_read_b64_tr_b16 v[50:51], v14 offset:9216
    v_mfma_f32_32x32x16_bf16 v[208:223], v[68:71], v[60:63], v[208:223]
    ds_read_b64_tr_b16 v[52:53], v15 offset:8192
    ds_read_b64_tr_b16 v[54:55], v15 offset:9216
    s_waitcnt lgkmcnt(12)
    v_mfma_f32_32x32x16_bf16 v[160:175], v[72:75], v[56:59], v[160:175]
    s_add_u32 m0, s54, 4096
    s_add_u32 s38, s35, 37888
    buffer_load_dwordx4 v2, s[12:15], s38 offen lds
    v_mfma_f32_32x32x16_bf16 v[224:239], v[72:75], v[60:63], v[224:239]
    s_add_u32 m0, s54, 5120
    s_add_u32 s38, s35, 47104
    buffer_load_dwordx4 v3, s[12:15], s38 offen lds
    s_waitcnt lgkmcnt(10)
    v_mfma_f32_32x32x16_bf16 v[176:191], v[76:79], v[56:59], v[176:191]
    s_add_u32 m0, s54, 6144
    s_add_u32 s38, s35, 56320
    buffer_load_dwordx4 v2, s[12:15], s38 offen lds
    v_mfma_f32_32x32x16_bf16 v[240:255], v[76:79], v[60:63], v[240:255]
    s_add_u32 m0, s54, 7168
    s_add_u32 s38, s35, 65536
    buffer_load_dwordx4 v3, s[12:15], s38 offen lds
    s_waitcnt lgkmcnt(7)
    v_mfma_f32_32x32x16_bf16 v[128:143], v[40:43], v[32:35], v[128:143]
    ds_read_b128 v[56:59], v11 offset:0
    ds_read_b64_tr_b16 v[64:65], v12 offset:12288
    ds_read_b64_tr_b16 v[66:67], v12 offset:13312
    ds_read_b128 v[60:63], v11 offset:16384
    s_waitcnt lgkmcnt(10)
    v_mfma_f32_32x32x16_bf16 v[192:207], v[40:43], v[36:39], v[192:207]
    ds_read_b64_tr_b16 v[68:69], v13 offset:12288
    ds_read_b64_tr_b16 v[70:71], v13 offset:13312
    s_waitcnt lgkmcnt(10)
    v_mfma_f32_32x32x16_bf16 v[144:159], v[44:47], v[32:35], v[144:159]
    ds_read_b64_tr_b16 v[72:73], v14 offset:12288
    ds_read_b64_tr_b16 v[74:75], v14 offset:13312
    v_mfma_f32_32x32x16_bf16 v[208:223], v[44:47], v[36:39], v[208:223]
    ds_read_b64_tr_b16 v[76:77], v15 offset:12288
    ds_read_b64_tr_b16 v[78:79], v15 offset:13312
    s_waitcnt lgkmcnt(12)
    v_mfma_f32_32x32x16_bf16 v[160:175], v[48:51], v[32:35], v[160:175]
    s_add_u32 m0, s37, 32768
    s_add_u32 s38, s36, 4194304
    buffer_load_dwordx4 v4, s[16:19], s38 offen lds
    v_mfma_f32_32x32x16_bf16 v[224:239], v[48:51], v[36:39], v[224:239]
    s_add_u32 m0, s37, 33792
    s_add_u32 s38, s36, 4227072
    buffer_load_dwordx4 v4, s[16:19], s38 offen lds
    s_waitcnt lgkmcnt(10)
    v_mfma_f32_32x32x16_bf16 v[176:191], v[52:55], v[32:35], v[176:191]
    s_add_u32 m0, s37, 34816
    s_add_u32 s38, s36, 4259840
    buffer_load_dwordx4 v4, s[16:19], s38 offen lds
    v_mfma_f32_32x32x16_bf16 v[240:255], v[52:55], v[36:39], v[240:255]
    s_add_u32 m0, s37, 35840
    s_add_u32 s38, s36, 4292608
    buffer_load_dwordx4 v4, s[16:19], s38 offen lds
    s_waitcnt vmcnt(12) lgkmcnt(0)
    s_barrier
    v_add_u32 v8, 98304, v5
    v_add_u32 v12, 131072, v6
    v_xor_b32 v9, 32, v8
    v_xor_b32 v10, 64, v8
    v_xor_b32 v11, 96, v8
    v_xor_b32 v13, 64, v12
    v_xor_b32 v14, 128, v12
    v_xor_b32 v15, 192, v12
    s_waitcnt lgkmcnt(7)
    v_mfma_f32_32x32x16_bf16 v[128:143], v[64:67], v[56:59], v[128:143]
    ds_read_b128 v[32:35], v8 offset:0
    ds_read_b64_tr_b16 v[40:41], v12 offset:0
    s_waitcnt lgkmcnt(8)
    v_mfma_f32_32x32x16_bf16 v[192:207], v[64:67], v[60:63], v[192:207]
    ds_read_b64_tr_b16 v[42:43], v12 offset:1024
    ds_read_b128 v[36:39], v8 offset:16384
    s_waitcnt lgkmcnt(8)
    v_mfma_f32_32x32x16_bf16 v[144:159], v[68:71], v[56:59], v[144:159]
    ds_read_b64_tr_b16 v[44:45], v13 offset:0
    ds_read_b64_tr_b16 v[46:47], v13 offset:1024
    v_mfma_f32_32x32x16_bf16 v[208:223], v[68:71], v[60:63], v[208:223]
    ds_read_b64_tr_b16 v[48:49], v14 offset:0
    ds_read_b64_tr_b16 v[50:51], v14 offset:1024
    s_waitcnt lgkmcnt(10)
    v_mfma_f32_32x32x16_bf16 v[160:175], v[72:75], v[56:59], v[160:175]
    ds_read_b64_tr_b16 v[52:53], v15 offset:0
    ds_read_b64_tr_b16 v[54:55], v15 offset:1024
    v_mfma_f32_32x32x16_bf16 v[224:239], v[72:75], v[60:63], v[224:239]
    s_waitcnt lgkmcnt(10)
    v_mfma_f32_32x32x16_bf16 v[176:191], v[76:79], v[56:59], v[176:191]
    v_mfma_f32_32x32x16_bf16 v[240:255], v[76:79], v[60:63], v[240:255]
    s_waitcnt lgkmcnt(7)
    v_mfma_f32_32x32x16_bf16 v[128:143], v[40:43], v[32:35], v[128:143]
    ds_read_b128 v[56:59], v9 offset:0
    ds_read_b64_tr_b16 v[64:65], v12 offset:4096
    s_waitcnt lgkmcnt(8)
    v_mfma_f32_32x32x16_bf16 v[192:207], v[40:43], v[36:39], v[192:207]
    ds_read_b64_tr_b16 v[66:67], v12 offset:5120
    ds_read_b128 v[60:63], v9 offset:16384
    s_waitcnt lgkmcnt(8)
    v_mfma_f32_32x32x16_bf16 v[144:159], v[44:47], v[32:35], v[144:159]
    ds_read_b64_tr_b16 v[68:69], v13 offset:4096
    ds_read_b64_tr_b16 v[70:71], v13 offset:5120
    v_mfma_f32_32x32x16_bf16 v[208:223], v[44:47], v[36:39], v[208:223]
    ds_read_b64_tr_b16 v[72:73], v14 offset:4096
    ds_read_b64_tr_b16 v[74:75], v14 offset:5120
    s_waitcnt lgkmcnt(10)
    v_mfma_f32_32x32x16_bf16 v[160:175], v[48:51], v[32:35], v[160:175]
    ds_read_b64_tr_b16 v[76:77], v15 offset:4096
    ds_read_b64_tr_b16 v[78:79], v15 offset:5120
    v_mfma_f32_32x32x16_bf16 v[224:239], v[48:51], v[36:39], v[224:239]
    v_and_b32 v122, 31, v0
    v_lshlrev_b32 v122, 2, v122
    buffer_load_dword v123, v122, s[68:71], 0 offen sc1
    s_waitcnt lgkmcnt(10)
    v_mfma_f32_32x32x16_bf16 v[176:191], v[52:55], v[32:35], v[176:191]
    v_mfma_f32_32x32x16_bf16 v[240:255], v[52:55], v[36:39], v[240:255]
    s_waitcnt lgkmcnt(7)
    v_mfma_f32_32x32x16_bf16 v[128:143], v[64:67], v[56:59], v[128:143]
    ds_read_b128 v[32:35], v10 offset:0
    ds_read_b64_tr_b16 v[40:41], v12 offset:8192
    s_waitcnt lgkmcnt(8)
    v_mfma_f32_32x32x16_bf16 v[192:207], v[64:67], v[60:63], v[192:207]
    ds_read_b64_tr_b16 v[42:43], v12 offset:9216
    ds_read_b128 v[36:39], v10 offset:16384
    s_waitcnt lgkmcnt(8)
    v_mfma_f32_32x32x16_bf16 v[144:159], v[68:71], v[56:59], v[144:159]
    ds_read_b64_tr_b16 v[44:45], v13 offset:8192
    ds_read_b64_tr_b16 v[46:47], v13 offset:9216
    v_mfma_f32_32x32x16_bf16 v[208:223], v[68:71], v[60:63], v[208:223]
    ds_read_b64_tr_b16 v[48:49], v14 offset:8192
    ds_read_b64_tr_b16 v[50:51], v14 offset:9216
    s_waitcnt lgkmcnt(10)
    v_mfma_f32_32x32x16_bf16 v[160:175], v[72:75], v[56:59], v[160:175]
    ds_read_b64_tr_b16 v[52:53], v15 offset:8192
    ds_read_b64_tr_b16 v[54:55], v15 offset:9216
    v_mfma_f32_32x32x16_bf16 v[224:239], v[72:75], v[60:63], v[224:239]
    s_waitcnt lgkmcnt(10)
    v_mfma_f32_32x32x16_bf16 v[176:191], v[76:79], v[56:59], v[176:191]
    v_mfma_f32_32x32x16_bf16 v[240:255], v[76:79], v[60:63], v[240:255]
    s_waitcnt lgkmcnt(7)
    v_mfma_f32_32x32x16_bf16 v[128:143], v[40:43], v[32:35], v[128:143]
    ds_read_b128 v[56:59], v11 offset:0
    ds_read_b64_tr_b16 v[64:65], v12 offset:12288
    s_waitcnt lgkmcnt(8)
    v_mfma_f32_32x32x16_bf16 v[192:207], v[40:43], v[36:39], v[192:207]
    ds_read_b64_tr_b16 v[66:67], v12 offset:13312
    ds_read_b128 v[60:63], v11 offset:16384
    s_waitcnt lgkmcnt(8)
    v_mfma_f32_32x32x16_bf16 v[144:159], v[44:47], v[32:35], v[144:159]
    ds_read_b64_tr_b16 v[68:69], v13 offset:12288
    ds_read_b64_tr_b16 v[70:71], v13 offset:13312
    v_mfma_f32_32x32x16_bf16 v[208:223], v[44:47], v[36:39], v[208:223]
    ds_read_b64_tr_b16 v[72:73], v14 offset:12288
    ds_read_b64_tr_b16 v[74:75], v14 offset:13312
    s_waitcnt lgkmcnt(10)
    v_mfma_f32_32x32x16_bf16 v[160:175], v[48:51], v[32:35], v[160:175]
    ds_read_b64_tr_b16 v[76:77], v15 offset:12288
    ds_read_b64_tr_b16 v[78:79], v15 offset:13312
    v_mfma_f32_32x32x16_bf16 v[224:239], v[48:51], v[36:39], v[224:239]
    s_waitcnt lgkmcnt(10)
    v_mfma_f32_32x32x16_bf16 v[176:191], v[52:55], v[32:35], v[176:191]
    v_mfma_f32_32x32x16_bf16 v[240:255], v[52:55], v[36:39], v[240:255]
    s_waitcnt vmcnt(0) lgkmcnt(0)
    s_barrier
    v_add_u32 v8, 0, v5
    v_add_u32 v12, 32768, v6
    v_xor_b32 v9, 32, v8
    v_xor_b32 v10, 64, v8
    v_xor_b32 v11, 96, v8
    v_xor_b32 v13, 64, v12
    v_xor_b32 v14, 128, v12
    v_xor_b32 v15, 192, v12
    s_waitcnt lgkmcnt(7)
    v_mfma_f32_32x32x16_bf16 v[128:143], v[64:67], v[56:59], v[128:143]
    ds_read_b128 v[32:35], v8 offset:0
    ds_read_b64_tr_b16 v[40:41], v12 offset:0
    s_waitcnt lgkmcnt(8)
    v_mfma_f32_32x32x16_bf16 v[192:207], v[64:67], v[60:63], v[192:207]
    ds_read_b64_tr_b16 v[42:43], v12 offset:1024
    ds_read_b128 v[36:39], v8 offset:16384
    s_waitcnt lgkmcnt(8)
    v_mfma_f32_32x32x16_bf16 v[144:159], v[68:71], v[56:59], v[144:159]
    ds_read_b64_tr_b16 v[44:45], v13 offset:0
    ds_read_b64_tr_b16 v[46:47], v13 offset:1024
    v_mfma_f32_32x32x16_bf16 v[208:223], v[68:71], v[60:63], v[208:223]
    ds_read_b64_tr_b16 v[48:49], v14 offset:0
    ds_read_b64_tr_b16 v[50:51], v14 offset:1024
    s_waitcnt lgkmcnt(10)
    v_mfma_f32_32x32x16_bf16 v[160:175], v[72:75], v[56:59], v[160:175]
    ds_read_b64_tr_b16 v[52:53], v15 offset:0
    ds_read_b64_tr_b16 v[54:55], v15 offset:1024
    v_mfma_f32_32x32x16_bf16 v[224:239], v[72:75], v[60:63], v[224:239]
    v_lshrrev_b32 v123, 8, v123
    v_cmp_ne_u32 vcc, 0xff, v123
    s_or_b32 s93, vcc_lo, vcc_hi
    s_waitcnt lgkmcnt(10)
    v_mfma_f32_32x32x16_bf16 v[176:191], v[76:79], v[56:59], v[176:191]
    v_mfma_f32_32x32x16_bf16 v[240:255], v[76:79], v[60:63], v[240:255]
    s_cmp_lg_u32 s93, 0
    s_cbranch_scc1 L_g24s_5
    s_waitcnt lgkmcnt(7)
    v_mfma_f32_32x32x16_bf16 v[128:143], v[40:43], v[32:35], v[128:143]
    ds_read_b128 v[56:59], v9 offset:0
    ds_read_b64_tr_b16 v[64:65], v12 offset:4096
    ds_read_b64_tr_b16 v[66:67], v12 offset:5120
    ds_read_b128 v[60:63], v9 offset:16384
    s_waitcnt lgkmcnt(10)
    v_mfma_f32_32x32x16_bf16 v[192:207], v[40:43], v[36:39], v[192:207]
    ds_read_b64_tr_b16 v[68:69], v13 offset:4096
    ds_read_b64_tr_b16 v[70:71], v13 offset:5120
    ds_read_b64_tr_b16 v[72:73], v14 offset:4096
    ds_read_b64_tr_b16 v[74:75], v14 offset:5120
    s_waitcnt lgkmcnt(12)
    v_mfma_f32_32x32x16_bf16 v[144:159], v[44:47], v[32:35], v[144:159]
    ds_read_b64_tr_b16 v[76:77], v15 offset:4096
    ds_read_b64_tr_b16 v[78:79], v15 offset:5120
    s_add_u32 m0, s42, 0
    s_nop 0
    buffer_load_dwordx4 v1, s[20:23], s41 offen offset:0 lds
    v_mfma_f32_32x32x16_bf16 v[208:223], v[44:47], v[36:39], v[208:223]
    buffer_load_dwordx4 v1, s[20:23], s41 offen offset:1024 lds
    buffer_load_dwordx4 v1, s[20:23], s41 offen offset:2048 lds
    s_waitcnt lgkmcnt(12)
    v_mfma_f32_32x32x16_bf16 v[160:175], v[48:51], v[32:35], v[160:175]
    buffer_load_dwordx4 v1, s[20:23], s41 offen offset:3072 lds
    s_add_u32 m0, s42, 16384
    s_nop 0
    buffer_load_dwordx4 v1, s[24:27], s41 offen offset:0 lds
    v_mfma_f32_32x32x16_bf16 v[224:239], v[48:51], v[36:39], v[224:239]
    buffer_load_dwordx4 v1, s[24:27], s41 offen offset:1024 lds
    buffer_load_dwordx4 v1, s[24:27], s41 offen offset:2048 lds
    s_waitcnt lgkmcnt(10)
    v_mfma_f32_32x32x16_bf16 v[176:191], v[52:55], v[32:35], v[176:191]
    buffer_load_dwordx4 v1, s[24:27], s41 offen offset:3072 lds
    s_add_u32 s41, s41, 16384
    s_add_u32 s42, s42, 32768
    v_mfma_f32_32x32x16_bf16 v[240:255], v[52:55], v[36:39], v[240:255]
    s_cmp_ge_u32 s42, 163840
    s_cselect_b32 s42, s37, s42
    s_waitcnt lgkmcnt(7)
    v_mfma_f32_32x32x16_bf16 v[128:143], v[64:67], v[56:59], v[128:143]
    ds_read_b128 v[32:35], v10 offset:0
    ds_read_b64_tr_b16 v[40:41], v12 offset:8192
    ds_read_b64_tr_b16 v[42:43], v12 offset:9216
    ds_read_b128 v[36:39], v10 offset:16384
    s_waitcnt lgkmcnt(10)
    v_mfma_f32_32x32x16_bf16 v[192:207], v[64:67], v[60:63], v[192:207]
    ds_read_b64_tr_b16 v[44:45], v13 offset:8192
    ds_read_b64_tr_b16 v[46:47], v13 offset:9216
    ds_read_b64_tr_b16 v[48:49], v14 offset:8192
    ds_read_b64_tr_b16 v[50:51], v14 offset:9216
    s_waitcnt lgkmcnt(12)
    v_mfma_f32_32x32x16_bf16 v[144:159], v[68:71], v[56:59], v[144:159]
    ds_read_b64_tr_b16 v[52:53], v15 offset:8192
    ds_read_b64_tr_b16 v[54:55], v15 offset:9216
    s_add_u32 m0, s42, 0
    s_nop 0
    buffer_load_dwordx4 v1, s[20:23], s41 offen offset:0 lds
    v_mfma_f32_32x32x16_bf16 v[208:223], v[68:71], v[60:63], v[208:223]
    buffer_load_dwordx4 v1, s[20:23], s41 offen offset:1024 lds
    buffer_load_dwordx4 v1, s[20:23], s41 offen offset:2048 lds
    s_waitcnt lgkmcnt(12)
    v_mfma_f32_32x32x16_bf16 v[160:175], v[72:75], v[56:59], v[160:175]
    buffer_load_dwordx4 v1, s[20:23], s41 offen offset:3072 lds
    s_add_u32 m0, s42, 16384
    s_nop 0
    buffer_load_dwordx4 v1, s[24:27], s41 offen offset:0 lds
    v_mfma_f32_32x32x16_bf16 v[224:239], v[72:75], v[60:63], v[224:239]
    buffer_load_dwordx4 v1, s[24:27], s41 offen offset:1024 lds
    buffer_load_dwordx4 v1, s[24:27], s41 offen offset:2048 lds
    s_waitcnt lgkmcnt(10)
    v_mfma_f32_32x32x16_bf16 v[176:191], v[76:79], v[56:59], v[176:191]
    buffer_load_dwordx4 v1, s[24:27], s41 offen offset:3072 lds
    s_add_u32 s41, s41, 16384
    s_add_u32 s42, s42, 32768
    v_mfma_f32_32x32x16_bf16 v[240:255], v[76:79], v[60:63], v[240:255]
    s_cmp_ge_u32 s42, 163840
    s_cselect_b32 s42, s37, s42
    s_waitcnt lgkmcnt(7)
    v_mfma_f32_32x32x16_bf16 v[128:143], v[40:43], v[32:35], v[128:143]
    ds_read_b128 v[56:59], v11 offset:0
    ds_read_b64_tr_b16 v[64:65], v12 offset:12288
    ds_read_b64_tr_b16 v[66:67], v12 offset:13312
    ds_read_b128 v[60:63], v11 offset:16384
    s_waitcnt lgkmcnt(10)
    v_mfma_f32_32x32x16_bf16 v[192:207], v[40:43], v[36:39], v[192:207]
    ds_read_b64_tr_b16 v[68:69], v13 offset:12288
    ds_read_b64_tr_b16 v[70:71], v13 offset:13312
    ds_read_b64_tr_b16 v[72:73], v14 offset:12288
    ds_read_b64_tr_b16 v[74:75], v14 offset:13312
    s_waitcnt lgkmcnt(12)
    v_mfma_f32_32x32x16_bf16 v[144:159], v[44:47], v[32:35], v[144:159]
    ds_read_b64_tr_b16 v[76:77], v15 offset:12288
    ds_read_b64_tr_b16 v[78:79], v15 offset:13312
    s_add_u32 m0, s42, 0
    s_nop 0
    buffer_load_dwordx4 v1, s[20:23], s41 offen offset:0 lds
    v_mfma_f32_32x32x16_bf16 v[208:223], v[44:47], v[36:39], v[208:223]
    buffer_load_dwordx4 v1, s[20:23], s41 offen offset:1024 lds
    buffer_load_dwordx4 v1, s[20:23], s41 offen offset:2048 lds
    s_waitcnt lgkmcnt(12)
    v_mfma_f32_32x32x16_bf16 v[160:175], v[48:51], v[32:35], v[160:175]
    buffer_load_dwordx4 v1, s[20:23], s41 offen offset:3072 lds
    s_add_u32 m0, s42, 16384
    s_nop 0
    buffer_load_dwordx4 v1, s[24:27], s41 offen offset:0 lds
    v_mfma_f32_32x32x16_bf16 v[224:239], v[48:51], v[36:39], v[224:239]
    buffer_load_dwordx4 v1, s[24:27], s41 offen offset:1024 lds
    buffer_load_dwordx4 v1, s[24:27], s41 offen offset:2048 lds
    s_waitcnt lgkmcnt(10)
    v_mfma_f32_32x32x16_bf16 v[176:191], v[52:55], v[32:35], v[176:191]
    buffer_load_dwordx4 v1, s[24:27], s41 offen offset:3072 lds
    s_add_u32 s41, s41, 16384
    s_add_u32 s42, s42, 32768
    v_mfma_f32_32x32x16_bf16 v[240:255], v[52:55], v[36:39], v[240:255]
    s_cmp_ge_u32 s42, 163840
    s_cselect_b32 s42, s37, s42
    s_waitcnt lgkmcnt(0)
    s_waitcnt lgkmcnt(7)
    v_mfma_f32_32x32x16_bf16 v[128:143], v[64:67], v[56:59], v[128:143]
    s_waitcnt lgkmcnt(6)
    v_mfma_f32_32x32x16_bf16 v[192:207], v[64:67], v[60:63], v[192:207]
    s_waitcnt lgkmcnt(4)
    v_mfma_f32_32x32x16_bf16 v[144:159], v[68:71], v[56:59], v[144:159]
    v_mfma_f32_32x32x16_bf16 v[208:223], v[68:71], v[60:63], v[208:223]
    s_waitcnt lgkmcnt(2)
    v_mfma_f32_32x32x16_bf16 v[160:175], v[72:75], v[56:59], v[160:175]
    v_mfma_f32_32x32x16_bf16 v[224:239], v[72:75], v[60:63], v[224:239]
    s_waitcnt lgkmcnt(0)
    v_mfma_f32_32x32x16_bf16 v[176:191], v[76:79], v[56:59], v[176:191]
    v_mfma_f32_32x32x16_bf16 v[240:255], v[76:79], v[60:63], v[240:255]
    s_branch L_g24j_6
L_g24s_5:
    s_waitcnt lgkmcnt(7)
    v_mfma_f32_32x32x16_bf16 v[128:143], v[40:43], v[32:35], v[128:143]
    ds_read_b128 v[56:59], v9 offset:0
    ds_read_b64_tr_b16 v[64:65], v12 offset:4096
    s_waitcnt lgkmcnt(8)
    v_mfma_f32_32x32x16_bf16 v[192:207], v[40:43], v[36:39], v[192:207]
    ds_read_b64_tr_b16 v[66:67], v12 offset:5120
    ds_read_b128 v[60:63], v9 offset:16384
    s_waitcnt lgkmcnt(8)
    v_mfma_f32_32x32x16_bf16 v[144:159], v[44:47], v[32:35], v[144:159]
    ds_read_b64_tr_b16 v[68:69], v13 offset:4096
    ds_read_b64_tr_b16 v[70:71], v13 offset:5120
    v_mfma_f32_32x32x16_bf16 v[208:223], v[44:47], v[36:39], v[208:223]
    ds_read_b64_tr_b16 v[72:73], v14 offset:4096
    ds_read_b64_tr_b16 v[74:75], v14 offset:5120
    s_waitcnt lgkmcnt(10)
    v_mfma_f32_32x32x16_bf16 v[160:175], v[48:51], v[32:35], v[160:175]
    ds_read_b64_tr_b16 v[76:77], v15 offset:4096
    ds_read_b64_tr_b16 v[78:79], v15 offset:5120
    v_mfma_f32_32x32x16_bf16 v[224:239], v[48:51], v[36:39], v[224:239]
    s_waitcnt lgkmcnt(10)
    v_mfma_f32_32x32x16_bf16 v[176:191], v[52:55], v[32:35], v[176:191]
    v_mfma_f32_32x32x16_bf16 v[240:255], v[52:55], v[36:39], v[240:255]
    s_waitcnt lgkmcnt(7)
    v_mfma_f32_32x32x16_bf16 v[128:143], v[64:67], v[56:59], v[128:143]
    ds_read_b128 v[32:35], v10 offset:0
    ds_read_b64_tr_b16 v[40:41], v12 offset:8192
    s_waitcnt lgkmcnt(8)
    v_mfma_f32_32x32x16_bf16 v[192:207], v[64:67], v[60:63], v[192:207]
    ds_read_b64_tr_b16 v[42:43], v12 offset:9216
    ds_read_b128 v[36:39], v10 offset:16384
    s_waitcnt lgkmcnt(8)
    v_mfma_f32_32x32x16_bf16 v[144:159], v[68:71], v[56:59], v[144:159]
    ds_read_b64_tr_b16 v[44:45], v13 offset:8192
    ds_read_b64_tr_b16 v[46:47], v13 offset:9216
    v_mfma_f32_32x32x16_bf16 v[208:223], v[68:71], v[60:63], v[208:223]
    ds_read_b64_tr_b16 v[48:49], v14 offset:8192
    ds_read_b64_tr_b16 v[50:51], v14 offset:9216
    s_waitcnt lgkmcnt(10)
    v_mfma_f32_32x32x16_bf16 v[160:175], v[72:75], v[56:59], v[160:175]
    ds_read_b64_tr_b16 v[52:53], v15 offset:8192
    ds_read_b64_tr_b16 v[54:55], v15 offset:9216
    v_mfma_f32_32x32x16_bf16 v[224:239], v[72:75], v[60:63], v[224:239]
    s_waitcnt lgkmcnt(10)
    v_mfma_f32_32x32x16_bf16 v[176:191], v[76:79], v[56:59], v[176:191]
    v_mfma_f32_32x32x16_bf16 v[240:255], v[76:79], v[60:63], v[240:255]
    s_waitcnt lgkmcnt(7)
    v_mfma_f32_32x32x16_bf16 v[128:143], v[40:43], v[32:35], v[128:143]
    ds_read_b128 v[56:59], v11 offset:0
    ds_read_b64_tr_b16 v[64:65], v12 offset:12288
    s_waitcnt lgkmcnt(8)
    v_mfma_f32_32x32x16_bf16 v[192:207], v[40:43], v[36:39], v[192:207]
    ds_read_b64_tr_b16 v[66:67], v12 offset:13312
    ds_read_b128 v[60:63], v11 offset:16384
    s_waitcnt lgkmcnt(8)
    v_mfma_f32_32x32x16_bf16 v[144:159], v[44:47], v[32:35], v[144:159]
    ds_read_b64_tr_b16 v[68:69], v13 offset:12288
    ds_read_b64_tr_b16 v[70:71], v13 offset:13312
    v_mfma_f32_32x32x16_bf16 v[208:223], v[44:47], v[36:39], v[208:223]
    ds_read_b64_tr_b16 v[72:73], v14 offset:12288
    ds_read_b64_tr_b16 v[74:75], v14 offset:13312
    s_waitcnt lgkmcnt(10)
    v_mfma_f32_32x32x16_bf16 v[160:175], v[48:51], v[32:35], v[160:175]
    ds_read_b64_tr_b16 v[76:77], v15 offset:12288
    ds_read_b64_tr_b16 v[78:79], v15 offset:13312
    v_mfma_f32_32x32x16_bf16 v[224:239], v[48:51], v[36:39], v[224:239]
    s_waitcnt lgkmcnt(10)
    v_mfma_f32_32x32x16_bf16 v[176:191], v[52:55], v[32:35], v[176:191]
    v_mfma_f32_32x32x16_bf16 v[240:255], v[52:55], v[36:39], v[240:255]
    s_waitcnt lgkmcnt(0)
    s_waitcnt lgkmcnt(7)
    v_mfma_f32_32x32x16_bf16 v[128:143], v[64:67], v[56:59], v[128:143]
    s_waitcnt lgkmcnt(6)
    v_mfma_f32_32x32x16_bf16 v[192:207], v[64:67], v[60:63], v[192:207]
    s_waitcnt lgkmcnt(4)
    v_mfma_f32_32x32x16_bf16 v[144:159], v[68:71], v[56:59], v[144:159]
    v_mfma_f32_32x32x16_bf16 v[208:223], v[68:71], v[60:63], v[208:223]
    s_waitcnt lgkmcnt(2)
    v_mfma_f32_32x32x16_bf16 v[160:175], v[72:75], v[56:59], v[160:175]
    v_mfma_f32_32x32x16_bf16 v[224:239], v[72:75], v[60:63], v[224:239]
    s_waitcnt lgkmcnt(0)
    v_mfma_f32_32x32x16_bf16 v[176:191], v[76:79], v[56:59], v[176:191]
    v_mfma_f32_32x32x16_bf16 v[240:255], v[76:79], v[60:63], v[240:255]
L_g24j_6:
L_k2_wait:
    v_mov_b32 v22, 0xf000
    s_cmp_lg_u32 s34, 0
    s_cbranch_scc1 L_ksync_9
    s_cmp_eq_u32 s93, 0
    s_cbranch_scc1 L_kgo_8
    v_and_b32 v23, 31, v0
    v_lshlrev_b32 v23, 2, v23
L_kpoll_7:
    buffer_load_dword v24, v23, s[68:71], 0 offen sc1
    s_waitcnt vmcnt(0)
    v_lshrrev_b32 v25, 8, v24
    v_cmp_ne_u32 vcc, 0xff, v25
    s_cbranch_vccz L_kgo_8
    v_and_b32 v25, 0xff, v24
    v_cmp_ne_u32 vcc, 0xff, v25
    s_cbranch_vccnz L_k2_steal
    s_sleep 24
    s_branch L_kpoll_7
L_kgo_8:
    v_mov_b32 v24, -1
L_k2_pub:
    ds_write_b32 v22, v24
    s_waitcnt lgkmcnt(0)
L_ksync_9:
    s_barrier
    ds_read_b32 v24, v22
    s_waitcnt lgkmcnt(0)
    v_readfirstlane_b32 s79, v24
    s_barrier
    s_cmp_lg_u32 s79, -1
    s_cbranch_scc1 L_k2_runsteal
    s_cmp_eq_u32 s93, 0
    s_cbranch_scc1 L_have_10
    s_add_u32 m0, s42, 0
    s_nop 0
    buffer_load_dwordx4 v1, s[20:23], s41 offen offset:0 lds
    buffer_load_dwordx4 v1, s[20:23], s41 offen offset:1024 lds
    buffer_load_dwordx4 v1, s[20:23], s41 offen offset:2048 lds
    buffer_load_dwordx4 v1, s[20:23], s41 offen offset:3072 lds
    s_add_u32 m0, s42, 16384
    s_nop 0
    buffer_load_dwordx4 v1, s[24:27], s41 offen offset:0 lds
    buffer_load_dwordx4 v1, s[24:27], s41 offen offset:1024 lds
    buffer_load_dwordx4 v1, s[24:27], s41 offen offset:2048 lds
    buffer_load_dwordx4 v1, s[24:27], s41 offen offset:3072 lds
    s_add_u32 s41, s41, 16384
    s_add_u32 s42, s42, 32768
    s_cmp_ge_u32 s42, 163840
    s_cselect_b32 s42, s37, s42
    s_add_u32 m0, s42, 0
    s_nop 0
    buffer_load_dwordx4 v1, s[20:23], s41 offen offset:0 lds
    buffer_load_dwordx4 v1, s[20:23], s41 offen offset:1024 lds
    buffer_load_dwordx4 v1, s[20:23], s41 offen offset:2048 lds
    buffer_load_dwordx4 v1, s[20:23], s41 offen offset:3072 lds
    s_add_u32 m0, s42, 16384
    s_nop 0
    buffer_load_dwordx4 v1, s[24:27], s41 offen offset:0 lds
    buffer_load_dwordx4 v1, s[24:27], s41 offen offset:1024 lds
    buffer_load_dwordx4 v1, s[24:27], s41 offen offset:2048 lds
    buffer_load_dwordx4 v1, s[24:27], s41 offen offset:3072 lds
    s_add_u32 s41, s41, 16384
    s_add_u32 s42, s42, 32768
    s_cmp_ge_u32 s42, 163840
    s_cselect_b32 s42, s37, s42
    s_add_u32 m0, s42, 0
    s_nop 0
    buffer_load_dwordx4 v1, s[20:23], s41 offen offset:0 lds
    buffer_load_dwordx4 v1, s[20:23], s41 offen offset:1024 lds
    buffer_load_dwordx4 v1, s[20:23], s41 offen offset:2048 lds
    buffer_load_dwordx4 v1, s[20:23], s41 offen offset:3072 lds
    s_add_u32 m0, s42, 16384
    s_nop 0
    buffer_load_dwordx4 v1, s[24:27], s41 offen offset:0 lds
    buffer_load_dwordx4 v1, s[24:27], s41 offen offset:1024 lds
    buffer_load_dwordx4 v1, s[24:27], s41 offen offset:2048 lds
    buffer_load_dwordx4 v1, s[24:27], s41 offen offset:3072 lds
    s_add_u32 s41, s41, 16384
    s_add_u32 s42, s42, 32768
    s_cmp_ge_u32 s42, 163840
    s_cselect_b32 s42, s37, s42
L_have_10:
    s_add_u32 m0, s42, 0
    s_nop 0
    buffer_load_dwordx4 v1, s[20:23], s41 offen offset:0 lds
    buffer_load_dwordx4 v1, s[20:23], s41 offen offset:1024 lds
    buffer_load_dwordx4 v1, s[20:23], s41 offen offset:2048 lds
    buffer_load_dwordx4 v1, s[20:23], s41 offen offset:3072 lds
    s_add_u32 m0, s42, 16384
    s_nop 0
    buffer_load_dwordx4 v1, s[24:27], s41 offen offset:0 lds
    buffer_load_dwordx4 v1, s[24:27], s41 offen offset:1024 lds
    buffer_load_dwordx4 v1, s[24:27], s41 offen offset:2048 lds
    buffer_load_dwordx4 v1, s[24:27], s41 offen offset:3072 lds
    s_add_u32 s41, s41, 16384
    s_add_u32 s42, s42, 32768
    s_cmp_ge_u32 s42, 163840
    s_cselect_b32 s42, s37, s42
    buffer_load_dwordx4 v[28:31], v1, s[88:91], s92 offen
    s_add_u32 s92, s92, 1024
    buffer_load_dwordx4 v[28:31], v1, s[88:91], s92 offen
    s_add_u32 s92, s92, 1024
    s_mov_b32 s56, 0xffffffff
    s_mov_b32 s57, 0xfffffff0
    s_mov_b32 s58, 0xfffffffe
    s_mov_b32 s59, 0xffffffe0
    s_mov_b32 s60, 0xfffffffc
    s_mov_b32 s61, 0xffffffc0
    s_mov_b32 s62, 0xfffffff8
    s_mov_b32 s63, 0xffffff80
    s_mov_b32 s64, 0xffffff00
    s_mov_b32 s65, 0xfffff000
    s_mov_b32 s66, 0xfffffe00
    s_mov_b32 s67, 0xffffe000
    s_mov_b32 s68, 0xfffffc00
    s_mov_b32 s69, 0xffffc000
    s_mov_b32 s70, 0xfffff800
    s_mov_b32 s71, 0xffff8000
    s_mov_b32 s72, 0xffff0000
    s_mov_b32 s73, 0xfff00000
    s_mov_b32 s74, 0xfffe0000
    s_mov_b32 s75, 0xffe00000
    s_mov_b32 s76, 0xfffc0000
    s_mov_b32 s77, 0xffc00000
    s_mov_b32 s78, 0xfff80000
    s_mov_b32 s79, 0xff800000
    s_mov_b32 s80, 0xff000000
    s_mov_b32 s81, 0xf0000000
    s_mov_b32 s82, 0xfe000000
    s_mov_b32 s83, 0xe0000000
    s_mov_b32 s84, 0xfc000000
    s_mov_b32 s85, 0xc0000000
    s_mov_b32 s86, 0xf8000000
    s_mov_b32 s87, 0x80000000
    v_add_u32 v16, 65536, v1
    s_mov_b32 s43, 0
    v_mov_b32 v20, 0
    s_cmp_eq_u32 s43, s46
    s_cbranch_scc1 L_md_11
    s_cmp_gt_u32 s43, s46
    s_cbranch_scc1 L_mf_12
    v_mov_b32 v64, v20
    v_mov_b32 v65, v20
    v_mov_b32 v66, v20
    v_mov_b32 v67, v20
    v_mov_b32 v68, v20
    v_mov_b32 v69, v20
    v_mov_b32 v70, v20
    v_mov_b32 v71, v20
    v_mov_b32 v72, v20
    v_mov_b32 v73, v20
    v_mov_b32 v74, v20
    v_mov_b32 v75, v20
    v_mov_b32 v76, v20
    v_mov_b32 v77, v20
    v_mov_b32 v78, v20
    v_mov_b32 v79, v20
    s_branch L_mx_13
L_md_11:
    v_mov_b32 v22, 0xf149f2ca
    v_cndmask_b32 v64, v22, v20, s[56:57]
    v_cndmask_b32 v65, v22, v20, s[58:59]
    v_cndmask_b32 v66, v22, v20, s[60:61]
    v_cndmask_b32 v67, v22, v20, s[62:63]
    v_cndmask_b32 v68, v22, v20, s[64:65]
    v_cndmask_b32 v69, v22, v20, s[66:67]
    v_cndmask_b32 v70, v22, v20, s[68:69]
    v_cndmask_b32 v71, v22, v20, s[70:71]
    v_cndmask_b32 v72, v22, v20, s[72:73]
    v_cndmask_b32 v73, v22, v20, s[74:75]
    v_cndmask_b32 v74, v22, v20, s[76:77]
    v_cndmask_b32 v75, v22, v20, s[78:79]
    v_cndmask_b32 v76, v22, v20, s[80:81]
    v_cndmask_b32 v77, v22, v20, s[82:83]
    v_cndmask_b32 v78, v22, v20, s[84:85]
    v_cndmask_b32 v79, v22, v20, s[86:87]
    s_branch L_mx_13
L_mf_12:
    v_mov_b32 v64, 0xf149f2ca
    v_mov_b32 v65, 0xf149f2ca
    v_mov_b32 v66, 0xf149f2ca
    v_mov_b32 v67, 0xf149f2ca
    v_mov_b32 v68, 0xf149f2ca
    v_mov_b32 v69, 0xf149f2ca
    v_mov_b32 v70, 0xf149f2ca
    v_mov_b32 v71, 0xf149f2ca
    v_mov_b32 v72, 0xf149f2ca
    v_mov_b32 v73, 0xf149f2ca
    v_mov_b32 v74, 0xf149f2ca
    v_mov_b32 v75, 0xf149f2ca
    v_mov_b32 v76, 0xf149f2ca
    v_mov_b32 v77, 0xf149f2ca
    v_mov_b32 v78, 0xf149f2ca
    v_mov_b32 v79, 0xf149f2ca
L_mx_13:
    v_cvt_pk_bf16_f32 v112, v128, v129
    v_cvt_pk_bf16_f32 v113, v130, v131
    v_cvt_pk_bf16_f32 v114, v132, v133
    v_cvt_pk_bf16_f32 v115, v134, v135
    v_accvgpr_write_b32 a0, v112
    v_accvgpr_write_b32 a1, v113
    v_accvgpr_write_b32 a2, v114
    v_accvgpr_write_b32 a3, v115
    v_cvt_pk_bf16_f32 v116, v136, v137
    v_cvt_pk_bf16_f32 v117, v138, v139
    v_cvt_pk_bf16_f32 v118, v140, v141
    v_cvt_pk_bf16_f32 v119, v142, v143
    v_accvgpr_write_b32 a4, v116
    v_accvgpr_write_b32 a5, v117
    v_accvgpr_write_b32 a6, v118
    v_accvgpr_write_b32 a7, v119
    v_cvt_pk_bf16_f32 v120, v144, v145
    v_cvt_pk_bf16_f32 v121, v146, v147
    v_cvt_pk_bf16_f32 v122, v148, v149
    v_cvt_pk_bf16_f32 v123, v150, v151
    v_accvgpr_write_b32 a8, v120
    v_accvgpr_write_b32 a9, v121
    v_accvgpr_write_b32 a10, v122
    v_accvgpr_write_b32 a11, v123
    v_cvt_pk_bf16_f32 v124, v152, v153
    v_cvt_pk_bf16_f32 v125, v154, v155
    v_cvt_pk_bf16_f32 v126, v156, v157
    v_cvt_pk_bf16_f32 v127, v158, v159
    v_accvgpr_write_b32 a12, v124
    v_accvgpr_write_b32 a13, v125
    v_accvgpr_write_b32 a14, v126
    v_accvgpr_write_b32 a15, v127
    v_cvt_pk_bf16_f32 v112, v160, v161
    v_cvt_pk_bf16_f32 v113, v162, v163
    v_cvt_pk_bf16_f32 v114, v164, v165
    v_cvt_pk_bf16_f32 v115, v166, v167
    v_accvgpr_write_b32 a16, v112
    v_accvgpr_write_b32 a17, v113
    v_accvgpr_write_b32 a18, v114
    v_accvgpr_write_b32 a19, v115
    v_cvt_pk_bf16_f32 v116, v168, v169
    v_cvt_pk_bf16_f32 v117, v170, v171
    v_cvt_pk_bf16_f32 v118, v172, v173
    v_cvt_pk_bf16_f32 v119, v174, v175
    v_accvgpr_write_b32 a20, v116
    v_accvgpr_write_b32 a21, v117
    v_accvgpr_write_b32 a22, v118
    v_accvgpr_write_b32 a23, v119
    v_cvt_pk_bf16_f32 v120, v176, v177
    v_cvt_pk_bf16_f32 v121, v178, v179
    v_cvt_pk_bf16_f32 v122, v180, v181
    v_cvt_pk_bf16_f32 v123, v182, v183
    v_accvgpr_write_b32 a24, v120
    v_accvgpr_write_b32 a25, v121
    v_accvgpr_write_b32 a26, v122
    v_accvgpr_write_b32 a27, v123
    v_cvt_pk_bf16_f32 v124, v184, v185
    v_cvt_pk_bf16_f32 v125, v186, v187
    v_cvt_pk_bf16_f32 v126, v188, v189
    v_cvt_pk_bf16_f32 v127, v190, v191
    v_accvgpr_write_b32 a28, v124
    v_accvgpr_write_b32 a29, v125
    v_accvgpr_write_b32 a30, v126
    v_accvgpr_write_b32 a31, v127
    v_cvt_pk_bf16_f32 v112, v192, v193
    v_cvt_pk_bf16_f32 v113, v194, v195
    v_cvt_pk_bf16_f32 v114, v196, v197
    v_cvt_pk_bf16_f32 v115, v198, v199
    v_accvgpr_write_b32 a32, v112
    v_accvgpr_write_b32 a33, v113
    v_accvgpr_write_b32 a34, v114
    v_accvgpr_write_b32 a35, v115
    v_cvt_pk_bf16_f32 v116, v200, v201
    v_cvt_pk_bf16_f32 v117, v202, v203
    v_cvt_pk_bf16_f32 v118, v204, v205
    v_cvt_pk_bf16_f32 v119, v206, v207
    v_accvgpr_write_b32 a36, v116
    v_accvgpr_write_b32 a37, v117
    v_accvgpr_write_b32 a38, v118
    v_accvgpr_write_b32 a39, v119
    v_cvt_pk_bf16_f32 v120, v208, v209
    v_cvt_pk_bf16_f32 v121, v210, v211
    v_cvt_pk_bf16_f32 v122, v212, v213
    v_cvt_pk_bf16_f32 v123, v214, v215
    v_accvgpr_write_b32 a40, v120
    v_accvgpr_write_b32 a41, v121
    v_accvgpr_write_b32 a42, v122
    v_accvgpr_write_b32 a43, v123
    v_cvt_pk_bf16_f32 v124, v216, v217
    v_cvt_pk_bf16_f32 v125, v218, v219
    v_cvt_pk_bf16_f32 v126, v220, v221
    v_cvt_pk_bf16_f32 v127, v222, v223
    v_accvgpr_write_b32 a44, v124
    v_accvgpr_write_b32 a45, v125
    v_accvgpr_write_b32 a46, v126
    v_accvgpr_write_b32 a47, v127
    v_cvt_pk_bf16_f32 v112, v224, v225
    v_cvt_pk_bf16_f32 v113, v226, v227
    v_cvt_pk_bf16_f32 v114, v228, v229
    v_cvt_pk_bf16_f32 v115, v230, v231
    v_accvgpr_write_b32 a48, v112
    v_accvgpr_write_b32 a49, v113
    v_accvgpr_write_b32 a50, v114
    v_accvgpr_write_b32 a51, v115
    v_cvt_pk_bf16_f32 v116, v232, v233
    v_cvt_pk_bf16_f32 v117, v234, v235
    v_cvt_pk_bf16_f32 v118, v236, v237
    v_cvt_pk_bf16_f32 v119, v238, v239
    v_accvgpr_write_b32 a52, v116
    v_accvgpr_write_b32 a53, v117
    v_accvgpr_write_b32 a54, v118
    v_accvgpr_write_b32 a55, v119
    v_cvt_pk_bf16_f32 v120, v240, v241
    v_cvt_pk_bf16_f32 v121, v242, v243
    v_cvt_pk_bf16_f32 v122, v244, v245
    v_cvt_pk_bf16_f32 v123, v246, v247
    v_accvgpr_write_b32 a56, v120
    v_accvgpr_write_b32 a57, v121
    v_accvgpr_write_b32 a58, v122
    v_accvgpr_write_b32 a59, v123
    v_cvt_pk_bf16_f32 v124, v248, v249
    v_cvt_pk_bf16_f32 v125, v250, v251
    v_cvt_pk_bf16_f32 v126, v252, v253
    v_cvt_pk_bf16_f32 v127, v254, v255
    v_accvgpr_write_b32 a60, v124
    v_accvgpr_write_b32 a61, v125
    v_accvgpr_write_b32 a62, v126
    v_accvgpr_write_b32 a63, v127
    v_mov_b32 v128, 0
    v_mov_b32 v129, 0
    v_mov_b32 v130, 0
    v_mov_b32 v131, 0
    v_mov_b32 v132, 0
    v_mov_b32 v133, 0
    v_mov_b32 v134, 0
    v_mov_b32 v135, 0
    v_mov_b32 v136, 0
    v_mov_b32 v137, 0
    v_mov_b32 v138, 0
    v_mov_b32 v139, 0
    v_mov_b32 v140, 0
    v_mov_b32 v141, 0
    v_mov_b32 v142, 0
    v_mov_b32 v143, 0
    v_mov_b32 v144, 0
    v_mov_b32 v145, 0
    v_mov_b32 v146, 0
    v_mov_b32 v147, 0
    v_mov_b32 v148, 0
    v_mov_b32 v149, 0
    v_mov_b32 v150, 0
    v_mov_b32 v151, 0
    v_mov_b32 v152, 0
    v_mov_b32 v153, 0
    v_mov_b32 v154, 0
    v_mov_b32 v155, 0
    v_mov_b32 v156, 0
    v_mov_b32 v157, 0
    v_mov_b32 v158, 0
    v_mov_b32 v159, 0
    v_mov_b32 v160, 0
    v_mov_b32 v161, 0
    v_mov_b32 v162, 0
    v_mov_b32 v163, 0
    v_mov_b32 v164, 0
    v_mov_b32 v165, 0
    v_mov_b32 v166, 0
    v_mov_b32 v167, 0
    v_mov_b32 v168, 0
    v_mov_b32 v169, 0
    v_mov_b32 v170, 0
    v_mov_b32 v171, 0
    v_mov_b32 v172, 0
    v_mov_b32 v173, 0
    v_mov_b32 v174, 0
    v_mov_b32 v175, 0
    v_mov_b32 v176, 0
    v_mov_b32 v177, 0
    v_mov_b32 v178, 0
    v_mov_b32 v179, 0
    v_mov_b32 v180, 0
    v_mov_b32 v181, 0
    v_mov_b32 v182, 0
    v_mov_b32 v183, 0
    v_mov_b32 v184, 0
    v_mov_b32 v185, 0
    v_mov_b32 v186, 0
    v_mov_b32 v187, 0
    v_mov_b32 v188, 0
    v_mov_b32 v189, 0
    v_mov_b32 v190, 0
    v_mov_b32 v191, 0
    v_mov_b32 v192, 0
    v_mov_b32 v193, 0
    v_mov_b32 v194, 0
    v_mov_b32 v195, 0
    v_mov_b32 v196, 0
    v_mov_b32 v197, 0
    v_mov_b32 v198, 0
    v_mov_b32 v199, 0
    v_mov_b32 v200, 0
    v_mov_b32 v201, 0
    v_mov_b32 v202, 0
    v_mov_b32 v203, 0
    v_mov_b32 v204, 0
    v_mov_b32 v205, 0
    v_mov_b32 v206, 0
    v_mov_b32 v207, 0
    v_mov_b32 v208, 0
    v_mov_b32 v209, 0
    v_mov_b32 v210, 0
    v_mov_b32 v211, 0
    v_mov_b32 v212, 0
    v_mov_b32 v213, 0
    v_mov_b32 v214, 0
    v_mov_b32 v215, 0
    v_mov_b32 v216, 0
    v_mov_b32 v217, 0
    v_mov_b32 v218, 0
    v_mov_b32 v219, 0
    v_mov_b32 v220, 0
    v_mov_b32 v221, 0
    v_mov_b32 v222, 0
    v_mov_b32 v223, 0
    v_mov_b32 v224, 0
    v_mov_b32 v225, 0
    v_mov_b32 v226, 0
    v_mov_b32 v227, 0
    v_mov_b32 v228, 0
    v_mov_b32 v229, 0
    v_mov_b32 v230, 0
    v_mov_b32 v231, 0
    v_mov_b32 v232, 0
    v_mov_b32 v233, 0
    v_mov_b32 v234, 0
    v_mov_b32 v235, 0
    v_mov_b32 v236, 0
    v_mov_b32 v237, 0
    v_mov_b32 v238, 0
    v_mov_b32 v239, 0
    v_mov_b32 v240, 0
    v_mov_b32 v241, 0
    v_mov_b32 v242, 0
    v_mov_b32 v243, 0
    v_mov_b32 v244, 0
    v_mov_b32 v245, 0
    v_mov_b32 v246, 0
    v_mov_b32 v247, 0
    v_mov_b32 v248, 0
    v_mov_b32 v249, 0
    v_mov_b32 v250, 0
    v_mov_b32 v251, 0
    v_mov_b32 v252, 0
    v_mov_b32 v253, 0
    v_mov_b32 v254, 0
    v_mov_b32 v255, 0
    s_waitcnt vmcnt(18)
    s_barrier
    ds_read_b128 a[64:67], v16 offset:0
    ds_read_b128 a[68:71], v16 offset:1024
    ds_read_b128 a[72:75], v16 offset:2048
    ds_read_b128 a[76:79], v16 offset:3072
    ds_read_b128 a[80:83], v16 offset:4096
    ds_read_b128 a[84:87], v16 offset:5120
    ds_read_b128 a[88:91], v16 offset:6144
    ds_read_b128 a[92:95], v16 offset:7168
    s_waitcnt lgkmcnt(0)
    v_mfma_f32_32x32x16_bf16 v[32:47], a[64:67], a[0:3], v[64:79]
    v_mfma_f32_32x32x16_bf16 v[32:47], a[68:71], a[4:7], v[32:47]
    v_mfma_f32_32x32x16_bf16 v[32:47], a[72:75], a[8:11], v[32:47]
    v_mfma_f32_32x32x16_bf16 v[32:47], a[76:79], a[12:15], v[32:47]
    v_mfma_f32_32x32x16_bf16 v[32:47], a[80:83], a[16:19], v[32:47]
    v_mfma_f32_32x32x16_bf16 v[32:47], a[84:87], a[20:23], v[32:47]
    v_mfma_f32_32x32x16_bf16 v[32:47], a[88:91], a[24:27], v[32:47]
    v_mfma_f32_32x32x16_bf16 v[32:47], a[92:95], a[28:31], v[32:47]
    v_mfma_f32_32x32x16_bf16 v[48:63], a[64:67], a[32:35], 0
    v_mfma_f32_32x32x16_bf16 v[48:63], a[68:71], a[36:39], v[48:63]
    v_mfma_f32_32x32x16_bf16 v[48:63], a[72:75], a[40:43], v[48:63]
    v_mfma_f32_32x32x16_bf16 v[48:63], a[76:79], a[44:47], v[48:63]
    v_mfma_f32_32x32x16_bf16 v[48:63], a[80:83], a[48:51], v[48:63]
    v_mfma_f32_32x32x16_bf16 v[48:63], a[84:87], a[52:55], v[48:63]
    v_mfma_f32_32x32x16_bf16 v[48:63], a[88:91], a[56:59], v[48:63]
    v_mfma_f32_32x32x16_bf16 v[48:63], a[92:95], a[60:63], v[48:63]
    s_nop 15
    s_nop 3
    v_max3_f32 v22, v32, v33, v34
    v_max3_f32 v22, v22, v35, v36
    v_max3_f32 v22, v22, v37, v38
    v_max3_f32 v22, v22, v39, v40
    v_max3_f32 v22, v22, v41, v42
    v_max3_f32 v22, v22, v43, v44
    v_max3_f32 v22, v22, v45, v46
    v_max_f32 v22, v22, v47
    v_mov_b32 v23, v22
    v_mov_b32 v24, v22
    s_nop 1
    v_permlane32_swap_b32 v23, v24
    s_nop 1
    v_max_f32 v22, v23, v24
    v_add_f32 v22, 0x42200000, v22
    v_sub_f32 v20, 0, v22
    v_max3_f32 v22, v48, v49, v50
    v_max3_f32 v22, v22, v51, v52
    v_max3_f32 v22, v22, v53, v54
    v_max3_f32 v22, v22, v55, v56
    v_max3_f32 v22, v22, v57, v58
    v_max3_f32 v22, v22, v59, v60
    v_max3_f32 v22, v22, v61, v62
    v_max_f32 v22, v22, v63
    v_mov_b32 v23, v22
    v_mov_b32 v24, v22
    s_nop 1
    v_permlane32_swap_b32 v23, v24
    s_nop 1
    v_max_f32 v22, v23, v24
    v_add_f32 v22, 0x42200000, v22
    v_sub_f32 v21, 0, v22
    s_branch L_main2_15
L_main_14:
    v_mov_b32 v128, 0
    v_mov_b32 v129, 0
    v_mov_b32 v130, 0
    v_mov_b32 v131, 0
    v_mov_b32 v132, 0
    v_mov_b32 v133, 0
    v_mov_b32 v134, 0
    v_mov_b32 v135, 0
    v_mov_b32 v136, 0
    v_mov_b32 v137, 0
    v_mov_b32 v138, 0
    v_mov_b32 v139, 0
    v_mov_b32 v140, 0
    v_mov_b32 v141, 0
    v_mov_b32 v142, 0
    v_mov_b32 v143, 0
    v_mov_b32 v144, 0
    v_mov_b32 v145, 0
    v_mov_b32 v146, 0
    v_mov_b32 v147, 0
    v_mov_b32 v148, 0
    v_mov_b32 v149, 0
    v_mov_b32 v150, 0
    v_mov_b32 v151, 0
    v_mov_b32 v152, 0
    v_mov_b32 v153, 0
    v_mov_b32 v154, 0
    v_mov_b32 v155, 0
    v_mov_b32 v156, 0
    v_mov_b32 v157, 0
    v_mov_b32 v158, 0
    v_mov_b32 v159, 0
    v_mov_b32 v160, 0
    v_mov_b32 v161, 0
    v_mov_b32 v162, 0
    v_mov_b32 v163, 0
    v_mov_b32 v164, 0
    v_mov_b32 v165, 0
    v_mov_b32 v166, 0
    v_mov_b32 v167, 0
    v_mov_b32 v168, 0
    v_mov_b32 v169, 0
    v_mov_b32 v170, 0
    v_mov_b32 v171, 0
    v_mov_b32 v172, 0
    v_mov_b32 v173, 0
    v_mov_b32 v174, 0
    v_mov_b32 v175, 0
    v_mov_b32 v176, 0
    v_mov_b32 v177, 0
    v_mov_b32 v178, 0
    v_mov_b32 v179, 0
    v_mov_b32 v180, 0
    v_mov_b32 v181, 0
    v_mov_b32 v182, 0
    v_mov_b32 v183, 0
    v_mov_b32 v184, 0
    v_mov_b32 v185, 0
    v_mov_b32 v186, 0
    v_mov_b32 v187, 0
    v_mov_b32 v188, 0
    v_mov_b32 v189, 0
    v_mov_b32 v190, 0
    v_mov_b32 v191, 0
    v_mov_b32 v192, 0
    v_mov_b32 v193, 0
    v_mov_b32 v194, 0
    v_mov_b32 v195, 0
    v_mov_b32 v196, 0
    v_mov_b32 v197, 0
    v_mov_b32 v198, 0
    v_mov_b32 v199, 0
    v_mov_b32 v200, 0
    v_mov_b32 v201, 0
    v_mov_b32 v202, 0
    v_mov_b32 v203, 0
    v_mov_b32 v204, 0
    v_mov_b32 v205, 0
    v_mov_b32 v206, 0
    v_mov_b32 v207, 0
    v_mov_b32 v208, 0
    v_mov_b32 v209, 0
    v_mov_b32 v210, 0
    v_mov_b32 v211, 0
    v_mov_b32 v212, 0
    v_mov_b32 v213, 0
    v_mov_b32 v214, 0
    v_mov_b32 v215, 0
    v_mov_b32 v216, 0
    v_mov_b32 v217, 0
    v_mov_b32 v218, 0
    v_mov_b32 v219, 0
    v_mov_b32 v220, 0
    v_mov_b32 v221, 0
    v_mov_b32 v222, 0
    v_mov_b32 v223, 0
    v_mov_b32 v224, 0
    v_mov_b32 v225, 0
    v_mov_b32 v226, 0
    v_mov_b32 v227, 0
    v_mov_b32 v228, 0
    v_mov_b32 v229, 0
    v_mov_b32 v230, 0
    v_mov_b32 v231, 0
    v_mov_b32 v232, 0
    v_mov_b32 v233, 0
    v_mov_b32 v234, 0
    v_mov_b32 v235, 0
    v_mov_b32 v236, 0
    v_mov_b32 v237, 0
    v_mov_b32 v238, 0
    v_mov_b32 v239, 0
    v_mov_b32 v240, 0
    v_mov_b32 v241, 0
    v_mov_b32 v242, 0
    v_mov_b32 v243, 0
    v_mov_b32 v244, 0
    v_mov_b32 v245, 0
    v_mov_b32 v246, 0
    v_mov_b32 v247, 0
    v_mov_b32 v248, 0
    v_mov_b32 v249, 0
    v_mov_b32 v250, 0
    v_mov_b32 v251, 0
    v_mov_b32 v252, 0
    v_mov_b32 v253, 0
    v_mov_b32 v254, 0
    v_mov_b32 v255, 0
L_main2_15:
    s_mov_b32 s43, 0
    v_mov_b32 v18, 0
    s_cmp_eq_u32 s43, s46
    s_cbranch_scc1 L_md_16
    s_cmp_gt_u32 s43, s46
    s_cbranch_scc1 L_mf_17
    v_mov_b32 v64, v20
    v_mov_b32 v65, v20
    v_mov_b32 v66, v20
    v_mov_b32 v67, v20
    v_mov_b32 v68, v20
    v_mov_b32 v69, v20
    v_mov_b32 v70, v20
    v_mov_b32 v71, v20
    v_mov_b32 v72, v20
    v_mov_b32 v73, v20
    v_mov_b32 v74, v20
    v_mov_b32 v75, v20
    v_mov_b32 v76, v20
    v_mov_b32 v77, v20
    v_mov_b32 v78, v20
    v_mov_b32 v79, v20
    s_branch L_mx_18
L_md_16:
    v_mov_b32 v22, 0xf149f2ca
    v_cndmask_b32 v64, v22, v20, s[56:57]
    v_cndmask_b32 v65, v22, v20, s[58:59]
    v_cndmask_b32 v66, v22, v20, s[60:61]
    v_cndmask_b32 v67, v22, v20, s[62:63]
    v_cndmask_b32 v68, v22, v20, s[64:65]
    v_cndmask_b32 v69, v22, v20, s[66:67]
    v_cndmask_b32 v70, v22, v20, s[68:69]
    v_cndmask_b32 v71, v22, v20, s[70:71]
    v_cndmask_b32 v72, v22, v20, s[72:73]
    v_cndmask_b32 v73, v22, v20, s[74:75]
    v_cndmask_b32 v74, v22, v20, s[76:77]
    v_cndmask_b32 v75, v22, v20, s[78:79]
    v_cndmask_b32 v76, v22, v20, s[80:81]
    v_cndmask_b32 v77, v22, v20, s[82:83]
    v_cndmask_b32 v78, v22, v20, s[84:85]
    v_cndmask_b32 v79, v22, v20, s[86:87]
    s_branch L_mx_18
L_mf_17:
    v_mov_b32 v64, 0xf149f2ca
    v_mov_b32 v65, 0xf149f2ca
    v_mov_b32 v66, 0xf149f2ca
    v_mov_b32 v67, 0xf149f2ca
    v_mov_b32 v68, 0xf149f2ca
    v_mov_b32 v69, 0xf149f2ca
    v_mov_b32 v70, 0xf149f2ca
    v_mov_b32 v71, 0xf149f2ca
    v_mov_b32 v72, 0xf149f2ca
    v_mov_b32 v73, 0xf149f2ca
    v_mov_b32 v74, 0xf149f2ca
    v_mov_b32 v75, 0xf149f2ca
    v_mov_b32 v76, 0xf149f2ca
    v_mov_b32 v77, 0xf149f2ca
    v_mov_b32 v78, 0xf149f2ca
    v_mov_b32 v79, 0xf149f2ca
L_mx_18:
    v_mov_b32 v19, 0
    s_cmp_eq_u32 s43, s47
    s_cbranch_scc1 L_md_19
    s_cmp_gt_u32 s43, s47
    s_cbranch_scc1 L_mf_20
    v_mov_b32 v80, v21
    v_mov_b32 v81, v21
    v_mov_b32 v82, v21
    v_mov_b32 v83, v21
    v_mov_b32 v84, v21
    v_mov_b32 v85, v21
    v_mov_b32 v86, v21
    v_mov_b32 v87, v21
    v_mov_b32 v88, v21
    v_mov_b32 v89, v21
    v_mov_b32 v90, v21
    v_mov_b32 v91, v21
    v_mov_b32 v92, v21
    v_mov_b32 v93, v21
    v_mov_b32 v94, v21
    v_mov_b32 v95, v21
    s_branch L_mx_21
L_md_19:
    v_mov_b32 v22, 0xf149f2ca
    v_cndmask_b32 v80, v22, v21, s[56:57]
    v_cndmask_b32 v81, v22, v21, s[58:59]
    v_cndmask_b32 v82, v22, v21, s[60:61]
    v_cndmask_b32 v83, v22, v21, s[62:63]
    v_cndmask_b32 v84, v22, v21, s[64:65]
    v_cndmask_b32 v85, v22, v21, s[66:67]
    v_cndmask_b32 v86, v22, v21, s[68:69]
    v_cndmask_b32 v87, v22, v21, s[70:71]
    v_cndmask_b32 v88, v22, v21, s[72:73]
    v_cndmask_b32 v89, v22, v21, s[74:75]
    v_cndmask_b32 v90, v22, v21, s[76:77]
    v_cndmask_b32 v91, v22, v21, s[78:79]
    v_cndmask_b32 v92, v22, v21, s[80:81]
    v_cndmask_b32 v93, v22, v21, s[82:83]
    v_cndmask_b32 v94, v22, v21, s[84:85]
    v_cndmask_b32 v95, v22, v21, s[86:87]
    s_branch L_mx_21
L_mf_20:
    v_mov_b32 v80, 0xf149f2ca
    v_mov_b32 v81, 0xf149f2ca
    v_mov_b32 v82, 0xf149f2ca
    v_mov_b32 v83, 0xf149f2ca
    v_mov_b32 v84, 0xf149f2ca
    v_mov_b32 v85, 0xf149f2ca
    v_mov_b32 v86, 0xf149f2ca
    v_mov_b32 v87, 0xf149f2ca
    v_mov_b32 v88, 0xf149f2ca
    v_mov_b32 v89, 0xf149f2ca
    v_mov_b32 v90, 0xf149f2ca
    v_mov_b32 v91, 0xf149f2ca
    v_mov_b32 v92, 0xf149f2ca
    v_mov_b32 v93, 0xf149f2ca
    v_mov_b32 v94, 0xf149f2ca
    v_mov_b32 v95, 0xf149f2ca
L_mx_21:
    s_mov_b32 s50, 65536
    v_add_u32 v16, 65536, v1
    s_sub_u32 s55, s48, 1
    s_sub_u32 s93, s49, 1
    s_nop 1
    v_mfma_f32_32x32x16_bf16 v[32:47], a[64:67], a[0:3], v[64:79]
    ds_read_b128 a[128:131], v16 offset:16384
    s_nop 1
    v_mfma_f32_32x32x16_bf16 v[32:47], a[68:71], a[4:7], v[32:47]
    ds_read_b128 a[132:135], v16 offset:17408
    s_nop 1
    v_mfma_f32_32x32x16_bf16 v[32:47], a[72:75], a[8:11], v[32:47]
    ds_read_b128 a[136:139], v16 offset:18432
    s_nop 1
    v_mfma_f32_32x32x16_bf16 v[32:47], a[76:79], a[12:15], v[32:47]
    ds_read_b128 a[140:143], v16 offset:19456
    s_nop 1
    v_mfma_f32_32x32x16_bf16 v[32:47], a[80:83], a[16:19], v[32:47]
    ds_read_b128 a[144:147], v16 offset:20480
    s_nop 1
    v_mfma_f32_32x32x16_bf16 v[32:47], a[84:87], a[20:23], v[32:47]
    s_nop 1
    v_mfma_f32_32x32x16_bf16 v[32:47], a[88:91], a[24:27], v[32:47]
    s_nop 1
    v_mfma_f32_32x32x16_bf16 v[32:47], a[92:95], a[28:31], v[32:47]
    s_nop 1
    ds_read_b128 a[148:151], v16 offset:21504
    s_nop 1
    ds_read_b128 a[152:155], v16 offset:22528
    ds_read_b128 a[156:159], v16 offset:23552
    s_nop 1
    s_nop 15
    v_exp_f32 v32, v32
    s_nop 1
    v_exp_f32 v33, v33
    v_add_f32 v18, v18, v32
    s_nop 1
    v_exp_f32 v34, v34
    v_add_f32 v18, v18, v33
    v_cvt_pk_bf16_f32 v96, v32, v33
    s_nop 1
    v_exp_f32 v35, v35
    v_add_f32 v18, v18, v34
    s_nop 1
    v_exp_f32 v36, v36
    v_add_f32 v18, v18, v35
    v_cvt_pk_bf16_f32 v97, v34, v35
    s_nop 1
    v_exp_f32 v37, v37
    v_add_f32 v18, v18, v36
    s_nop 1
    s_branch L_dmid_23
L_dual_22:
    s_waitcnt lgkmcnt(0)
    v_mfma_f32_32x32x16_bf16 v[32:47], a[64:67], a[0:3], v[64:79]
    v_exp_f32 v54, v54
    v_add_f32 v19, v19, v53
    v_cvt_pk_bf16_f32 v106, v52, v53
    s_add_u32 m0, s42, 0
    s_nop 0
    buffer_load_dwordx4 v1, s[20:23], s41 offen offset:0 lds
    v_mfma_f32_32x32x16_bf16 v[32:47], a[68:71], a[4:7], v[32:47]
    v_exp_f32 v55, v55
    v_add_f32 v19, v19, v54
    ds_read_b128 a[128:131], v16 offset:16384
    buffer_load_dwordx4 v1, s[20:23], s41 offen offset:1024 lds
    v_mfma_f32_32x32x16_bf16 v[32:47], a[72:75], a[8:11], v[32:47]
    v_exp_f32 v56, v56
    v_add_f32 v19, v19, v55
    v_cvt_pk_bf16_f32 v107, v54, v55
    buffer_load_dwordx4 v1, s[20:23], s41 offen offset:2048 lds
    v_mfma_f32_32x32x16_bf16 v[32:47], a[76:79], a[12:15], v[32:47]
    v_exp_f32 v57, v57
    v_add_f32 v19, v19, v56
    ds_read_b128 a[132:135], v16 offset:17408
    buffer_load_dwordx4 v1, s[20:23], s41 offen offset:3072 lds
    v_mfma_f32_32x32x16_bf16 v[32:47], a[80:83], a[16:19], v[32:47]
    v_exp_f32 v58, v58
    v_add_f32 v19, v19, v57
    v_cvt_pk_bf16_f32 v108, v56, v57
    s_add_u32 m0, s42, 16384
    s_nop 0
    buffer_load_dwordx4 v1, s[24:27], s41 offen offset:0 lds
    v_mfma_f32_32x32x16_bf16 v[32:47], a[84:87], a[20:23], v[32:47]
    v_exp_f32 v59, v59
    v_add_f32 v19, v19, v58
    ds_read_b128 a[136:139], v16 offset:18432
    ds_read_b128 a[140:143], v16 offset:19456
    buffer_load_dwordx4 v1, s[24:27], s41 offen offset:1024 lds
    v_mfma_f32_32x32x16_bf16 v[32:47], a[88:91], a[24:27], v[32:47]
    v_exp_f32 v60, v60
    v_add_f32 v19, v19, v59
    v_cvt_pk_bf16_f32 v109, v58, v59
    ds_read_b128 a[144:147], v16 offset:20480
    v_mfma_f32_32x32x16_bf16 v[32:47], a[92:95], a[28:31], v[32:47]
    v_exp_f32 v61, v61
    v_add_f32 v19, v19, v60
    buffer_load_dwordx4 v1, s[24:27], s41 offen offset:2048 lds
    v_mfma_f32_32x32x16_bf16 v[192:207], a[160:163], v[104:107], v[192:207]
    v_exp_f32 v62, v62
    v_add_f32 v19, v19, v61
    v_cvt_pk_bf16_f32 v110, v60, v61
    buffer_load_dwordx4 v1, s[24:27], s41 offen offset:3072 lds
    v_mfma_f32_32x32x16_bf16 v[208:223], a[164:167], v[104:107], v[208:223]
    v_exp_f32 v63, v63
    v_add_f32 v19, v19, v62
    ds_read_b128 a[148:151], v16 offset:21504
    s_add_u32 s41, s41, 16384
    s_add_u32 s42, s42, 32768
    v_mfma_f32_32x32x16_bf16 v[224:239], a[168:171], v[104:107], v[224:239]
    v_add_f32 v19, v19, v63
    v_cvt_pk_bf16_f32 v111, v62, v63
    v_exp_f32 v32, v32
    s_cmp_ge_u32 s42, 163840
    s_cselect_b32 s42, s37, s42
    v_mfma_f32_32x32x16_bf16 v[240:255], a[172:175], v[104:107], v[240:255]
    v_exp_f32 v33, v33
    v_add_f32 v18, v18, v32
    ds_read_b128 a[152:155], v16 offset:22528
    buffer_load_dwordx4 v[28:31], v1, s[88:91], s92 offen
    s_add_u32 s92, s92, 1024
    v_mfma_f32_32x32x16_bf16 v[192:207], a[176:179], v[108:111], v[192:207]
    v_exp_f32 v34, v34
    v_add_f32 v18, v18, v33
    v_cvt_pk_bf16_f32 v96, v32, v33
    buffer_load_dwordx4 v[28:31], v1, s[88:91], s92 offen
    s_add_u32 s92, s92, 1024
    v_mfma_f32_32x32x16_bf16 v[208:223], a[180:183], v[108:111], v[208:223]
    v_exp_f32 v35, v35
    v_add_f32 v18, v18, v34
    ds_read_b128 a[156:159], v16 offset:23552
    v_mfma_f32_32x32x16_bf16 v[224:239], a[184:187], v[108:111], v[224:239]
    v_exp_f32 v36, v36
    v_add_f32 v18, v18, v35
    v_cvt_pk_bf16_f32 v97, v34, v35
    v_mfma_f32_32x32x16_bf16 v[240:255], a[188:191], v[108:111], v[240:255]
    v_exp_f32 v37, v37
    v_add_f32 v18, v18, v36
L_dmid_23:
    v_mfma_f32_32x32x16_bf16 v[48:63], a[64:67], a[32:35], v[80:95]
    v_exp_f32 v38, v38
    v_add_f32 v18, v18, v37
    v_cvt_pk_bf16_f32 v98, v36, v37
    s_cmp_ge_i32 s43, s55
    s_cbranch_scc1 L_hko_25
L_hkb_26:
    v_mfma_f32_32x32x16_bf16 v[48:63], a[68:71], a[36:39], v[48:63]
    v_exp_f32 v39, v39
    v_add_f32 v18, v18, v38
    ds_read_b128 a[96:99], v16 offset:8192
    s_add_u32 s50, s50, 32768
    v_mfma_f32_32x32x16_bf16 v[48:63], a[72:75], a[40:43], v[48:63]
    v_exp_f32 v40, v40
    v_add_f32 v18, v18, v39
    v_cvt_pk_bf16_f32 v99, v38, v39
    s_cmp_ge_u32 s50, 163840
    s_cselect_b32 s50, 0, s50
    v_mfma_f32_32x32x16_bf16 v[48:63], a[76:79], a[44:47], v[48:63]
    v_exp_f32 v41, v41
    v_add_f32 v18, v18, v40
    ds_read_b128 a[100:103], v16 offset:9216
    v_add_u32 v17, s50, v1
    v_mfma_f32_32x32x16_bf16 v[48:63], a[80:83], a[48:51], v[48:63]
    v_exp_f32 v42, v42
    v_add_f32 v18, v18, v41
    v_cvt_pk_bf16_f32 v100, v40, v41
    v_mfma_f32_32x32x16_bf16 v[48:63], a[84:87], a[52:55], v[48:63]
    v_exp_f32 v43, v43
    v_add_f32 v18, v18, v42
    ds_read_b128 a[104:107], v16 offset:10240
    ds_read_b128 a[108:111], v16 offset:11264
    v_mfma_f32_32x32x16_bf16 v[48:63], a[88:91], a[56:59], v[48:63]
    v_exp_f32 v44, v44
    v_add_f32 v18, v18, v43
    v_cvt_pk_bf16_f32 v101, v42, v43
    ds_read_b128 a[112:115], v16 offset:12288
    v_mfma_f32_32x32x16_bf16 v[48:63], a[92:95], a[60:63], v[48:63]
    v_exp_f32 v45, v45
    v_add_f32 v18, v18, v44
    s_waitcnt lgkmcnt(5)
    v_mfma_f32_32x32x16_bf16 v[128:143], a[128:131], v[96:99], v[128:143]
    v_exp_f32 v46, v46
    v_add_f32 v18, v18, v45
    v_cvt_pk_bf16_f32 v102, v44, v45
    v_mfma_f32_32x32x16_bf16 v[144:159], a[132:135], v[96:99], v[144:159]
    v_exp_f32 v47, v47
    v_add_f32 v18, v18, v46
    ds_read_b128 a[116:119], v16 offset:13312
    v_mfma_f32_32x32x16_bf16 v[160:175], a[136:139], v[96:99], v[160:175]
    v_add_f32 v18, v18, v47
    v_cvt_pk_bf16_f32 v103, v46, v47
    v_exp_f32 v48, v48
    v_mfma_f32_32x32x16_bf16 v[176:191], a[140:143], v[96:99], v[176:191]
    v_exp_f32 v49, v49
    v_add_f32 v19, v19, v48
    ds_read_b128 a[120:123], v16 offset:14336
    ds_read_b128 a[124:127], v16 offset:15360
    v_mfma_f32_32x32x16_bf16 v[128:143], a[144:147], v[100:103], v[128:143]
    v_exp_f32 v50, v50
    v_add_f32 v19, v19, v49
    v_cvt_pk_bf16_f32 v104, v48, v49
    v_mfma_f32_32x32x16_bf16 v[144:159], a[148:151], v[100:103], v[144:159]
    v_exp_f32 v51, v51
    v_add_f32 v19, v19, v50
    s_add_u32 s43, s43, 1
    v_mfma_f32_32x32x16_bf16 v[160:175], a[152:155], v[100:103], v[160:175]
    v_exp_f32 v52, v52
    v_add_f32 v19, v19, v51
    v_cvt_pk_bf16_f32 v105, v50, v51
    v_mfma_f32_32x32x16_bf16 v[176:191], a[156:159], v[100:103], v[176:191]
    v_exp_f32 v53, v53
    v_add_f32 v19, v19, v52
    s_waitcnt lgkmcnt(0)
    v_mfma_f32_32x32x16_bf16 v[32:47], a[96:99], a[0:3], v[64:79]
    v_exp_f32 v54, v54
    v_add_f32 v19, v19, v53
    v_cvt_pk_bf16_f32 v106, v52, v53
    v_mfma_f32_32x32x16_bf16 v[32:47], a[100:103], a[4:7], v[32:47]
    v_exp_f32 v55, v55
    v_add_f32 v19, v19, v54
    ds_read_b128 a[160:163], v16 offset:24576
    v_mfma_f32_32x32x16_bf16 v[32:47], a[104:107], a[8:11], v[32:47]
    v_exp_f32 v56, v56
    v_add_f32 v19, v19, v55
    v_cvt_pk_bf16_f32 v107, v54, v55
    v_mfma_f32_32x32x16_bf16 v[32:47], a[108:111], a[12:15], v[32:47]
    v_exp_f32 v57, v57
    v_add_f32 v19, v19, v56
    ds_read_b128 a[164:167], v16 offset:25600
    v_mfma_f32_32x32x16_bf16 v[32:47], a[112:115], a[16:19], v[32:47]
    v_exp_f32 v58, v58
    v_add_f32 v19, v19, v57
    v_cvt_pk_bf16_f32 v108, v56, v57
    v_mfma_f32_32x32x16_bf16 v[32:47], a[116:119], a[20:23], v[32:47]
    v_exp_f32 v59, v59
    v_add_f32 v19, v19, v58
    ds_read_b128 a[168:171], v16 offset:26624
    ds_read_b128 a[172:175], v16 offset:27648
    v_mfma_f32_32x32x16_bf16 v[32:47], a[120:123], a[24:27], v[32:47]
    v_exp_f32 v60, v60
    v_add_f32 v19, v19, v59
    v_cvt_pk_bf16_f32 v109, v58, v59
    ds_read_b128 a[176:179], v16 offset:28672
    v_mfma_f32_32x32x16_bf16 v[32:47], a[124:127], a[28:31], v[32:47]
    v_exp_f32 v61, v61
    v_add_f32 v19, v19, v60
    v_mfma_f32_32x32x16_bf16 v[192:207], a[128:131], v[104:107], v[192:207]
    v_exp_f32 v62, v62
    v_add_f32 v19, v19, v61
    v_cvt_pk_bf16_f32 v110, v60, v61
    v_mfma_f32_32x32x16_bf16 v[208:223], a[132:135], v[104:107], v[208:223]
    v_exp_f32 v63, v63
    v_add_f32 v19, v19, v62
    ds_read_b128 a[180:183], v16 offset:29696
    v_mfma_f32_32x32x16_bf16 v[224:239], a[136:139], v[104:107], v[224:239]
    v_add_f32 v19, v19, v63
    v_cvt_pk_bf16_f32 v111, v62, v63
    v_exp_f32 v32, v32
    v_mfma_f32_32x32x16_bf16 v[240:255], a[140:143], v[104:107], v[240:255]
    v_exp_f32 v33, v33
    v_add_f32 v18, v18, v32
    ds_read_b128 a[184:187], v16 offset:30720
    v_mfma_f32_32x32x16_bf16 v[192:207], a[144:147], v[108:111], v[192:207]
    v_exp_f32 v34, v34
    v_add_f32 v18, v18, v33
    v_cvt_pk_bf16_f32 v96, v32, v33
    v_mfma_f32_32x32x16_bf16 v[208:223], a[148:151], v[108:111], v[208:223]
    v_exp_f32 v35, v35
    v_add_f32 v18, v18, v34
    ds_read_b128 a[188:191], v16 offset:31744
    v_mfma_f32_32x32x16_bf16 v[224:239], a[152:155], v[108:111], v[224:239]
    v_exp_f32 v36, v36
    v_add_f32 v18, v18, v35
    v_cvt_pk_bf16_f32 v97, v34, v35
    v_mfma_f32_32x32x16_bf16 v[240:255], a[156:159], v[108:111], v[240:255]
    v_exp_f32 v37, v37
    v_add_f32 v18, v18, v36
    v_mfma_f32_32x32x16_bf16 v[48:63], a[96:99], a[32:35], v[80:95]
    v_exp_f32 v38, v38
    v_add_f32 v18, v18, v37
    v_cvt_pk_bf16_f32 v98, v36, v37
    v_mfma_f32_32x32x16_bf16 v[48:63], a[100:103], a[36:39], v[48:63]
    v_exp_f32 v39, v39
    v_add_f32 v18, v18, v38
    ds_read_b128 a[64:67], v17 offset:0
    s_cmp_ge_i32 s43, s55
    s_cbranch_scc1 L_hko_27
L_hkb_28:
    v_mfma_f32_32x32x16_bf16 v[48:63], a[104:107], a[40:43], v[48:63]
    v_exp_f32 v40, v40
    v_add_f32 v18, v18, v39
    v_cvt_pk_bf16_f32 v99, v38, v39
    s_add_u32 s43, s43, 1
    v_mfma_f32_32x32x16_bf16 v[48:63], a[108:111], a[44:47], v[48:63]
    v_exp_f32 v41, v41
    v_add_f32 v18, v18, v40
    ds_read_b128 a[68:71], v17 offset:1024
    v_mfma_f32_32x32x16_bf16 v[48:63], a[112:115], a[48:51], v[48:63]
    v_exp_f32 v42, v42
    v_add_f32 v18, v18, v41
    v_cvt_pk_bf16_f32 v100, v40, v41
    v_mfma_f32_32x32x16_bf16 v[48:63], a[116:119], a[52:55], v[48:63]
    v_exp_f32 v43, v43
    v_add_f32 v18, v18, v42
    ds_read_b128 a[72:75], v17 offset:2048
    ds_read_b128 a[76:79], v17 offset:3072
    v_mfma_f32_32x32x16_bf16 v[48:63], a[120:123], a[56:59], v[48:63]
    v_exp_f32 v44, v44
    v_add_f32 v18, v18, v43
    v_cvt_pk_bf16_f32 v101, v42, v43
    ds_read_b128 a[80:83], v17 offset:4096
    v_mfma_f32_32x32x16_bf16 v[48:63], a[124:127], a[60:63], v[48:63]
    v_exp_f32 v45, v45
    v_add_f32 v18, v18, v44
    s_waitcnt lgkmcnt(5)
    v_mfma_f32_32x32x16_bf16 v[128:143], a[160:163], v[96:99], v[128:143]
    v_exp_f32 v46, v46
    v_add_f32 v18, v18, v45
    v_cvt_pk_bf16_f32 v102, v44, v45
    v_mfma_f32_32x32x16_bf16 v[144:159], a[164:167], v[96:99], v[144:159]
    v_exp_f32 v47, v47
    v_add_f32 v18, v18, v46
    ds_read_b128 a[84:87], v17 offset:5120
    v_mfma_f32_32x32x16_bf16 v[160:175], a[168:171], v[96:99], v[160:175]
    v_add_f32 v18, v18, v47
    v_cvt_pk_bf16_f32 v103, v46, v47
    v_exp_f32 v48, v48
    v_mfma_f32_32x32x16_bf16 v[176:191], a[172:175], v[96:99], v[176:191]
    v_exp_f32 v49, v49
    v_add_f32 v19, v19, v48
    ds_read_b128 a[88:91], v17 offset:6144
    ds_read_b128 a[92:95], v17 offset:7168
    v_mfma_f32_32x32x16_bf16 v[128:143], a[176:179], v[100:103], v[128:143]
    v_exp_f32 v50, v50
    v_add_f32 v19, v19, v49
    v_cvt_pk_bf16_f32 v104, v48, v49
    v_mfma_f32_32x32x16_bf16 v[144:159], a[180:183], v[100:103], v[144:159]
    v_exp_f32 v51, v51
    v_add_f32 v19, v19, v50
    v_mov_b32 v16, v17
    v_mfma_f32_32x32x16_bf16 v[160:175], a[184:187], v[100:103], v[160:175]
    v_exp_f32 v52, v52
    v_add_f32 v19, v19, v51
    v_cvt_pk_bf16_f32 v105, v50, v51
    v_mfma_f32_32x32x16_bf16 v[176:191], a[188:191], v[100:103], v[176:191]
    v_exp_f32 v53, v53
    v_add_f32 v19, v19, v52
    s_waitcnt lgkmcnt(0)
    v_mfma_f32_32x32x16_bf16 v[32:47], a[64:67], a[0:3], v[64:79]
    v_exp_f32 v54, v54
    v_add_f32 v19, v19, v53
    v_cvt_pk_bf16_f32 v106, v52, v53
    v_mfma_f32_32x32x16_bf16 v[32:47], a[68:71], a[4:7], v[32:47]
    v_exp_f32 v55, v55
    v_add_f32 v19, v19, v54
    ds_read_b128 a[128:131], v16 offset:16384
    v_mfma_f32_32x32x16_bf16 v[32:47], a[72:75], a[8:11], v[32:47]
    v_exp_f32 v56, v56
    v_add_f32 v19, v19, v55
    v_cvt_pk_bf16_f32 v107, v54, v55
    v_mfma_f32_32x32x16_bf16 v[32:47], a[76:79], a[12:15], v[32:47]
    v_exp_f32 v57, v57
    v_add_f32 v19, v19, v56
    ds_read_b128 a[132:135], v16 offset:17408
    v_mfma_f32_32x32x16_bf16 v[32:47], a[80:83], a[16:19], v[32:47]
    v_exp_f32 v58, v58
    v_add_f32 v19, v19, v57
    v_cvt_pk_bf16_f32 v108, v56, v57
    v_mfma_f32_32x32x16_bf16 v[32:47], a[84:87], a[20:23], v[32:47]
    v_exp_f32 v59, v59
    v_add_f32 v19, v19, v58
    ds_read_b128 a[136:139], v16 offset:18432
    ds_read_b128 a[140:143], v16 offset:19456
    v_mfma_f32_32x32x16_bf16 v[32:47], a[88:91], a[24:27], v[32:47]
    v_exp_f32 v60, v60
    v_add_f32 v19, v19, v59
    v_cvt_pk_bf16_f32 v109, v58, v59
    ds_read_b128 a[144:147], v16 offset:20480
    v_mfma_f32_32x32x16_bf16 v[32:47], a[92:95], a[28:31], v[32:47]
    v_exp_f32 v61, v61
    v_add_f32 v19, v19, v60
    v_mfma_f32_32x32x16_bf16 v[192:207], a[160:163], v[104:107], v[192:207]
    v_exp_f32 v62, v62
    v_add_f32 v19, v19, v61
    v_cvt_pk_bf16_f32 v110, v60, v61
    v_mfma_f32_32x32x16_bf16 v[208:223], a[164:167], v[104:107], v[208:223]
    v_exp_f32 v63, v63
    v_add_f32 v19, v19, v62
    ds_read_b128 a[148:151], v16 offset:21504
    v_mfma_f32_32x32x16_bf16 v[224:239], a[168:171], v[104:107], v[224:239]
    v_add_f32 v19, v19, v63
    v_cvt_pk_bf16_f32 v111, v62, v63
    v_exp_f32 v32, v32
    v_mfma_f32_32x32x16_bf16 v[240:255], a[172:175], v[104:107], v[240:255]
    v_exp_f32 v33, v33
    v_add_f32 v18, v18, v32
    ds_read_b128 a[152:155], v16 offset:22528
    v_mfma_f32_32x32x16_bf16 v[192:207], a[176:179], v[108:111], v[192:207]
    v_exp_f32 v34, v34
    v_add_f32 v18, v18, v33
    v_cvt_pk_bf16_f32 v96, v32, v33
    v_mfma_f32_32x32x16_bf16 v[208:223], a[180:183], v[108:111], v[208:223]
    v_exp_f32 v35, v35
    v_add_f32 v18, v18, v34
    ds_read_b128 a[156:159], v16 offset:23552
    v_mfma_f32_32x32x16_bf16 v[224:239], a[184:187], v[108:111], v[224:239]
    v_exp_f32 v36, v36
    v_add_f32 v18, v18, v35
    v_cvt_pk_bf16_f32 v97, v34, v35
    v_mfma_f32_32x32x16_bf16 v[240:255], a[188:191], v[108:111], v[240:255]
    v_exp_f32 v37, v37
    v_add_f32 v18, v18, v36
    v_mfma_f32_32x32x16_bf16 v[48:63], a[64:67], a[32:35], v[80:95]
    v_exp_f32 v38, v38
    v_add_f32 v18, v18, v37
    v_cvt_pk_bf16_f32 v98, v36, v37
    s_cmp_ge_i32 s43, s55
    s_cbranch_scc1 L_hko_29
L_hkb_30:
    v_mfma_f32_32x32x16_bf16 v[48:63], a[68:71], a[36:39], v[48:63]
    v_exp_f32 v39, v39
    v_add_f32 v18, v18, v38
    ds_read_b128 a[96:99], v16 offset:8192
    s_add_u32 s50, s50, 32768
    v_mfma_f32_32x32x16_bf16 v[48:63], a[72:75], a[40:43], v[48:63]
    v_exp_f32 v40, v40
    v_add_f32 v18, v18, v39
    v_cvt_pk_bf16_f32 v99, v38, v39
    s_cmp_ge_u32 s50, 163840
    s_cselect_b32 s50, 0, s50
    v_mfma_f32_32x32x16_bf16 v[48:63], a[76:79], a[44:47], v[48:63]
    v_exp_f32 v41, v41
    v_add_f32 v18, v18, v40
    ds_read_b128 a[100:103], v16 offset:9216
    v_add_u32 v17, s50, v1
    v_mfma_f32_32x32x16_bf16 v[48:63], a[80:83], a[48:51], v[48:63]
    v_exp_f32 v42, v42
    v_add_f32 v18, v18, v41
    v_cvt_pk_bf16_f32 v100, v40, v41
    v_mfma_f32_32x32x16_bf16 v[48:63], a[84:87], a[52:55], v[48:63]
    v_exp_f32 v43, v43
    v_add_f32 v18, v18, v42
    ds_read_b128 a[104:107], v16 offset:10240
    ds_read_b128 a[108:111], v16 offset:11264
    v_mfma_f32_32x32x16_bf16 v[48:63], a[88:91], a[56:59], v[48:63]
    v_exp_f32 v44, v44
    v_add_f32 v18, v18, v43
    v_cvt_pk_bf16_f32 v101, v42, v43
    ds_read_b128 a[112:115], v16 offset:12288
    v_mfma_f32_32x32x16_bf16 v[48:63], a[92:95], a[60:63], v[48:63]
    v_exp_f32 v45, v45
    v_add_f32 v18, v18, v44
    s_waitcnt lgkmcnt(5)
    v_mfma_f32_32x32x16_bf16 v[128:143], a[128:131], v[96:99], v[128:143]
    v_exp_f32 v46, v46
    v_add_f32 v18, v18, v45
    v_cvt_pk_bf16_f32 v102, v44, v45
    v_mfma_f32_32x32x16_bf16 v[144:159], a[132:135], v[96:99], v[144:159]
    v_exp_f32 v47, v47
    v_add_f32 v18, v18, v46
    ds_read_b128 a[116:119], v16 offset:13312
    v_mfma_f32_32x32x16_bf16 v[160:175], a[136:139], v[96:99], v[160:175]
    v_add_f32 v18, v18, v47
    v_cvt_pk_bf16_f32 v103, v46, v47
    v_exp_f32 v48, v48
    v_mfma_f32_32x32x16_bf16 v[176:191], a[140:143], v[96:99], v[176:191]
    v_exp_f32 v49, v49
    v_add_f32 v19, v19, v48
    ds_read_b128 a[120:123], v16 offset:14336
    ds_read_b128 a[124:127], v16 offset:15360
    v_mfma_f32_32x32x16_bf16 v[128:143], a[144:147], v[100:103], v[128:143]
    v_exp_f32 v50, v50
    v_add_f32 v19, v19, v49
    v_cvt_pk_bf16_f32 v104, v48, v49
    v_mfma_f32_32x32x16_bf16 v[144:159], a[148:151], v[100:103], v[144:159]
    v_exp_f32 v51, v51
    v_add_f32 v19, v19, v50
    s_add_u32 s43, s43, 1
    v_mfma_f32_32x32x16_bf16 v[160:175], a[152:155], v[100:103], v[160:175]
    v_exp_f32 v52, v52
    v_add_f32 v19, v19, v51
    v_cvt_pk_bf16_f32 v105, v50, v51
    v_mfma_f32_32x32x16_bf16 v[176:191], a[156:159], v[100:103], v[176:191]
    v_exp_f32 v53, v53
    v_add_f32 v19, v19, v52
    s_waitcnt lgkmcnt(0)
    v_mfma_f32_32x32x16_bf16 v[32:47], a[96:99], a[0:3], v[64:79]
    v_exp_f32 v54, v54
    v_add_f32 v19, v19, v53
    v_cvt_pk_bf16_f32 v106, v52, v53
    v_mfma_f32_32x32x16_bf16 v[32:47], a[100:103], a[4:7], v[32:47]
    v_exp_f32 v55, v55
    v_add_f32 v19, v19, v54
    ds_read_b128 a[160:163], v16 offset:24576
    v_mfma_f32_32x32x16_bf16 v[32:47], a[104:107], a[8:11], v[32:47]
    v_exp_f32 v56, v56
    v_add_f32 v19, v19, v55
    v_cvt_pk_bf16_f32 v107, v54, v55
    v_mfma_f32_32x32x16_bf16 v[32:47], a[108:111], a[12:15], v[32:47]
    v_exp_f32 v57, v57
    v_add_f32 v19, v19, v56
    ds_read_b128 a[164:167], v16 offset:25600
    v_mfma_f32_32x32x16_bf16 v[32:47], a[112:115], a[16:19], v[32:47]
    v_exp_f32 v58, v58
    v_add_f32 v19, v19, v57
    v_cvt_pk_bf16_f32 v108, v56, v57
    v_mfma_f32_32x32x16_bf16 v[32:47], a[116:119], a[20:23], v[32:47]
    v_exp_f32 v59, v59
    v_add_f32 v19, v19, v58
    ds_read_b128 a[168:171], v16 offset:26624
    ds_read_b128 a[172:175], v16 offset:27648
    v_mfma_f32_32x32x16_bf16 v[32:47], a[120:123], a[24:27], v[32:47]
    v_exp_f32 v60, v60
    v_add_f32 v19, v19, v59
    v_cvt_pk_bf16_f32 v109, v58, v59
    ds_read_b128 a[176:179], v16 offset:28672
    v_mfma_f32_32x32x16_bf16 v[32:47], a[124:127], a[28:31], v[32:47]
    v_exp_f32 v61, v61
    v_add_f32 v19, v19, v60
    v_mfma_f32_32x32x16_bf16 v[192:207], a[128:131], v[104:107], v[192:207]
    v_exp_f32 v62, v62
    v_add_f32 v19, v19, v61
    v_cvt_pk_bf16_f32 v110, v60, v61
    v_mfma_f32_32x32x16_bf16 v[208:223], a[132:135], v[104:107], v[208:223]
    v_exp_f32 v63, v63
    v_add_f32 v19, v19, v62
    ds_read_b128 a[180:183], v16 offset:29696
    v_mfma_f32_32x32x16_bf16 v[224:239], a[136:139], v[104:107], v[224:239]
    v_add_f32 v19, v19, v63
    v_cvt_pk_bf16_f32 v111, v62, v63
    v_exp_f32 v32, v32
    v_mfma_f32_32x32x16_bf16 v[240:255], a[140:143], v[104:107], v[240:255]
    v_exp_f32 v33, v33
    v_add_f32 v18, v18, v32
    ds_read_b128 a[184:187], v16 offset:30720
    v_mfma_f32_32x32x16_bf16 v[192:207], a[144:147], v[108:111], v[192:207]
    v_exp_f32 v34, v34
    v_add_f32 v18, v18, v33
    v_cvt_pk_bf16_f32 v96, v32, v33
    v_mfma_f32_32x32x16_bf16 v[208:223], a[148:151], v[108:111], v[208:223]
    v_exp_f32 v35, v35
    v_add_f32 v18, v18, v34
    ds_read_b128 a[188:191], v16 offset:31744
    v_mfma_f32_32x32x16_bf16 v[224:239], a[152:155], v[108:111], v[224:239]
    v_exp_f32 v36, v36
    v_add_f32 v18, v18, v35
    v_cvt_pk_bf16_f32 v97, v34, v35
    v_mfma_f32_32x32x16_bf16 v[240:255], a[156:159], v[108:111], v[240:255]
    v_exp_f32 v37, v37
    v_add_f32 v18, v18, v36
    v_mfma_f32_32x32x16_bf16 v[48:63], a[96:99], a[32:35], v[80:95]
    s_waitcnt vmcnt(2)
    s_barrier
    v_exp_f32 v38, v38
    v_add_f32 v18, v18, v37
    v_cvt_pk_bf16_f32 v98, v36, v37
    v_mfma_f32_32x32x16_bf16 v[48:63], a[100:103], a[36:39], v[48:63]
    v_exp_f32 v39, v39
    v_add_f32 v18, v18, v38
    ds_read_b128 a[64:67], v17 offset:0
    s_add_u32 m0, s42, 0
    s_nop 0
    buffer_load_dwordx4 v1, s[20:23], s41 offen offset:0 lds
    v_mfma_f32_32x32x16_bf16 v[48:63], a[104:107], a[40:43], v[48:63]
    v_exp_f32 v40, v40
    v_add_f32 v18, v18, v39
    v_cvt_pk_bf16_f32 v99, v38, v39
    buffer_load_dwordx4 v1, s[20:23], s41 offen offset:1024 lds
    s_cmp_ge_i32 s43, s55
    s_cbranch_scc1 L_hko_31
L_hkb_32:
    v_mfma_f32_32x32x16_bf16 v[48:63], a[108:111], a[44:47], v[48:63]
    v_exp_f32 v41, v41
    v_add_f32 v18, v18, v40
    ds_read_b128 a[68:71], v17 offset:1024
    buffer_load_dwordx4 v1, s[20:23], s41 offen offset:2048 lds
    s_add_u32 s43, s43, 1
    v_mfma_f32_32x32x16_bf16 v[48:63], a[112:115], a[48:51], v[48:63]
    v_exp_f32 v42, v42
    v_add_f32 v18, v18, v41
    v_cvt_pk_bf16_f32 v100, v40, v41
    buffer_load_dwordx4 v1, s[20:23], s41 offen offset:3072 lds
    s_add_u32 m0, s42, 16384
    s_nop 0
    buffer_load_dwordx4 v1, s[24:27], s41 offen offset:0 lds
    v_mfma_f32_32x32x16_bf16 v[48:63], a[116:119], a[52:55], v[48:63]
    v_exp_f32 v43, v43
    v_add_f32 v18, v18, v42
    ds_read_b128 a[72:75], v17 offset:2048
    ds_read_b128 a[76:79], v17 offset:3072
    v_mfma_f32_32x32x16_bf16 v[48:63], a[120:123], a[56:59], v[48:63]
    v_exp_f32 v44, v44
    v_add_f32 v18, v18, v43
    v_cvt_pk_bf16_f32 v101, v42, v43
    ds_read_b128 a[80:83], v17 offset:4096
    v_mfma_f32_32x32x16_bf16 v[48:63], a[124:127], a[60:63], v[48:63]
    v_exp_f32 v45, v45
    v_add_f32 v18, v18, v44
    buffer_load_dwordx4 v1, s[24:27], s41 offen offset:1024 lds
    s_waitcnt lgkmcnt(5)
    v_mfma_f32_32x32x16_bf16 v[128:143], a[160:163], v[96:99], v[128:143]
    v_exp_f32 v46, v46
    v_add_f32 v18, v18, v45
    v_cvt_pk_bf16_f32 v102, v44, v45
    buffer_load_dwordx4 v1, s[24:27], s41 offen offset:2048 lds
    v_mfma_f32_32x32x16_bf16 v[144:159], a[164:167], v[96:99], v[144:159]
    v_exp_f32 v47, v47
    v_add_f32 v18, v18, v46
    ds_read_b128 a[84:87], v17 offset:5120
    buffer_load_dwordx4 v1, s[24:27], s41 offen offset:3072 lds
    v_mfma_f32_32x32x16_bf16 v[160:175], a[168:171], v[96:99], v[160:175]
    v_add_f32 v18, v18, v47
    v_cvt_pk_bf16_f32 v103, v46, v47
    v_exp_f32 v48, v48
    v_mov_b32 v16, v17
    v_mfma_f32_32x32x16_bf16 v[176:191], a[172:175], v[96:99], v[176:191]
    v_exp_f32 v49, v49
    v_add_f32 v19, v19, v48
    ds_read_b128 a[88:91], v17 offset:6144
    ds_read_b128 a[92:95], v17 offset:7168
    v_mfma_f32_32x32x16_bf16 v[128:143], a[176:179], v[100:103], v[128:143]
    v_exp_f32 v50, v50
    v_add_f32 v19, v19, v49
    v_cvt_pk_bf16_f32 v104, v48, v49
    v_mfma_f32_32x32x16_bf16 v[144:159], a[180:183], v[100:103], v[144:159]
    v_exp_f32 v51, v51
    v_add_f32 v19, v19, v50
    s_add_u32 s41, s41, 16384
    s_add_u32 s42, s42, 32768
    v_mfma_f32_32x32x16_bf16 v[160:175], a[184:187], v[100:103], v[160:175]
    v_exp_f32 v52, v52
    v_add_f32 v19, v19, v51
    v_cvt_pk_bf16_f32 v105, v50, v51
    s_cmp_ge_u32 s42, 163840
    s_cselect_b32 s42, s37, s42
    v_mfma_f32_32x32x16_bf16 v[176:191], a[188:191], v[100:103], v[176:191]
    v_exp_f32 v53, v53
    v_add_f32 v19, v19, v52
    s_cmp_lt_u32 s43, s44
    s_cbranch_scc1 L_dual_22
    s_cmp_lt_u32 s43, s49
    s_cbranch_scc1 L_tr_33
    s_cmp_eq_u32 s43, s47
    s_cbranch_scc1 L_md_34
    s_cmp_gt_u32 s43, s47
    s_cbranch_scc1 L_mf_35
    v_mov_b32 v80, v21
    v_mov_b32 v81, v21
    v_mov_b32 v82, v21
    v_mov_b32 v83, v21
    v_mov_b32 v84, v21
    v_mov_b32 v85, v21
    v_mov_b32 v86, v21
    v_mov_b32 v87, v21
    v_mov_b32 v88, v21
    v_mov_b32 v89, v21
    v_mov_b32 v90, v21
    v_mov_b32 v91, v21
    v_mov_b32 v92, v21
    v_mov_b32 v93, v21
    v_mov_b32 v94, v21
    v_mov_b32 v95, v21
    s_branch L_mx_36
L_md_34:
    v_mov_b32 v22, 0xf149f2ca
    v_cndmask_b32 v80, v22, v21, s[56:57]
    v_cndmask_b32 v81, v22, v21, s[58:59]
    v_cndmask_b32 v82, v22, v21, s[60:61]
    v_cndmask_b32 v83, v22, v21, s[62:63]
    v_cndmask_b32 v84, v22, v21, s[64:65]
    v_cndmask_b32 v85, v22, v21, s[66:67]
    v_cndmask_b32 v86, v22, v21, s[68:69]
    v_cndmask_b32 v87, v22, v21, s[70:71]
    v_cndmask_b32 v88, v22, v21, s[72:73]
    v_cndmask_b32 v89, v22, v21, s[74:75]
    v_cndmask_b32 v90, v22, v21, s[76:77]
    v_cndmask_b32 v91, v22, v21, s[78:79]
    v_cndmask_b32 v92, v22, v21, s[80:81]
    v_cndmask_b32 v93, v22, v21, s[82:83]
    v_cndmask_b32 v94, v22, v21, s[84:85]
    v_cndmask_b32 v95, v22, v21, s[86:87]
    s_branch L_mx_36
L_mf_35:
    v_mov_b32 v80, 0xf149f2ca
    v_mov_b32 v81, 0xf149f2ca
    v_mov_b32 v82, 0xf149f2ca
    v_mov_b32 v83, 0xf149f2ca
    v_mov_b32 v84, 0xf149f2ca
    v_mov_b32 v85, 0xf149f2ca
    v_mov_b32 v86, 0xf149f2ca
    v_mov_b32 v87, 0xf149f2ca
    v_mov_b32 v88, 0xf149f2ca
    v_mov_b32 v89, 0xf149f2ca
    v_mov_b32 v90, 0xf149f2ca
    v_mov_b32 v91, 0xf149f2ca
    v_mov_b32 v92, 0xf149f2ca
    v_mov_b32 v93, 0xf149f2ca
    v_mov_b32 v94, 0xf149f2ca
    v_mov_b32 v95, 0xf149f2ca
L_mx_36:
L_tr_33:
    s_waitcnt lgkmcnt(0)
L_single_24:
    s_waitcnt lgkmcnt(8)
    v_mfma_f32_32x32x16_bf16 v[32:47], a[64:67], a[32:35], v[80:95]
    v_exp_f32 v54, v54
    v_add_f32 v19, v19, v53
    v_cvt_pk_bf16_f32 v106, v52, v53
    s_add_u32 m0, s42, 0
    s_nop 0
    buffer_load_dwordx4 v1, s[20:23], s41 offen offset:0 lds
    v_mfma_f32_32x32x16_bf16 v[32:47], a[68:71], a[36:39], v[32:47]
    v_exp_f32 v55, v55
    v_add_f32 v19, v19, v54
    ds_read_b128 a[96:99], v16 offset:8192
    ds_read_b128 a[100:103], v16 offset:9216
    s_add_u32 s50, s50, 32768
    v_mfma_f32_32x32x16_bf16 v[32:47], a[72:75], a[40:43], v[32:47]
    v_exp_f32 v56, v56
    v_add_f32 v19, v19, v55
    v_cvt_pk_bf16_f32 v107, v54, v55
    buffer_load_dwordx4 v1, s[20:23], s41 offen offset:1024 lds
    s_cmp_ge_u32 s50, 163840
    s_cselect_b32 s50, 0, s50
    v_mfma_f32_32x32x16_bf16 v[32:47], a[76:79], a[44:47], v[32:47]
    v_exp_f32 v57, v57
    v_add_f32 v19, v19, v56
    ds_read_b128 a[104:107], v16 offset:10240
    ds_read_b128 a[108:111], v16 offset:11264
    v_add_u32 v17, s50, v1
    v_mfma_f32_32x32x16_bf16 v[32:47], a[80:83], a[48:51], v[32:47]
    v_exp_f32 v58, v58
    v_add_f32 v19, v19, v57
    v_cvt_pk_bf16_f32 v108, v56, v57
    buffer_load_dwordx4 v1, s[20:23], s41 offen offset:2048 lds
    buffer_load_dwordx4 v1, s[20:23], s41 offen offset:3072 lds
    v_mfma_f32_32x32x16_bf16 v[32:47], a[84:87], a[52:55], v[32:47]
    v_exp_f32 v59, v59
    v_add_f32 v19, v19, v58
    ds_read_b128 a[112:115], v16 offset:12288
    ds_read_b128 a[116:119], v16 offset:13312
    s_add_u32 m0, s42, 16384
    s_nop 0
    buffer_load_dwordx4 v1, s[24:27], s41 offen offset:0 lds
    v_mfma_f32_32x32x16_bf16 v[32:47], a[88:91], a[56:59], v[32:47]
    v_exp_f32 v60, v60
    v_add_f32 v19, v19, v59
    v_cvt_pk_bf16_f32 v109, v58, v59
    ds_read_b128 a[120:123], v16 offset:14336
    buffer_load_dwordx4 v1, s[24:27], s41 offen offset:1024 lds
    v_mfma_f32_32x32x16_bf16 v[32:47], a[92:95], a[60:63], v[32:47]
    v_exp_f32 v61, v61
    v_add_f32 v19, v19, v60
    ds_read_b128 a[124:127], v16 offset:15360
    s_cmp_ge_i32 s43, s93
    s_cbranch_scc1 L_hko_37
L_hkb_38:
    s_waitcnt lgkmcnt(8)
    v_mfma_f32_32x32x16_bf16 v[192:207], a[160:163], v[104:107], v[192:207]
    v_exp_f32 v62, v62
    v_add_f32 v19, v19, v61
    v_cvt_pk_bf16_f32 v110, v60, v61
    buffer_load_dwordx4 v1, s[24:27], s41 offen offset:2048 lds
    s_add_u32 s43, s43, 1
    v_mfma_f32_32x32x16_bf16 v[208:223], a[164:167], v[104:107], v[208:223]
    v_exp_f32 v63, v63
    v_add_f32 v19, v19, v62
    ds_read_b128 a[128:131], v16 offset:16384
    ds_read_b128 a[132:135], v16 offset:17408
    v_mfma_f32_32x32x16_bf16 v[224:239], a[168:171], v[104:107], v[224:239]
    v_add_f32 v19, v19, v63
    v_cvt_pk_bf16_f32 v111, v62, v63
    v_exp_f32 v32, v32
    buffer_load_dwordx4 v1, s[24:27], s41 offen offset:3072 lds
    v_mfma_f32_32x32x16_bf16 v[240:255], a[172:175], v[104:107], v[240:255]
    v_exp_f32 v33, v33
    v_add_f32 v19, v19, v32
    ds_read_b128 a[136:139], v16 offset:18432
    ds_read_b128 a[140:143], v16 offset:19456
    v_mfma_f32_32x32x16_bf16 v[192:207], a[176:179], v[108:111], v[192:207]
    v_exp_f32 v34, v34
    v_add_f32 v19, v19, v33
    v_cvt_pk_bf16_f32 v96, v32, v33
    s_add_u32 s41, s41, 16384
    s_add_u32 s42, s42, 32768
    v_mfma_f32_32x32x16_bf16 v[208:223], a[180:183], v[108:111], v[208:223]
    v_exp_f32 v35, v35
    v_add_f32 v19, v19, v34
    ds_read_b128 a[144:147], v16 offset:20480
    ds_read_b128 a[148:151], v16 offset:21504
    s_cmp_ge_u32 s42, 163840
    s_cselect_b32 s42, s37, s42
    v_mfma_f32_32x32x16_bf16 v[224:239], a[184:187], v[108:111], v[224:239]
    v_exp_f32 v36, v36
    v_add_f32 v19, v19, v35
    v_cvt_pk_bf16_f32 v97, v34, v35
    ds_read_b128 a[152:155], v16 offset:22528
    buffer_load_dwordx4 v[28:31], v1, s[88:91], s92 offen
    s_add_u32 s92, s92, 1024
    v_mfma_f32_32x32x16_bf16 v[240:255], a[188:191], v[108:111], v[240:255]
    v_exp_f32 v37, v37
    v_add_f32 v19, v19, v36
    ds_read_b128 a[156:159], v16 offset:23552
    buffer_load_dwordx4 v[28:31], v1, s[88:91], s92 offen
    s_add_u32 s92, s92, 1024
    s_waitcnt lgkmcnt(8)
    v_mfma_f32_32x32x16_bf16 v[48:63], a[96:99], a[32:35], v[80:95]
    v_exp_f32 v38, v38
    v_add_f32 v19, v19, v37
    v_cvt_pk_bf16_f32 v98, v36, v37
    v_mfma_f32_32x32x16_bf16 v[48:63], a[100:103], a[36:39], v[48:63]
    v_exp_f32 v39, v39
    v_add_f32 v19, v19, v38
    ds_read_b128 a[64:67], v17 offset:0
    ds_read_b128 a[68:71], v17 offset:1024
    v_mfma_f32_32x32x16_bf16 v[48:63], a[104:107], a[40:43], v[48:63]
    v_exp_f32 v40, v40
    v_add_f32 v19, v19, v39
    v_cvt_pk_bf16_f32 v99, v38, v39
    v_mfma_f32_32x32x16_bf16 v[48:63], a[108:111], a[44:47], v[48:63]
    v_exp_f32 v41, v41
    v_add_f32 v19, v19, v40
    ds_read_b128 a[72:75], v17 offset:2048
    ds_read_b128 a[76:79], v17 offset:3072
    v_mfma_f32_32x32x16_bf16 v[48:63], a[112:115], a[48:51], v[48:63]
    v_exp_f32 v42, v42
    v_add_f32 v19, v19, v41
    v_cvt_pk_bf16_f32 v100, v40, v41
    s_cmp_ge_i32 s43, s93
    s_cbranch_scc1 L_hko_39
L_hkb_40:
    v_mfma_f32_32x32x16_bf16 v[48:63], a[116:119], a[52:55], v[48:63]
    v_exp_f32 v43, v43
    v_add_f32 v19, v19, v42
    ds_read_b128 a[80:83], v17 offset:4096
    ds_read_b128 a[84:87], v17 offset:5120
    v_mfma_f32_32x32x16_bf16 v[48:63], a[120:123], a[56:59], v[48:63]
    v_exp_f32 v44, v44
    v_add_f32 v19, v19, v43
    v_cvt_pk_bf16_f32 v101, v42, v43
    ds_read_b128 a[88:91], v17 offset:6144
    v_mfma_f32_32x32x16_bf16 v[48:63], a[124:127], a[60:63], v[48:63]
    v_exp_f32 v45, v45
    v_add_f32 v19, v19, v44
    ds_read_b128 a[92:95], v17 offset:7168
    s_waitcnt lgkmcnt(8)
    v_mfma_f32_32x32x16_bf16 v[192:207], a[128:131], v[96:99], v[192:207]
    v_exp_f32 v46, v46
    v_add_f32 v19, v19, v45
    v_cvt_pk_bf16_f32 v102, v44, v45
    s_add_u32 s43, s43, 1
    v_mfma_f32_32x32x16_bf16 v[208:223], a[132:135], v[96:99], v[208:223]
    v_exp_f32 v47, v47
    v_add_f32 v19, v19, v46
    ds_read_b128 a[160:163], v16 offset:24576
    ds_read_b128 a[164:167], v16 offset:25600
    v_mfma_f32_32x32x16_bf16 v[224:239], a[136:139], v[96:99], v[224:239]
    v_add_f32 v19, v19, v47
    v_cvt_pk_bf16_f32 v103, v46, v47
    v_exp_f32 v48, v48
    v_mfma_f32_32x32x16_bf16 v[240:255], a[140:143], v[96:99], v[240:255]
    v_exp_f32 v49, v49
    v_add_f32 v19, v19, v48
    ds_read_b128 a[168:171], v16 offset:26624
    ds_read_b128 a[172:175], v16 offset:27648
    v_mfma_f32_32x32x16_bf16 v[192:207], a[144:147], v[100:103], v[192:207]
    v_exp_f32 v50, v50
    v_add_f32 v19, v19, v49
    v_cvt_pk_bf16_f32 v104, v48, v49
    v_mfma_f32_32x32x16_bf16 v[208:223], a[148:151], v[100:103], v[208:223]
    v_exp_f32 v51, v51
    v_add_f32 v19, v19, v50
    ds_read_b128 a[176:179], v16 offset:28672
    ds_read_b128 a[180:183], v16 offset:29696
    v_mfma_f32_32x32x16_bf16 v[224:239], a[152:155], v[100:103], v[224:239]
    v_exp_f32 v52, v52
    v_add_f32 v19, v19, v51
    v_cvt_pk_bf16_f32 v105, v50, v51
    ds_read_b128 a[184:187], v16 offset:30720
    v_mfma_f32_32x32x16_bf16 v[240:255], a[156:159], v[100:103], v[240:255]
    v_exp_f32 v53, v53
    v_add_f32 v19, v19, v52
    ds_read_b128 a[188:191], v16 offset:31744
    v_mov_b32 v16, v17
    s_waitcnt lgkmcnt(8)
    v_mfma_f32_32x32x16_bf16 v[32:47], a[64:67], a[32:35], v[80:95]
    v_exp_f32 v54, v54
    v_add_f32 v19, v19, v53
    v_cvt_pk_bf16_f32 v106, v52, v53
    s_add_u32 s50, s50, 32768
    v_mfma_f32_32x32x16_bf16 v[32:47], a[68:71], a[36:39], v[32:47]
    v_exp_f32 v55, v55
    v_add_f32 v19, v19, v54
    ds_read_b128 a[96:99], v16 offset:8192
    ds_read_b128 a[100:103], v16 offset:9216
    v_mfma_f32_32x32x16_bf16 v[32:47], a[72:75], a[40:43], v[32:47]
    v_exp_f32 v56, v56
    v_add_f32 v19, v19, v55
    v_cvt_pk_bf16_f32 v107, v54, v55
    s_cmp_ge_u32 s50, 163840
    s_cselect_b32 s50, 0, s50
    v_mfma_f32_32x32x16_bf16 v[32:47], a[76:79], a[44:47], v[32:47]
    v_exp_f32 v57, v57
    v_add_f32 v19, v19, v56
    ds_read_b128 a[104:107], v16 offset:10240
    ds_read_b128 a[108:111], v16 offset:11264
    v_mfma_f32_32x32x16_bf16 v[32:47], a[80:83], a[48:51], v[32:47]
    v_exp_f32 v58, v58
    v_add_f32 v19, v19, v57
    v_cvt_pk_bf16_f32 v108, v56, v57
    s_cmp_ge_i32 s43, s93
    s_cbranch_scc1 L_hko_41
L_hkb_42:
    v_mfma_f32_32x32x16_bf16 v[32:47], a[84:87], a[52:55], v[32:47]
    v_exp_f32 v59, v59
    v_add_f32 v19, v19, v58
    ds_read_b128 a[112:115], v16 offset:12288
    ds_read_b128 a[116:119], v16 offset:13312
    v_mfma_f32_32x32x16_bf16 v[32:47], a[88:91], a[56:59], v[32:47]
    v_exp_f32 v60, v60
    v_add_f32 v19, v19, v59
    v_cvt_pk_bf16_f32 v109, v58, v59
    ds_read_b128 a[120:123], v16 offset:14336
    v_mfma_f32_32x32x16_bf16 v[32:47], a[92:95], a[60:63], v[32:47]
    v_exp_f32 v61, v61
    v_add_f32 v19, v19, v60
    ds_read_b128 a[124:127], v16 offset:15360
    s_waitcnt lgkmcnt(8)
    v_mfma_f32_32x32x16_bf16 v[192:207], a[160:163], v[104:107], v[192:207]
    v_exp_f32 v62, v62
    v_add_f32 v19, v19, v61
    v_cvt_pk_bf16_f32 v110, v60, v61
    s_add_u32 s43, s43, 1
    v_mfma_f32_32x32x16_bf16 v[208:223], a[164:167], v[104:107], v[208:223]
    v_exp_f32 v63, v63
    v_add_f32 v19, v19, v62
    ds_read_b128 a[128:131], v16 offset:16384
    ds_read_b128 a[132:135], v16 offset:17408
    v_mfma_f32_32x32x16_bf16 v[224:239], a[168:171], v[104:107], v[224:239]
    v_add_f32 v19, v19, v63
    v_cvt_pk_bf16_f32 v111, v62, v63
    v_exp_f32 v32, v32
    v_add_u32 v17, s50, v1
    v_mfma_f32_32x32x16_bf16 v[240:255], a[172:175], v[104:107], v[240:255]
    v_exp_f32 v33, v33
    v_add_f32 v19, v19, v32
    ds_read_b128 a[136:139], v16 offset:18432
    ds_read_b128 a[140:143], v16 offset:19456
    v_mfma_f32_32x32x16_bf16 v[192:207], a[176:179], v[108:111], v[192:207]
    v_exp_f32 v34, v34
    v_add_f32 v19, v19, v33
    v_cvt_pk_bf16_f32 v96, v32, v33
    v_mfma_f32_32x32x16_bf16 v[208:223], a[180:183], v[108:111], v[208:223]
    v_exp_f32 v35, v35
    v_add_f32 v19, v19, v34
    ds_read_b128 a[144:147], v16 offset:20480
    ds_read_b128 a[148:151], v16 offset:21504
    v_mfma_f32_32x32x16_bf16 v[224:239], a[184:187], v[108:111], v[224:239]
    v_exp_f32 v36, v36
    v_add_f32 v19, v19, v35
    v_cvt_pk_bf16_f32 v97, v34, v35
    ds_read_b128 a[152:155], v16 offset:22528
    v_mfma_f32_32x32x16_bf16 v[240:255], a[188:191], v[108:111], v[240:255]
    v_exp_f32 v37, v37
    v_add_f32 v19, v19, v36
    ds_read_b128 a[156:159], v16 offset:23552
    s_waitcnt lgkmcnt(8)
    v_mfma_f32_32x32x16_bf16 v[48:63], a[96:99], a[32:35], v[80:95]
    s_waitcnt vmcnt(2)
    s_barrier
    v_exp_f32 v38, v38
    v_add_f32 v19, v19, v37
    v_cvt_pk_bf16_f32 v98, v36, v37
    v_mfma_f32_32x32x16_bf16 v[48:63], a[100:103], a[36:39], v[48:63]
    v_exp_f32 v39, v39
    v_add_f32 v19, v19, v38
    ds_read_b128 a[64:67], v17 offset:0
    ds_read_b128 a[68:71], v17 offset:1024
    v_mfma_f32_32x32x16_bf16 v[48:63], a[104:107], a[40:43], v[48:63]
    v_exp_f32 v40, v40
    v_add_f32 v19, v19, v39
    v_cvt_pk_bf16_f32 v99, v38, v39
    s_add_u32 m0, s42, 0
    s_nop 0
    buffer_load_dwordx4 v1, s[20:23], s41 offen offset:0 lds
    v_mfma_f32_32x32x16_bf16 v[48:63], a[108:111], a[44:47], v[48:63]
    v_exp_f32 v41, v41
    v_add_f32 v19, v19, v40
    ds_read_b128 a[72:75], v17 offset:2048
    ds_read_b128 a[76:79], v17 offset:3072
    v_mfma_f32_32x32x16_bf16 v[48:63], a[112:115], a[48:51], v[48:63]
    v_exp_f32 v42, v42
    v_add_f32 v19, v19, v41
    v_cvt_pk_bf16_f32 v100, v40, v41
    buffer_load_dwordx4 v1, s[20:23], s41 offen offset:1024 lds
    buffer_load_dwordx4 v1, s[20:23], s41 offen offset:2048 lds
    v_mfma_f32_32x32x16_bf16 v[48:63], a[116:119], a[52:55], v[48:63]
    v_exp_f32 v43, v43
    v_add_f32 v19, v19, v42
    ds_read_b128 a[80:83], v17 offset:4096
    ds_read_b128 a[84:87], v17 offset:5120
    buffer_load_dwordx4 v1, s[20:23], s41 offen offset:3072 lds
    v_mfma_f32_32x32x16_bf16 v[48:63], a[120:123], a[56:59], v[48:63]
    v_exp_f32 v44, v44
    v_add_f32 v19, v19, v43
    v_cvt_pk_bf16_f32 v101, v42, v43
    ds_read_b128 a[88:91], v17 offset:6144
    s_add_u32 m0, s42, 16384
    s_nop 0
    buffer_load_dwordx4 v1, s[24:27], s41 offen offset:0 lds
    v_mfma_f32_32x32x16_bf16 v[48:63], a[124:127], a[60:63], v[48:63]
    v_exp_f32 v45, v45
    v_add_f32 v19, v19, v44
    ds_read_b128 a[92:95], v17 offset:7168
    s_cmp_ge_i32 s43, s93
    s_cbranch_scc1 L_hko_43
L_hkb_44:
    s_waitcnt lgkmcnt(8)
    v_mfma_f32_32x32x16_bf16 v[192:207], a[128:131], v[96:99], v[192:207]
    v_exp_f32 v46, v46
    v_add_f32 v19, v19, v45
    v_cvt_pk_bf16_f32 v102, v44, v45
    buffer_load_dwordx4 v1, s[24:27], s41 offen offset:1024 lds
    s_add_u32 s43, s43, 1
    v_mfma_f32_32x32x16_bf16 v[208:223], a[132:135], v[96:99], v[208:223]
    v_exp_f32 v47, v47
    v_add_f32 v19, v19, v46
    ds_read_b128 a[160:163], v16 offset:24576
    ds_read_b128 a[164:167], v16 offset:25600
    v_mfma_f32_32x32x16_bf16 v[224:239], a[136:139], v[96:99], v[224:239]
    v_add_f32 v19, v19, v47
    v_cvt_pk_bf16_f32 v103, v46, v47
    v_exp_f32 v48, v48
    buffer_load_dwordx4 v1, s[24:27], s41 offen offset:2048 lds
    v_mfma_f32_32x32x16_bf16 v[240:255], a[140:143], v[96:99], v[240:255]
    v_exp_f32 v49, v49
    v_add_f32 v19, v19, v48
    ds_read_b128 a[168:171], v16 offset:26624
    ds_read_b128 a[172:175], v16 offset:27648
    v_mfma_f32_32x32x16_bf16 v[192:207], a[144:147], v[100:103], v[192:207]
    v_exp_f32 v50, v50
    v_add_f32 v19, v19, v49
    v_cvt_pk_bf16_f32 v104, v48, v49
    buffer_load_dwordx4 v1, s[24:27], s41 offen offset:3072 lds
    s_add_u32 s41, s41, 16384
    s_add_u32 s42, s42, 32768
    v_mfma_f32_32x32x16_bf16 v[208:223], a[148:151], v[100:103], v[208:223]
    v_exp_f32 v51, v51
    v_add_f32 v19, v19, v50
    ds_read_b128 a[176:179], v16 offset:28672
    ds_read_b128 a[180:183], v16 offset:29696
    s_cmp_ge_u32 s42, 163840
    s_cselect_b32 s42, s37, s42
    v_mfma_f32_32x32x16_bf16 v[224:239], a[152:155], v[100:103], v[224:239]
    v_exp_f32 v52, v52
    v_add_f32 v19, v19, v51
    v_cvt_pk_bf16_f32 v105, v50, v51
    ds_read_b128 a[184:187], v16 offset:30720
    v_mfma_f32_32x32x16_bf16 v[240:255], a[156:159], v[100:103], v[240:255]
    v_exp_f32 v53, v53
    v_add_f32 v19, v19, v52
    ds_read_b128 a[188:191], v16 offset:31744
    v_mov_b32 v16, v17
    s_cmp_lt_u32 s43, s45
    s_cbranch_scc1 L_single_24
    v_exp_f32 v54, v54
    v_add_f32 v19, v19, v53
    v_cvt_pk_bf16_f32 v106, v52, v53
    s_nop 1
    v_exp_f32 v55, v55
    v_add_f32 v19, v19, v54
    s_nop 1
    v_exp_f32 v56, v56
    v_add_f32 v19, v19, v55
    v_cvt_pk_bf16_f32 v107, v54, v55
    s_nop 1
    v_exp_f32 v57, v57
    v_add_f32 v19, v19, v56
    s_nop 1
    v_exp_f32 v58, v58
    v_add_f32 v19, v19, v57
    v_cvt_pk_bf16_f32 v108, v56, v57
    s_nop 1
    v_exp_f32 v59, v59
    v_add_f32 v19, v19, v58
    s_nop 1
    v_exp_f32 v60, v60
    v_add_f32 v19, v19, v59
    v_cvt_pk_bf16_f32 v109, v58, v59
    s_nop 1
    v_exp_f32 v61, v61
    v_add_f32 v19, v19, v60
    s_nop 1
    s_waitcnt lgkmcnt(0)
    v_mfma_f32_32x32x16_bf16 v[192:207], a[160:163], v[104:107], v[192:207]
    v_exp_f32 v62, v62
    v_add_f32 v19, v19, v61
    v_cvt_pk_bf16_f32 v110, v60, v61
    s_nop 1
    v_mfma_f32_32x32x16_bf16 v[208:223], a[164:167], v[104:107], v[208:223]
    v_exp_f32 v63, v63
    v_add_f32 v19, v19, v62
    s_nop 1
    v_mfma_f32_32x32x16_bf16 v[224:239], a[168:171], v[104:107], v[224:239]
    v_add_f32 v19, v19, v63
    v_cvt_pk_bf16_f32 v111, v62, v63
    s_nop 1
    v_mfma_f32_32x32x16_bf16 v[240:255], a[172:175], v[104:107], v[240:255]
    s_nop 1
    v_mfma_f32_32x32x16_bf16 v[192:207], a[176:179], v[108:111], v[192:207]
    s_nop 1
    v_mfma_f32_32x32x16_bf16 v[208:223], a[180:183], v[108:111], v[208:223]
    s_nop 1
    v_mfma_f32_32x32x16_bf16 v[224:239], a[184:187], v[108:111], v[224:239]
    s_nop 1
    v_mfma_f32_32x32x16_bf16 v[240:255], a[188:191], v[108:111], v[240:255]
    s_nop 1
    s_nop 15
    v_mov_b32 v23, v18
    v_mov_b32 v24, v18
    s_nop 1
    v_permlane32_swap_b32 v23, v24
    s_nop 1
    v_add_f32 v18, v23, v24
    v_mov_b32 v23, v19
    v_mov_b32 v24, v19
    s_nop 1
    v_permlane32_swap_b32 v23, v24
    s_nop 1
    v_add_f32 v19, v23, v24
    s_mov_b32 s38, 0x67800000
    v_cmp_nlt_f32 vcc, v18, s38
    s_mov_b64 s[52:53], vcc
    v_cmp_nlt_f32 vcc, v19, s38
    s_or_b64 s[52:53], s[52:53], vcc
    s_or_b32 s52, s52, s53
    s_waitcnt vmcnt(0) lgkmcnt(0)
    s_barrier
    v_mov_b32 v22, 0x20000
    v_lshl_add_u32 v23, s34, 2, v22
    v_mov_b32 v24, s52
    ds_write_b32 v23, v24
    s_waitcnt lgkmcnt(0)
    s_barrier
    ds_read_b128 v[24:27], v22
    s_waitcnt lgkmcnt(0)
    v_or3_b32 v24, v24, v25, v26
    v_or_b32 v24, v24, v27
    s_nop 0
    v_readfirstlane_b32 s38, v24
    s_cmp_eq_u32 s38, 0
    s_cbranch_scc1 L_ok_45
    s_cmp_eq_u32 s51, 0
    s_cbranch_scc1 L_fb_46
L_ok_45:
    v_rcp_f32 v18, v18
    v_rcp_f32 v19, v19
    s_lshl_b32 s38, s46, 18
    s_lshl_b32 s39, s32, 13
    s_add_u32 s96, s38, s39
    s_add_u32 s97, s96, 4096
    s_lshl_b32 s38, s47, 18
    s_lshl_b32 s39, s32, 13
    s_add_u32 s98, s38, s39
    s_add_u32 s99, s98, 4096
    v_mov_b32 v120, v18
    v_mov_b32 v121, v19
    v_mov_b32 v122, v1
    s_mov_b32 s100, 1
    v_lshl_add_u32 v0, s34, 6, v0
    s_barrier
    s_branch L_k2_aproj
L_fb_46:
    s_mov_b32 s51, 1
    v_mov_b32 v26, 0xf149f2ca
    v_mov_b32 v27, 0xf149f2ca
    v_mov_b32 v20, 0
    v_mov_b32 v21, 0
    s_mov_b32 s43, 0
    s_lshr_b32 s41, s37, 1
L_ml_47:
    s_barrier
    s_lshr_b32 s39, s37, 1
    s_mov_b32 m0, s39
    s_nop 0
    buffer_load_dwordx4 v1, s[20:23], s41 offen offset:0 lds
    buffer_load_dwordx4 v1, s[20:23], s41 offen offset:1024 lds
    s_add_u32 s41, s41, 8192
    s_waitcnt vmcnt(0)
    s_barrier
    ds_read_b128 a[64:67], v1 offset:0
    ds_read_b128 a[68:71], v1 offset:1024
    ds_read_b128 a[72:75], v1 offset:2048
    ds_read_b128 a[76:79], v1 offset:3072
    ds_read_b128 a[80:83], v1 offset:4096
    ds_read_b128 a[84:87], v1 offset:5120
    ds_read_b128 a[88:91], v1 offset:6144
    ds_read_b128 a[92:95], v1 offset:7168
    s_cmp_eq_u32 s43, s46
    s_cbranch_scc1 L_md_48
    s_cmp_gt_u32 s43, s46
    s_cbranch_scc1 L_mf_49
    v_mov_b32 v64, v20
    v_mov_b32 v65, v20
    v_mov_b32 v66, v20
    v_mov_b32 v67, v20
    v_mov_b32 v68, v20
    v_mov_b32 v69, v20
    v_mov_b32 v70, v20
    v_mov_b32 v71, v20
    v_mov_b32 v72, v20
    v_mov_b32 v73, v20
    v_mov_b32 v74, v20
    v_mov_b32 v75, v20
    v_mov_b32 v76, v20
    v_mov_b32 v77, v20
    v_mov_b32 v78, v20
    v_mov_b32 v79, v20
    s_branch L_mx_50
L_md_48:
    v_mov_b32 v22, 0xf149f2ca
    v_cndmask_b32 v64, v22, v20, s[56:57]
    v_cndmask_b32 v65, v22, v20, s[58:59]
    v_cndmask_b32 v66, v22, v20, s[60:61]
    v_cndmask_b32 v67, v22, v20, s[62:63]
    v_cndmask_b32 v68, v22, v20, s[64:65]
    v_cndmask_b32 v69, v22, v20, s[66:67]
    v_cndmask_b32 v70, v22, v20, s[68:69]
    v_cndmask_b32 v71, v22, v20, s[70:71]
    v_cndmask_b32 v72, v22, v20, s[72:73]
    v_cndmask_b32 v73, v22, v20, s[74:75]
    v_cndmask_b32 v74, v22, v20, s[76:77]
    v_cndmask_b32 v75, v22, v20, s[78:79]
    v_cndmask_b32 v76, v22, v20, s[80:81]
    v_cndmask_b32 v77, v22, v20, s[82:83]
    v_cndmask_b32 v78, v22, v20, s[84:85]
    v_cndmask_b32 v79, v22, v20, s[86:87]
    s_branch L_mx_50
L_mf_49:
    v_mov_b32 v64, 0xf149f2ca
    v_mov_b32 v65, 0xf149f2ca
    v_mov_b32 v66, 0xf149f2ca
    v_mov_b32 v67, 0xf149f2ca
    v_mov_b32 v68, 0xf149f2ca
    v_mov_b32 v69, 0xf149f2ca
    v_mov_b32 v70, 0xf149f2ca
    v_mov_b32 v71, 0xf149f2ca
    v_mov_b32 v72, 0xf149f2ca
    v_mov_b32 v73, 0xf149f2ca
    v_mov_b32 v74, 0xf149f2ca
    v_mov_b32 v75, 0xf149f2ca
    v_mov_b32 v76, 0xf149f2ca
    v_mov_b32 v77, 0xf149f2ca
    v_mov_b32 v78, 0xf149f2ca
    v_mov_b32 v79, 0xf149f2ca
L_mx_50:
    s_cmp_eq_u32 s43, s47
    s_cbranch_scc1 L_md_51
    s_cmp_gt_u32 s43, s47
    s_cbranch_scc1 L_mf_52
    v_mov_b32 v80, v21
    v_mov_b32 v81, v21
    v_mov_b32 v82, v21
    v_mov_b32 v83, v21
    v_mov_b32 v84, v21
    v_mov_b32 v85, v21
    v_mov_b32 v86, v21
    v_mov_b32 v87, v21
    v_mov_b32 v88, v21
    v_mov_b32 v89, v21
    v_mov_b32 v90, v21
    v_mov_b32 v91, v21
    v_mov_b32 v92, v21
    v_mov_b32 v93, v21
    v_mov_b32 v94, v21
    v_mov_b32 v95, v21
    s_branch L_mx_53
L_md_51:
    v_mov_b32 v22, 0xf149f2ca
    v_cndmask_b32 v80, v22, v21, s[56:57]
    v_cndmask_b32 v81, v22, v21, s[58:59]
    v_cndmask_b32 v82, v22, v21, s[60:61]
    v_cndmask_b32 v83, v22, v21, s[62:63]
    v_cndmask_b32 v84, v22, v21, s[64:65]
    v_cndmask_b32 v85, v22, v21, s[66:67]
    v_cndmask_b32 v86, v22, v21, s[68:69]
    v_cndmask_b32 v87, v22, v21, s[70:71]
    v_cndmask_b32 v88, v22, v21, s[72:73]
    v_cndmask_b32 v89, v22, v21, s[74:75]
    v_cndmask_b32 v90, v22, v21, s[76:77]
    v_cndmask_b32 v91, v22, v21, s[78:79]
    v_cndmask_b32 v92, v22, v21, s[80:81]
    v_cndmask_b32 v93, v22, v21, s[82:83]
    v_cndmask_b32 v94, v22, v21, s[84:85]
    v_cndmask_b32 v95, v22, v21, s[86:87]
    s_branch L_mx_53
L_mf_52:
    v_mov_b32 v80, 0xf149f2ca
    v_mov_b32 v81, 0xf149f2ca
    v_mov_b32 v82, 0xf149f2ca
    v_mov_b32 v83, 0xf149f2ca
    v_mov_b32 v84, 0xf149f2ca
    v_mov_b32 v85, 0xf149f2ca
    v_mov_b32 v86, 0xf149f2ca
    v_mov_b32 v87, 0xf149f2ca
    v_mov_b32 v88, 0xf149f2ca
    v_mov_b32 v89, 0xf149f2ca
    v_mov_b32 v90, 0xf149f2ca
    v_mov_b32 v91, 0xf149f2ca
    v_mov_b32 v92, 0xf149f2ca
    v_mov_b32 v93, 0xf149f2ca
    v_mov_b32 v94, 0xf149f2ca
    v_mov_b32 v95, 0xf149f2ca
L_mx_53:
    s_waitcnt lgkmcnt(0)
    s_nop 1
    v_mfma_f32_32x32x16_bf16 v[32:47], a[64:67], a[0:3], v[64:79]
    v_mfma_f32_32x32x16_bf16 v[32:47], a[68:71], a[4:7], v[32:47]
    v_mfma_f32_32x32x16_bf16 v[32:47], a[72:75], a[8:11], v[32:47]
    v_mfma_f32_32x32x16_bf16 v[32:47], a[76:79], a[12:15], v[32:47]
    v_mfma_f32_32x32x16_bf16 v[32:47], a[80:83], a[16:19], v[32:47]
    v_mfma_f32_32x32x16_bf16 v[32:47], a[84:87], a[20:23], v[32:47]
    v_mfma_f32_32x32x16_bf16 v[32:47], a[88:91], a[24:27], v[32:47]
    v_mfma_f32_32x32x16_bf16 v[32:47], a[92:95], a[28:31], v[32:47]
    v_mfma_f32_32x32x16_bf16 v[48:63], a[64:67], a[32:35], v[80:95]
    v_mfma_f32_32x32x16_bf16 v[48:63], a[68:71], a[36:39], v[48:63]
    v_mfma_f32_32x32x16_bf16 v[48:63], a[72:75], a[40:43], v[48:63]
    v_mfma_f32_32x32x16_bf16 v[48:63], a[76:79], a[44:47], v[48:63]
    v_mfma_f32_32x32x16_bf16 v[48:63], a[80:83], a[48:51], v[48:63]
    v_mfma_f32_32x32x16_bf16 v[48:63], a[84:87], a[52:55], v[48:63]
    v_mfma_f32_32x32x16_bf16 v[48:63], a[88:91], a[56:59], v[48:63]
    v_mfma_f32_32x32x16_bf16 v[48:63], a[92:95], a[60:63], v[48:63]
    s_nop 15
    s_nop 3
    v_max3_f32 v26, v26, v32, v33
    v_max3_f32 v26, v26, v34, v35
    v_max3_f32 v26, v26, v36, v37
    v_max3_f32 v26, v26, v38, v39
    v_max3_f32 v26, v26, v40, v41
    v_max3_f32 v26, v26, v42, v43
    v_max3_f32 v26, v26, v44, v45
    v_max3_f32 v26, v26, v46, v47
    v_max3_f32 v27, v27, v48, v49
    v_max3_f32 v27, v27, v50, v51
    v_max3_f32 v27, v27, v52, v53
    v_max3_f32 v27, v27, v54, v55
    v_max3_f32 v27, v27, v56, v57
    v_max3_f32 v27, v27, v58, v59
    v_max3_f32 v27, v27, v60, v61
    v_max3_f32 v27, v27, v62, v63
    s_add_u32 s43, s43, 1
    s_cmp_lt_u32 s43, s45
    s_cbranch_scc1 L_ml_47
    v_mov_b32 v23, v26
    v_mov_b32 v24, v26
    s_nop 1
    v_permlane32_swap_b32 v23, v24
    s_nop 1
    v_max_f32 v26, v23, v24
    v_sub_f32 v20, 0, v26
    v_mov_b32 v23, v27
    v_mov_b32 v24, v27
    s_nop 1
    v_permlane32_swap_b32 v23, v24
    s_nop 1
    v_max_f32 v27, v23, v24
    v_sub_f32 v21, 0, v27
    s_barrier
    s_mov_b32 s41, s37
    s_add_u32 s42, s37, 65536
    s_add_u32 m0, s42, 0
    s_nop 0
    buffer_load_dwordx4 v1, s[20:23], s41 offen offset:0 lds
    buffer_load_dwordx4 v1, s[20:23], s41 offen offset:1024 lds
    buffer_load_dwordx4 v1, s[20:23], s41 offen offset:2048 lds
    buffer_load_dwordx4 v1, s[20:23], s41 offen offset:3072 lds
    s_add_u32 m0, s42, 16384
    s_nop 0
    buffer_load_dwordx4 v1, s[24:27], s41 offen offset:0 lds
    buffer_load_dwordx4 v1, s[24:27], s41 offen offset:1024 lds
    buffer_load_dwordx4 v1, s[24:27], s41 offen offset:2048 lds
    buffer_load_dwordx4 v1, s[24:27], s41 offen offset:3072 lds
    s_add_u32 s41, s41, 16384
    s_add_u32 s42, s42, 32768
    s_cmp_ge_u32 s42, 163840
    s_cselect_b32 s42, s37, s42
    s_add_u32 m0, s42, 0
    s_nop 0
    buffer_load_dwordx4 v1, s[20:23], s41 offen offset:0 lds
    buffer_load_dwordx4 v1, s[20:23], s41 offen offset:1024 lds
    buffer_load_dwordx4 v1, s[20:23], s41 offen offset:2048 lds
    buffer_load_dwordx4 v1, s[20:23], s41 offen offset:3072 lds
    s_add_u32 m0, s42, 16384
    s_nop 0
    buffer_load_dwordx4 v1, s[24:27], s41 offen offset:0 lds
    buffer_load_dwordx4 v1, s[24:27], s41 offen offset:1024 lds
    buffer_load_dwordx4 v1, s[24:27], s41 offen offset:2048 lds
    buffer_load_dwordx4 v1, s[24:27], s41 offen offset:3072 lds
    s_add_u32 s41, s41, 16384
    s_add_u32 s42, s42, 32768
    s_cmp_ge_u32 s42, 163840
    s_cselect_b32 s42, s37, s42
    s_add_u32 m0, s42, 0
    s_nop 0
    buffer_load_dwordx4 v1, s[20:23], s41 offen offset:0 lds
    buffer_load_dwordx4 v1, s[20:23], s41 offen offset:1024 lds
    buffer_load_dwordx4 v1, s[20:23], s41 offen offset:2048 lds
    buffer_load_dwordx4 v1, s[20:23], s41 offen offset:3072 lds
    s_add_u32 m0, s42, 16384
    s_nop 0
    buffer_load_dwordx4 v1, s[24:27], s41 offen offset:0 lds
    buffer_load_dwordx4 v1, s[24:27], s41 offen offset:1024 lds
    buffer_load_dwordx4 v1, s[24:27], s41 offen offset:2048 lds
    buffer_load_dwordx4 v1, s[24:27], s41 offen offset:3072 lds
    s_add_u32 s41, s41, 16384
    s_add_u32 s42, s42, 32768
    s_cmp_ge_u32 s42, 163840
    s_cselect_b32 s42, s37, s42
    s_add_u32 m0, s42, 0
    s_nop 0
    buffer_load_dwordx4 v1, s[20:23], s41 offen offset:0 lds
    buffer_load_dwordx4 v1, s[20:23], s41 offen offset:1024 lds
    buffer_load_dwordx4 v1, s[20:23], s41 offen offset:2048 lds
    buffer_load_dwordx4 v1, s[20:23], s41 offen offset:3072 lds
    s_add_u32 m0, s42, 16384
    s_nop 0
    buffer_load_dwordx4 v1, s[24:27], s41 offen offset:0 lds
    buffer_load_dwordx4 v1, s[24:27], s41 offen offset:1024 lds
    buffer_load_dwordx4 v1, s[24:27], s41 offen offset:2048 lds
    buffer_load_dwordx4 v1, s[24:27], s41 offen offset:3072 lds
    s_add_u32 s41, s41, 16384
    s_add_u32 s42, s42, 32768
    s_cmp_ge_u32 s42, 163840
    s_cselect_b32 s42, s37, s42
    buffer_load_dwordx4 v[28:31], v1, s[88:91], s92 offen
    s_add_u32 s92, s92, 1024
    buffer_load_dwordx4 v[28:31], v1, s[88:91], s92 offen
    s_add_u32 s92, s92, 1024
    s_waitcnt vmcnt(18)
    s_barrier
    v_add_u32 v16, 65536, v1
    ds_read_b128 a[64:67], v16 offset:0
    ds_read_b128 a[68:71], v16 offset:1024
    ds_read_b128 a[72:75], v16 offset:2048
    ds_read_b128 a[76:79], v16 offset:3072
    ds_read_b128 a[80:83], v16 offset:4096
    ds_read_b128 a[84:87], v16 offset:5120
    ds_read_b128 a[88:91], v16 offset:6144
    ds_read_b128 a[92:95], v16 offset:7168
    s_waitcnt lgkmcnt(0)
    s_branch L_main_14
L_hko_25:
    s_add_u32 s40, s43, 1
    s_cmp_eq_u32 s40, s46
    s_cbranch_scc1 L_md_54
    s_cmp_eq_u32 s43, s46
    s_cbranch_scc1 L_mf_55
    s_branch L_mx_56
L_md_54:
    v_mov_b32 v22, 0xf149f2ca
    v_cndmask_b32 v64, v22, v20, s[56:57]
    v_cndmask_b32 v65, v22, v20, s[58:59]
    v_cndmask_b32 v66, v22, v20, s[60:61]
    v_cndmask_b32 v67, v22, v20, s[62:63]
    v_cndmask_b32 v68, v22, v20, s[64:65]
    v_cndmask_b32 v69, v22, v20, s[66:67]
    v_cndmask_b32 v70, v22, v20, s[68:69]
    v_cndmask_b32 v71, v22, v20, s[70:71]
    v_cndmask_b32 v72, v22, v20, s[72:73]
    v_cndmask_b32 v73, v22, v20, s[74:75]
    v_cndmask_b32 v74, v22, v20, s[76:77]
    v_cndmask_b32 v75, v22, v20, s[78:79]
    v_cndmask_b32 v76, v22, v20, s[80:81]
    v_cndmask_b32 v77, v22, v20, s[82:83]
    v_cndmask_b32 v78, v22, v20, s[84:85]
    v_cndmask_b32 v79, v22, v20, s[86:87]
    s_branch L_mx_56
L_mf_55:
    v_mov_b32 v64, 0xf149f2ca
    v_mov_b32 v65, 0xf149f2ca
    v_mov_b32 v66, 0xf149f2ca
    v_mov_b32 v67, 0xf149f2ca
    v_mov_b32 v68, 0xf149f2ca
    v_mov_b32 v69, 0xf149f2ca
    v_mov_b32 v70, 0xf149f2ca
    v_mov_b32 v71, 0xf149f2ca
    v_mov_b32 v72, 0xf149f2ca
    v_mov_b32 v73, 0xf149f2ca
    v_mov_b32 v74, 0xf149f2ca
    v_mov_b32 v75, 0xf149f2ca
    v_mov_b32 v76, 0xf149f2ca
    v_mov_b32 v77, 0xf149f2ca
    v_mov_b32 v78, 0xf149f2ca
    v_mov_b32 v79, 0xf149f2ca
L_mx_56:
    s_nop 1
    s_branch L_hkb_26
L_hko_27:
    s_add_u32 s40, s43, 1
    s_cmp_eq_u32 s40, s46
    s_cbranch_scc1 L_md_57
    s_cmp_eq_u32 s43, s46
    s_cbranch_scc1 L_mf_58
    s_branch L_mx_59
L_md_57:
    v_mov_b32 v22, 0xf149f2ca
    v_cndmask_b32 v64, v22, v20, s[56:57]
    v_cndmask_b32 v65, v22, v20, s[58:59]
    v_cndmask_b32 v66, v22, v20, s[60:61]
    v_cndmask_b32 v67, v22, v20, s[62:63]
    v_cndmask_b32 v68, v22, v20, s[64:65]
    v_cndmask_b32 v69, v22, v20, s[66:67]
    v_cndmask_b32 v70, v22, v20, s[68:69]
    v_cndmask_b32 v71, v22, v20, s[70:71]
    v_cndmask_b32 v72, v22, v20, s[72:73]
    v_cndmask_b32 v73, v22, v20, s[74:75]
    v_cndmask_b32 v74, v22, v20, s[76:77]
    v_cndmask_b32 v75, v22, v20, s[78:79]
    v_cndmask_b32 v76, v22, v20, s[80:81]
    v_cndmask_b32 v77, v22, v20, s[82:83]
    v_cndmask_b32 v78, v22, v20, s[84:85]
    v_cndmask_b32 v79, v22, v20, s[86:87]
    s_branch L_mx_59
L_mf_58:
    v_mov_b32 v64, 0xf149f2ca
    v_mov_b32 v65, 0xf149f2ca
    v_mov_b32 v66, 0xf149f2ca
    v_mov_b32 v67, 0xf149f2ca
    v_mov_b32 v68, 0xf149f2ca
    v_mov_b32 v69, 0xf149f2ca
    v_mov_b32 v70, 0xf149f2ca
    v_mov_b32 v71, 0xf149f2ca
    v_mov_b32 v72, 0xf149f2ca
    v_mov_b32 v73, 0xf149f2ca
    v_mov_b32 v74, 0xf149f2ca
    v_mov_b32 v75, 0xf149f2ca
    v_mov_b32 v76, 0xf149f2ca
    v_mov_b32 v77, 0xf149f2ca
    v_mov_b32 v78, 0xf149f2ca
    v_mov_b32 v79, 0xf149f2ca
L_mx_59:
    s_nop 1
    s_branch L_hkb_28
L_hko_29:
    s_add_u32 s40, s43, 1
    s_cmp_eq_u32 s40, s46
    s_cbranch_scc1 L_md_60
    s_cmp_eq_u32 s43, s46
    s_cbranch_scc1 L_mf_61
    s_branch L_mx_62
L_md_60:
    v_mov_b32 v22, 0xf149f2ca
    v_cndmask_b32 v64, v22, v20, s[56:57]
    v_cndmask_b32 v65, v22, v20, s[58:59]
    v_cndmask_b32 v66, v22, v20, s[60:61]
    v_cndmask_b32 v67, v22, v20, s[62:63]
    v_cndmask_b32 v68, v22, v20, s[64:65]
    v_cndmask_b32 v69, v22, v20, s[66:67]
    v_cndmask_b32 v70, v22, v20, s[68:69]
    v_cndmask_b32 v71, v22, v20, s[70:71]
    v_cndmask_b32 v72, v22, v20, s[72:73]
    v_cndmask_b32 v73, v22, v20, s[74:75]
    v_cndmask_b32 v74, v22, v20, s[76:77]
    v_cndmask_b32 v75, v22, v20, s[78:79]
    v_cndmask_b32 v76, v22, v20, s[80:81]
    v_cndmask_b32 v77, v22, v20, s[82:83]
    v_cndmask_b32 v78, v22, v20, s[84:85]
    v_cndmask_b32 v79, v22, v20, s[86:87]
    s_branch L_mx_62
L_mf_61:
    v_mov_b32 v64, 0xf149f2ca
    v_mov_b32 v65, 0xf149f2ca
    v_mov_b32 v66, 0xf149f2ca
    v_mov_b32 v67, 0xf149f2ca
    v_mov_b32 v68, 0xf149f2ca
    v_mov_b32 v69, 0xf149f2ca
    v_mov_b32 v70, 0xf149f2ca
    v_mov_b32 v71, 0xf149f2ca
    v_mov_b32 v72, 0xf149f2ca
    v_mov_b32 v73, 0xf149f2ca
    v_mov_b32 v74, 0xf149f2ca
    v_mov_b32 v75, 0xf149f2ca
    v_mov_b32 v76, 0xf149f2ca
    v_mov_b32 v77, 0xf149f2ca
    v_mov_b32 v78, 0xf149f2ca
    v_mov_b32 v79, 0xf149f2ca
L_mx_62:
    s_nop 1
    s_branch L_hkb_30
L_hko_31:
    s_add_u32 s40, s43, 1
    s_cmp_eq_u32 s40, s46
    s_cbranch_scc1 L_md_63
    s_cmp_eq_u32 s43, s46
    s_cbranch_scc1 L_mf_64
    s_branch L_mx_65
L_md_63:
    v_mov_b32 v22, 0xf149f2ca
    v_cndmask_b32 v64, v22, v20, s[56:57]
    v_cndmask_b32 v65, v22, v20, s[58:59]
    v_cndmask_b32 v66, v22, v20, s[60:61]
    v_cndmask_b32 v67, v22, v20, s[62:63]
    v_cndmask_b32 v68, v22, v20, s[64:65]
    v_cndmask_b32 v69, v22, v20, s[66:67]
    v_cndmask_b32 v70, v22, v20, s[68:69]
    v_cndmask_b32 v71, v22, v20, s[70:71]
    v_cndmask_b32 v72, v22, v20, s[72:73]
    v_cndmask_b32 v73, v22, v20, s[74:75]
    v_cndmask_b32 v74, v22, v20, s[76:77]
    v_cndmask_b32 v75, v22, v20, s[78:79]
    v_cndmask_b32 v76, v22, v20, s[80:81]
    v_cndmask_b32 v77, v22, v20, s[82:83]
    v_cndmask_b32 v78, v22, v20, s[84:85]
    v_cndmask_b32 v79, v22, v20, s[86:87]
    s_branch L_mx_65
L_mf_64:
    v_mov_b32 v64, 0xf149f2ca
    v_mov_b32 v65, 0xf149f2ca
    v_mov_b32 v66, 0xf149f2ca
    v_mov_b32 v67, 0xf149f2ca
    v_mov_b32 v68, 0xf149f2ca
    v_mov_b32 v69, 0xf149f2ca
    v_mov_b32 v70, 0xf149f2ca
    v_mov_b32 v71, 0xf149f2ca
    v_mov_b32 v72, 0xf149f2ca
    v_mov_b32 v73, 0xf149f2ca
    v_mov_b32 v74, 0xf149f2ca
    v_mov_b32 v75, 0xf149f2ca
    v_mov_b32 v76, 0xf149f2ca
    v_mov_b32 v77, 0xf149f2ca
    v_mov_b32 v78, 0xf149f2ca
    v_mov_b32 v79, 0xf149f2ca
L_mx_65:
    s_nop 1
    s_branch L_hkb_32
L_hko_37:
    s_add_u32 s40, s43, 1
    s_cmp_eq_u32 s40, s47
    s_cbranch_scc1 L_md_66
    s_cmp_eq_u32 s43, s47
    s_cbranch_scc1 L_mf_67
    s_branch L_mx_68
L_md_66:
    v_mov_b32 v22, 0xf149f2ca
    v_cndmask_b32 v80, v22, v21, s[56:57]
    v_cndmask_b32 v81, v22, v21, s[58:59]
    v_cndmask_b32 v82, v22, v21, s[60:61]
    v_cndmask_b32 v83, v22, v21, s[62:63]
    v_cndmask_b32 v84, v22, v21, s[64:65]
    v_cndmask_b32 v85, v22, v21, s[66:67]
    v_cndmask_b32 v86, v22, v21, s[68:69]
    v_cndmask_b32 v87, v22, v21, s[70:71]
    v_cndmask_b32 v88, v22, v21, s[72:73]
    v_cndmask_b32 v89, v22, v21, s[74:75]
    v_cndmask_b32 v90, v22, v21, s[76:77]
    v_cndmask_b32 v91, v22, v21, s[78:79]
    v_cndmask_b32 v92, v22, v21, s[80:81]
    v_cndmask_b32 v93, v22, v21, s[82:83]
    v_cndmask_b32 v94, v22, v21, s[84:85]
    v_cndmask_b32 v95, v22, v21, s[86:87]
    s_branch L_mx_68
L_mf_67:
    v_mov_b32 v80, 0xf149f2ca
    v_mov_b32 v81, 0xf149f2ca
    v_mov_b32 v82, 0xf149f2ca
    v_mov_b32 v83, 0xf149f2ca
    v_mov_b32 v84, 0xf149f2ca
    v_mov_b32 v85, 0xf149f2ca
    v_mov_b32 v86, 0xf149f2ca
    v_mov_b32 v87, 0xf149f2ca
    v_mov_b32 v88, 0xf149f2ca
    v_mov_b32 v89, 0xf149f2ca
    v_mov_b32 v90, 0xf149f2ca
    v_mov_b32 v91, 0xf149f2ca
    v_mov_b32 v92, 0xf149f2ca
    v_mov_b32 v93, 0xf149f2ca
    v_mov_b32 v94, 0xf149f2ca
    v_mov_b32 v95, 0xf149f2ca
L_mx_68:
    s_nop 1
    s_branch L_hkb_38
L_hko_39:
    s_add_u32 s40, s43, 1
    s_cmp_eq_u32 s40, s47
    s_cbranch_scc1 L_md_69
    s_cmp_eq_u32 s43, s47
    s_cbranch_scc1 L_mf_70
    s_branch L_mx_71
L_md_69:
    v_mov_b32 v22, 0xf149f2ca
    v_cndmask_b32 v80, v22, v21, s[56:57]
    v_cndmask_b32 v81, v22, v21, s[58:59]
    v_cndmask_b32 v82, v22, v21, s[60:61]
    v_cndmask_b32 v83, v22, v21, s[62:63]
    v_cndmask_b32 v84, v22, v21, s[64:65]
    v_cndmask_b32 v85, v22, v21, s[66:67]
    v_cndmask_b32 v86, v22, v21, s[68:69]
    v_cndmask_b32 v87, v22, v21, s[70:71]
    v_cndmask_b32 v88, v22, v21, s[72:73]
    v_cndmask_b32 v89, v22, v21, s[74:75]
    v_cndmask_b32 v90, v22, v21, s[76:77]
    v_cndmask_b32 v91, v22, v21, s[78:79]
    v_cndmask_b32 v92, v22, v21, s[80:81]
    v_cndmask_b32 v93, v22, v21, s[82:83]
    v_cndmask_b32 v94, v22, v21, s[84:85]
    v_cndmask_b32 v95, v22, v21, s[86:87]
    s_branch L_mx_71
L_mf_70:
    v_mov_b32 v80, 0xf149f2ca
    v_mov_b32 v81, 0xf149f2ca
    v_mov_b32 v82, 0xf149f2ca
    v_mov_b32 v83, 0xf149f2ca
    v_mov_b32 v84, 0xf149f2ca
    v_mov_b32 v85, 0xf149f2ca
    v_mov_b32 v86, 0xf149f2ca
    v_mov_b32 v87, 0xf149f2ca
    v_mov_b32 v88, 0xf149f2ca
    v_mov_b32 v89, 0xf149f2ca
    v_mov_b32 v90, 0xf149f2ca
    v_mov_b32 v91, 0xf149f2ca
    v_mov_b32 v92, 0xf149f2ca
    v_mov_b32 v93, 0xf149f2ca
    v_mov_b32 v94, 0xf149f2ca
    v_mov_b32 v95, 0xf149f2ca
L_mx_71:
    s_nop 1
    s_branch L_hkb_40
L_hko_41:
    s_add_u32 s40, s43, 1
    s_cmp_eq_u32 s40, s47
    s_cbranch_scc1 L_md_72
    s_cmp_eq_u32 s43, s47
    s_cbranch_scc1 L_mf_73
    s_branch L_mx_74
L_md_72:
    v_mov_b32 v22, 0xf149f2ca
    v_cndmask_b32 v80, v22, v21, s[56:57]
    v_cndmask_b32 v81, v22, v21, s[58:59]
    v_cndmask_b32 v82, v22, v21, s[60:61]
    v_cndmask_b32 v83, v22, v21, s[62:63]
    v_cndmask_b32 v84, v22, v21, s[64:65]
    v_cndmask_b32 v85, v22, v21, s[66:67]
    v_cndmask_b32 v86, v22, v21, s[68:69]
    v_cndmask_b32 v87, v22, v21, s[70:71]
    v_cndmask_b32 v88, v22, v21, s[72:73]
    v_cndmask_b32 v89, v22, v21, s[74:75]
    v_cndmask_b32 v90, v22, v21, s[76:77]
    v_cndmask_b32 v91, v22, v21, s[78:79]
    v_cndmask_b32 v92, v22, v21, s[80:81]
    v_cndmask_b32 v93, v22, v21, s[82:83]
    v_cndmask_b32 v94, v22, v21, s[84:85]
    v_cndmask_b32 v95, v22, v21, s[86:87]
    s_branch L_mx_74
L_mf_73:
    v_mov_b32 v80, 0xf149f2ca
    v_mov_b32 v81, 0xf149f2ca
    v_mov_b32 v82, 0xf149f2ca
    v_mov_b32 v83, 0xf149f2ca
    v_mov_b32 v84, 0xf149f2ca
    v_mov_b32 v85, 0xf149f2ca
    v_mov_b32 v86, 0xf149f2ca
    v_mov_b32 v87, 0xf149f2ca
    v_mov_b32 v88, 0xf149f2ca
    v_mov_b32 v89, 0xf149f2ca
    v_mov_b32 v90, 0xf149f2ca
    v_mov_b32 v91, 0xf149f2ca
    v_mov_b32 v92, 0xf149f2ca
    v_mov_b32 v93, 0xf149f2ca
    v_mov_b32 v94, 0xf149f2ca
    v_mov_b32 v95, 0xf149f2ca
L_mx_74:
    s_nop 1
    s_branch L_hkb_42
L_hko_43:
    s_add_u32 s40, s43, 1
    s_cmp_eq_u32 s40, s47
    s_cbranch_scc1 L_md_75
    s_cmp_eq_u32 s43, s47
    s_cbranch_scc1 L_mf_76
    s_branch L_mx_77
L_md_75:
    v_mov_b32 v22, 0xf149f2ca
    v_cndmask_b32 v80, v22, v21, s[56:57]
    v_cndmask_b32 v81, v22, v21, s[58:59]
    v_cndmask_b32 v82, v22, v21, s[60:61]
    v_cndmask_b32 v83, v22, v21, s[62:63]
    v_cndmask_b32 v84, v22, v21, s[64:65]
    v_cndmask_b32 v85, v22, v21, s[66:67]
    v_cndmask_b32 v86, v22, v21, s[68:69]
    v_cndmask_b32 v87, v22, v21, s[70:71]
    v_cndmask_b32 v88, v22, v21, s[72:73]
    v_cndmask_b32 v89, v22, v21, s[74:75]
    v_cndmask_b32 v90, v22, v21, s[76:77]
    v_cndmask_b32 v91, v22, v21, s[78:79]
    v_cndmask_b32 v92, v22, v21, s[80:81]
    v_cndmask_b32 v93, v22, v21, s[82:83]
    v_cndmask_b32 v94, v22, v21, s[84:85]
    v_cndmask_b32 v95, v22, v21, s[86:87]
    s_branch L_mx_77
L_mf_76:
    v_mov_b32 v80, 0xf149f2ca
    v_mov_b32 v81, 0xf149f2ca
    v_mov_b32 v82, 0xf149f2ca
    v_mov_b32 v83, 0xf149f2ca
    v_mov_b32 v84, 0xf149f2ca
    v_mov_b32 v85, 0xf149f2ca
    v_mov_b32 v86, 0xf149f2ca
    v_mov_b32 v87, 0xf149f2ca
    v_mov_b32 v88, 0xf149f2ca
    v_mov_b32 v89, 0xf149f2ca
    v_mov_b32 v90, 0xf149f2ca
    v_mov_b32 v91, 0xf149f2ca
    v_mov_b32 v92, 0xf149f2ca
    v_mov_b32 v93, 0xf149f2ca
    v_mov_b32 v94, 0xf149f2ca
    v_mov_b32 v95, 0xf149f2ca
L_mx_77:
    s_nop 1
    s_branch L_hkb_44
L_k2_steal:
    s_ff1_i32_b64 s75, vcc
    s_nop 3
    v_readlane_b32 s76, v24, s75
    s_and_b32 s75, s75, 31
    s_not_b32 s76, s76
    s_and_b32 s76, s76, 0xff
    s_ff1_i32_b32 s76, s76
    s_lshl_b32 s77, 1, s76
    s_lshl_b32 s78, s75, 2
    v_mov_b32 v24, s77
    v_mov_b32 v25, 0
    s_mov_b64 exec, 1
    buffer_atomic_or v24, v25, s[68:71], s78 offen sc0
    s_waitcnt vmcnt(0)
    s_mov_b64 exec, -1
    v_readfirstlane_b32 s78, v24
    s_and_b32 s78, s78, s77
    s_cmp_lg_u32 s78, 0
    s_cbranch_scc1 L_kpoll_7
    s_lshl_b32 s75, s75, 3
    s_add_u32 s75, s75, s76
    v_mov_b32 v24, s75
    s_branch L_k2_pub
L_k2_runsteal:
    s_lshr_b32 s94, s79, 3
    s_and_b32 s95, s79, 7
    s_and_b32 s96, s94, 3
    s_lshl_b32 s96, s96, 3
    s_add_u32 s96, s96, s95
    s_lshl_b32 s96, s96, 3
    s_lshr_b32 s97, s94, 2
    s_add_u32 s96, s96, s97
    v_mov_b32 v125, 0x7fffffff
    s_lshl_b32 s75, s96, 2
    s_add_u32 s75, s75, s34
    s_cmp_ge_u32 s75, 162
    s_cbranch_scc1 L_pl_78
    s_cmp_ge_u32 s75, 81
    s_cselect_b32 s76, 81, 0
    s_cselect_b32 s80, s86, s84
    s_cselect_b32 s81, s87, s85
    s_cselect_b32 s77, 64, 0
    s_mov_b32 s82, 20736
    s_mov_b32 s83, 0x00020000
    s_sub_u32 s75, s75, s76
    s_lshl_b32 s75, s75, 6
    v_add_u32 v126, s75, v0
    s_mov_b32 s75, 7282
    v_mul_lo_u32 v125, v126, s75
    v_lshrrev_b32 v125, 16, v125
    v_mul_u32_u24 v127, 9, v125
    v_sub_u32 v127, v126, v127
    v_lshlrev_b32 v125, 7, v125
    v_lshl_add_u32 v125, v127, 2, v125
    v_add_u32 v125, s77, v125
    v_lshlrev_b32 v126, 2, v126
    buffer_load_dword v124, v126, s[80:83], 0 offen
L_pl_78:
    s_waitcnt vmcnt(0)
    s_add_u32 s80, s6, 58720256
    s_addc_u32 s81, s7, 0
    s_mov_b32 s82, 73728
    s_mov_b32 s83, 0x00020000
    buffer_store_dword v124, v125, s[80:83], 0 offen sc1
    s_lshl_b32 s97, s95, 8
    s_lshl_b32 s98, s34, 6
    s_add_u32 s97, s97, s98
    s_lshl_b32 s97, s97, 10
    s_lshl_b32 s100, s95, 3
    s_add_u32 s100, s100, s34
    s_lshl_b32 s100, s100, 13
    s_lshl_b32 s98, s34, 17
    s_lshl_b32 s99, s94, 8
    s_add_u32 s98, s98, s99
    s_mov_b32 s99, s97
    s_lshl_b32 s75, s94, 19
    s_add_u32 s75, s75, 0
    s_add_u32 s76, s6, s75
    s_addc_u32 s77, s7, 0
    s_mov_b32 s78, 524288
    s_mov_b32 s79, 0x00020000
    v_accvgpr_write_b32 a0, 0
    v_accvgpr_write_b32 a1, 0
    v_accvgpr_write_b32 a2, 0
    v_accvgpr_write_b32 a3, 0
    v_accvgpr_write_b32 a4, 0
    v_accvgpr_write_b32 a5, 0
    v_accvgpr_write_b32 a6, 0
    v_accvgpr_write_b32 a7, 0
    v_accvgpr_write_b32 a8, 0
    v_accvgpr_write_b32 a9, 0
    v_accvgpr_write_b32 a10, 0
    v_accvgpr_write_b32 a11, 0
    v_accvgpr_write_b32 a12, 0
    v_accvgpr_write_b32 a13, 0
    v_accvgpr_write_b32 a14, 0
    v_accvgpr_write_b32 a15, 0
    v_accvgpr_write_b32 a16, 0
    v_accvgpr_write_b32 a17, 0
    v_accvgpr_write_b32 a18, 0
    v_accvgpr_write_b32 a19, 0
    v_accvgpr_write_b32 a20, 0
    v_accvgpr_write_b32 a21, 0
    v_accvgpr_write_b32 a22, 0
    v_accvgpr_write_b32 a23, 0
    v_accvgpr_write_b32 a24, 0
    v_accvgpr_write_b32 a25, 0
    v_accvgpr_write_b32 a26, 0
    v_accvgpr_write_b32 a27, 0
    v_accvgpr_write_b32 a28, 0
    v_accvgpr_write_b32 a29, 0
    v_accvgpr_write_b32 a30, 0
    v_accvgpr_write_b32 a31, 0
    v_accvgpr_write_b32 a32, 0
    v_accvgpr_write_b32 a33, 0
    v_accvgpr_write_b32 a34, 0
    v_accvgpr_write_b32 a35, 0
    v_accvgpr_write_b32 a36, 0
    v_accvgpr_write_b32 a37, 0
    v_accvgpr_write_b32 a38, 0
    v_accvgpr_write_b32 a39, 0
    v_accvgpr_write_b32 a40, 0
    v_accvgpr_write_b32 a41, 0
    v_accvgpr_write_b32 a42, 0
    v_accvgpr_write_b32 a43, 0
    v_accvgpr_write_b32 a44, 0
    v_accvgpr_write_b32 a45, 0
    v_accvgpr_write_b32 a46, 0
    v_accvgpr_write_b32 a47, 0
    v_accvgpr_write_b32 a48, 0
    v_accvgpr_write_b32 a49, 0
    v_accvgpr_write_b32 a50, 0
    v_accvgpr_write_b32 a51, 0
    v_accvgpr_write_b32 a52, 0
    v_accvgpr_write_b32 a53, 0
    v_accvgpr_write_b32 a54, 0
    v_accvgpr_write_b32 a55, 0
    v_accvgpr_write_b32 a56, 0
    v_accvgpr_write_b32 a57, 0
    v_accvgpr_write_b32 a58, 0
    v_accvgpr_write_b32 a59, 0
    v_accvgpr_write_b32 a60, 0
    v_accvgpr_write_b32 a61, 0
    v_accvgpr_write_b32 a62, 0
    v_accvgpr_write_b32 a63, 0
    v_accvgpr_write_b32 a64, 0
    v_accvgpr_write_b32 a65, 0
    v_accvgpr_write_b32 a66, 0
    v_accvgpr_write_b32 a67, 0
    v_accvgpr_write_b32 a68, 0
    v_accvgpr_write_b32 a69, 0
    v_accvgpr_write_b32 a70, 0
    v_accvgpr_write_b32 a71, 0
    v_accvgpr_write_b32 a72, 0
    v_accvgpr_write_b32 a73, 0
    v_accvgpr_write_b32 a74, 0
    v_accvgpr_write_b32 a75, 0
    v_accvgpr_write_b32 a76, 0
    v_accvgpr_write_b32 a77, 0
    v_accvgpr_write_b32 a78, 0
    v_accvgpr_write_b32 a79, 0
    v_accvgpr_write_b32 a80, 0
    v_accvgpr_write_b32 a81, 0
    v_accvgpr_write_b32 a82, 0
    v_accvgpr_write_b32 a83, 0
    v_accvgpr_write_b32 a84, 0
    v_accvgpr_write_b32 a85, 0
    v_accvgpr_write_b32 a86, 0
    v_accvgpr_write_b32 a87, 0
    v_accvgpr_write_b32 a88, 0
    v_accvgpr_write_b32 a89, 0
    v_accvgpr_write_b32 a90, 0
    v_accvgpr_write_b32 a91, 0
    v_accvgpr_write_b32 a92, 0
    v_accvgpr_write_b32 a93, 0
    v_accvgpr_write_b32 a94, 0
    v_accvgpr_write_b32 a95, 0
    v_accvgpr_write_b32 a96, 0
    v_accvgpr_write_b32 a97, 0
    v_accvgpr_write_b32 a98, 0
    v_accvgpr_write_b32 a99, 0
    v_accvgpr_write_b32 a100, 0
    v_accvgpr_write_b32 a101, 0
    v_accvgpr_write_b32 a102, 0
    v_accvgpr_write_b32 a103, 0
    v_accvgpr_write_b32 a104, 0
    v_accvgpr_write_b32 a105, 0
    v_accvgpr_write_b32 a106, 0
    v_accvgpr_write_b32 a107, 0
    v_accvgpr_write_b32 a108, 0
    v_accvgpr_write_b32 a109, 0
    v_accvgpr_write_b32 a110, 0
    v_accvgpr_write_b32 a111, 0
    v_accvgpr_write_b32 a112, 0
    v_accvgpr_write_b32 a113, 0
    v_accvgpr_write_b32 a114, 0
    v_accvgpr_write_b32 a115, 0
    v_accvgpr_write_b32 a116, 0
    v_accvgpr_write_b32 a117, 0
    v_accvgpr_write_b32 a118, 0
    v_accvgpr_write_b32 a119, 0
    v_accvgpr_write_b32 a120, 0
    v_accvgpr_write_b32 a121, 0
    v_accvgpr_write_b32 a122, 0
    v_accvgpr_write_b32 a123, 0
    v_accvgpr_write_b32 a124, 0
    v_accvgpr_write_b32 a125, 0
    v_accvgpr_write_b32 a126, 0
    v_accvgpr_write_b32 a127, 0
    v_add_u32 v8, 0, v5
    v_add_u32 v12, 32768, v6
    v_xor_b32 v9, 32, v8
    v_xor_b32 v10, 64, v8
    v_xor_b32 v11, 96, v8
    v_xor_b32 v13, 64, v12
    v_xor_b32 v14, 128, v12
    v_xor_b32 v15, 192, v12
    s_mov_b32 s101, 8
L_sl_79:
    s_barrier
    s_add_u32 m0, s54, 0
    s_add_u32 s38, s99, 0
    buffer_load_dwordx4 v26, s[56:59], s38 offen lds
    s_add_u32 m0, s54, 1024
    s_add_u32 s38, s99, 8192
    buffer_load_dwordx4 v27, s[56:59], s38 offen lds
    s_add_u32 m0, s54, 2048
    s_add_u32 s38, s99, 16384
    buffer_load_dwordx4 v26, s[56:59], s38 offen lds
    s_add_u32 m0, s54, 3072
    s_add_u32 s38, s99, 24576
    buffer_load_dwordx4 v27, s[56:59], s38 offen lds
    s_add_u32 m0, s54, 4096
    s_add_u32 s38, s99, 32768
    buffer_load_dwordx4 v26, s[56:59], s38 offen lds
    s_add_u32 m0, s54, 5120
    s_add_u32 s38, s99, 40960
    buffer_load_dwordx4 v27, s[56:59], s38 offen lds
    s_add_u32 m0, s54, 6144
    s_add_u32 s38, s99, 49152
    buffer_load_dwordx4 v26, s[56:59], s38 offen lds
    s_add_u32 m0, s54, 7168
    s_add_u32 s38, s99, 57344
    buffer_load_dwordx4 v27, s[56:59], s38 offen lds
    s_add_u32 m0, s37, 32768
    s_add_u32 s38, s98, 0
    buffer_load_dwordx4 v4, s[60:63], s38 offen lds
    s_add_u32 m0, s37, 33792
    s_add_u32 s38, s98, 32768
    buffer_load_dwordx4 v4, s[60:63], s38 offen lds
    s_add_u32 m0, s37, 34816
    s_add_u32 s38, s98, 65536
    buffer_load_dwordx4 v4, s[60:63], s38 offen lds
    s_add_u32 m0, s37, 35840
    s_add_u32 s38, s98, 98304
    buffer_load_dwordx4 v4, s[60:63], s38 offen lds
    s_add_u32 s99, s99, 128
    s_add_u32 s98, s98, 524288
    s_waitcnt vmcnt(0)
    s_barrier
    ds_read_b128 v[32:35], v8 offset:0
    ds_read_b64_tr_b16 v[40:41], v12 offset:0
    ds_read_b64_tr_b16 v[42:43], v12 offset:1024
    ds_read_b128 v[36:39], v8 offset:16384
    ds_read_b64_tr_b16 v[44:45], v13 offset:0
    ds_read_b64_tr_b16 v[46:47], v13 offset:1024
    ds_read_b64_tr_b16 v[48:49], v14 offset:0
    ds_read_b64_tr_b16 v[50:51], v14 offset:1024
    ds_read_b64_tr_b16 v[52:53], v15 offset:0
    ds_read_b64_tr_b16 v[54:55], v15 offset:1024
    s_waitcnt lgkmcnt(7)
    v_mfma_f32_32x32x16_bf16 a[0:15], v[40:43], v[32:35], a[0:15]
    s_waitcnt lgkmcnt(6)
    v_mfma_f32_32x32x16_bf16 a[64:79], v[40:43], v[36:39], a[64:79]
    s_waitcnt lgkmcnt(4)
    v_mfma_f32_32x32x16_bf16 a[16:31], v[44:47], v[32:35], a[16:31]
    v_mfma_f32_32x32x16_bf16 a[80:95], v[44:47], v[36:39], a[80:95]
    s_waitcnt lgkmcnt(2)
    v_mfma_f32_32x32x16_bf16 a[32:47], v[48:51], v[32:35], a[32:47]
    v_mfma_f32_32x32x16_bf16 a[96:111], v[48:51], v[36:39], a[96:111]
    s_waitcnt lgkmcnt(0)
    v_mfma_f32_32x32x16_bf16 a[48:63], v[52:55], v[32:35], a[48:63]
    v_mfma_f32_32x32x16_bf16 a[112:127], v[52:55], v[36:39], a[112:127]
    ds_read_b128 v[32:35], v9 offset:0
    ds_read_b64_tr_b16 v[40:41], v12 offset:4096
    ds_read_b64_tr_b16 v[42:43], v12 offset:5120
    ds_read_b128 v[36:39], v9 offset:16384
    ds_read_b64_tr_b16 v[44:45], v13 offset:4096
    ds_read_b64_tr_b16 v[46:47], v13 offset:5120
    ds_read_b64_tr_b16 v[48:49], v14 offset:4096
    ds_read_b64_tr_b16 v[50:51], v14 offset:5120
    ds_read_b64_tr_b16 v[52:53], v15 offset:4096
    ds_read_b64_tr_b16 v[54:55], v15 offset:5120
    s_waitcnt lgkmcnt(7)
    v_mfma_f32_32x32x16_bf16 a[0:15], v[40:43], v[32:35], a[0:15]
    s_waitcnt lgkmcnt(6)
    v_mfma_f32_32x32x16_bf16 a[64:79], v[40:43], v[36:39], a[64:79]
    s_waitcnt lgkmcnt(4)
    v_mfma_f32_32x32x16_bf16 a[16:31], v[44:47], v[32:35], a[16:31]
    v_mfma_f32_32x32x16_bf16 a[80:95], v[44:47], v[36:39], a[80:95]
    s_waitcnt lgkmcnt(2)
    v_mfma_f32_32x32x16_bf16 a[32:47], v[48:51], v[32:35], a[32:47]
    v_mfma_f32_32x32x16_bf16 a[96:111], v[48:51], v[36:39], a[96:111]
    s_waitcnt lgkmcnt(0)
    v_mfma_f32_32x32x16_bf16 a[48:63], v[52:55], v[32:35], a[48:63]
    v_mfma_f32_32x32x16_bf16 a[112:127], v[52:55], v[36:39], a[112:127]
    ds_read_b128 v[32:35], v10 offset:0
    ds_read_b64_tr_b16 v[40:41], v12 offset:8192
    ds_read_b64_tr_b16 v[42:43], v12 offset:9216
    ds_read_b128 v[36:39], v10 offset:16384
    ds_read_b64_tr_b16 v[44:45], v13 offset:8192
    ds_read_b64_tr_b16 v[46:47], v13 offset:9216
    ds_read_b64_tr_b16 v[48:49], v14 offset:8192
    ds_read_b64_tr_b16 v[50:51], v14 offset:9216
    ds_read_b64_tr_b16 v[52:53], v15 offset:8192
    ds_read_b64_tr_b16 v[54:55], v15 offset:9216
    s_waitcnt lgkmcnt(7)
    v_mfma_f32_32x32x16_bf16 a[0:15], v[40:43], v[32:35], a[0:15]
    s_waitcnt lgkmcnt(6)
    v_mfma_f32_32x32x16_bf16 a[64:79], v[40:43], v[36:39], a[64:79]
    s_waitcnt lgkmcnt(4)
    v_mfma_f32_32x32x16_bf16 a[16:31], v[44:47], v[32:35], a[16:31]
    v_mfma_f32_32x32x16_bf16 a[80:95], v[44:47], v[36:39], a[80:95]
    s_waitcnt lgkmcnt(2)
    v_mfma_f32_32x32x16_bf16 a[32:47], v[48:51], v[32:35], a[32:47]
    v_mfma_f32_32x32x16_bf16 a[96:111], v[48:51], v[36:39], a[96:111]
    s_waitcnt lgkmcnt(0)
    v_mfma_f32_32x32x16_bf16 a[48:63], v[52:55], v[32:35], a[48:63]
    v_mfma_f32_32x32x16_bf16 a[112:127], v[52:55], v[36:39], a[112:127]
    ds_read_b128 v[32:35], v11 offset:0
    ds_read_b64_tr_b16 v[40:41], v12 offset:12288
    ds_read_b64_tr_b16 v[42:43], v12 offset:13312
    ds_read_b128 v[36:39], v11 offset:16384
    ds_read_b64_tr_b16 v[44:45], v13 offset:12288
    ds_read_b64_tr_b16 v[46:47], v13 offset:13312
    ds_read_b64_tr_b16 v[48:49], v14 offset:12288
    ds_read_b64_tr_b16 v[50:51], v14 offset:13312
    ds_read_b64_tr_b16 v[52:53], v15 offset:12288
    ds_read_b64_tr_b16 v[54:55], v15 offset:13312
    s_waitcnt lgkmcnt(7)
    v_mfma_f32_32x32x16_bf16 a[0:15], v[40:43], v[32:35], a[0:15]
    s_waitcnt lgkmcnt(6)
    v_mfma_f32_32x32x16_bf16 a[64:79], v[40:43], v[36:39], a[64:79]
    s_waitcnt lgkmcnt(4)
    v_mfma_f32_32x32x16_bf16 a[16:31], v[44:47], v[32:35], a[16:31]
    v_mfma_f32_32x32x16_bf16 a[80:95], v[44:47], v[36:39], a[80:95]
    s_waitcnt lgkmcnt(2)
    v_mfma_f32_32x32x16_bf16 a[32:47], v[48:51], v[32:35], a[32:47]
    v_mfma_f32_32x32x16_bf16 a[96:111], v[48:51], v[36:39], a[96:111]
    s_waitcnt lgkmcnt(0)
    v_mfma_f32_32x32x16_bf16 a[48:63], v[52:55], v[32:35], a[48:63]
    v_mfma_f32_32x32x16_bf16 a[112:127], v[52:55], v[36:39], a[112:127]
    s_sub_u32 s101, s101, 1
    s_cmp_lg_u32 s101, 0
    s_cbranch_scc1 L_sl_79
    s_nop 15
    v_accvgpr_read_b32 v80, a0
    v_accvgpr_read_b32 v81, a1
    v_accvgpr_read_b32 v82, a2
    v_accvgpr_read_b32 v83, a3
    v_accvgpr_read_b32 v84, a4
    v_accvgpr_read_b32 v85, a5
    v_accvgpr_read_b32 v86, a6
    v_accvgpr_read_b32 v87, a7
    v_mul_f32 v80, s74, v80
    v_mul_f32 v81, s74, v81
    v_mul_f32 v82, s74, v82
    v_mul_f32 v83, s74, v83
    v_mul_f32 v84, s74, v84
    v_mul_f32 v85, s74, v85
    v_mul_f32 v86, s74, v86
    v_mul_f32 v87, s74, v87
    v_cvt_pk_bf16_f32 v96, v80, v81
    v_cvt_pk_bf16_f32 v97, v82, v83
    v_cvt_pk_bf16_f32 v98, v84, v85
    v_cvt_pk_bf16_f32 v99, v86, v87
    s_add_u32 s39, s100, 0
    buffer_store_dwordx4 v[96:99], v1, s[76:79], s39 offen offset:0 sc1
    v_accvgpr_read_b32 v88, a8
    v_accvgpr_read_b32 v89, a9
    v_accvgpr_read_b32 v90, a10
    v_accvgpr_read_b32 v91, a11
    v_accvgpr_read_b32 v92, a12
    v_accvgpr_read_b32 v93, a13
    v_accvgpr_read_b32 v94, a14
    v_accvgpr_read_b32 v95, a15
    v_mul_f32 v88, s74, v88
    v_mul_f32 v89, s74, v89
    v_mul_f32 v90, s74, v90
    v_mul_f32 v91, s74, v91
    v_mul_f32 v92, s74, v92
    v_mul_f32 v93, s74, v93
    v_mul_f32 v94, s74, v94
    v_mul_f32 v95, s74, v95
    v_cvt_pk_bf16_f32 v100, v88, v89
    v_cvt_pk_bf16_f32 v101, v90, v91
    v_cvt_pk_bf16_f32 v102, v92, v93
    v_cvt_pk_bf16_f32 v103, v94, v95
    s_add_u32 s39, s100, 0
    buffer_store_dwordx4 v[100:103], v1, s[76:79], s39 offen offset:1024 sc1
    v_accvgpr_read_b32 v80, a16
    v_accvgpr_read_b32 v81, a17
    v_accvgpr_read_b32 v82, a18
    v_accvgpr_read_b32 v83, a19
    v_accvgpr_read_b32 v84, a20
    v_accvgpr_read_b32 v85, a21
    v_accvgpr_read_b32 v86, a22
    v_accvgpr_read_b32 v87, a23
    v_mul_f32 v80, s74, v80
    v_mul_f32 v81, s74, v81
    v_mul_f32 v82, s74, v82
    v_mul_f32 v83, s74, v83
    v_mul_f32 v84, s74, v84
    v_mul_f32 v85, s74, v85
    v_mul_f32 v86, s74, v86
    v_mul_f32 v87, s74, v87
    v_cvt_pk_bf16_f32 v104, v80, v81
    v_cvt_pk_bf16_f32 v105, v82, v83
    v_cvt_pk_bf16_f32 v106, v84, v85
    v_cvt_pk_bf16_f32 v107, v86, v87
    s_add_u32 s39, s100, 0
    buffer_store_dwordx4 v[104:107], v1, s[76:79], s39 offen offset:2048 sc1
    v_accvgpr_read_b32 v88, a24
    v_accvgpr_read_b32 v89, a25
    v_accvgpr_read_b32 v90, a26
    v_accvgpr_read_b32 v91, a27
    v_accvgpr_read_b32 v92, a28
    v_accvgpr_read_b32 v93, a29
    v_accvgpr_read_b32 v94, a30
    v_accvgpr_read_b32 v95, a31
    v_mul_f32 v88, s74, v88
    v_mul_f32 v89, s74, v89
    v_mul_f32 v90, s74, v90
    v_mul_f32 v91, s74, v91
    v_mul_f32 v92, s74, v92
    v_mul_f32 v93, s74, v93
    v_mul_f32 v94, s74, v94
    v_mul_f32 v95, s74, v95
    v_cvt_pk_bf16_f32 v108, v88, v89
    v_cvt_pk_bf16_f32 v109, v90, v91
    v_cvt_pk_bf16_f32 v110, v92, v93
    v_cvt_pk_bf16_f32 v111, v94, v95
    s_add_u32 s39, s100, 0
    buffer_store_dwordx4 v[108:111], v1, s[76:79], s39 offen offset:3072 sc1
    v_accvgpr_read_b32 v80, a32
    v_accvgpr_read_b32 v81, a33
    v_accvgpr_read_b32 v82, a34
    v_accvgpr_read_b32 v83, a35
    v_accvgpr_read_b32 v84, a36
    v_accvgpr_read_b32 v85, a37
    v_accvgpr_read_b32 v86, a38
    v_accvgpr_read_b32 v87, a39
    v_mul_f32 v80, s74, v80
    v_mul_f32 v81, s74, v81
    v_mul_f32 v82, s74, v82
    v_mul_f32 v83, s74, v83
    v_mul_f32 v84, s74, v84
    v_mul_f32 v85, s74, v85
    v_mul_f32 v86, s74, v86
    v_mul_f32 v87, s74, v87
    v_cvt_pk_bf16_f32 v96, v80, v81
    v_cvt_pk_bf16_f32 v97, v82, v83
    v_cvt_pk_bf16_f32 v98, v84, v85
    v_cvt_pk_bf16_f32 v99, v86, v87
    s_add_u32 s39, s100, 4096
    buffer_store_dwordx4 v[96:99], v1, s[76:79], s39 offen offset:0 sc1
    v_accvgpr_read_b32 v88, a40
    v_accvgpr_read_b32 v89, a41
    v_accvgpr_read_b32 v90, a42
    v_accvgpr_read_b32 v91, a43
    v_accvgpr_read_b32 v92, a44
    v_accvgpr_read_b32 v93, a45
    v_accvgpr_read_b32 v94, a46
    v_accvgpr_read_b32 v95, a47
    v_mul_f32 v88, s74, v88
    v_mul_f32 v89, s74, v89
    v_mul_f32 v90, s74, v90
    v_mul_f32 v91, s74, v91
    v_mul_f32 v92, s74, v92
    v_mul_f32 v93, s74, v93
    v_mul_f32 v94, s74, v94
    v_mul_f32 v95, s74, v95
    v_cvt_pk_bf16_f32 v100, v88, v89
    v_cvt_pk_bf16_f32 v101, v90, v91
    v_cvt_pk_bf16_f32 v102, v92, v93
    v_cvt_pk_bf16_f32 v103, v94, v95
    s_add_u32 s39, s100, 4096
    buffer_store_dwordx4 v[100:103], v1, s[76:79], s39 offen offset:1024 sc1
    v_accvgpr_read_b32 v80, a48
    v_accvgpr_read_b32 v81, a49
    v_accvgpr_read_b32 v82, a50
    v_accvgpr_read_b32 v83, a51
    v_accvgpr_read_b32 v84, a52
    v_accvgpr_read_b32 v85, a53
    v_accvgpr_read_b32 v86, a54
    v_accvgpr_read_b32 v87, a55
    v_mul_f32 v80, s74, v80
    v_mul_f32 v81, s74, v81
    v_mul_f32 v82, s74, v82
    v_mul_f32 v83, s74, v83
    v_mul_f32 v84, s74, v84
    v_mul_f32 v85, s74, v85
    v_mul_f32 v86, s74, v86
    v_mul_f32 v87, s74, v87
    v_cvt_pk_bf16_f32 v104, v80, v81
    v_cvt_pk_bf16_f32 v105, v82, v83
    v_cvt_pk_bf16_f32 v106, v84, v85
    v_cvt_pk_bf16_f32 v107, v86, v87
    s_add_u32 s39, s100, 4096
    buffer_store_dwordx4 v[104:107], v1, s[76:79], s39 offen offset:2048 sc1
    v_accvgpr_read_b32 v88, a56
    v_accvgpr_read_b32 v89, a57
    v_accvgpr_read_b32 v90, a58
    v_accvgpr_read_b32 v91, a59
    v_accvgpr_read_b32 v92, a60
    v_accvgpr_read_b32 v93, a61
    v_accvgpr_read_b32 v94, a62
    v_accvgpr_read_b32 v95, a63
    v_mul_f32 v88, s74, v88
    v_mul_f32 v89, s74, v89
    v_mul_f32 v90, s74, v90
    v_mul_f32 v91, s74, v91
    v_mul_f32 v92, s74, v92
    v_mul_f32 v93, s74, v93
    v_mul_f32 v94, s74, v94
    v_mul_f32 v95, s74, v95
    v_cvt_pk_bf16_f32 v108, v88, v89
    v_cvt_pk_bf16_f32 v109, v90, v91
    v_cvt_pk_bf16_f32 v110, v92, v93
    v_cvt_pk_bf16_f32 v111, v94, v95
    s_add_u32 s39, s100, 4096
    buffer_store_dwordx4 v[108:111], v1, s[76:79], s39 offen offset:3072 sc1
    v_accvgpr_read_b32 v80, a64
    v_accvgpr_read_b32 v81, a65
    v_accvgpr_read_b32 v82, a66
    v_accvgpr_read_b32 v83, a67
    v_accvgpr_read_b32 v84, a68
    v_accvgpr_read_b32 v85, a69
    v_accvgpr_read_b32 v86, a70
    v_accvgpr_read_b32 v87, a71
    v_mul_f32 v80, s74, v80
    v_mul_f32 v81, s74, v81
    v_mul_f32 v82, s74, v82
    v_mul_f32 v83, s74, v83
    v_mul_f32 v84, s74, v84
    v_mul_f32 v85, s74, v85
    v_mul_f32 v86, s74, v86
    v_mul_f32 v87, s74, v87
    v_cvt_pk_bf16_f32 v96, v80, v81
    v_cvt_pk_bf16_f32 v97, v82, v83
    v_cvt_pk_bf16_f32 v98, v84, v85
    v_cvt_pk_bf16_f32 v99, v86, v87
    s_add_u32 s39, s100, 32768
    buffer_store_dwordx4 v[96:99], v1, s[76:79], s39 offen offset:0 sc1
    v_accvgpr_read_b32 v88, a72
    v_accvgpr_read_b32 v89, a73
    v_accvgpr_read_b32 v90, a74
    v_accvgpr_read_b32 v91, a75
    v_accvgpr_read_b32 v92, a76
    v_accvgpr_read_b32 v93, a77
    v_accvgpr_read_b32 v94, a78
    v_accvgpr_read_b32 v95, a79
    v_mul_f32 v88, s74, v88
    v_mul_f32 v89, s74, v89
    v_mul_f32 v90, s74, v90
    v_mul_f32 v91, s74, v91
    v_mul_f32 v92, s74, v92
    v_mul_f32 v93, s74, v93
    v_mul_f32 v94, s74, v94
    v_mul_f32 v95, s74, v95
    v_cvt_pk_bf16_f32 v100, v88, v89
    v_cvt_pk_bf16_f32 v101, v90, v91
    v_cvt_pk_bf16_f32 v102, v92, v93
    v_cvt_pk_bf16_f32 v103, v94, v95
    s_add_u32 s39, s100, 32768
    buffer_store_dwordx4 v[100:103], v1, s[76:79], s39 offen offset:1024 sc1
    v_accvgpr_read_b32 v80, a80
    v_accvgpr_read_b32 v81, a81
    v_accvgpr_read_b32 v82, a82
    v_accvgpr_read_b32 v83, a83
    v_accvgpr_read_b32 v84, a84
    v_accvgpr_read_b32 v85, a85
    v_accvgpr_read_b32 v86, a86
    v_accvgpr_read_b32 v87, a87
    v_mul_f32 v80, s74, v80
    v_mul_f32 v81, s74, v81
    v_mul_f32 v82, s74, v82
    v_mul_f32 v83, s74, v83
    v_mul_f32 v84, s74, v84
    v_mul_f32 v85, s74, v85
    v_mul_f32 v86, s74, v86
    v_mul_f32 v87, s74, v87
    v_cvt_pk_bf16_f32 v104, v80, v81
    v_cvt_pk_bf16_f32 v105, v82, v83
    v_cvt_pk_bf16_f32 v106, v84, v85
    v_cvt_pk_bf16_f32 v107, v86, v87
    s_add_u32 s39, s100, 32768
    buffer_store_dwordx4 v[104:107], v1, s[76:79], s39 offen offset:2048 sc1
    v_accvgpr_read_b32 v88, a88
    v_accvgpr_read_b32 v89, a89
    v_accvgpr_read_b32 v90, a90
    v_accvgpr_read_b32 v91, a91
    v_accvgpr_read_b32 v92, a92
    v_accvgpr_read_b32 v93, a93
    v_accvgpr_read_b32 v94, a94
    v_accvgpr_read_b32 v95, a95
    v_mul_f32 v88, s74, v88
    v_mul_f32 v89, s74, v89
    v_mul_f32 v90, s74, v90
    v_mul_f32 v91, s74, v91
    v_mul_f32 v92, s74, v92
    v_mul_f32 v93, s74, v93
    v_mul_f32 v94, s74, v94
    v_mul_f32 v95, s74, v95
    v_cvt_pk_bf16_f32 v108, v88, v89
    v_cvt_pk_bf16_f32 v109, v90, v91
    v_cvt_pk_bf16_f32 v110, v92, v93
    v_cvt_pk_bf16_f32 v111, v94, v95
    s_add_u32 s39, s100, 32768
    buffer_store_dwordx4 v[108:111], v1, s[76:79], s39 offen offset:3072 sc1
    v_accvgpr_read_b32 v80, a96
    v_accvgpr_read_b32 v81, a97
    v_accvgpr_read_b32 v82, a98
    v_accvgpr_read_b32 v83, a99
    v_accvgpr_read_b32 v84, a100
    v_accvgpr_read_b32 v85, a101
    v_accvgpr_read_b32 v86, a102
    v_accvgpr_read_b32 v87, a103
    v_mul_f32 v80, s74, v80
    v_mul_f32 v81, s74, v81
    v_mul_f32 v82, s74, v82
    v_mul_f32 v83, s74, v83
    v_mul_f32 v84, s74, v84
    v_mul_f32 v85, s74, v85
    v_mul_f32 v86, s74, v86
    v_mul_f32 v87, s74, v87
    v_cvt_pk_bf16_f32 v96, v80, v81
    v_cvt_pk_bf16_f32 v97, v82, v83
    v_cvt_pk_bf16_f32 v98, v84, v85
    v_cvt_pk_bf16_f32 v99, v86, v87
    s_add_u32 s39, s100, 36864
    buffer_store_dwordx4 v[96:99], v1, s[76:79], s39 offen offset:0 sc1
    v_accvgpr_read_b32 v88, a104
    v_accvgpr_read_b32 v89, a105
    v_accvgpr_read_b32 v90, a106
    v_accvgpr_read_b32 v91, a107
    v_accvgpr_read_b32 v92, a108
    v_accvgpr_read_b32 v93, a109
    v_accvgpr_read_b32 v94, a110
    v_accvgpr_read_b32 v95, a111
    v_mul_f32 v88, s74, v88
    v_mul_f32 v89, s74, v89
    v_mul_f32 v90, s74, v90
    v_mul_f32 v91, s74, v91
    v_mul_f32 v92, s74, v92
    v_mul_f32 v93, s74, v93
    v_mul_f32 v94, s74, v94
    v_mul_f32 v95, s74, v95
    v_cvt_pk_bf16_f32 v100, v88, v89
    v_cvt_pk_bf16_f32 v101, v90, v91
    v_cvt_pk_bf16_f32 v102, v92, v93
    v_cvt_pk_bf16_f32 v103, v94, v95
    s_add_u32 s39, s100, 36864
    buffer_store_dwordx4 v[100:103], v1, s[76:79], s39 offen offset:1024 sc1
    v_accvgpr_read_b32 v80, a112
    v_accvgpr_read_b32 v81, a113
    v_accvgpr_read_b32 v82, a114
    v_accvgpr_read_b32 v83, a115
    v_accvgpr_read_b32 v84, a116
    v_accvgpr_read_b32 v85, a117
    v_accvgpr_read_b32 v86, a118
    v_accvgpr_read_b32 v87, a119
    v_mul_f32 v80, s74, v80
    v_mul_f32 v81, s74, v81
    v_mul_f32 v82, s74, v82
    v_mul_f32 v83, s74, v83
    v_mul_f32 v84, s74, v84
    v_mul_f32 v85, s74, v85
    v_mul_f32 v86, s74, v86
    v_mul_f32 v87, s74, v87
    v_cvt_pk_bf16_f32 v104, v80, v81
    v_cvt_pk_bf16_f32 v105, v82, v83
    v_cvt_pk_bf16_f32 v106, v84, v85
    v_cvt_pk_bf16_f32 v107, v86, v87
    s_add_u32 s39, s100, 36864
    buffer_store_dwordx4 v[104:107], v1, s[76:79], s39 offen offset:2048 sc1
    v_accvgpr_read_b32 v88, a120
    v_accvgpr_read_b32 v89, a121
    v_accvgpr_read_b32 v90, a122
    v_accvgpr_read_b32 v91, a123
    v_accvgpr_read_b32 v92, a124
    v_accvgpr_read_b32 v93, a125
    v_accvgpr_read_b32 v94, a126
    v_accvgpr_read_b32 v95, a127
    v_mul_f32 v88, s74, v88
    v_mul_f32 v89, s74, v89
    v_mul_f32 v90, s74, v90
    v_mul_f32 v91, s74, v91
    v_mul_f32 v92, s74, v92
    v_mul_f32 v93, s74, v93
    v_mul_f32 v94, s74, v94
    v_mul_f32 v95, s74, v95
    v_cvt_pk_bf16_f32 v108, v88, v89
    v_cvt_pk_bf16_f32 v109, v90, v91
    v_cvt_pk_bf16_f32 v110, v92, v93
    v_cvt_pk_bf16_f32 v111, v94, v95
    s_add_u32 s39, s100, 36864
    buffer_store_dwordx4 v[108:111], v1, s[76:79], s39 offen offset:3072 sc1
    s_lshl_b32 s98, s34, 17
    s_lshl_b32 s99, s94, 8
    s_add_u32 s98, s98, s99
    s_mov_b32 s99, s97
    s_lshl_b32 s75, s94, 19
    s_add_u32 s75, s75, 16777216
    s_add_u32 s76, s6, s75
    s_addc_u32 s77, s7, 0
    s_mov_b32 s78, 524288
    s_mov_b32 s79, 0x00020000
    v_accvgpr_write_b32 a0, 0
    v_accvgpr_write_b32 a1, 0
    v_accvgpr_write_b32 a2, 0
    v_accvgpr_write_b32 a3, 0
    v_accvgpr_write_b32 a4, 0
    v_accvgpr_write_b32 a5, 0
    v_accvgpr_write_b32 a6, 0
    v_accvgpr_write_b32 a7, 0
    v_accvgpr_write_b32 a8, 0
    v_accvgpr_write_b32 a9, 0
    v_accvgpr_write_b32 a10, 0
    v_accvgpr_write_b32 a11, 0
    v_accvgpr_write_b32 a12, 0
    v_accvgpr_write_b32 a13, 0
    v_accvgpr_write_b32 a14, 0
    v_accvgpr_write_b32 a15, 0
    v_accvgpr_write_b32 a16, 0
    v_accvgpr_write_b32 a17, 0
    v_accvgpr_write_b32 a18, 0
    v_accvgpr_write_b32 a19, 0
    v_accvgpr_write_b32 a20, 0
    v_accvgpr_write_b32 a21, 0
    v_accvgpr_write_b32 a22, 0
    v_accvgpr_write_b32 a23, 0
    v_accvgpr_write_b32 a24, 0
    v_accvgpr_write_b32 a25, 0
    v_accvgpr_write_b32 a26, 0
    v_accvgpr_write_b32 a27, 0
    v_accvgpr_write_b32 a28, 0
    v_accvgpr_write_b32 a29, 0
    v_accvgpr_write_b32 a30, 0
    v_accvgpr_write_b32 a31, 0
    v_accvgpr_write_b32 a32, 0
    v_accvgpr_write_b32 a33, 0
    v_accvgpr_write_b32 a34, 0
    v_accvgpr_write_b32 a35, 0
    v_accvgpr_write_b32 a36, 0
    v_accvgpr_write_b32 a37, 0
    v_accvgpr_write_b32 a38, 0
    v_accvgpr_write_b32 a39, 0
    v_accvgpr_write_b32 a40, 0
    v_accvgpr_write_b32 a41, 0
    v_accvgpr_write_b32 a42, 0
    v_accvgpr_write_b32 a43, 0
    v_accvgpr_write_b32 a44, 0
    v_accvgpr_write_b32 a45, 0
    v_accvgpr_write_b32 a46, 0
    v_accvgpr_write_b32 a47, 0
    v_accvgpr_write_b32 a48, 0
    v_accvgpr_write_b32 a49, 0
    v_accvgpr_write_b32 a50, 0
    v_accvgpr_write_b32 a51, 0
    v_accvgpr_write_b32 a52, 0
    v_accvgpr_write_b32 a53, 0
    v_accvgpr_write_b32 a54, 0
    v_accvgpr_write_b32 a55, 0
    v_accvgpr_write_b32 a56, 0
    v_accvgpr_write_b32 a57, 0
    v_accvgpr_write_b32 a58, 0
    v_accvgpr_write_b32 a59, 0
    v_accvgpr_write_b32 a60, 0
    v_accvgpr_write_b32 a61, 0
    v_accvgpr_write_b32 a62, 0
    v_accvgpr_write_b32 a63, 0
    v_accvgpr_write_b32 a64, 0
    v_accvgpr_write_b32 a65, 0
    v_accvgpr_write_b32 a66, 0
    v_accvgpr_write_b32 a67, 0
    v_accvgpr_write_b32 a68, 0
    v_accvgpr_write_b32 a69, 0
    v_accvgpr_write_b32 a70, 0
    v_accvgpr_write_b32 a71, 0
    v_accvgpr_write_b32 a72, 0
    v_accvgpr_write_b32 a73, 0
    v_accvgpr_write_b32 a74, 0
    v_accvgpr_write_b32 a75, 0
    v_accvgpr_write_b32 a76, 0
    v_accvgpr_write_b32 a77, 0
    v_accvgpr_write_b32 a78, 0
    v_accvgpr_write_b32 a79, 0
    v_accvgpr_write_b32 a80, 0
    v_accvgpr_write_b32 a81, 0
    v_accvgpr_write_b32 a82, 0
    v_accvgpr_write_b32 a83, 0
    v_accvgpr_write_b32 a84, 0
    v_accvgpr_write_b32 a85, 0
    v_accvgpr_write_b32 a86, 0
    v_accvgpr_write_b32 a87, 0
    v_accvgpr_write_b32 a88, 0
    v_accvgpr_write_b32 a89, 0
    v_accvgpr_write_b32 a90, 0
    v_accvgpr_write_b32 a91, 0
    v_accvgpr_write_b32 a92, 0
    v_accvgpr_write_b32 a93, 0
    v_accvgpr_write_b32 a94, 0
    v_accvgpr_write_b32 a95, 0
    v_accvgpr_write_b32 a96, 0
    v_accvgpr_write_b32 a97, 0
    v_accvgpr_write_b32 a98, 0
    v_accvgpr_write_b32 a99, 0
    v_accvgpr_write_b32 a100, 0
    v_accvgpr_write_b32 a101, 0
    v_accvgpr_write_b32 a102, 0
    v_accvgpr_write_b32 a103, 0
    v_accvgpr_write_b32 a104, 0
    v_accvgpr_write_b32 a105, 0
    v_accvgpr_write_b32 a106, 0
    v_accvgpr_write_b32 a107, 0
    v_accvgpr_write_b32 a108, 0
    v_accvgpr_write_b32 a109, 0
    v_accvgpr_write_b32 a110, 0
    v_accvgpr_write_b32 a111, 0
    v_accvgpr_write_b32 a112, 0
    v_accvgpr_write_b32 a113, 0
    v_accvgpr_write_b32 a114, 0
    v_accvgpr_write_b32 a115, 0
    v_accvgpr_write_b32 a116, 0
    v_accvgpr_write_b32 a117, 0
    v_accvgpr_write_b32 a118, 0
    v_accvgpr_write_b32 a119, 0
    v_accvgpr_write_b32 a120, 0
    v_accvgpr_write_b32 a121, 0
    v_accvgpr_write_b32 a122, 0
    v_accvgpr_write_b32 a123, 0
    v_accvgpr_write_b32 a124, 0
    v_accvgpr_write_b32 a125, 0
    v_accvgpr_write_b32 a126, 0
    v_accvgpr_write_b32 a127, 0
    v_add_u32 v8, 0, v5
    v_add_u32 v12, 32768, v6
    v_xor_b32 v9, 32, v8
    v_xor_b32 v10, 64, v8
    v_xor_b32 v11, 96, v8
    v_xor_b32 v13, 64, v12
    v_xor_b32 v14, 128, v12
    v_xor_b32 v15, 192, v12
    s_mov_b32 s101, 8
L_sl_80:
    s_barrier
    s_add_u32 m0, s54, 0
    s_add_u32 s38, s99, 0
    buffer_load_dwordx4 v26, s[56:59], s38 offen lds
    s_add_u32 m0, s54, 1024
    s_add_u32 s38, s99, 8192
    buffer_load_dwordx4 v27, s[56:59], s38 offen lds
    s_add_u32 m0, s54, 2048
    s_add_u32 s38, s99, 16384
    buffer_load_dwordx4 v26, s[56:59], s38 offen lds
    s_add_u32 m0, s54, 3072
    s_add_u32 s38, s99, 24576
    buffer_load_dwordx4 v27, s[56:59], s38 offen lds
    s_add_u32 m0, s54, 4096
    s_add_u32 s38, s99, 32768
    buffer_load_dwordx4 v26, s[56:59], s38 offen lds
    s_add_u32 m0, s54, 5120
    s_add_u32 s38, s99, 40960
    buffer_load_dwordx4 v27, s[56:59], s38 offen lds
    s_add_u32 m0, s54, 6144
    s_add_u32 s38, s99, 49152
    buffer_load_dwordx4 v26, s[56:59], s38 offen lds
    s_add_u32 m0, s54, 7168
    s_add_u32 s38, s99, 57344
    buffer_load_dwordx4 v27, s[56:59], s38 offen lds
    s_add_u32 m0, s37, 32768
    s_add_u32 s38, s98, 0
    buffer_load_dwordx4 v4, s[64:67], s38 offen lds
    s_add_u32 m0, s37, 33792
    s_add_u32 s38, s98, 32768
    buffer_load_dwordx4 v4, s[64:67], s38 offen lds
    s_add_u32 m0, s37, 34816
    s_add_u32 s38, s98, 65536
    buffer_load_dwordx4 v4, s[64:67], s38 offen lds
    s_add_u32 m0, s37, 35840
    s_add_u32 s38, s98, 98304
    buffer_load_dwordx4 v4, s[64:67], s38 offen lds
    s_add_u32 s99, s99, 128
    s_add_u32 s98, s98, 524288
    s_waitcnt vmcnt(0)
    s_barrier
    ds_read_b128 v[32:35], v8 offset:0
    ds_read_b64_tr_b16 v[40:41], v12 offset:0
    ds_read_b64_tr_b16 v[42:43], v12 offset:1024
    ds_read_b128 v[36:39], v8 offset:16384
    ds_read_b64_tr_b16 v[44:45], v13 offset:0
    ds_read_b64_tr_b16 v[46:47], v13 offset:1024
    ds_read_b64_tr_b16 v[48:49], v14 offset:0
    ds_read_b64_tr_b16 v[50:51], v14 offset:1024
    ds_read_b64_tr_b16 v[52:53], v15 offset:0
    ds_read_b64_tr_b16 v[54:55], v15 offset:1024
    s_waitcnt lgkmcnt(7)
    v_mfma_f32_32x32x16_bf16 a[0:15], v[32:35], v[40:43], a[0:15]
    s_waitcnt lgkmcnt(6)
    v_mfma_f32_32x32x16_bf16 a[64:79], v[36:39], v[40:43], a[64:79]
    s_waitcnt lgkmcnt(4)
    v_mfma_f32_32x32x16_bf16 a[16:31], v[32:35], v[44:47], a[16:31]
    v_mfma_f32_32x32x16_bf16 a[80:95], v[36:39], v[44:47], a[80:95]
    s_waitcnt lgkmcnt(2)
    v_mfma_f32_32x32x16_bf16 a[32:47], v[32:35], v[48:51], a[32:47]
    v_mfma_f32_32x32x16_bf16 a[96:111], v[36:39], v[48:51], a[96:111]
    s_waitcnt lgkmcnt(0)
    v_mfma_f32_32x32x16_bf16 a[48:63], v[32:35], v[52:55], a[48:63]
    v_mfma_f32_32x32x16_bf16 a[112:127], v[36:39], v[52:55], a[112:127]
    ds_read_b128 v[32:35], v9 offset:0
    ds_read_b64_tr_b16 v[40:41], v12 offset:4096
    ds_read_b64_tr_b16 v[42:43], v12 offset:5120
    ds_read_b128 v[36:39], v9 offset:16384
    ds_read_b64_tr_b16 v[44:45], v13 offset:4096
    ds_read_b64_tr_b16 v[46:47], v13 offset:5120
    ds_read_b64_tr_b16 v[48:49], v14 offset:4096
    ds_read_b64_tr_b16 v[50:51], v14 offset:5120
    ds_read_b64_tr_b16 v[52:53], v15 offset:4096
    ds_read_b64_tr_b16 v[54:55], v15 offset:5120
    s_waitcnt lgkmcnt(7)
    v_mfma_f32_32x32x16_bf16 a[0:15], v[32:35], v[40:43], a[0:15]
    s_waitcnt lgkmcnt(6)
    v_mfma_f32_32x32x16_bf16 a[64:79], v[36:39], v[40:43], a[64:79]
    s_waitcnt lgkmcnt(4)
    v_mfma_f32_32x32x16_bf16 a[16:31], v[32:35], v[44:47], a[16:31]
    v_mfma_f32_32x32x16_bf16 a[80:95], v[36:39], v[44:47], a[80:95]
    s_waitcnt lgkmcnt(2)
    v_mfma_f32_32x32x16_bf16 a[32:47], v[32:35], v[48:51], a[32:47]
    v_mfma_f32_32x32x16_bf16 a[96:111], v[36:39], v[48:51], a[96:111]
    s_waitcnt lgkmcnt(0)
    v_mfma_f32_32x32x16_bf16 a[48:63], v[32:35], v[52:55], a[48:63]
    v_mfma_f32_32x32x16_bf16 a[112:127], v[36:39], v[52:55], a[112:127]
    ds_read_b128 v[32:35], v10 offset:0
    ds_read_b64_tr_b16 v[40:41], v12 offset:8192
    ds_read_b64_tr_b16 v[42:43], v12 offset:9216
    ds_read_b128 v[36:39], v10 offset:16384
    ds_read_b64_tr_b16 v[44:45], v13 offset:8192
    ds_read_b64_tr_b16 v[46:47], v13 offset:9216
    ds_read_b64_tr_b16 v[48:49], v14 offset:8192
    ds_read_b64_tr_b16 v[50:51], v14 offset:9216
    ds_read_b64_tr_b16 v[52:53], v15 offset:8192
    ds_read_b64_tr_b16 v[54:55], v15 offset:9216
    s_waitcnt lgkmcnt(7)
    v_mfma_f32_32x32x16_bf16 a[0:15], v[32:35], v[40:43], a[0:15]
    s_waitcnt lgkmcnt(6)
    v_mfma_f32_32x32x16_bf16 a[64:79], v[36:39], v[40:43], a[64:79]
    s_waitcnt lgkmcnt(4)
    v_mfma_f32_32x32x16_bf16 a[16:31], v[32:35], v[44:47], a[16:31]
    v_mfma_f32_32x32x16_bf16 a[80:95], v[36:39], v[44:47], a[80:95]
    s_waitcnt lgkmcnt(2)
    v_mfma_f32_32x32x16_bf16 a[32:47], v[32:35], v[48:51], a[32:47]
    v_mfma_f32_32x32x16_bf16 a[96:111], v[36:39], v[48:51], a[96:111]
    s_waitcnt lgkmcnt(0)
    v_mfma_f32_32x32x16_bf16 a[48:63], v[32:35], v[52:55], a[48:63]
    v_mfma_f32_32x32x16_bf16 a[112:127], v[36:39], v[52:55], a[112:127]
    ds_read_b128 v[32:35], v11 offset:0
    ds_read_b64_tr_b16 v[40:41], v12 offset:12288
    ds_read_b64_tr_b16 v[42:43], v12 offset:13312
    ds_read_b128 v[36:39], v11 offset:16384
    ds_read_b64_tr_b16 v[44:45], v13 offset:12288
    ds_read_b64_tr_b16 v[46:47], v13 offset:13312
    ds_read_b64_tr_b16 v[48:49], v14 offset:12288
    ds_read_b64_tr_b16 v[50:51], v14 offset:13312
    ds_read_b64_tr_b16 v[52:53], v15 offset:12288
    ds_read_b64_tr_b16 v[54:55], v15 offset:13312
    s_waitcnt lgkmcnt(7)
    v_mfma_f32_32x32x16_bf16 a[0:15], v[32:35], v[40:43], a[0:15]
    s_waitcnt lgkmcnt(6)
    v_mfma_f32_32x32x16_bf16 a[64:79], v[36:39], v[40:43], a[64:79]
    s_waitcnt lgkmcnt(4)
    v_mfma_f32_32x32x16_bf16 a[16:31], v[32:35], v[44:47], a[16:31]
    v_mfma_f32_32x32x16_bf16 a[80:95], v[36:39], v[44:47], a[80:95]
    s_waitcnt lgkmcnt(2)
    v_mfma_f32_32x32x16_bf16 a[32:47], v[32:35], v[48:51], a[32:47]
    v_mfma_f32_32x32x16_bf16 a[96:111], v[36:39], v[48:51], a[96:111]
    s_waitcnt lgkmcnt(0)
    v_mfma_f32_32x32x16_bf16 a[48:63], v[32:35], v[52:55], a[48:63]
    v_mfma_f32_32x32x16_bf16 a[112:127], v[36:39], v[52:55], a[112:127]
    s_sub_u32 s101, s101, 1
    s_cmp_lg_u32 s101, 0
    s_cbranch_scc1 L_sl_80
    s_nop 15
    v_accvgpr_read_b32 v80, a0
    v_accvgpr_read_b32 v81, a1
    v_accvgpr_read_b32 v82, a2
    v_accvgpr_read_b32 v83, a3
    v_accvgpr_read_b32 v84, a4
    v_accvgpr_read_b32 v85, a5
    v_accvgpr_read_b32 v86, a6
    v_accvgpr_read_b32 v87, a7
    v_cvt_pk_bf16_f32 v96, v80, v81
    v_cvt_pk_bf16_f32 v97, v82, v83
    v_cvt_pk_bf16_f32 v98, v84, v85
    v_cvt_pk_bf16_f32 v99, v86, v87
    s_add_u32 s39, s100, 0
    buffer_store_dwordx4 v[96:99], v1, s[76:79], s39 offen offset:0 sc1
    v_accvgpr_read_b32 v88, a8
    v_accvgpr_read_b32 v89, a9
    v_accvgpr_read_b32 v90, a10
    v_accvgpr_read_b32 v91, a11
    v_accvgpr_read_b32 v92, a12
    v_accvgpr_read_b32 v93, a13
    v_accvgpr_read_b32 v94, a14
    v_accvgpr_read_b32 v95, a15
    v_cvt_pk_bf16_f32 v100, v88, v89
    v_cvt_pk_bf16_f32 v101, v90, v91
    v_cvt_pk_bf16_f32 v102, v92, v93
    v_cvt_pk_bf16_f32 v103, v94, v95
    s_add_u32 s39, s100, 4096
    buffer_store_dwordx4 v[100:103], v1, s[76:79], s39 offen offset:0 sc1
    v_accvgpr_read_b32 v80, a16
    v_accvgpr_read_b32 v81, a17
    v_accvgpr_read_b32 v82, a18
    v_accvgpr_read_b32 v83, a19
    v_accvgpr_read_b32 v84, a20
    v_accvgpr_read_b32 v85, a21
    v_accvgpr_read_b32 v86, a22
    v_accvgpr_read_b32 v87, a23
    v_cvt_pk_bf16_f32 v104, v80, v81
    v_cvt_pk_bf16_f32 v105, v82, v83
    v_cvt_pk_bf16_f32 v106, v84, v85
    v_cvt_pk_bf16_f32 v107, v86, v87
    s_add_u32 s39, s100, 0
    buffer_store_dwordx4 v[104:107], v1, s[76:79], s39 offen offset:1024 sc1
    v_accvgpr_read_b32 v88, a24
    v_accvgpr_read_b32 v89, a25
    v_accvgpr_read_b32 v90, a26
    v_accvgpr_read_b32 v91, a27
    v_accvgpr_read_b32 v92, a28
    v_accvgpr_read_b32 v93, a29
    v_accvgpr_read_b32 v94, a30
    v_accvgpr_read_b32 v95, a31
    v_cvt_pk_bf16_f32 v108, v88, v89
    v_cvt_pk_bf16_f32 v109, v90, v91
    v_cvt_pk_bf16_f32 v110, v92, v93
    v_cvt_pk_bf16_f32 v111, v94, v95
    s_add_u32 s39, s100, 4096
    buffer_store_dwordx4 v[108:111], v1, s[76:79], s39 offen offset:1024 sc1
    v_accvgpr_read_b32 v80, a32
    v_accvgpr_read_b32 v81, a33
    v_accvgpr_read_b32 v82, a34
    v_accvgpr_read_b32 v83, a35
    v_accvgpr_read_b32 v84, a36
    v_accvgpr_read_b32 v85, a37
    v_accvgpr_read_b32 v86, a38
    v_accvgpr_read_b32 v87, a39
    v_cvt_pk_bf16_f32 v96, v80, v81
    v_cvt_pk_bf16_f32 v97, v82, v83
    v_cvt_pk_bf16_f32 v98, v84, v85
    v_cvt_pk_bf16_f32 v99, v86, v87
    s_add_u32 s39, s100, 0
    buffer_store_dwordx4 v[96:99], v1, s[76:79], s39 offen offset:2048 sc1
    v_accvgpr_read_b32 v88, a40
    v_accvgpr_read_b32 v89, a41
    v_accvgpr_read_b32 v90, a42
    v_accvgpr_read_b32 v91, a43
    v_accvgpr_read_b32 v92, a44
    v_accvgpr_read_b32 v93, a45
    v_accvgpr_read_b32 v94, a46
    v_accvgpr_read_b32 v95, a47
    v_cvt_pk_bf16_f32 v100, v88, v89
    v_cvt_pk_bf16_f32 v101, v90, v91
    v_cvt_pk_bf16_f32 v102, v92, v93
    v_cvt_pk_bf16_f32 v103, v94, v95
    s_add_u32 s39, s100, 4096
    buffer_store_dwordx4 v[100:103], v1, s[76:79], s39 offen offset:2048 sc1
    v_accvgpr_read_b32 v80, a48
    v_accvgpr_read_b32 v81, a49
    v_accvgpr_read_b32 v82, a50
    v_accvgpr_read_b32 v83, a51
    v_accvgpr_read_b32 v84, a52
    v_accvgpr_read_b32 v85, a53
    v_accvgpr_read_b32 v86, a54
    v_accvgpr_read_b32 v87, a55
    v_cvt_pk_bf16_f32 v104, v80, v81
    v_cvt_pk_bf16_f32 v105, v82, v83
    v_cvt_pk_bf16_f32 v106, v84, v85
    v_cvt_pk_bf16_f32 v107, v86, v87
    s_add_u32 s39, s100, 0
    buffer_store_dwordx4 v[104:107], v1, s[76:79], s39 offen offset:3072 sc1
    v_accvgpr_read_b32 v88, a56
    v_accvgpr_read_b32 v89, a57
    v_accvgpr_read_b32 v90, a58
    v_accvgpr_read_b32 v91, a59
    v_accvgpr_read_b32 v92, a60
    v_accvgpr_read_b32 v93, a61
    v_accvgpr_read_b32 v94, a62
    v_accvgpr_read_b32 v95, a63
    v_cvt_pk_bf16_f32 v108, v88, v89
    v_cvt_pk_bf16_f32 v109, v90, v91
    v_cvt_pk_bf16_f32 v110, v92, v93
    v_cvt_pk_bf16_f32 v111, v94, v95
    s_add_u32 s39, s100, 4096
    buffer_store_dwordx4 v[108:111], v1, s[76:79], s39 offen offset:3072 sc1
    v_accvgpr_read_b32 v80, a64
    v_accvgpr_read_b32 v81, a65
    v_accvgpr_read_b32 v82, a66
    v_accvgpr_read_b32 v83, a67
    v_accvgpr_read_b32 v84, a68
    v_accvgpr_read_b32 v85, a69
    v_accvgpr_read_b32 v86, a70
    v_accvgpr_read_b32 v87, a71
    v_cvt_pk_bf16_f32 v96, v80, v81
    v_cvt_pk_bf16_f32 v97, v82, v83
    v_cvt_pk_bf16_f32 v98, v84, v85
    v_cvt_pk_bf16_f32 v99, v86, v87
    s_add_u32 s39, s100, 32768
    buffer_store_dwordx4 v[96:99], v1, s[76:79], s39 offen offset:0 sc1
    v_accvgpr_read_b32 v88, a72
    v_accvgpr_read_b32 v89, a73
    v_accvgpr_read_b32 v90, a74
    v_accvgpr_read_b32 v91, a75
    v_accvgpr_read_b32 v92, a76
    v_accvgpr_read_b32 v93, a77
    v_accvgpr_read_b32 v94, a78
    v_accvgpr_read_b32 v95, a79
    v_cvt_pk_bf16_f32 v100, v88, v89
    v_cvt_pk_bf16_f32 v101, v90, v91
    v_cvt_pk_bf16_f32 v102, v92, v93
    v_cvt_pk_bf16_f32 v103, v94, v95
    s_add_u32 s39, s100, 36864
    buffer_store_dwordx4 v[100:103], v1, s[76:79], s39 offen offset:0 sc1
    v_accvgpr_read_b32 v80, a80
    v_accvgpr_read_b32 v81, a81
    v_accvgpr_read_b32 v82, a82
    v_accvgpr_read_b32 v83, a83
    v_accvgpr_read_b32 v84, a84
    v_accvgpr_read_b32 v85, a85
    v_accvgpr_read_b32 v86, a86
    v_accvgpr_read_b32 v87, a87
    v_cvt_pk_bf16_f32 v104, v80, v81
    v_cvt_pk_bf16_f32 v105, v82, v83
    v_cvt_pk_bf16_f32 v106, v84, v85
    v_cvt_pk_bf16_f32 v107, v86, v87
    s_add_u32 s39, s100, 32768
    buffer_store_dwordx4 v[104:107], v1, s[76:79], s39 offen offset:1024 sc1
    v_accvgpr_read_b32 v88, a88
    v_accvgpr_read_b32 v89, a89
    v_accvgpr_read_b32 v90, a90
    v_accvgpr_read_b32 v91, a91
    v_accvgpr_read_b32 v92, a92
    v_accvgpr_read_b32 v93, a93
    v_accvgpr_read_b32 v94, a94
    v_accvgpr_read_b32 v95, a95
    v_cvt_pk_bf16_f32 v108, v88, v89
    v_cvt_pk_bf16_f32 v109, v90, v91
    v_cvt_pk_bf16_f32 v110, v92, v93
    v_cvt_pk_bf16_f32 v111, v94, v95
    s_add_u32 s39, s100, 36864
    buffer_store_dwordx4 v[108:111], v1, s[76:79], s39 offen offset:1024 sc1
    v_accvgpr_read_b32 v80, a96
    v_accvgpr_read_b32 v81, a97
    v_accvgpr_read_b32 v82, a98
    v_accvgpr_read_b32 v83, a99
    v_accvgpr_read_b32 v84, a100
    v_accvgpr_read_b32 v85, a101
    v_accvgpr_read_b32 v86, a102
    v_accvgpr_read_b32 v87, a103
    v_cvt_pk_bf16_f32 v96, v80, v81
    v_cvt_pk_bf16_f32 v97, v82, v83
    v_cvt_pk_bf16_f32 v98, v84, v85
    v_cvt_pk_bf16_f32 v99, v86, v87
    s_add_u32 s39, s100, 32768
    buffer_store_dwordx4 v[96:99], v1, s[76:79], s39 offen offset:2048 sc1
    v_accvgpr_read_b32 v88, a104
    v_accvgpr_read_b32 v89, a105
    v_accvgpr_read_b32 v90, a106
    v_accvgpr_read_b32 v91, a107
    v_accvgpr_read_b32 v92, a108
    v_accvgpr_read_b32 v93, a109
    v_accvgpr_read_b32 v94, a110
    v_accvgpr_read_b32 v95, a111
    v_cvt_pk_bf16_f32 v100, v88, v89
    v_cvt_pk_bf16_f32 v101, v90, v91
    v_cvt_pk_bf16_f32 v102, v92, v93
    v_cvt_pk_bf16_f32 v103, v94, v95
    s_add_u32 s39, s100, 36864
    buffer_store_dwordx4 v[100:103], v1, s[76:79], s39 offen offset:2048 sc1
    v_accvgpr_read_b32 v80, a112
    v_accvgpr_read_b32 v81, a113
    v_accvgpr_read_b32 v82, a114
    v_accvgpr_read_b32 v83, a115
    v_accvgpr_read_b32 v84, a116
    v_accvgpr_read_b32 v85, a117
    v_accvgpr_read_b32 v86, a118
    v_accvgpr_read_b32 v87, a119
    v_cvt_pk_bf16_f32 v104, v80, v81
    v_cvt_pk_bf16_f32 v105, v82, v83
    v_cvt_pk_bf16_f32 v106, v84, v85
    v_cvt_pk_bf16_f32 v107, v86, v87
    s_add_u32 s39, s100, 32768
    buffer_store_dwordx4 v[104:107], v1, s[76:79], s39 offen offset:3072 sc1
    v_accvgpr_read_b32 v88, a120
    v_accvgpr_read_b32 v89, a121
    v_accvgpr_read_b32 v90, a122
    v_accvgpr_read_b32 v91, a123
    v_accvgpr_read_b32 v92, a124
    v_accvgpr_read_b32 v93, a125
    v_accvgpr_read_b32 v94, a126
    v_accvgpr_read_b32 v95, a127
    v_cvt_pk_bf16_f32 v108, v88, v89
    v_cvt_pk_bf16_f32 v109, v90, v91
    v_cvt_pk_bf16_f32 v110, v92, v93
    v_cvt_pk_bf16_f32 v111, v94, v95
    s_add_u32 s39, s100, 36864
    buffer_store_dwordx4 v[108:111], v1, s[76:79], s39 offen offset:3072 sc1
    s_waitcnt vmcnt(0)
    s_barrier
    s_cmp_lg_u32 s34, 0
    s_cbranch_scc1 L_fo_81
    s_lshl_b32 s75, 256, s95
    s_lshl_b32 s76, s94, 2
    v_mov_b32 v22, s75
    v_mov_b32 v23, 0
    s_mov_b64 exec, 1
    buffer_atomic_or v22, v23, s[68:71], s76 offen
    s_mov_b64 exec, -1
L_fo_81:
    s_branch L_k2_wait
L_k2_aproj:
    s_load_dwordx2 s[6:7], s[0:1], 104
    s_load_dwordx4 s[8:11], s[0:1], 0
    v_lshrrev_b32 v1, 6, v0
    v_and_b32 v0, 63, v0
    v_readfirstlane_b32 s34, v1
    s_and_b32 s35, s2, 7
    s_lshr_b32 s36, s2, 3
    s_mul_i32 s37, s35, 260
    s_add_u32 s38, s37, 260
    s_lshr_b32 s37, s37, 3
    s_lshr_b32 s38, s38, 3
    s_add_u32 s37, s37, s36
    s_cmp_ge_u32 s37, s38
    s_cbranch_scc1 L_k2_after
    s_mul_i32 s32, s37, 6554
    s_lshr_b32 s32, s32, 16
    s_mul_i32 s33, s32, 10
    s_sub_u32 s33, s37, s33
    s_waitcnt lgkmcnt(0)
    s_movk_i32 s38, 1152
    s_movk_i32 s35, 1152
    s_lshl_b32 s43, s33, 7
    s_mov_b32 s46, s43
    s_mov_b32 s12, s8
    s_mov_b32 s13, s9
    s_mov_b32 s14, 2359296
    s_mov_b32 s15, 0x00020000
    s_add_u32 s36, s6, 58720256
    s_addc_u32 s37, s7, 0
    s_cmp_lt_u32 s33, 9
    s_cselect_b32 s16, s10, s36
    s_cselect_b32 s17, s11, s37
    s_mov_b32 s18, 73728
    s_cselect_b32 s18, 663552, s18
    s_mov_b32 s19, 0x00020000
    s_movk_i32 s35, 128
    s_cselect_b32 s35, 1152, s35
    s_cselect_b32 s46, s46, 0
    s_mov_b32 s36, 54525952
    s_cselect_b32 s36, 50331648, s36
    s_mov_b32 s22, 163840
    s_cselect_b32 s22, 2359296, s22
    s_add_u32 s20, s6, s36
    s_addc_u32 s21, s7, 0
    s_mov_b32 s23, 0x00020000
    v_lshrrev_b32 v8, 4, v0
    v_lshrrev_b32 v9, 2, v0
    v_mul_lo_u32 v9, v9, s38
    v_and_b32 v11, 3, v0
    v_lshl_add_u32 v2, v11, 4, v9
    v_lshrrev_b32 v9, 3, v0
    v_mul_lo_u32 v10, v9, s35
    v_lshrrev_b32 v9, 1, v9
    v_lshlrev_b32 v9, 1, v9
    v_and_b32 v11, 7, v0
    v_xor_b32 v9, v9, v11
    v_lshl_add_u32 v3, v9, 4, v10
    s_mul_i32 s39, s34, 36864
    s_mul_i32 s40, s32, 92160
    s_lshl_b32 s41, s34, 6
    s_add_u32 s40, s40, s41
    s_add_u32 s52, s40, 0
    s_add_u32 s53, s40, 18432
    s_add_u32 s54, s40, 36864
    s_add_u32 s55, s40, 55296
    s_add_u32 s56, s40, 73728
    s_lshl_b32 s47, s35, 3
    s_lshl_b32 s48, s35, 5
    s_mul_i32 s42, s34, s48
    s_add_u32 s42, s42, s46
    s_mul_i32 s48, s35, 104
    s_add_u32 m0, s39, 0
    s_nop 0
    buffer_load_dwordx4 v3, s[16:19], s42 offen lds
    s_add_u32 s42, s42, s47
    s_add_u32 m0, s39, 1024
    s_nop 0
    buffer_load_dwordx4 v3, s[16:19], s42 offen lds
    s_add_u32 s42, s42, s47
    s_add_u32 m0, s39, 2048
    s_nop 0
    buffer_load_dwordx4 v3, s[16:19], s42 offen lds
    s_add_u32 s42, s42, s47
    s_add_u32 m0, s39, 3072
    s_nop 0
    buffer_load_dwordx4 v3, s[16:19], s42 offen lds
    s_add_u32 s42, s42, s48
    s_add_u32 m0, s39, 4096
    s_nop 0
    buffer_load_dwordx4 v2, s[12:15], s52 offen lds
    s_add_u32 s52, s52, 256
    s_add_u32 m0, s39, 5120
    s_nop 0
    buffer_load_dwordx4 v2, s[12:15], s53 offen lds
    s_add_u32 s53, s53, 256
    s_add_u32 m0, s39, 6144
    s_nop 0
    buffer_load_dwordx4 v2, s[12:15], s54 offen lds
    s_add_u32 s54, s54, 256
    s_add_u32 m0, s39, 7168
    s_nop 0
    buffer_load_dwordx4 v2, s[12:15], s55 offen lds
    s_add_u32 s55, s55, 256
    s_add_u32 m0, s39, 8192
    s_nop 0
    buffer_load_dwordx4 v2, s[12:15], s56 offen lds
    s_add_u32 s56, s56, 256
    s_add_u32 m0, s39, 9216
    s_nop 0
    buffer_load_dwordx4 v3, s[16:19], s42 offen lds
    s_add_u32 s42, s42, s47
    s_add_u32 m0, s39, 10240
    s_nop 0
    buffer_load_dwordx4 v3, s[16:19], s42 offen lds
    s_add_u32 s42, s42, s47
    s_add_u32 m0, s39, 11264
    s_nop 0
    buffer_load_dwordx4 v3, s[16:19], s42 offen lds
    s_add_u32 s42, s42, s47
    s_add_u32 m0, s39, 12288
    s_nop 0
    buffer_load_dwordx4 v3, s[16:19], s42 offen lds
    s_add_u32 s42, s42, s48
    s_add_u32 m0, s39, 13312
    s_nop 0
    buffer_load_dwordx4 v2, s[12:15], s52 offen lds
    s_add_u32 s52, s52, 256
    s_add_u32 m0, s39, 14336
    s_nop 0
    buffer_load_dwordx4 v2, s[12:15], s53 offen lds
    s_add_u32 s53, s53, 256
    s_add_u32 m0, s39, 15360
    s_nop 0
    buffer_load_dwordx4 v2, s[12:15], s54 offen lds
    s_add_u32 s54, s54, 256
    s_add_u32 m0, s39, 16384
    s_nop 0
    buffer_load_dwordx4 v2, s[12:15], s55 offen lds
    s_add_u32 s55, s55, 256
    s_add_u32 m0, s39, 17408
    s_nop 0
    buffer_load_dwordx4 v2, s[12:15], s56 offen lds
    s_add_u32 s56, s56, 256
    s_add_u32 m0, s39, 18432
    s_nop 0
    buffer_load_dwordx4 v3, s[16:19], s42 offen lds
    s_add_u32 s42, s42, s47
    s_add_u32 m0, s39, 19456
    s_nop 0
    buffer_load_dwordx4 v3, s[16:19], s42 offen lds
    s_add_u32 s42, s42, s47
    s_add_u32 m0, s39, 20480
    s_nop 0
    buffer_load_dwordx4 v3, s[16:19], s42 offen lds
    s_add_u32 s42, s42, s47
    s_add_u32 m0, s39, 21504
    s_nop 0
    buffer_load_dwordx4 v3, s[16:19], s42 offen lds
    s_add_u32 s42, s42, s48
    s_add_u32 m0, s39, 22528
    s_nop 0
    buffer_load_dwordx4 v2, s[12:15], s52 offen lds
    s_add_u32 s52, s52, 256
    s_add_u32 m0, s39, 23552
    s_nop 0
    buffer_load_dwordx4 v2, s[12:15], s53 offen lds
    s_add_u32 s53, s53, 256
    s_add_u32 m0, s39, 24576
    s_nop 0
    buffer_load_dwordx4 v2, s[12:15], s54 offen lds
    s_add_u32 s54, s54, 256
    s_add_u32 m0, s39, 25600
    s_nop 0
    buffer_load_dwordx4 v2, s[12:15], s55 offen lds
    s_add_u32 s55, s55, 256
    s_add_u32 m0, s39, 26624
    s_nop 0
    buffer_load_dwordx4 v2, s[12:15], s56 offen lds
    s_add_u32 s56, s56, 256
    s_cmp_lg_u32 s100, 1
    s_cbranch_scc1 L_noepi_82
    s_mov_b32 s100, 0
    v_mul_f32 v128, v120, v128
    v_mul_f32 v129, v120, v129
    v_mul_f32 v130, v120, v130
    v_mul_f32 v131, v120, v131
    v_mul_f32 v132, v120, v132
    v_mul_f32 v133, v120, v133
    v_mul_f32 v134, v120, v134
    v_mul_f32 v135, v120, v135
    v_cvt_pk_bf16_f32 v112, v128, v129
    v_cvt_pk_bf16_f32 v113, v130, v131
    v_cvt_pk_bf16_f32 v114, v132, v133
    v_cvt_pk_bf16_f32 v115, v134, v135
    buffer_store_dwordx4 v[112:115], v122, s[28:31], s96 offen offset:0
    v_mul_f32 v136, v120, v136
    v_mul_f32 v137, v120, v137
    v_mul_f32 v138, v120, v138
    v_mul_f32 v139, v120, v139
    v_mul_f32 v140, v120, v140
    v_mul_f32 v141, v120, v141
    v_mul_f32 v142, v120, v142
    v_mul_f32 v143, v120, v143
    v_cvt_pk_bf16_f32 v116, v136, v137
    v_cvt_pk_bf16_f32 v117, v138, v139
    v_cvt_pk_bf16_f32 v118, v140, v141
    v_cvt_pk_bf16_f32 v119, v142, v143
    buffer_store_dwordx4 v[116:119], v122, s[28:31], s96 offen offset:1024
    v_mul_f32 v144, v120, v144
    v_mul_f32 v145, v120, v145
    v_mul_f32 v146, v120, v146
    v_mul_f32 v147, v120, v147
    v_mul_f32 v148, v120, v148
    v_mul_f32 v149, v120, v149
    v_mul_f32 v150, v120, v150
    v_mul_f32 v151, v120, v151
    v_cvt_pk_bf16_f32 v112, v144, v145
    v_cvt_pk_bf16_f32 v113, v146, v147
    v_cvt_pk_bf16_f32 v114, v148, v149
    v_cvt_pk_bf16_f32 v115, v150, v151
    buffer_store_dwordx4 v[112:115], v122, s[28:31], s96 offen offset:2048
    v_mul_f32 v152, v120, v152
    v_mul_f32 v153, v120, v153
    v_mul_f32 v154, v120, v154
    v_mul_f32 v155, v120, v155
    v_mul_f32 v156, v120, v156
    v_mul_f32 v157, v120, v157
    v_mul_f32 v158, v120, v158
    v_mul_f32 v159, v120, v159
    v_cvt_pk_bf16_f32 v116, v152, v153
    v_cvt_pk_bf16_f32 v117, v154, v155
    v_cvt_pk_bf16_f32 v118, v156, v157
    v_cvt_pk_bf16_f32 v119, v158, v159
    buffer_store_dwordx4 v[116:119], v122, s[28:31], s96 offen offset:3072
    v_mul_f32 v160, v120, v160
    v_mul_f32 v161, v120, v161
    v_mul_f32 v162, v120, v162
    v_mul_f32 v163, v120, v163
    v_mul_f32 v164, v120, v164
    v_mul_f32 v165, v120, v165
    v_mul_f32 v166, v120, v166
    v_mul_f32 v167, v120, v167
    v_cvt_pk_bf16_f32 v112, v160, v161
    v_cvt_pk_bf16_f32 v113, v162, v163
    v_cvt_pk_bf16_f32 v114, v164, v165
    v_cvt_pk_bf16_f32 v115, v166, v167
    buffer_store_dwordx4 v[112:115], v122, s[28:31], s97 offen offset:0
    v_mul_f32 v168, v120, v168
    v_mul_f32 v169, v120, v169
    v_mul_f32 v170, v120, v170
    v_mul_f32 v171, v120, v171
    v_mul_f32 v172, v120, v172
    v_mul_f32 v173, v120, v173
    v_mul_f32 v174, v120, v174
    v_mul_f32 v175, v120, v175
    v_cvt_pk_bf16_f32 v116, v168, v169
    v_cvt_pk_bf16_f32 v117, v170, v171
    v_cvt_pk_bf16_f32 v118, v172, v173
    v_cvt_pk_bf16_f32 v119, v174, v175
    buffer_store_dwordx4 v[116:119], v122, s[28:31], s97 offen offset:1024
    v_mul_f32 v176, v120, v176
    v_mul_f32 v177, v120, v177
    v_mul_f32 v178, v120, v178
    v_mul_f32 v179, v120, v179
    v_mul_f32 v180, v120, v180
    v_mul_f32 v181, v120, v181
    v_mul_f32 v182, v120, v182
    v_mul_f32 v183, v120, v183
    v_cvt_pk_bf16_f32 v112, v176, v177
    v_cvt_pk_bf16_f32 v113, v178, v179
    v_cvt_pk_bf16_f32 v114, v180, v181
    v_cvt_pk_bf16_f32 v115, v182, v183
    buffer_store_dwordx4 v[112:115], v122, s[28:31], s97 offen offset:2048
    v_mul_f32 v184, v120, v184
    v_mul_f32 v185, v120, v185
    v_mul_f32 v186, v120, v186
    v_mul_f32 v187, v120, v187
    v_mul_f32 v188, v120, v188
    v_mul_f32 v189, v120, v189
    v_mul_f32 v190, v120, v190
    v_mul_f32 v191, v120, v191
    v_cvt_pk_bf16_f32 v116, v184, v185
    v_cvt_pk_bf16_f32 v117, v186, v187
    v_cvt_pk_bf16_f32 v118, v188, v189
    v_cvt_pk_bf16_f32 v119, v190, v191
    buffer_store_dwordx4 v[116:119], v122, s[28:31], s97 offen offset:3072
    v_mul_f32 v192, v121, v192
    v_mul_f32 v193, v121, v193
    v_mul_f32 v194, v121, v194
    v_mul_f32 v195, v121, v195
    v_mul_f32 v196, v121, v196
    v_mul_f32 v197, v121, v197
    v_mul_f32 v198, v121, v198
    v_mul_f32 v199, v121, v199
    v_cvt_pk_bf16_f32 v112, v192, v193
    v_cvt_pk_bf16_f32 v113, v194, v195
    v_cvt_pk_bf16_f32 v114, v196, v197
    v_cvt_pk_bf16_f32 v115, v198, v199
    buffer_store_dwordx4 v[112:115], v122, s[28:31], s98 offen offset:0
    v_mul_f32 v200, v121, v200
    v_mul_f32 v201, v121, v201
    v_mul_f32 v202, v121, v202
    v_mul_f32 v203, v121, v203
    v_mul_f32 v204, v121, v204
    v_mul_f32 v205, v121, v205
    v_mul_f32 v206, v121, v206
    v_mul_f32 v207, v121, v207
    v_cvt_pk_bf16_f32 v116, v200, v201
    v_cvt_pk_bf16_f32 v117, v202, v203
    v_cvt_pk_bf16_f32 v118, v204, v205
    v_cvt_pk_bf16_f32 v119, v206, v207
    buffer_store_dwordx4 v[116:119], v122, s[28:31], s98 offen offset:1024
    v_mul_f32 v208, v121, v208
    v_mul_f32 v209, v121, v209
    v_mul_f32 v210, v121, v210
    v_mul_f32 v211, v121, v211
    v_mul_f32 v212, v121, v212
    v_mul_f32 v213, v121, v213
    v_mul_f32 v214, v121, v214
    v_mul_f32 v215, v121, v215
    v_cvt_pk_bf16_f32 v112, v208, v209
    v_cvt_pk_bf16_f32 v113, v210, v211
    v_cvt_pk_bf16_f32 v114, v212, v213
    v_cvt_pk_bf16_f32 v115, v214, v215
    buffer_store_dwordx4 v[112:115], v122, s[28:31], s98 offen offset:2048
    v_mul_f32 v216, v121, v216
    v_mul_f32 v217, v121, v217
    v_mul_f32 v218, v121, v218
    v_mul_f32 v219, v121, v219
    v_mul_f32 v220, v121, v220
    v_mul_f32 v221, v121, v221
    v_mul_f32 v222, v121, v222
    v_mul_f32 v223, v121, v223
    v_cvt_pk_bf16_f32 v116, v216, v217
    v_cvt_pk_bf16_f32 v117, v218, v219
    v_cvt_pk_bf16_f32 v118, v220, v221
    v_cvt_pk_bf16_f32 v119, v222, v223
    buffer_store_dwordx4 v[116:119], v122, s[28:31], s98 offen offset:3072
    v_mul_f32 v224, v121, v224
    v_mul_f32 v225, v121, v225
    v_mul_f32 v226, v121, v226
    v_mul_f32 v227, v121, v227
    v_mul_f32 v228, v121, v228
    v_mul_f32 v229, v121, v229
    v_mul_f32 v230, v121, v230
    v_mul_f32 v231, v121, v231
    v_cvt_pk_bf16_f32 v112, v224, v225
    v_cvt_pk_bf16_f32 v113, v226, v227
    v_cvt_pk_bf16_f32 v114, v228, v229
    v_cvt_pk_bf16_f32 v115, v230, v231
    buffer_store_dwordx4 v[112:115], v122, s[28:31], s99 offen offset:0
    v_mul_f32 v232, v121, v232
    v_mul_f32 v233, v121, v233
    v_mul_f32 v234, v121, v234
    v_mul_f32 v235, v121, v235
    v_mul_f32 v236, v121, v236
    v_mul_f32 v237, v121, v237
    v_mul_f32 v238, v121, v238
    v_mul_f32 v239, v121, v239
    v_cvt_pk_bf16_f32 v116, v232, v233
    v_cvt_pk_bf16_f32 v117, v234, v235
    v_cvt_pk_bf16_f32 v118, v236, v237
    v_cvt_pk_bf16_f32 v119, v238, v239
    buffer_store_dwordx4 v[116:119], v122, s[28:31], s99 offen offset:1024
    v_mul_f32 v240, v121, v240
    v_mul_f32 v241, v121, v241
    v_mul_f32 v242, v121, v242
    v_mul_f32 v243, v121, v243
    v_mul_f32 v244, v121, v244
    v_mul_f32 v245, v121, v245
    v_mul_f32 v246, v121, v246
    v_mul_f32 v247, v121, v247
    v_cvt_pk_bf16_f32 v112, v240, v241
    v_cvt_pk_bf16_f32 v113, v242, v243
    v_cvt_pk_bf16_f32 v114, v244, v245
    v_cvt_pk_bf16_f32 v115, v246, v247
    buffer_store_dwordx4 v[112:115], v122, s[28:31], s99 offen offset:2048
    v_mul_f32 v248, v121, v248
    v_mul_f32 v249, v121, v249
    v_mul_f32 v250, v121, v250
    v_mul_f32 v251, v121, v251
    v_mul_f32 v252, v121, v252
    v_mul_f32 v253, v121, v253
    v_mul_f32 v254, v121, v254
    v_mul_f32 v255, v121, v255
    v_cvt_pk_bf16_f32 v116, v248, v249
    v_cvt_pk_bf16_f32 v117, v250, v251
    v_cvt_pk_bf16_f32 v118, v252, v253
    v_cvt_pk_bf16_f32 v119, v254, v255
    buffer_store_dwordx4 v[116:119], v122, s[28:31], s99 offen offset:3072
L_noepi_82:
    v_lshrrev_b32 v10, 2, v0
    v_and_b32 v10, 3, v10
    v_and_b32 v11, 3, v0
    v_lshl_add_u32 v9, v8, 3, v10
    v_lshlrev_b32 v9, 7, v9
    v_lshl_add_u32 v9, v11, 3, v9
    v_add_u32 v9, s39, v9
    v_lshrrev_b32 v1, 1, v10
    v_lshl_add_u32 v4, v1, 5, v9
    v_xor_b32 v5, 32, v4
    v_xor_b32 v6, 64, v4
    v_xor_b32 v7, 96, v4
    v_and_b32 v9, 15, v0
    v_lshlrev_b32 v9, 6, v9
    v_lshl_add_u32 v9, v8, 4, v9
    v_add_u32 v14, s39, v9
    v_accvgpr_write_b32 a0, 0
    v_accvgpr_write_b32 a1, 0
    v_accvgpr_write_b32 a2, 0
    v_accvgpr_write_b32 a3, 0
    v_accvgpr_write_b32 a4, 0
    v_accvgpr_write_b32 a5, 0
    v_accvgpr_write_b32 a6, 0
    v_accvgpr_write_b32 a7, 0
    v_accvgpr_write_b32 a8, 0
    v_accvgpr_write_b32 a9, 0
    v_accvgpr_write_b32 a10, 0
    v_accvgpr_write_b32 a11, 0
    v_accvgpr_write_b32 a12, 0
    v_accvgpr_write_b32 a13, 0
    v_accvgpr_write_b32 a14, 0
    v_accvgpr_write_b32 a15, 0
    v_accvgpr_write_b32 a16, 0
    v_accvgpr_write_b32 a17, 0
    v_accvgpr_write_b32 a18, 0
    v_accvgpr_write_b32 a19, 0
    v_accvgpr_write_b32 a20, 0
    v_accvgpr_write_b32 a21, 0
    v_accvgpr_write_b32 a22, 0
    v_accvgpr_write_b32 a23, 0
    v_accvgpr_write_b32 a24, 0
    v_accvgpr_write_b32 a25, 0
    v_accvgpr_write_b32 a26, 0
    v_accvgpr_write_b32 a27, 0
    v_accvgpr_write_b32 a28, 0
    v_accvgpr_write_b32 a29, 0
    v_accvgpr_write_b32 a30, 0
    v_accvgpr_write_b32 a31, 0
    v_accvgpr_write_b32 a32, 0
    v_accvgpr_write_b32 a33, 0
    v_accvgpr_write_b32 a34, 0
    v_accvgpr_write_b32 a35, 0
    v_accvgpr_write_b32 a36, 0
    v_accvgpr_write_b32 a37, 0
    v_accvgpr_write_b32 a38, 0
    v_accvgpr_write_b32 a39, 0
    v_accvgpr_write_b32 a40, 0
    v_accvgpr_write_b32 a41, 0
    v_accvgpr_write_b32 a42, 0
    v_accvgpr_write_b32 a43, 0
    v_accvgpr_write_b32 a44, 0
    v_accvgpr_write_b32 a45, 0
    v_accvgpr_write_b32 a46, 0
    v_accvgpr_write_b32 a47, 0
    v_accvgpr_write_b32 a48, 0
    v_accvgpr_write_b32 a49, 0
    v_accvgpr_write_b32 a50, 0
    v_accvgpr_write_b32 a51, 0
    v_accvgpr_write_b32 a52, 0
    v_accvgpr_write_b32 a53, 0
    v_accvgpr_write_b32 a54, 0
    v_accvgpr_write_b32 a55, 0
    v_accvgpr_write_b32 a56, 0
    v_accvgpr_write_b32 a57, 0
    v_accvgpr_write_b32 a58, 0
    v_accvgpr_write_b32 a59, 0
    v_accvgpr_write_b32 a60, 0
    v_accvgpr_write_b32 a61, 0
    v_accvgpr_write_b32 a62, 0
    v_accvgpr_write_b32 a63, 0
    v_accvgpr_write_b32 a64, 0
    v_accvgpr_write_b32 a65, 0
    v_accvgpr_write_b32 a66, 0
    v_accvgpr_write_b32 a67, 0
    v_accvgpr_write_b32 a68, 0
    v_accvgpr_write_b32 a69, 0
    v_accvgpr_write_b32 a70, 0
    v_accvgpr_write_b32 a71, 0
    v_accvgpr_write_b32 a72, 0
    v_accvgpr_write_b32 a73, 0
    v_accvgpr_write_b32 a74, 0
    v_accvgpr_write_b32 a75, 0
    v_accvgpr_write_b32 a76, 0
    v_accvgpr_write_b32 a77, 0
    v_accvgpr_write_b32 a78, 0
    v_accvgpr_write_b32 a79, 0
    s_cmp_ge_u32 s33, 9
    s_cbranch_scc1 L_kv_83
    s_waitcnt vmcnt(18)
    ds_read_b64_tr_b16 v[16:17], v4 offset:0
    ds_read_b64_tr_b16 v[18:19], v6 offset:512
    ds_read_b64_tr_b16 v[20:21], v5 offset:0
    ds_read_b64_tr_b16 v[22:23], v7 offset:512
    ds_read_b64_tr_b16 v[24:25], v6 offset:0
    ds_read_b64_tr_b16 v[26:27], v4 offset:512
    ds_read_b64_tr_b16 v[28:29], v7 offset:0
    ds_read_b64_tr_b16 v[30:31], v5 offset:512
    ds_read_b128 v[48:51], v14 offset:4096
    ds_read_b128 v[52:55], v14 offset:5120
    ds_read_b128 v[56:59], v14 offset:6144
    ds_read_b128 v[60:63], v14 offset:7168
    ds_read_b128 v[64:67], v14 offset:8192
    s_waitcnt vmcnt(9)
    ds_read_b64_tr_b16 v[32:33], v4 offset:9216
    ds_read_b64_tr_b16 v[34:35], v6 offset:9728
    ds_read_b64_tr_b16 v[36:37], v5 offset:9216
    ds_read_b64_tr_b16 v[38:39], v7 offset:9728
    ds_read_b64_tr_b16 v[40:41], v6 offset:9216
    ds_read_b64_tr_b16 v[42:43], v4 offset:9728
    ds_read_b64_tr_b16 v[44:45], v7 offset:9216
    ds_read_b64_tr_b16 v[46:47], v5 offset:9728
    ds_read_b128 v[68:71], v14 offset:13312
    ds_read_b128 v[72:75], v14 offset:14336
    ds_read_b128 v[76:79], v14 offset:15360
    ds_read_b128 v[80:83], v14 offset:16384
    ds_read_b128 v[84:87], v14 offset:17408
    s_waitcnt lgkmcnt(13)
    v_mfma_f32_16x16x32_bf16 a[0:3], v[16:19], v[48:51], a[0:3]
    v_mfma_f32_16x16x32_bf16 a[16:19], v[16:19], v[52:55], a[16:19]
    s_add_u32 m0, s39, 27648
    s_nop 0
    buffer_load_dwordx4 v3, s[16:19], s42 offen lds
    s_add_u32 s42, s42, s47
    v_mfma_f32_16x16x32_bf16 a[32:35], v[16:19], v[56:59], a[32:35]
    v_mfma_f32_16x16x32_bf16 a[48:51], v[16:19], v[60:63], a[48:51]
    s_add_u32 m0, s39, 28672
    s_nop 0
    buffer_load_dwordx4 v3, s[16:19], s42 offen lds
    s_add_u32 s42, s42, s47
    v_mfma_f32_16x16x32_bf16 a[64:67], v[16:19], v[64:67], a[64:67]
    v_mfma_f32_16x16x32_bf16 a[4:7], v[20:23], v[48:51], a[4:7]
    s_add_u32 m0, s39, 29696
    s_nop 0
    buffer_load_dwordx4 v3, s[16:19], s42 offen lds
    s_add_u32 s42, s42, s47
    v_mfma_f32_16x16x32_bf16 a[20:23], v[20:23], v[52:55], a[20:23]
    v_mfma_f32_16x16x32_bf16 a[36:39], v[20:23], v[56:59], a[36:39]
    s_add_u32 m0, s39, 30720
    s_nop 0
    buffer_load_dwordx4 v3, s[16:19], s42 offen lds
    s_add_u32 s42, s42, s48
    v_mfma_f32_16x16x32_bf16 a[52:55], v[20:23], v[60:63], a[52:55]
    v_mfma_f32_16x16x32_bf16 a[68:71], v[20:23], v[64:67], a[68:71]
    s_add_u32 m0, s39, 31744
    s_nop 0
    buffer_load_dwordx4 v2, s[12:15], s52 offen lds
    s_add_u32 s52, s52, 256
    v_mfma_f32_16x16x32_bf16 a[8:11], v[24:27], v[48:51], a[8:11]
    v_mfma_f32_16x16x32_bf16 a[24:27], v[24:27], v[52:55], a[24:27]
    s_add_u32 m0, s39, 32768
    s_nop 0
    buffer_load_dwordx4 v2, s[12:15], s53 offen lds
    s_add_u32 s53, s53, 256
    v_mfma_f32_16x16x32_bf16 a[40:43], v[24:27], v[56:59], a[40:43]
    v_mfma_f32_16x16x32_bf16 a[56:59], v[24:27], v[60:63], a[56:59]
    s_add_u32 m0, s39, 33792
    s_nop 0
    buffer_load_dwordx4 v2, s[12:15], s54 offen lds
    s_add_u32 s54, s54, 256
    v_mfma_f32_16x16x32_bf16 a[72:75], v[24:27], v[64:67], a[72:75]
    v_mfma_f32_16x16x32_bf16 a[12:15], v[28:31], v[48:51], a[12:15]
    s_add_u32 m0, s39, 34816
    s_nop 0
    buffer_load_dwordx4 v2, s[12:15], s55 offen lds
    s_add_u32 s55, s55, 256
    v_mfma_f32_16x16x32_bf16 a[28:31], v[28:31], v[52:55], a[28:31]
    v_mfma_f32_16x16x32_bf16 a[44:47], v[28:31], v[56:59], a[44:47]
    s_add_u32 m0, s39, 35840
    s_nop 0
    buffer_load_dwordx4 v2, s[12:15], s56 offen lds
    s_add_u32 s56, s56, 256
    v_mfma_f32_16x16x32_bf16 a[60:63], v[28:31], v[60:63], a[60:63]
    v_mfma_f32_16x16x32_bf16 a[76:79], v[28:31], v[64:67], a[76:79]
    s_waitcnt vmcnt(9)
    ds_read_b64_tr_b16 v[16:17], v4 offset:18432
    ds_read_b64_tr_b16 v[18:19], v6 offset:18944
    ds_read_b64_tr_b16 v[20:21], v5 offset:18432
    ds_read_b64_tr_b16 v[22:23], v7 offset:18944
    ds_read_b64_tr_b16 v[24:25], v6 offset:18432
    ds_read_b64_tr_b16 v[26:27], v4 offset:18944
    ds_read_b64_tr_b16 v[28:29], v7 offset:18432
    ds_read_b64_tr_b16 v[30:31], v5 offset:18944
    ds_read_b128 v[48:51], v14 offset:22528
    ds_read_b128 v[52:55], v14 offset:23552
    ds_read_b128 v[56:59], v14 offset:24576
    ds_read_b128 v[60:63], v14 offset:25600
    ds_read_b128 v[64:67], v14 offset:26624
    s_waitcnt lgkmcnt(13)
    v_mfma_f32_16x16x32_bf16 a[0:3], v[32:35], v[68:71], a[0:3]
    v_mfma_f32_16x16x32_bf16 a[16:19], v[32:35], v[72:75], a[16:19]
    s_add_u32 m0, s39, 0
    s_nop 0
    buffer_load_dwordx4 v3, s[16:19], s42 offen lds
    s_add_u32 s42, s42, s47
    v_mfma_f32_16x16x32_bf16 a[32:35], v[32:35], v[76:79], a[32:35]
    v_mfma_f32_16x16x32_bf16 a[48:51], v[32:35], v[80:83], a[48:51]
    s_add_u32 m0, s39, 1024
    s_nop 0
    buffer_load_dwordx4 v3, s[16:19], s42 offen lds
    s_add_u32 s42, s42, s47
    v_mfma_f32_16x16x32_bf16 a[64:67], v[32:35], v[84:87], a[64:67]
    v_mfma_f32_16x16x32_bf16 a[4:7], v[36:39], v[68:71], a[4:7]
    s_add_u32 m0, s39, 2048
    s_nop 0
    buffer_load_dwordx4 v3, s[16:19], s42 offen lds
    s_add_u32 s42, s42, s47
    v_mfma_f32_16x16x32_bf16 a[20:23], v[36:39], v[72:75], a[20:23]
    v_mfma_f32_16x16x32_bf16 a[36:39], v[36:39], v[76:79], a[36:39]
    s_add_u32 m0, s39, 3072
    s_nop 0
    buffer_load_dwordx4 v3, s[16:19], s42 offen lds
    s_add_u32 s42, s42, s48
    v_mfma_f32_16x16x32_bf16 a[52:55], v[36:39], v[80:83], a[52:55]
    v_mfma_f32_16x16x32_bf16 a[68:71], v[36:39], v[84:87], a[68:71]
    s_add_u32 m0, s39, 4096
    s_nop 0
    buffer_load_dwordx4 v2, s[12:15], s52 offen lds
    s_add_u32 s52, s52, 256
    v_mfma_f32_16x16x32_bf16 a[8:11], v[40:43], v[68:71], a[8:11]
    v_mfma_f32_16x16x32_bf16 a[24:27], v[40:43], v[72:75], a[24:27]
    s_add_u32 m0, s39, 5120
    s_nop 0
    buffer_load_dwordx4 v2, s[12:15], s53 offen lds
    s_add_u32 s53, s53, 256
    v_mfma_f32_16x16x32_bf16 a[40:43], v[40:43], v[76:79], a[40:43]
    v_mfma_f32_16x16x32_bf16 a[56:59], v[40:43], v[80:83], a[56:59]
    s_add_u32 m0, s39, 6144
    s_nop 0
    buffer_load_dwordx4 v2, s[12:15], s54 offen lds
    s_add_u32 s54, s54, 256
    v_mfma_f32_16x16x32_bf16 a[72:75], v[40:43], v[84:87], a[72:75]
    v_mfma_f32_16x16x32_bf16 a[12:15], v[44:47], v[68:71], a[12:15]
    s_add_u32 m0, s39, 7168
    s_nop 0
    buffer_load_dwordx4 v2, s[12:15], s55 offen lds
    s_add_u32 s55, s55, 256
    v_mfma_f32_16x16x32_bf16 a[28:31], v[44:47], v[72:75], a[28:31]
    v_mfma_f32_16x16x32_bf16 a[44:47], v[44:47], v[76:79], a[44:47]
    s_add_u32 m0, s39, 8192
    s_nop 0
    buffer_load_dwordx4 v2, s[12:15], s56 offen lds
    s_add_u32 s56, s56, 256
    v_mfma_f32_16x16x32_bf16 a[60:63], v[44:47], v[80:83], a[60:63]
    v_mfma_f32_16x16x32_bf16 a[76:79], v[44:47], v[84:87], a[76:79]
    s_waitcnt vmcnt(9)
    ds_read_b64_tr_b16 v[32:33], v4 offset:27648
    ds_read_b64_tr_b16 v[34:35], v6 offset:28160
    ds_read_b64_tr_b16 v[36:37], v5 offset:27648
    ds_read_b64_tr_b16 v[38:39], v7 offset:28160
    ds_read_b64_tr_b16 v[40:41], v6 offset:27648
    ds_read_b64_tr_b16 v[42:43], v4 offset:28160
    ds_read_b64_tr_b16 v[44:45], v7 offset:27648
    ds_read_b64_tr_b16 v[46:47], v5 offset:28160
    ds_read_b128 v[68:71], v14 offset:31744
    ds_read_b128 v[72:75], v14 offset:32768
    ds_read_b128 v[76:79], v14 offset:33792
    ds_read_b128 v[80:83], v14 offset:34816
    ds_read_b128 v[84:87], v14 offset:35840
    s_waitcnt lgkmcnt(13)
    v_mfma_f32_16x16x32_bf16 a[0:3], v[16:19], v[48:51], a[0:3]
    v_mfma_f32_16x16x32_bf16 a[16:19], v[16:19], v[52:55], a[16:19]
    v_mfma_f32_16x16x32_bf16 a[32:35], v[16:19], v[56:59], a[32:35]
    v_mfma_f32_16x16x32_bf16 a[48:51], v[16:19], v[60:63], a[48:51]
    v_mfma_f32_16x16x32_bf16 a[64:67], v[16:19], v[64:67], a[64:67]
    v_mfma_f32_16x16x32_bf16 a[4:7], v[20:23], v[48:51], a[4:7]
    v_mfma_f32_16x16x32_bf16 a[20:23], v[20:23], v[52:55], a[20:23]
    v_mfma_f32_16x16x32_bf16 a[36:39], v[20:23], v[56:59], a[36:39]
    v_mfma_f32_16x16x32_bf16 a[52:55], v[20:23], v[60:63], a[52:55]
    v_mfma_f32_16x16x32_bf16 a[68:71], v[20:23], v[64:67], a[68:71]
    v_mfma_f32_16x16x32_bf16 a[8:11], v[24:27], v[48:51], a[8:11]
    v_mfma_f32_16x16x32_bf16 a[24:27], v[24:27], v[52:55], a[24:27]
    v_mfma_f32_16x16x32_bf16 a[40:43], v[24:27], v[56:59], a[40:43]
    v_mfma_f32_16x16x32_bf16 a[56:59], v[24:27], v[60:63], a[56:59]
    v_mfma_f32_16x16x32_bf16 a[72:75], v[24:27], v[64:67], a[72:75]
    v_mfma_f32_16x16x32_bf16 a[12:15], v[28:31], v[48:51], a[12:15]
    v_mfma_f32_16x16x32_bf16 a[28:31], v[28:31], v[52:55], a[28:31]
    v_mfma_f32_16x16x32_bf16 a[44:47], v[28:31], v[56:59], a[44:47]
    v_mfma_f32_16x16x32_bf16 a[60:63], v[28:31], v[60:63], a[60:63]
    v_mfma_f32_16x16x32_bf16 a[76:79], v[28:31], v[64:67], a[76:79]
    s_waitcnt vmcnt(0)
    ds_read_b64_tr_b16 v[16:17], v4 offset:0
    ds_read_b64_tr_b16 v[18:19], v6 offset:512
    ds_read_b64_tr_b16 v[20:21], v5 offset:0
    ds_read_b64_tr_b16 v[22:23], v7 offset:512
    ds_read_b64_tr_b16 v[24:25], v6 offset:0
    ds_read_b64_tr_b16 v[26:27], v4 offset:512
    ds_read_b64_tr_b16 v[28:29], v7 offset:0
    ds_read_b64_tr_b16 v[30:31], v5 offset:512
    ds_read_b128 v[48:51], v14 offset:4096
    ds_read_b128 v[52:55], v14 offset:5120
    ds_read_b128 v[56:59], v14 offset:6144
    ds_read_b128 v[60:63], v14 offset:7168
    ds_read_b128 v[64:67], v14 offset:8192
    s_waitcnt lgkmcnt(13)
    v_mfma_f32_16x16x32_bf16 a[0:3], v[32:35], v[68:71], a[0:3]
    v_mfma_f32_16x16x32_bf16 a[16:19], v[32:35], v[72:75], a[16:19]
    v_mfma_f32_16x16x32_bf16 a[32:35], v[32:35], v[76:79], a[32:35]
    v_mfma_f32_16x16x32_bf16 a[48:51], v[32:35], v[80:83], a[48:51]
    v_mfma_f32_16x16x32_bf16 a[64:67], v[32:35], v[84:87], a[64:67]
    v_mfma_f32_16x16x32_bf16 a[4:7], v[36:39], v[68:71], a[4:7]
    v_mfma_f32_16x16x32_bf16 a[20:23], v[36:39], v[72:75], a[20:23]
    v_mfma_f32_16x16x32_bf16 a[36:39], v[36:39], v[76:79], a[36:39]
    v_mfma_f32_16x16x32_bf16 a[52:55], v[36:39], v[80:83], a[52:55]
    v_mfma_f32_16x16x32_bf16 a[68:71], v[36:39], v[84:87], a[68:71]
    v_mfma_f32_16x16x32_bf16 a[8:11], v[40:43], v[68:71], a[8:11]
    v_mfma_f32_16x16x32_bf16 a[24:27], v[40:43], v[72:75], a[24:27]
    v_mfma_f32_16x16x32_bf16 a[40:43], v[40:43], v[76:79], a[40:43]
    v_mfma_f32_16x16x32_bf16 a[56:59], v[40:43], v[80:83], a[56:59]
    v_mfma_f32_16x16x32_bf16 a[72:75], v[40:43], v[84:87], a[72:75]
    v_mfma_f32_16x16x32_bf16 a[12:15], v[44:47], v[68:71], a[12:15]
    v_mfma_f32_16x16x32_bf16 a[28:31], v[44:47], v[72:75], a[28:31]
    v_mfma_f32_16x16x32_bf16 a[44:47], v[44:47], v[76:79], a[44:47]
    v_mfma_f32_16x16x32_bf16 a[60:63], v[44:47], v[80:83], a[60:63]
    v_mfma_f32_16x16x32_bf16 a[76:79], v[44:47], v[84:87], a[76:79]
    s_waitcnt lgkmcnt(0)
    s_cmp_ge_u32 s34, 2
    s_cbranch_scc1 L_sk5_84
    v_mfma_f32_16x16x32_bf16 a[0:3], v[16:19], v[48:51], a[0:3]
    v_mfma_f32_16x16x32_bf16 a[16:19], v[16:19], v[52:55], a[16:19]
    v_mfma_f32_16x16x32_bf16 a[32:35], v[16:19], v[56:59], a[32:35]
    v_mfma_f32_16x16x32_bf16 a[48:51], v[16:19], v[60:63], a[48:51]
    v_mfma_f32_16x16x32_bf16 a[64:67], v[16:19], v[64:67], a[64:67]
    v_mfma_f32_16x16x32_bf16 a[4:7], v[20:23], v[48:51], a[4:7]
    v_mfma_f32_16x16x32_bf16 a[20:23], v[20:23], v[52:55], a[20:23]
    v_mfma_f32_16x16x32_bf16 a[36:39], v[20:23], v[56:59], a[36:39]
    v_mfma_f32_16x16x32_bf16 a[52:55], v[20:23], v[60:63], a[52:55]
    v_mfma_f32_16x16x32_bf16 a[68:71], v[20:23], v[64:67], a[68:71]
    v_mfma_f32_16x16x32_bf16 a[8:11], v[24:27], v[48:51], a[8:11]
    v_mfma_f32_16x16x32_bf16 a[24:27], v[24:27], v[52:55], a[24:27]
    v_mfma_f32_16x16x32_bf16 a[40:43], v[24:27], v[56:59], a[40:43]
    v_mfma_f32_16x16x32_bf16 a[56:59], v[24:27], v[60:63], a[56:59]
    v_mfma_f32_16x16x32_bf16 a[72:75], v[24:27], v[64:67], a[72:75]
    v_mfma_f32_16x16x32_bf16 a[12:15], v[28:31], v[48:51], a[12:15]
    v_mfma_f32_16x16x32_bf16 a[28:31], v[28:31], v[52:55], a[28:31]
    v_mfma_f32_16x16x32_bf16 a[44:47], v[28:31], v[56:59], a[44:47]
    v_mfma_f32_16x16x32_bf16 a[60:63], v[28:31], v[60:63], a[60:63]
    v_mfma_f32_16x16x32_bf16 a[76:79], v[28:31], v[64:67], a[76:79]
L_sk5_84:
    s_nop 15
    v_lshlrev_b32 v1, 4, v0
    v_add_u32 v13, s39, v1
    ds_write_b128 v13, a[0:3] offset:0
    ds_write_b128 v13, a[4:7] offset:1024
    ds_write_b128 v13, a[8:11] offset:2048
    ds_write_b128 v13, a[12:15] offset:3072
    ds_write_b128 v13, a[16:19] offset:4096
    ds_write_b128 v13, a[20:23] offset:5120
    ds_write_b128 v13, a[24:27] offset:6144
    ds_write_b128 v13, a[28:31] offset:7168
    ds_write_b128 v13, a[32:35] offset:8192
    ds_write_b128 v13, a[36:39] offset:9216
    ds_write_b128 v13, a[40:43] offset:10240
    ds_write_b128 v13, a[44:47] offset:11264
    ds_write_b128 v13, a[48:51] offset:12288
    ds_write_b128 v13, a[52:55] offset:13312
    ds_write_b128 v13, a[56:59] offset:14336
    ds_write_b128 v13, a[60:63] offset:15360
    ds_write_b128 v13, a[64:67] offset:16384
    ds_write_b128 v13, a[68:71] offset:17408
    ds_write_b128 v13, a[72:75] offset:18432
    ds_write_b128 v13, a[76:79] offset:19456
    s_waitcnt lgkmcnt(0)
    s_barrier
    s_lshl_b32 s44, s34, 10
    v_add_u32 v12, s44, v1
    v_add_u32 v13, 73728, v12
    ds_read_b128 v[16:19], v12 offset:0
    ds_read_b128 v[20:23], v12 offset:36864
    ds_read_b128 v[24:27], v13 offset:0
    ds_read_b128 v[28:31], v13 offset:36864
    ds_read_b128 v[32:35], v12 offset:4096
    ds_read_b128 v[36:39], v12 offset:40960
    ds_read_b128 v[40:43], v13 offset:4096
    ds_read_b128 v[44:47], v13 offset:40960
    ds_read_b128 v[48:51], v12 offset:8192
    ds_read_b128 v[52:55], v12 offset:45056
    ds_read_b128 v[56:59], v13 offset:8192
    ds_read_b128 v[60:63], v13 offset:45056
    ds_read_b128 v[64:67], v12 offset:12288
    ds_read_b128 v[68:71], v12 offset:49152
    ds_read_b128 v[72:75], v13 offset:12288
    ds_read_b128 v[76:79], v13 offset:49152
    ds_read_b128 v[80:83], v12 offset:16384
    ds_read_b128 v[84:87], v12 offset:53248
    ds_read_b128 v[88:91], v13 offset:16384
    ds_read_b128 v[92:95], v13 offset:53248
    s_waitcnt lgkmcnt(0)
    v_add_f32 v16, v16, v20
    v_add_f32 v24, v24, v28
    v_add_f32 v16, v16, v24
    v_add_f32 v17, v17, v21
    v_add_f32 v25, v25, v29
    v_add_f32 v17, v17, v25
    v_add_f32 v18, v18, v22
    v_add_f32 v26, v26, v30
    v_add_f32 v18, v18, v26
    v_add_f32 v19, v19, v23
    v_add_f32 v27, v27, v31
    v_add_f32 v19, v19, v27
    v_add_f32 v32, v32, v36
    v_add_f32 v40, v40, v44
    v_add_f32 v32, v32, v40
    v_add_f32 v33, v33, v37
    v_add_f32 v41, v41, v45
    v_add_f32 v33, v33, v41
    v_add_f32 v34, v34, v38
    v_add_f32 v42, v42, v46
    v_add_f32 v34, v34, v42
    v_add_f32 v35, v35, v39
    v_add_f32 v43, v43, v47
    v_add_f32 v35, v35, v43
    v_add_f32 v48, v48, v52
    v_add_f32 v56, v56, v60
    v_add_f32 v48, v48, v56
    v_add_f32 v49, v49, v53
    v_add_f32 v57, v57, v61
    v_add_f32 v49, v49, v57
    v_add_f32 v50, v50, v54
    v_add_f32 v58, v58, v62
    v_add_f32 v50, v50, v58
    v_add_f32 v51, v51, v55
    v_add_f32 v59, v59, v63
    v_add_f32 v51, v51, v59
    v_add_f32 v64, v64, v68
    v_add_f32 v72, v72, v76
    v_add_f32 v64, v64, v72
    v_add_f32 v65, v65, v69
    v_add_f32 v73, v73, v77
    v_add_f32 v65, v65, v73
    v_add_f32 v66, v66, v70
    v_add_f32 v74, v74, v78
    v_add_f32 v66, v66, v74
    v_add_f32 v67, v67, v71
    v_add_f32 v75, v75, v79
    v_add_f32 v67, v67, v75
    v_add_f32 v80, v80, v84
    v_add_f32 v88, v88, v92
    v_add_f32 v80, v80, v88
    v_add_f32 v81, v81, v85
    v_add_f32 v89, v89, v93
    v_add_f32 v81, v81, v89
    v_add_f32 v82, v82, v86
    v_add_f32 v90, v90, v94
    v_add_f32 v82, v82, v90
    v_add_f32 v83, v83, v87
    v_add_f32 v91, v91, v95
    v_add_f32 v83, v83, v91
    s_mul_i32 s44, s32, 80
    v_and_b32 v9, 15, v0
    v_add_u32 v9, s44, v9
    s_movk_i32 s45, 1152
    v_mul_lo_u32 v9, v9, s45
    v_lshl_add_u32 v9, v8, 3, v9
    s_lshl_b32 s44, s34, 5
    s_add_u32 s43, s43, s44
    s_mov_b32 s45, 0x3eae1a93
    v_mul_f32 v16, s45, v16
    v_mul_f32 v17, s45, v17
    v_mul_f32 v18, s45, v18
    v_mul_f32 v19, s45, v19
    v_cvt_pk_bf16_f32 v100, v16, v17
    v_cvt_pk_bf16_f32 v101, v18, v19
    s_add_u32 s44, s43, 0
    buffer_store_dwordx2 v[100:101], v9, s[20:23], s44 offen
    v_mul_f32 v32, s45, v32
    v_mul_f32 v33, s45, v33
    v_mul_f32 v34, s45, v34
    v_mul_f32 v35, s45, v35
    v_cvt_pk_bf16_f32 v102, v32, v33
    v_cvt_pk_bf16_f32 v103, v34, v35
    s_add_u32 s44, s43, 18432
    buffer_store_dwordx2 v[102:103], v9, s[20:23], s44 offen
    v_mul_f32 v48, s45, v48
    v_mul_f32 v49, s45, v49
    v_mul_f32 v50, s45, v50
    v_mul_f32 v51, s45, v51
    v_cvt_pk_bf16_f32 v104, v48, v49
    v_cvt_pk_bf16_f32 v105, v50, v51
    s_add_u32 s44, s43, 36864
    buffer_store_dwordx2 v[104:105], v9, s[20:23], s44 offen
    v_mul_f32 v64, s45, v64
    v_mul_f32 v65, s45, v65
    v_mul_f32 v66, s45, v66
    v_mul_f32 v67, s45, v67
    v_cvt_pk_bf16_f32 v106, v64, v65
    v_cvt_pk_bf16_f32 v107, v66, v67
    s_add_u32 s44, s43, 55296
    buffer_store_dwordx2 v[106:107], v9, s[20:23], s44 offen
    v_mul_f32 v80, s45, v80
    v_mul_f32 v81, s45, v81
    v_mul_f32 v82, s45, v82
    v_mul_f32 v83, s45, v83
    v_cvt_pk_bf16_f32 v108, v80, v81
    v_cvt_pk_bf16_f32 v109, v82, v83
    s_add_u32 s44, s43, 73728
    buffer_store_dwordx2 v[108:109], v9, s[20:23], s44 offen
    s_branch L_k2_after
L_kv_83:
    s_waitcnt vmcnt(18)
    ds_read_b64_tr_b16 v[16:17], v4 offset:0
    ds_read_b64_tr_b16 v[18:19], v6 offset:512
    ds_read_b64_tr_b16 v[20:21], v5 offset:0
    ds_read_b64_tr_b16 v[22:23], v7 offset:512
    ds_read_b64_tr_b16 v[24:25], v6 offset:0
    ds_read_b64_tr_b16 v[26:27], v4 offset:512
    ds_read_b64_tr_b16 v[28:29], v7 offset:0
    ds_read_b64_tr_b16 v[30:31], v5 offset:512
    ds_read_b128 v[48:51], v14 offset:4096
    ds_read_b128 v[52:55], v14 offset:5120
    ds_read_b128 v[56:59], v14 offset:6144
    ds_read_b128 v[60:63], v14 offset:7168
    ds_read_b128 v[64:67], v14 offset:8192
    s_waitcnt vmcnt(9)
    ds_read_b64_tr_b16 v[32:33], v4 offset:9216
    ds_read_b64_tr_b16 v[34:35], v6 offset:9728
    ds_read_b64_tr_b16 v[36:37], v5 offset:9216
    ds_read_b64_tr_b16 v[38:39], v7 offset:9728
    ds_read_b64_tr_b16 v[40:41], v6 offset:9216
    ds_read_b64_tr_b16 v[42:43], v4 offset:9728
    ds_read_b64_tr_b16 v[44:45], v7 offset:9216
    ds_read_b64_tr_b16 v[46:47], v5 offset:9728
    ds_read_b128 v[68:71], v14 offset:13312
    ds_read_b128 v[72:75], v14 offset:14336
    ds_read_b128 v[76:79], v14 offset:15360
    ds_read_b128 v[80:83], v14 offset:16384
    ds_read_b128 v[84:87], v14 offset:17408
    s_waitcnt lgkmcnt(13)
    v_mfma_f32_16x16x32_bf16 a[0:3], v[16:19], v[48:51], a[0:3]
    v_mfma_f32_16x16x32_bf16 a[16:19], v[16:19], v[52:55], a[16:19]
    s_add_u32 m0, s39, 27648
    s_nop 0
    buffer_load_dwordx4 v3, s[16:19], s42 offen lds
    s_add_u32 s42, s42, s47
    v_mfma_f32_16x16x32_bf16 a[32:35], v[16:19], v[56:59], a[32:35]
    v_mfma_f32_16x16x32_bf16 a[48:51], v[16:19], v[60:63], a[48:51]
    s_add_u32 m0, s39, 28672
    s_nop 0
    buffer_load_dwordx4 v3, s[16:19], s42 offen lds
    s_add_u32 s42, s42, s47
    v_mfma_f32_16x16x32_bf16 a[64:67], v[16:19], v[64:67], a[64:67]
    v_mfma_f32_16x16x32_bf16 a[4:7], v[20:23], v[48:51], a[4:7]
    s_add_u32 m0, s39, 29696
    s_nop 0
    buffer_load_dwordx4 v3, s[16:19], s42 offen lds
    s_add_u32 s42, s42, s47
    v_mfma_f32_16x16x32_bf16 a[20:23], v[20:23], v[52:55], a[20:23]
    v_mfma_f32_16x16x32_bf16 a[36:39], v[20:23], v[56:59], a[36:39]
    s_add_u32 m0, s39, 30720
    s_nop 0
    buffer_load_dwordx4 v3, s[16:19], s42 offen lds
    s_add_u32 s42, s42, s48
    v_mfma_f32_16x16x32_bf16 a[52:55], v[20:23], v[60:63], a[52:55]
    v_mfma_f32_16x16x32_bf16 a[68:71], v[20:23], v[64:67], a[68:71]
    s_add_u32 m0, s39, 31744
    s_nop 0
    buffer_load_dwordx4 v2, s[12:15], s52 offen lds
    s_add_u32 s52, s52, 256
    v_mfma_f32_16x16x32_bf16 a[8:11], v[48:51], v[24:27], a[8:11]
    v_mfma_f32_16x16x32_bf16 a[24:27], v[52:55], v[24:27], a[24:27]
    s_add_u32 m0, s39, 32768
    s_nop 0
    buffer_load_dwordx4 v2, s[12:15], s53 offen lds
    s_add_u32 s53, s53, 256
    v_mfma_f32_16x16x32_bf16 a[40:43], v[56:59], v[24:27], a[40:43]
    v_mfma_f32_16x16x32_bf16 a[56:59], v[60:63], v[24:27], a[56:59]
    s_add_u32 m0, s39, 33792
    s_nop 0
    buffer_load_dwordx4 v2, s[12:15], s54 offen lds
    s_add_u32 s54, s54, 256
    v_mfma_f32_16x16x32_bf16 a[72:75], v[64:67], v[24:27], a[72:75]
    v_mfma_f32_16x16x32_bf16 a[12:15], v[48:51], v[28:31], a[12:15]
    s_add_u32 m0, s39, 34816
    s_nop 0
    buffer_load_dwordx4 v2, s[12:15], s55 offen lds
    s_add_u32 s55, s55, 256
    v_mfma_f32_16x16x32_bf16 a[28:31], v[52:55], v[28:31], a[28:31]
    v_mfma_f32_16x16x32_bf16 a[44:47], v[56:59], v[28:31], a[44:47]
    s_add_u32 m0, s39, 35840
    s_nop 0
    buffer_load_dwordx4 v2, s[12:15], s56 offen lds
    s_add_u32 s56, s56, 256
    v_mfma_f32_16x16x32_bf16 a[60:63], v[60:63], v[28:31], a[60:63]
    v_mfma_f32_16x16x32_bf16 a[76:79], v[64:67], v[28:31], a[76:79]
    s_waitcnt vmcnt(9)
    ds_read_b64_tr_b16 v[16:17], v4 offset:18432
    ds_read_b64_tr_b16 v[18:19], v6 offset:18944
    ds_read_b64_tr_b16 v[20:21], v5 offset:18432
    ds_read_b64_tr_b16 v[22:23], v7 offset:18944
    ds_read_b64_tr_b16 v[24:25], v6 offset:18432
    ds_read_b64_tr_b16 v[26:27], v4 offset:18944
    ds_read_b64_tr_b16 v[28:29], v7 offset:18432
    ds_read_b64_tr_b16 v[30:31], v5 offset:18944
    ds_read_b128 v[48:51], v14 offset:22528
    ds_read_b128 v[52:55], v14 offset:23552
    ds_read_b128 v[56:59], v14 offset:24576
    ds_read_b128 v[60:63], v14 offset:25600
    ds_read_b128 v[64:67], v14 offset:26624
    s_waitcnt lgkmcnt(13)
    v_mfma_f32_16x16x32_bf16 a[0:3], v[32:35], v[68:71], a[0:3]
    v_mfma_f32_16x16x32_bf16 a[16:19], v[32:35], v[72:75], a[16:19]
    s_add_u32 m0, s39, 0
    s_nop 0
    buffer_load_dwordx4 v3, s[16:19], s42 offen lds
    s_add_u32 s42, s42, s47
    v_mfma_f32_16x16x32_bf16 a[32:35], v[32:35], v[76:79], a[32:35]
    v_mfma_f32_16x16x32_bf16 a[48:51], v[32:35], v[80:83], a[48:51]
    s_add_u32 m0, s39, 1024
    s_nop 0
    buffer_load_dwordx4 v3, s[16:19], s42 offen lds
    s_add_u32 s42, s42, s47
    v_mfma_f32_16x16x32_bf16 a[64:67], v[32:35], v[84:87], a[64:67]
    v_mfma_f32_16x16x32_bf16 a[4:7], v[36:39], v[68:71], a[4:7]
    s_add_u32 m0, s39, 2048
    s_nop 0
    buffer_load_dwordx4 v3, s[16:19], s42 offen lds
    s_add_u32 s42, s42, s47
    v_mfma_f32_16x16x32_bf16 a[20:23], v[36:39], v[72:75], a[20:23]
    v_mfma_f32_16x16x32_bf16 a[36:39], v[36:39], v[76:79], a[36:39]
    s_add_u32 m0, s39, 3072
    s_nop 0
    buffer_load_dwordx4 v3, s[16:19], s42 offen lds
    s_add_u32 s42, s42, s48
    v_mfma_f32_16x16x32_bf16 a[52:55], v[36:39], v[80:83], a[52:55]
    v_mfma_f32_16x16x32_bf16 a[68:71], v[36:39], v[84:87], a[68:71]
    s_add_u32 m0, s39, 4096
    s_nop 0
    buffer_load_dwordx4 v2, s[12:15], s52 offen lds
    s_add_u32 s52, s52, 256
    v_mfma_f32_16x16x32_bf16 a[8:11], v[68:71], v[40:43], a[8:11]
    v_mfma_f32_16x16x32_bf16 a[24:27], v[72:75], v[40:43], a[24:27]
    s_add_u32 m0, s39, 5120
    s_nop 0
    buffer_load_dwordx4 v2, s[12:15], s53 offen lds
    s_add_u32 s53, s53, 256
    v_mfma_f32_16x16x32_bf16 a[40:43], v[76:79], v[40:43], a[40:43]
    v_mfma_f32_16x16x32_bf16 a[56:59], v[80:83], v[40:43], a[56:59]
    s_add_u32 m0, s39, 6144
    s_nop 0
    buffer_load_dwordx4 v2, s[12:15], s54 offen lds
    s_add_u32 s54, s54, 256
    v_mfma_f32_16x16x32_bf16 a[72:75], v[84:87], v[40:43], a[72:75]
    v_mfma_f32_16x16x32_bf16 a[12:15], v[68:71], v[44:47], a[12:15]
    s_add_u32 m0, s39, 7168
    s_nop 0
    buffer_load_dwordx4 v2, s[12:15], s55 offen lds
    s_add_u32 s55, s55, 256
    v_mfma_f32_16x16x32_bf16 a[28:31], v[72:75], v[44:47], a[28:31]
    v_mfma_f32_16x16x32_bf16 a[44:47], v[76:79], v[44:47], a[44:47]
    s_add_u32 m0, s39, 8192
    s_nop 0
    buffer_load_dwordx4 v2, s[12:15], s56 offen lds
    s_add_u32 s56, s56, 256
    v_mfma_f32_16x16x32_bf16 a[60:63], v[80:83], v[44:47], a[60:63]
    v_mfma_f32_16x16x32_bf16 a[76:79], v[84:87], v[44:47], a[76:79]
    s_waitcnt vmcnt(9)
    ds_read_b64_tr_b16 v[32:33], v4 offset:27648
    ds_read_b64_tr_b16 v[34:35], v6 offset:28160
    ds_read_b64_tr_b16 v[36:37], v5 offset:27648
    ds_read_b64_tr_b16 v[38:39], v7 offset:28160
    ds_read_b64_tr_b16 v[40:41], v6 offset:27648
    ds_read_b64_tr_b16 v[42:43], v4 offset:28160
    ds_read_b64_tr_b16 v[44:45], v7 offset:27648
    ds_read_b64_tr_b16 v[46:47], v5 offset:28160
    ds_read_b128 v[68:71], v14 offset:31744
    ds_read_b128 v[72:75], v14 offset:32768
    ds_read_b128 v[76:79], v14 offset:33792
    ds_read_b128 v[80:83], v14 offset:34816
    ds_read_b128 v[84:87], v14 offset:35840
    s_waitcnt lgkmcnt(13)
    v_mfma_f32_16x16x32_bf16 a[0:3], v[16:19], v[48:51], a[0:3]
    v_mfma_f32_16x16x32_bf16 a[16:19], v[16:19], v[52:55], a[16:19]
    v_mfma_f32_16x16x32_bf16 a[32:35], v[16:19], v[56:59], a[32:35]
    v_mfma_f32_16x16x32_bf16 a[48:51], v[16:19], v[60:63], a[48:51]
    v_mfma_f32_16x16x32_bf16 a[64:67], v[16:19], v[64:67], a[64:67]
    v_mfma_f32_16x16x32_bf16 a[4:7], v[20:23], v[48:51], a[4:7]
    v_mfma_f32_16x16x32_bf16 a[20:23], v[20:23], v[52:55], a[20:23]
    v_mfma_f32_16x16x32_bf16 a[36:39], v[20:23], v[56:59], a[36:39]
    v_mfma_f32_16x16x32_bf16 a[52:55], v[20:23], v[60:63], a[52:55]
    v_mfma_f32_16x16x32_bf16 a[68:71], v[20:23], v[64:67], a[68:71]
    v_mfma_f32_16x16x32_bf16 a[8:11], v[48:51], v[24:27], a[8:11]
    v_mfma_f32_16x16x32_bf16 a[24:27], v[52:55], v[24:27], a[24:27]
    v_mfma_f32_16x16x32_bf16 a[40:43], v[56:59], v[24:27], a[40:43]
    v_mfma_f32_16x16x32_bf16 a[56:59], v[60:63], v[24:27], a[56:59]
    v_mfma_f32_16x16x32_bf16 a[72:75], v[64:67], v[24:27], a[72:75]
    v_mfma_f32_16x16x32_bf16 a[12:15], v[48:51], v[28:31], a[12:15]
    v_mfma_f32_16x16x32_bf16 a[28:31], v[52:55], v[28:31], a[28:31]
    v_mfma_f32_16x16x32_bf16 a[44:47], v[56:59], v[28:31], a[44:47]
    v_mfma_f32_16x16x32_bf16 a[60:63], v[60:63], v[28:31], a[60:63]
    v_mfma_f32_16x16x32_bf16 a[76:79], v[64:67], v[28:31], a[76:79]
    s_waitcnt vmcnt(0)
    ds_read_b64_tr_b16 v[16:17], v4 offset:0
    ds_read_b64_tr_b16 v[18:19], v6 offset:512
    ds_read_b64_tr_b16 v[20:21], v5 offset:0
    ds_read_b64_tr_b16 v[22:23], v7 offset:512
    ds_read_b64_tr_b16 v[24:25], v6 offset:0
    ds_read_b64_tr_b16 v[26:27], v4 offset:512
    ds_read_b64_tr_b16 v[28:29], v7 offset:0
    ds_read_b64_tr_b16 v[30:31], v5 offset:512
    ds_read_b128 v[48:51], v14 offset:4096
    ds_read_b128 v[52:55], v14 offset:5120
    ds_read_b128 v[56:59], v14 offset:6144
    ds_read_b128 v[60:63], v14 offset:7168
    ds_read_b128 v[64:67], v14 offset:8192
    s_waitcnt lgkmcnt(13)
    v_mfma_f32_16x16x32_bf16 a[0:3], v[32:35], v[68:71], a[0:3]
    v_mfma_f32_16x16x32_bf16 a[16:19], v[32:35], v[72:75], a[16:19]
    v_mfma_f32_16x16x32_bf16 a[32:35], v[32:35], v[76:79], a[32:35]
    v_mfma_f32_16x16x32_bf16 a[48:51], v[32:35], v[80:83], a[48:51]
    v_mfma_f32_16x16x32_bf16 a[64:67], v[32:35], v[84:87], a[64:67]
    v_mfma_f32_16x16x32_bf16 a[4:7], v[36:39], v[68:71], a[4:7]
    v_mfma_f32_16x16x32_bf16 a[20:23], v[36:39], v[72:75], a[20:23]
    v_mfma_f32_16x16x32_bf16 a[36:39], v[36:39], v[76:79], a[36:39]
    v_mfma_f32_16x16x32_bf16 a[52:55], v[36:39], v[80:83], a[52:55]
    v_mfma_f32_16x16x32_bf16 a[68:71], v[36:39], v[84:87], a[68:71]
    v_mfma_f32_16x16x32_bf16 a[8:11], v[68:71], v[40:43], a[8:11]
    v_mfma_f32_16x16x32_bf16 a[24:27], v[72:75], v[40:43], a[24:27]
    v_mfma_f32_16x16x32_bf16 a[40:43], v[76:79], v[40:43], a[40:43]
    v_mfma_f32_16x16x32_bf16 a[56:59], v[80:83], v[40:43], a[56:59]
    v_mfma_f32_16x16x32_bf16 a[72:75], v[84:87], v[40:43], a[72:75]
    v_mfma_f32_16x16x32_bf16 a[12:15], v[68:71], v[44:47], a[12:15]
    v_mfma_f32_16x16x32_bf16 a[28:31], v[72:75], v[44:47], a[28:31]
    v_mfma_f32_16x16x32_bf16 a[44:47], v[76:79], v[44:47], a[44:47]
    v_mfma_f32_16x16x32_bf16 a[60:63], v[80:83], v[44:47], a[60:63]
    v_mfma_f32_16x16x32_bf16 a[76:79], v[84:87], v[44:47], a[76:79]
    s_waitcnt lgkmcnt(0)
    s_cmp_ge_u32 s34, 2
    s_cbranch_scc1 L_sk5_85
    v_mfma_f32_16x16x32_bf16 a[0:3], v[16:19], v[48:51], a[0:3]
    v_mfma_f32_16x16x32_bf16 a[16:19], v[16:19], v[52:55], a[16:19]
    v_mfma_f32_16x16x32_bf16 a[32:35], v[16:19], v[56:59], a[32:35]
    v_mfma_f32_16x16x32_bf16 a[48:51], v[16:19], v[60:63], a[48:51]
    v_mfma_f32_16x16x32_bf16 a[64:67], v[16:19], v[64:67], a[64:67]
    v_mfma_f32_16x16x32_bf16 a[4:7], v[20:23], v[48:51], a[4:7]
    v_mfma_f32_16x16x32_bf16 a[20:23], v[20:23], v[52:55], a[20:23]
    v_mfma_f32_16x16x32_bf16 a[36:39], v[20:23], v[56:59], a[36:39]
    v_mfma_f32_16x16x32_bf16 a[52:55], v[20:23], v[60:63], a[52:55]
    v_mfma_f32_16x16x32_bf16 a[68:71], v[20:23], v[64:67], a[68:71]
    v_mfma_f32_16x16x32_bf16 a[8:11], v[48:51], v[24:27], a[8:11]
    v_mfma_f32_16x16x32_bf16 a[24:27], v[52:55], v[24:27], a[24:27]
    v_mfma_f32_16x16x32_bf16 a[40:43], v[56:59], v[24:27], a[40:43]
    v_mfma_f32_16x16x32_bf16 a[56:59], v[60:63], v[24:27], a[56:59]
    v_mfma_f32_16x16x32_bf16 a[72:75], v[64:67], v[24:27], a[72:75]
    v_mfma_f32_16x16x32_bf16 a[12:15], v[48:51], v[28:31], a[12:15]
    v_mfma_f32_16x16x32_bf16 a[28:31], v[52:55], v[28:31], a[28:31]
    v_mfma_f32_16x16x32_bf16 a[44:47], v[56:59], v[28:31], a[44:47]
    v_mfma_f32_16x16x32_bf16 a[60:63], v[60:63], v[28:31], a[60:63]
    v_mfma_f32_16x16x32_bf16 a[76:79], v[64:67], v[28:31], a[76:79]
L_sk5_85:
    s_nop 15
    v_lshlrev_b32 v1, 4, v0
    v_add_u32 v13, s39, v1
    ds_write_b128 v13, a[0:3] offset:0
    ds_write_b128 v13, a[4:7] offset:1024
    ds_write_b128 v13, a[8:11] offset:2048
    ds_write_b128 v13, a[12:15] offset:3072
    ds_write_b128 v13, a[16:19] offset:4096
    ds_write_b128 v13, a[20:23] offset:5120
    ds_write_b128 v13, a[24:27] offset:6144
    ds_write_b128 v13, a[28:31] offset:7168
    ds_write_b128 v13, a[32:35] offset:8192
    ds_write_b128 v13, a[36:39] offset:9216
    ds_write_b128 v13, a[40:43] offset:10240
    ds_write_b128 v13, a[44:47] offset:11264
    ds_write_b128 v13, a[48:51] offset:12288
    ds_write_b128 v13, a[52:55] offset:13312
    ds_write_b128 v13, a[56:59] offset:14336
    ds_write_b128 v13, a[60:63] offset:15360
    ds_write_b128 v13, a[64:67] offset:16384
    ds_write_b128 v13, a[68:71] offset:17408
    ds_write_b128 v13, a[72:75] offset:18432
    ds_write_b128 v13, a[76:79] offset:19456
    s_waitcnt lgkmcnt(0)
    s_barrier
    s_lshl_b32 s44, s34, 10
    v_add_u32 v12, s44, v1
    v_add_u32 v13, 73728, v12
    ds_read_b128 v[16:19], v12 offset:0
    ds_read_b128 v[20:23], v12 offset:36864
    ds_read_b128 v[24:27], v13 offset:0
    ds_read_b128 v[28:31], v13 offset:36864
    ds_read_b128 v[32:35], v12 offset:4096
    ds_read_b128 v[36:39], v12 offset:40960
    ds_read_b128 v[40:43], v13 offset:4096
    ds_read_b128 v[44:47], v13 offset:40960
    ds_read_b128 v[48:51], v12 offset:8192
    ds_read_b128 v[52:55], v12 offset:45056
    ds_read_b128 v[56:59], v13 offset:8192
    ds_read_b128 v[60:63], v13 offset:45056
    ds_read_b128 v[64:67], v12 offset:12288
    ds_read_b128 v[68:71], v12 offset:49152
    ds_read_b128 v[72:75], v13 offset:12288
    ds_read_b128 v[76:79], v13 offset:49152
    ds_read_b128 v[80:83], v12 offset:16384
    ds_read_b128 v[84:87], v12 offset:53248
    ds_read_b128 v[88:91], v13 offset:16384
    ds_read_b128 v[92:95], v13 offset:53248
    s_waitcnt lgkmcnt(0)
    v_add_f32 v16, v16, v20
    v_add_f32 v24, v24, v28
    v_add_f32 v16, v16, v24
    v_add_f32 v17, v17, v21
    v_add_f32 v25, v25, v29
    v_add_f32 v17, v17, v25
    v_add_f32 v18, v18, v22
    v_add_f32 v26, v26, v30
    v_add_f32 v18, v18, v26
    v_add_f32 v19, v19, v23
    v_add_f32 v27, v27, v31
    v_add_f32 v19, v19, v27
    v_add_f32 v32, v32, v36
    v_add_f32 v40, v40, v44
    v_add_f32 v32, v32, v40
    v_add_f32 v33, v33, v37
    v_add_f32 v41, v41, v45
    v_add_f32 v33, v33, v41
    v_add_f32 v34, v34, v38
    v_add_f32 v42, v42, v46
    v_add_f32 v34, v34, v42
    v_add_f32 v35, v35, v39
    v_add_f32 v43, v43, v47
    v_add_f32 v35, v35, v43
    v_add_f32 v48, v48, v52
    v_add_f32 v56, v56, v60
    v_add_f32 v48, v48, v56
    v_add_f32 v49, v49, v53
    v_add_f32 v57, v57, v61
    v_add_f32 v49, v49, v57
    v_add_f32 v50, v50, v54
    v_add_f32 v58, v58, v62
    v_add_f32 v50, v50, v58
    v_add_f32 v51, v51, v55
    v_add_f32 v59, v59, v63
    v_add_f32 v51, v51, v59
    v_add_f32 v64, v64, v68
    v_add_f32 v72, v72, v76
    v_add_f32 v64, v64, v72
    v_add_f32 v65, v65, v69
    v_add_f32 v73, v73, v77
    v_add_f32 v65, v65, v73
    v_add_f32 v66, v66, v70
    v_add_f32 v74, v74, v78
    v_add_f32 v66, v66, v74
    v_add_f32 v67, v67, v71
    v_add_f32 v75, v75, v79
    v_add_f32 v67, v67, v75
    v_add_f32 v80, v80, v84
    v_add_f32 v88, v88, v92
    v_add_f32 v80, v80, v88
    v_add_f32 v81, v81, v85
    v_add_f32 v89, v89, v93
    v_add_f32 v81, v81, v89
    v_add_f32 v82, v82, v86
    v_add_f32 v90, v90, v94
    v_add_f32 v82, v82, v90
    v_add_f32 v83, v83, v87
    v_add_f32 v91, v91, v95
    v_add_f32 v83, v83, v91
    v_and_b32 v9, 15, v0
    v_and_b32 v10, 1, v8
    v_lshrrev_b32 v11, 1, v8
    v_lshlrev_b32 v11, 3, v11
    v_lshl_add_u32 v12, v10, 5, v9
    v_lshl_add_u32 v12, v12, 4, v11
    v_lshlrev_b32 v13, 2, v9
    v_mul_u32_u24 v14, 320, v10
    v_lshl_add_u32 v14, v9, 4, v14
    v_add_u32 v14, v14, v11
    v_cvt_pk_bf16_f32 v100, v16, v17
    v_cvt_pk_bf16_f32 v101, v18, v19
    v_cvt_pk_bf16_f32 v102, v32, v33
    v_cvt_pk_bf16_f32 v103, v34, v35
    v_cvt_pk_bf16_f32 v104, v48, v49
    v_cvt_pk_bf16_f32 v105, v50, v51
    v_cvt_pk_bf16_f32 v106, v64, v65
    v_cvt_pk_bf16_f32 v107, v66, v67
    v_cvt_pk_bf16_f32 v108, v80, v81
    v_cvt_pk_bf16_f32 v109, v82, v83
    s_cmp_eq_u32 s34, 1
    s_cbranch_scc1 L_w_87
    s_cmp_eq_u32 s34, 2
    s_cbranch_scc1 L_w_88
    s_cmp_eq_u32 s34, 3
    s_cbranch_scc1 L_w_89
    s_mul_i32 s44, s32, 5
    s_add_u32 s44, s44, 0
    s_lshr_b32 s45, s44, 4
    s_mul_i32 s45, s45, 20480
    s_lshr_b32 s46, s44, 1
    s_and_b32 s46, s46, 7
    s_mul_i32 s46, s46, 1024
    s_add_u32 s45, s45, s46
    s_and_b32 s44, s44, 1
    s_mul_i32 s44, s44, 256
    s_add_u32 s44, s44, s45
    buffer_store_dwordx2 v[100:101], v12, s[20:23], s44 offen
    s_mul_i32 s44, s32, 5
    s_add_u32 s44, s44, 1
    s_lshr_b32 s45, s44, 4
    s_mul_i32 s45, s45, 20480
    s_lshr_b32 s46, s44, 1
    s_and_b32 s46, s46, 7
    s_mul_i32 s46, s46, 1024
    s_add_u32 s45, s45, s46
    s_and_b32 s44, s44, 1
    s_mul_i32 s44, s44, 256
    s_add_u32 s44, s44, s45
    buffer_store_dwordx2 v[102:103], v12, s[20:23], s44 offen
    s_mul_i32 s44, s32, 5
    s_add_u32 s44, s44, 2
    s_lshr_b32 s45, s44, 4
    s_mul_i32 s45, s45, 20480
    s_lshr_b32 s46, s44, 1
    s_and_b32 s46, s46, 7
    s_mul_i32 s46, s46, 1024
    s_add_u32 s45, s45, s46
    s_and_b32 s44, s44, 1
    s_mul_i32 s44, s44, 256
    s_add_u32 s44, s44, s45
    buffer_store_dwordx2 v[104:105], v12, s[20:23], s44 offen
    s_mul_i32 s44, s32, 5
    s_add_u32 s44, s44, 3
    s_lshr_b32 s45, s44, 4
    s_mul_i32 s45, s45, 20480
    s_lshr_b32 s46, s44, 1
    s_and_b32 s46, s46, 7
    s_mul_i32 s46, s46, 1024
    s_add_u32 s45, s45, s46
    s_and_b32 s44, s44, 1
    s_mul_i32 s44, s44, 256
    s_add_u32 s44, s44, s45
    buffer_store_dwordx2 v[106:107], v12, s[20:23], s44 offen
    s_mul_i32 s44, s32, 5
    s_add_u32 s44, s44, 4
    s_lshr_b32 s45, s44, 4
    s_mul_i32 s45, s45, 20480
    s_lshr_b32 s46, s44, 1
    s_and_b32 s46, s46, 7
    s_mul_i32 s46, s46, 1024
    s_add_u32 s45, s45, s46
    s_and_b32 s44, s44, 1
    s_mul_i32 s44, s44, 256
    s_add_u32 s44, s44, s45
    buffer_store_dwordx2 v[108:109], v12, s[20:23], s44 offen
    s_branch L_k2_after
L_w_87:
    v_cmp_gt_u32 vcc, 16, v0
    s_and_saveexec_b64 s[50:51], vcc
    s_mul_i32 s44, s32, 5
    s_add_u32 s44, s44, 0
    s_lshr_b32 s45, s44, 4
    s_mul_i32 s45, s45, 20480
    s_lshr_b32 s46, s44, 1
    s_and_b32 s46, s46, 7
    s_mul_i32 s46, s46, 128
    s_add_u32 s45, s45, s46
    s_and_b32 s44, s44, 1
    s_mul_i32 s44, s44, 64
    s_add_u32 s44, s44, s45
    s_add_u32 s44, s44, 8192
    buffer_store_dword v100, v13, s[20:23], s44 offen
    s_mul_i32 s44, s32, 5
    s_add_u32 s44, s44, 1
    s_lshr_b32 s45, s44, 4
    s_mul_i32 s45, s45, 20480
    s_lshr_b32 s46, s44, 1
    s_and_b32 s46, s46, 7
    s_mul_i32 s46, s46, 128
    s_add_u32 s45, s45, s46
    s_and_b32 s44, s44, 1
    s_mul_i32 s44, s44, 64
    s_add_u32 s44, s44, s45
    s_add_u32 s44, s44, 8192
    buffer_store_dword v102, v13, s[20:23], s44 offen
    s_mul_i32 s44, s32, 5
    s_add_u32 s44, s44, 2
    s_lshr_b32 s45, s44, 4
    s_mul_i32 s45, s45, 20480
    s_lshr_b32 s46, s44, 1
    s_and_b32 s46, s46, 7
    s_mul_i32 s46, s46, 128
    s_add_u32 s45, s45, s46
    s_and_b32 s44, s44, 1
    s_mul_i32 s44, s44, 64
    s_add_u32 s44, s44, s45
    s_add_u32 s44, s44, 8192
    buffer_store_dword v104, v13, s[20:23], s44 offen
    s_mul_i32 s44, s32, 5
    s_add_u32 s44, s44, 3
    s_lshr_b32 s45, s44, 4
    s_mul_i32 s45, s45, 20480
    s_lshr_b32 s46, s44, 1
    s_and_b32 s46, s46, 7
    s_mul_i32 s46, s46, 128
    s_add_u32 s45, s45, s46
    s_and_b32 s44, s44, 1
    s_mul_i32 s44, s44, 64
    s_add_u32 s44, s44, s45
    s_add_u32 s44, s44, 8192
    buffer_store_dword v106, v13, s[20:23], s44 offen
    s_mul_i32 s44, s32, 5
    s_add_u32 s44, s44, 4
    s_lshr_b32 s45, s44, 4
    s_mul_i32 s45, s45, 20480
    s_lshr_b32 s46, s44, 1
    s_and_b32 s46, s46, 7
    s_mul_i32 s46, s46, 128
    s_add_u32 s45, s45, s46
    s_and_b32 s44, s44, 1
    s_mul_i32 s44, s44, 64
    s_add_u32 s44, s44, s45
    s_add_u32 s44, s44, 8192
    buffer_store_dword v108, v13, s[20:23], s44 offen
    s_branch L_k2_after
L_w_88:
    s_mul_i32 s44, s32, 5
    s_add_u32 s44, s44, 0
    s_lshr_b32 s45, s44, 4
    s_mul_i32 s45, s45, 20480
    s_lshr_b32 s46, s44, 1
    s_and_b32 s46, s46, 7
    s_mul_i32 s46, s46, 1280
    s_add_u32 s45, s45, s46
    s_and_b32 s44, s44, 1
    s_mul_i32 s44, s44, 640
    s_add_u32 s44, s44, s45
    s_add_u32 s44, s44, 9216
    buffer_store_dwordx2 v[100:101], v14, s[20:23], s44 offen
    s_mul_i32 s44, s32, 5
    s_add_u32 s44, s44, 1
    s_lshr_b32 s45, s44, 4
    s_mul_i32 s45, s45, 20480
    s_lshr_b32 s46, s44, 1
    s_and_b32 s46, s46, 7
    s_mul_i32 s46, s46, 1280
    s_add_u32 s45, s45, s46
    s_and_b32 s44, s44, 1
    s_mul_i32 s44, s44, 640
    s_add_u32 s44, s44, s45
    s_add_u32 s44, s44, 9216
    buffer_store_dwordx2 v[102:103], v14, s[20:23], s44 offen
    s_mul_i32 s44, s32, 5
    s_add_u32 s44, s44, 2
    s_lshr_b32 s45, s44, 4
    s_mul_i32 s45, s45, 20480
    s_lshr_b32 s46, s44, 1
    s_and_b32 s46, s46, 7
    s_mul_i32 s46, s46, 1280
    s_add_u32 s45, s45, s46
    s_and_b32 s44, s44, 1
    s_mul_i32 s44, s44, 640
    s_add_u32 s44, s44, s45
    s_add_u32 s44, s44, 9216
    buffer_store_dwordx2 v[104:105], v14, s[20:23], s44 offen
    s_mul_i32 s44, s32, 5
    s_add_u32 s44, s44, 3
    s_lshr_b32 s45, s44, 4
    s_mul_i32 s45, s45, 20480
    s_lshr_b32 s46, s44, 1
    s_and_b32 s46, s46, 7
    s_mul_i32 s46, s46, 1280
    s_add_u32 s45, s45, s46
    s_and_b32 s44, s44, 1
    s_mul_i32 s44, s44, 640
    s_add_u32 s44, s44, s45
    s_add_u32 s44, s44, 9216
    buffer_store_dwordx2 v[106:107], v14, s[20:23], s44 offen
    s_mul_i32 s44, s32, 5
    s_add_u32 s44, s44, 4
    s_lshr_b32 s45, s44, 4
    s_mul_i32 s45, s45, 20480
    s_lshr_b32 s46, s44, 1
    s_and_b32 s46, s46, 7
    s_mul_i32 s46, s46, 1280
    s_add_u32 s45, s45, s46
    s_and_b32 s44, s44, 1
    s_mul_i32 s44, s44, 640
    s_add_u32 s44, s44, s45
    s_add_u32 s44, s44, 9216
    buffer_store_dwordx2 v[108:109], v14, s[20:23], s44 offen
    s_branch L_k2_after
L_w_89:
    v_cmp_eq_u32 vcc, 2, v9
    v_mov_b32 v15, 0x3f803f80
    s_nop 1
    v_cndmask_b32 v100, v100, v15, vcc
    v_cndmask_b32 v101, v101, v15, vcc
    v_cndmask_b32 v102, v102, v15, vcc
    v_cndmask_b32 v103, v103, v15, vcc
    v_cndmask_b32 v104, v104, v15, vcc
    v_cndmask_b32 v105, v105, v15, vcc
    v_cndmask_b32 v106, v106, v15, vcc
    v_cndmask_b32 v107, v107, v15, vcc
    v_cndmask_b32 v108, v108, v15, vcc
    v_cndmask_b32 v109, v109, v15, vcc
    v_cmp_eq_u32 vcc, 3, v9
    v_mov_b32 v15, 0
    s_nop 1
    v_cndmask_b32 v100, v100, v15, vcc
    v_cndmask_b32 v101, v101, v15, vcc
    v_cndmask_b32 v102, v102, v15, vcc
    v_cndmask_b32 v103, v103, v15, vcc
    v_cndmask_b32 v104, v104, v15, vcc
    v_cndmask_b32 v105, v105, v15, vcc
    v_cndmask_b32 v106, v106, v15, vcc
    v_cndmask_b32 v107, v107, v15, vcc
    v_cndmask_b32 v108, v108, v15, vcc
    v_cndmask_b32 v109, v109, v15, vcc
    v_cmp_gt_u32 vcc, 4, v9
    s_and_saveexec_b64 s[50:51], vcc
    s_mul_i32 s44, s32, 5
    s_add_u32 s44, s44, 0
    s_lshr_b32 s45, s44, 4
    s_mul_i32 s45, s45, 20480
    s_lshr_b32 s46, s44, 1
    s_and_b32 s46, s46, 7
    s_mul_i32 s46, s46, 1280
    s_add_u32 s45, s45, s46
    s_and_b32 s44, s44, 1
    s_mul_i32 s44, s44, 640
    s_add_u32 s44, s44, s45
    s_add_u32 s44, s44, 9472
    buffer_store_dwordx2 v[100:101], v14, s[20:23], s44 offen
    s_mul_i32 s44, s32, 5
    s_add_u32 s44, s44, 1
    s_lshr_b32 s45, s44, 4
    s_mul_i32 s45, s45, 20480
    s_lshr_b32 s46, s44, 1
    s_and_b32 s46, s46, 7
    s_mul_i32 s46, s46, 1280
    s_add_u32 s45, s45, s46
    s_and_b32 s44, s44, 1
    s_mul_i32 s44, s44, 640
    s_add_u32 s44, s44, s45
    s_add_u32 s44, s44, 9472
    buffer_store_dwordx2 v[102:103], v14, s[20:23], s44 offen
    s_mul_i32 s44, s32, 5
    s_add_u32 s44, s44, 2
    s_lshr_b32 s45, s44, 4
    s_mul_i32 s45, s45, 20480
    s_lshr_b32 s46, s44, 1
    s_and_b32 s46, s46, 7
    s_mul_i32 s46, s46, 1280
    s_add_u32 s45, s45, s46
    s_and_b32 s44, s44, 1
    s_mul_i32 s44, s44, 640
    s_add_u32 s44, s44, s45
    s_add_u32 s44, s44, 9472
    buffer_store_dwordx2 v[104:105], v14, s[20:23], s44 offen
    s_mul_i32 s44, s32, 5
    s_add_u32 s44, s44, 3
    s_lshr_b32 s45, s44, 4
    s_mul_i32 s45, s45, 20480
    s_lshr_b32 s46, s44, 1
    s_and_b32 s46, s46, 7
    s_mul_i32 s46, s46, 1280
    s_add_u32 s45, s45, s46
    s_and_b32 s44, s44, 1
    s_mul_i32 s44, s44, 640
    s_add_u32 s44, s44, s45
    s_add_u32 s44, s44, 9472
    buffer_store_dwordx2 v[106:107], v14, s[20:23], s44 offen
    s_mul_i32 s44, s32, 5
    s_add_u32 s44, s44, 4
    s_lshr_b32 s45, s44, 4
    s_mul_i32 s45, s45, 20480
    s_lshr_b32 s46, s44, 1
    s_and_b32 s46, s46, 7
    s_mul_i32 s46, s46, 1280
    s_add_u32 s45, s45, s46
    s_and_b32 s44, s44, 1
    s_mul_i32 s44, s44, 640
    s_add_u32 s44, s44, s45
    s_add_u32 s44, s44, 9472
    buffer_store_dwordx2 v[108:109], v14, s[20:23], s44 offen
    s_branch L_k2_after
L_k2_after:
    s_lshr_b32 s3, s2, 3
    s_cmp_lg_u32 s3, 7
    s_cbranch_scc1 L_k2b_end
    s_and_b32 s2, s2, 7
    s_add_u32 s2, s2, 256
    s_mov_b64 exec, -1
    v_lshl_add_u32 v0, s34, 6, v0
    s_waitcnt lgkmcnt(0)
    s_barrier
    s_branch L_k2_aproj
L_k2b_end:
    s_endpgm
.globl k3_kernel
.p2align 8
.type k3_kernel,@function
k3_kernel:
    s_cmp_ge_u32 s2, 496
    s_cbranch_scc1 L_k3_end
    s_load_dwordx2 s[58:59], s[0:1], 104
    s_waitcnt lgkmcnt(0)
    s_add_u32 s60, s58, 59768832
    s_addc_u32 s61, s59, 0
    s_mov_b32 s62, 8192
    s_mov_b32 s63, 0x00020000
    s_cmp_ge_u32 s2, 256
    s_cbranch_scc1 L_k3_o
    s_mov_b32 s66, s2
    s_mov_b32 s67, 0
    v_mov_b32 v147, 0
    v_mov_b32 v4, 0
    s_lshr_b32 s3, s66, 2
    s_lshl_b32 s3, s3, 7
    s_and_b32 s4, s66, 3
    s_lshl_b32 s68, 0x10000, s4
    v_cmp_eq_u32 vcc, 0, v0
    s_and_saveexec_b64 s[64:65], vcc
    s_cbranch_execz L_k3_c1
    v_mov_b32 v147, s68
    buffer_atomic_or v147, v4, s[60:63], s3 offen sc0
L_k3_c1:
    s_mov_b64 exec, s[64:65]
L_k3_abody:
    s_load_dwordx2 s[6:7], s[0:1], 104
    s_setprio 1
    v_lshrrev_b32 v1, 6, v0
    v_and_b32 v0, 63, v0
    v_readfirstlane_b32 s34, v1
    s_waitcnt lgkmcnt(0)
    s_add_u32 s12, s6, 54525952
    s_addc_u32 s13, s7, 0
    s_mov_b32 s14, 163840
    s_mov_b32 s15, 0x00020000
    s_add_u32 s16, s6, 50331648
    s_addc_u32 s17, s7, 0
    s_mov_b32 s18, 2359296
    s_mov_b32 s19, 0x00020000
    s_add_u32 s20, s6, 55574528
    s_addc_u32 s21, s7, 0
    s_mov_b32 s22, 2359296
    s_mov_b32 s23, 0x00020000
    v_lshlrev_b32 v1, 4, v0
    s_mul_i32 s35, s34, 5120
    s_lshr_b32 s37, s66, 2
    s_and_b32 s38, s66, 3
    s_lshl_b32 s38, s38, 3
    s_lshl_b32 s39, s34, 1
    s_add_u32 s38, s38, s39
    v_and_b32 v2, 31, v0
    v_lshrrev_b32 v3, 5, v0
    s_lshl_b32 s37, s37, 5
    v_add_u32 v4, s37, v2
    s_movk_i32 s39, 1152
    v_mul_lo_u32 v4, v4, s39
    v_lshl_add_u32 v4, v3, 3, v4
    s_mul_i32 s38, s38, 36
    buffer_load_dwordx2 v[8:9], v4, s[16:19], s38 offen offset:0
    buffer_load_dwordx2 v[10:11], v4, s[16:19], s38 offen offset:16
    buffer_load_dword v12, v4, s[16:19], s38 offen offset:32
    buffer_load_dwordx2 v[16:17], v4, s[16:19], s38 offen offset:36
    buffer_load_dwordx2 v[18:19], v4, s[16:19], s38 offen offset:52
    buffer_load_dword v20, v4, s[16:19], s38 offen offset:68
    s_add_u32 s36, s35, 0
    s_add_u32 m0, s35, 0
    s_nop 0
    buffer_load_dwordx4 v1, s[12:15], s36 offen lds
    buffer_load_dwordx4 v1, s[12:15], s36 offen offset:1024 lds
    buffer_load_dwordx4 v1, s[12:15], s36 offen offset:2048 lds
    buffer_load_dwordx4 v1, s[12:15], s36 offen offset:3072 lds
    s_add_u32 s36, s35, 4096
    s_add_u32 m0, s35, 4096
    s_nop 0
    buffer_load_dwordx4 v1, s[12:15], s36 offen lds
    s_add_u32 s36, s35, 20480
    s_add_u32 m0, s35, 20480
    s_nop 0
    buffer_load_dwordx4 v1, s[12:15], s36 offen lds
    buffer_load_dwordx4 v1, s[12:15], s36 offen offset:1024 lds
    buffer_load_dwordx4 v1, s[12:15], s36 offen offset:2048 lds
    buffer_load_dwordx4 v1, s[12:15], s36 offen offset:3072 lds
    s_add_u32 s36, s35, 24576
    s_add_u32 m0, s35, 24576
    s_nop 0
    buffer_load_dwordx4 v1, s[12:15], s36 offen lds
    s_add_u32 s36, s35, 40960
    s_add_u32 m0, s35, 40960
    s_nop 0
    buffer_load_dwordx4 v1, s[12:15], s36 offen lds
    buffer_load_dwordx4 v1, s[12:15], s36 offen offset:1024 lds
    buffer_load_dwordx4 v1, s[12:15], s36 offen offset:2048 lds
    buffer_load_dwordx4 v1, s[12:15], s36 offen offset:3072 lds
    s_add_u32 s36, s35, 45056
    s_add_u32 m0, s35, 45056
    s_nop 0
    buffer_load_dwordx4 v1, s[12:15], s36 offen lds
    v_mov_b32 v33, 0x3f80
    v_mov_b32 v34, 0
    v_mov_b32 v35, 0
    v_mov_b32 v13, 0
    v_mov_b32 v14, 0
    v_mov_b32 v15, 0
    v_mov_b32 v37, 0x3f80
    v_mov_b32 v38, 0
    v_mov_b32 v39, 0
    v_mov_b32 v21, 0
    v_mov_b32 v22, 0
    v_mov_b32 v23, 0
    v_lshlrev_b32 v6, 2, v2
    v_add_u32 v6, 8192, v6
    v_min_u32 v7, 19, v2
    v_lshlrev_b32 v7, 4, v7
    v_mul_u32_u24 v136, 320, v3
    v_add_u32 v7, v7, v136
    v_add_u32 v7, 9216, v7
    v_mov_b32 v144, v1
    v_mov_b32 v145, v6
    v_mov_b32 v146, v7
    v_cmp_gt_u32 s[40:41], 32, v0
    s_waitcnt vmcnt(10)
    v_cndmask_b32 v12, 0, v12, s[40:41]
    v_cndmask_b32 v20, 0, v20, s[40:41]
    v_mov_b32 v136, 0
    s_cmp_lg_u32 s34, 0
    s_cbranch_scc1 L_cl_90
    v_and_b32 v147, s68, v147
    s_nop 0
    v_readfirstlane_b32 s3, v147
    s_nop 1
    v_mov_b32 v137, s3
    ds_write_b32 v136, v137 offset:65000
    s_waitcnt lgkmcnt(0)
L_cl_90:
    s_barrier
    ds_read_b32 v137, v136 offset:65000
    s_waitcnt lgkmcnt(0)
    v_readfirstlane_b32 s3, v137
    s_cmp_lg_u32 s3, 0
    s_cbranch_scc1 L_k3_end
    ds_read_b128 v[24:27], v144 offset:0
    ds_read_b32 v32, v145 offset:0
    ds_read_b128 v[40:43], v146 offset:0
    ds_read_b128 v[44:47], v146 offset:640
    s_waitcnt lgkmcnt(2)
    v_mfma_f32_32x32x16_bf16 v[56:71], v[24:27], v[8:11], 0
    v_mfma_f32_32x32x16_bf16 v[56:71], v[32:35], v[12:15], v[56:71]
    v_mfma_f32_32x32x16_bf16 v[72:87], v[24:27], v[16:19], 0
    v_mfma_f32_32x32x16_bf16 v[72:87], v[32:35], v[20:23], v[72:87]
    v_mov_b32 v104, 0
    v_mov_b32 v105, 0
    v_mov_b32 v106, 0
    v_mov_b32 v107, 0
    v_mov_b32 v108, 0
    v_mov_b32 v109, 0
    v_mov_b32 v110, 0
    v_mov_b32 v111, 0
    v_mov_b32 v112, 0
    v_mov_b32 v113, 0
    v_mov_b32 v114, 0
    v_mov_b32 v115, 0
    v_mov_b32 v116, 0
    v_mov_b32 v117, 0
    v_mov_b32 v118, 0
    v_mov_b32 v119, 0
    v_mov_b32 v120, 0
    v_mov_b32 v121, 0
    v_mov_b32 v122, 0
    v_mov_b32 v123, 0
    v_mov_b32 v124, 0
    v_mov_b32 v125, 0
    v_mov_b32 v126, 0
    v_mov_b32 v127, 0
    v_mov_b32 v128, 0
    v_mov_b32 v129, 0
    v_mov_b32 v130, 0
    v_mov_b32 v131, 0
    v_mov_b32 v132, 0
    v_mov_b32 v133, 0
    v_mov_b32 v134, 0
    v_mov_b32 v135, 0
    v_mov_b32 v96, 0
    v_mov_b32 v97, 0
    v_mov_b32 v98, 0
    v_mov_b32 v99, 0
    v_mov_b32 v100, 0
    v_mov_b32 v101, 0
    v_mov_b32 v102, 0
    v_mov_b32 v103, 0
    v_mov_b32 v48, 0
    v_mov_b32 v49, 0
    v_mov_b32 v50, 0
    v_mov_b32 v51, 0
    v_mov_b32 v52, 0
    v_mov_b32 v53, 0
    v_mov_b32 v54, 0
    v_mov_b32 v55, 0
    v_max3_f32 v136, v56, v57, v58
    v_max3_f32 v136, v136, v59, v60
    v_max3_f32 v136, v136, v61, v62
    v_max3_f32 v136, v136, v63, v64
    v_max3_f32 v136, v136, v65, v66
    v_max3_f32 v136, v136, v67, v68
    v_max3_f32 v136, v136, v69, v70
    v_max_f32 v136, v136, v71
    v_mov_b32 v137, v136
    v_mov_b32 v138, v136
    s_nop 1
    v_permlane32_swap_b32 v137, v138
    s_nop 1
    v_max_f32 v136, v137, v138
    v_add_f32 v136, 0x42200000, v136
    v_sub_f32 v136, 0, v136
    v_cvt_pk_bf16_f32 v136, v136, 0
    v_cndmask_b32 v13, 0, v136, s[40:41]
    v_max3_f32 v136, v72, v73, v74
    v_max3_f32 v136, v136, v75, v76
    v_max3_f32 v136, v136, v77, v78
    v_max3_f32 v136, v136, v79, v80
    v_max3_f32 v136, v136, v81, v82
    v_max3_f32 v136, v136, v83, v84
    v_max3_f32 v136, v136, v85, v86
    v_max_f32 v136, v136, v87
    v_mov_b32 v137, v136
    v_mov_b32 v138, v136
    s_nop 1
    v_permlane32_swap_b32 v137, v138
    s_nop 1
    v_max_f32 v136, v137, v138
    v_add_f32 v136, 0x42200000, v136
    v_sub_f32 v136, 0, v136
    v_cvt_pk_bf16_f32 v136, v136, 0
    v_cndmask_b32 v21, 0, v136, s[40:41]
    s_nop 1
    v_mfma_f32_32x32x16_bf16 v[56:71], v[24:27], v[8:11], 0
    v_mfma_f32_32x32x16_bf16 v[56:71], v[32:35], v[12:15], v[56:71]
    s_nop 15
    s_mov_b32 s50, 0
    s_add_u32 s51, s35, 61440
    s_mov_b32 s52, 8
L_aloop_91:
    v_exp_f32 v56, v56
    v_exp_f32 v57, v57
    v_mfma_f32_32x32x16_bf16 v[120:135], v[48:51], v[96:99], v[120:135]
    v_exp_f32 v58, v58
    v_exp_f32 v59, v59
    ds_read_b128 v[28:31], v144 offset:1024
    v_cvt_pk_bf16_f32 v88, v56, v57
    v_exp_f32 v60, v60
    v_mfma_f32_32x32x16_bf16 v[120:135], v[52:55], v[100:103], v[120:135]
    v_exp_f32 v61, v61
    ds_read_b32 v36, v145 offset:128
    v_cvt_pk_bf16_f32 v89, v58, v59
    v_exp_f32 v62, v62
    v_mfma_f32_32x32x16_bf16 v[72:87], v[24:27], v[16:19], 0
    v_exp_f32 v63, v63
    v_cvt_pk_bf16_f32 v90, v60, v61
    v_exp_f32 v64, v64
    v_exp_f32 v65, v65
    v_mfma_f32_32x32x16_bf16 v[72:87], v[32:35], v[20:23], v[72:87]
    v_cvt_pk_bf16_f32 v91, v62, v63
    v_exp_f32 v66, v66
    v_exp_f32 v67, v67
    v_cvt_pk_bf16_f32 v92, v64, v65
    v_exp_f32 v68, v68
    v_exp_f32 v69, v69
    v_cvt_pk_bf16_f32 v93, v66, v67
    v_exp_f32 v70, v70
    v_exp_f32 v71, v71
    v_cvt_pk_bf16_f32 v94, v68, v69
    s_nop 0
    v_cvt_pk_bf16_f32 v95, v70, v71
    v_exp_f32 v72, v72
    v_exp_f32 v73, v73
    s_waitcnt lgkmcnt(0)
    v_mfma_f32_32x32x16_bf16 v[104:119], v[40:43], v[88:91], v[104:119]
    v_exp_f32 v74, v74
    v_exp_f32 v75, v75
    ds_read_b128 v[48:51], v146 offset:1280
    v_cvt_pk_bf16_f32 v96, v72, v73
    v_exp_f32 v76, v76
    v_mfma_f32_32x32x16_bf16 v[104:119], v[44:47], v[92:95], v[104:119]
    v_exp_f32 v77, v77
    ds_read_b128 v[52:55], v146 offset:1920
    v_cvt_pk_bf16_f32 v97, v74, v75
    v_exp_f32 v78, v78
    v_mfma_f32_32x32x16_bf16 v[56:71], v[28:31], v[8:11], 0
    v_exp_f32 v79, v79
    v_cvt_pk_bf16_f32 v98, v76, v77
    v_exp_f32 v80, v80
    v_exp_f32 v81, v81
    v_mfma_f32_32x32x16_bf16 v[56:71], v[36:39], v[12:15], v[56:71]
    v_cvt_pk_bf16_f32 v99, v78, v79
    v_exp_f32 v82, v82
    v_exp_f32 v83, v83
    v_cvt_pk_bf16_f32 v100, v80, v81
    v_exp_f32 v84, v84
    v_exp_f32 v85, v85
    v_cvt_pk_bf16_f32 v101, v82, v83
    v_exp_f32 v86, v86
    v_exp_f32 v87, v87
    v_cvt_pk_bf16_f32 v102, v84, v85
    s_nop 0
    v_cvt_pk_bf16_f32 v103, v86, v87
    v_exp_f32 v56, v56
    v_exp_f32 v57, v57
    v_mfma_f32_32x32x16_bf16 v[120:135], v[40:43], v[96:99], v[120:135]
    v_exp_f32 v58, v58
    v_exp_f32 v59, v59
    ds_read_b128 v[24:27], v144 offset:2048
    v_cvt_pk_bf16_f32 v88, v56, v57
    v_exp_f32 v60, v60
    v_mfma_f32_32x32x16_bf16 v[120:135], v[44:47], v[100:103], v[120:135]
    v_exp_f32 v61, v61
    ds_read_b32 v32, v145 offset:256
    v_cvt_pk_bf16_f32 v89, v58, v59
    v_exp_f32 v62, v62
    v_mfma_f32_32x32x16_bf16 v[72:87], v[28:31], v[16:19], 0
    v_exp_f32 v63, v63
    v_cvt_pk_bf16_f32 v90, v60, v61
    v_exp_f32 v64, v64
    v_exp_f32 v65, v65
    v_mfma_f32_32x32x16_bf16 v[72:87], v[36:39], v[20:23], v[72:87]
    v_cvt_pk_bf16_f32 v91, v62, v63
    v_exp_f32 v66, v66
    v_exp_f32 v67, v67
    v_cvt_pk_bf16_f32 v92, v64, v65
    v_exp_f32 v68, v68
    v_exp_f32 v69, v69
    v_cvt_pk_bf16_f32 v93, v66, v67
    v_exp_f32 v70, v70
    v_exp_f32 v71, v71
    v_cvt_pk_bf16_f32 v94, v68, v69
    s_nop 0
    v_cvt_pk_bf16_f32 v95, v70, v71
    v_exp_f32 v72, v72
    v_exp_f32 v73, v73
    s_waitcnt lgkmcnt(0)
    v_mfma_f32_32x32x16_bf16 v[104:119], v[48:51], v[88:91], v[104:119]
    v_exp_f32 v74, v74
    v_exp_f32 v75, v75
    ds_read_b128 v[40:43], v146 offset:2560
    v_cvt_pk_bf16_f32 v96, v72, v73
    v_exp_f32 v76, v76
    v_mfma_f32_32x32x16_bf16 v[104:119], v[52:55], v[92:95], v[104:119]
    v_exp_f32 v77, v77
    ds_read_b128 v[44:47], v146 offset:3200
    v_cvt_pk_bf16_f32 v97, v74, v75
    v_exp_f32 v78, v78
    v_mfma_f32_32x32x16_bf16 v[56:71], v[24:27], v[8:11], 0
    v_exp_f32 v79, v79
    v_cvt_pk_bf16_f32 v98, v76, v77
    v_exp_f32 v80, v80
    v_exp_f32 v81, v81
    v_mfma_f32_32x32x16_bf16 v[56:71], v[32:35], v[12:15], v[56:71]
    v_cvt_pk_bf16_f32 v99, v78, v79
    v_exp_f32 v82, v82
    v_exp_f32 v83, v83
    v_cvt_pk_bf16_f32 v100, v80, v81
    v_exp_f32 v84, v84
    v_exp_f32 v85, v85
    v_cvt_pk_bf16_f32 v101, v82, v83
    v_exp_f32 v86, v86
    v_exp_f32 v87, v87
    v_cvt_pk_bf16_f32 v102, v84, v85
    s_nop 0
    v_cvt_pk_bf16_f32 v103, v86, v87
    v_exp_f32 v56, v56
    v_exp_f32 v57, v57
    v_mfma_f32_32x32x16_bf16 v[120:135], v[48:51], v[96:99], v[120:135]
    v_exp_f32 v58, v58
    v_exp_f32 v59, v59
    ds_read_b128 v[28:31], v144 offset:3072
    v_cvt_pk_bf16_f32 v88, v56, v57
    v_exp_f32 v60, v60
    v_mfma_f32_32x32x16_bf16 v[120:135], v[52:55], v[100:103], v[120:135]
    v_exp_f32 v61, v61
    ds_read_b32 v36, v145 offset:384
    v_cvt_pk_bf16_f32 v89, v58, v59
    v_exp_f32 v62, v62
    v_mfma_f32_32x32x16_bf16 v[72:87], v[24:27], v[16:19], 0
    v_exp_f32 v63, v63
    s_add_u32 s53, s50, 61440
    s_sub_u32 s54, s53, 81920
    s_cmp_ge_u32 s53, 81920
    s_cselect_b32 s53, s54, s53
    v_cvt_pk_bf16_f32 v90, v60, v61
    v_exp_f32 v64, v64
    v_exp_f32 v65, v65
    s_add_u32 s50, s50, 20480
    s_cmp_ge_u32 s50, 81920
    s_cselect_b32 s50, 0, s50
    v_mfma_f32_32x32x16_bf16 v[72:87], v[32:35], v[20:23], v[72:87]
    v_cvt_pk_bf16_f32 v91, v62, v63
    v_exp_f32 v66, v66
    v_exp_f32 v67, v67
    s_add_u32 s53, s53, s35
    v_cvt_pk_bf16_f32 v92, v64, v65
    v_exp_f32 v68, v68
    v_exp_f32 v69, v69
    v_cvt_pk_bf16_f32 v93, v66, v67
    v_exp_f32 v70, v70
    v_exp_f32 v71, v71
    v_cvt_pk_bf16_f32 v94, v68, v69
    s_nop 0
    v_cvt_pk_bf16_f32 v95, v70, v71
    v_exp_f32 v72, v72
    v_exp_f32 v73, v73
    s_waitcnt lgkmcnt(0)
    v_mfma_f32_32x32x16_bf16 v[104:119], v[40:43], v[88:91], v[104:119]
    v_exp_f32 v74, v74
    v_exp_f32 v75, v75
    ds_read_b128 v[48:51], v146 offset:3840
    v_cvt_pk_bf16_f32 v96, v72, v73
    v_exp_f32 v76, v76
    v_mfma_f32_32x32x16_bf16 v[104:119], v[44:47], v[92:95], v[104:119]
    v_exp_f32 v77, v77
    ds_read_b128 v[52:55], v146 offset:4480
    v_cvt_pk_bf16_f32 v97, v74, v75
    v_exp_f32 v78, v78
    v_mfma_f32_32x32x16_bf16 v[56:71], v[28:31], v[8:11], 0
    v_exp_f32 v79, v79
    v_cvt_pk_bf16_f32 v98, v76, v77
    v_exp_f32 v80, v80
    v_exp_f32 v81, v81
    v_mfma_f32_32x32x16_bf16 v[56:71], v[36:39], v[12:15], v[56:71]
    v_cvt_pk_bf16_f32 v99, v78, v79
    v_exp_f32 v82, v82
    v_exp_f32 v83, v83
    v_cvt_pk_bf16_f32 v100, v80, v81
    v_exp_f32 v84, v84
    v_exp_f32 v85, v85
    v_cvt_pk_bf16_f32 v101, v82, v83
    v_exp_f32 v86, v86
    v_exp_f32 v87, v87
    v_cvt_pk_bf16_f32 v102, v84, v85
    s_nop 0
    v_cvt_pk_bf16_f32 v103, v86, v87
    v_exp_f32 v56, v56
    v_exp_f32 v57, v57
    v_mfma_f32_32x32x16_bf16 v[120:135], v[40:43], v[96:99], v[120:135]
    v_exp_f32 v58, v58
    v_exp_f32 v59, v59
    ds_read_b128 v[24:27], v144 offset:4096
    v_cvt_pk_bf16_f32 v88, v56, v57
    v_exp_f32 v60, v60
    v_mfma_f32_32x32x16_bf16 v[120:135], v[44:47], v[100:103], v[120:135]
    v_exp_f32 v61, v61
    ds_read_b32 v32, v145 offset:512
    v_cvt_pk_bf16_f32 v89, v58, v59
    v_exp_f32 v62, v62
    v_mfma_f32_32x32x16_bf16 v[72:87], v[28:31], v[16:19], 0
    v_exp_f32 v63, v63
    v_add_u32 v141, s50, v1
    v_cvt_pk_bf16_f32 v90, v60, v61
    v_exp_f32 v64, v64
    v_exp_f32 v65, v65
    v_add_u32 v142, s50, v6
    v_mfma_f32_32x32x16_bf16 v[72:87], v[36:39], v[20:23], v[72:87]
    v_cvt_pk_bf16_f32 v91, v62, v63
    v_exp_f32 v66, v66
    v_exp_f32 v67, v67
    v_add_u32 v143, s50, v7
    v_cvt_pk_bf16_f32 v92, v64, v65
    v_exp_f32 v68, v68
    v_exp_f32 v69, v69
    v_cvt_pk_bf16_f32 v93, v66, v67
    v_exp_f32 v70, v70
    v_exp_f32 v71, v71
    v_cvt_pk_bf16_f32 v94, v68, v69
    s_nop 0
    v_cvt_pk_bf16_f32 v95, v70, v71
    v_exp_f32 v72, v72
    v_exp_f32 v73, v73
    s_waitcnt lgkmcnt(0)
    v_mfma_f32_32x32x16_bf16 v[104:119], v[48:51], v[88:91], v[104:119]
    v_exp_f32 v74, v74
    v_exp_f32 v75, v75
    ds_read_b128 v[40:43], v146 offset:5120
    v_cvt_pk_bf16_f32 v96, v72, v73
    v_exp_f32 v76, v76
    v_mfma_f32_32x32x16_bf16 v[104:119], v[52:55], v[92:95], v[104:119]
    v_exp_f32 v77, v77
    ds_read_b128 v[44:47], v146 offset:5760
    v_cvt_pk_bf16_f32 v97, v74, v75
    v_exp_f32 v78, v78
    v_mfma_f32_32x32x16_bf16 v[56:71], v[24:27], v[8:11], 0
    v_exp_f32 v79, v79
    v_cvt_pk_bf16_f32 v98, v76, v77
    v_exp_f32 v80, v80
    v_exp_f32 v81, v81
    v_mfma_f32_32x32x16_bf16 v[56:71], v[32:35], v[12:15], v[56:71]
    v_cvt_pk_bf16_f32 v99, v78, v79
    v_exp_f32 v82, v82
    v_exp_f32 v83, v83
    v_cvt_pk_bf16_f32 v100, v80, v81
    v_exp_f32 v84, v84
    v_exp_f32 v85, v85
    v_cvt_pk_bf16_f32 v101, v82, v83
    v_exp_f32 v86, v86
    v_exp_f32 v87, v87
    v_cvt_pk_bf16_f32 v102, v84, v85
    s_nop 0
    v_cvt_pk_bf16_f32 v103, v86, v87
    v_exp_f32 v56, v56
    v_exp_f32 v57, v57
    v_mfma_f32_32x32x16_bf16 v[120:135], v[48:51], v[96:99], v[120:135]
    v_exp_f32 v58, v58
    v_exp_f32 v59, v59
    ds_read_b128 v[28:31], v144 offset:5120
    v_cvt_pk_bf16_f32 v88, v56, v57
    v_exp_f32 v60, v60
    v_mfma_f32_32x32x16_bf16 v[120:135], v[52:55], v[100:103], v[120:135]
    v_exp_f32 v61, v61
    ds_read_b32 v36, v145 offset:640
    v_cvt_pk_bf16_f32 v89, v58, v59
    v_exp_f32 v62, v62
    v_mfma_f32_32x32x16_bf16 v[72:87], v[24:27], v[16:19], 0
    v_exp_f32 v63, v63
    v_cvt_pk_bf16_f32 v90, v60, v61
    v_exp_f32 v64, v64
    v_exp_f32 v65, v65
    v_mfma_f32_32x32x16_bf16 v[72:87], v[32:35], v[20:23], v[72:87]
    v_cvt_pk_bf16_f32 v91, v62, v63
    v_exp_f32 v66, v66
    v_exp_f32 v67, v67
    v_cvt_pk_bf16_f32 v92, v64, v65
    v_exp_f32 v68, v68
    v_exp_f32 v69, v69
    v_cvt_pk_bf16_f32 v93, v66, v67
    v_exp_f32 v70, v70
    v_exp_f32 v71, v71
    v_cvt_pk_bf16_f32 v94, v68, v69
    s_nop 0
    v_cvt_pk_bf16_f32 v95, v70, v71
    v_exp_f32 v72, v72
    v_exp_f32 v73, v73
    s_waitcnt lgkmcnt(0)
    v_mfma_f32_32x32x16_bf16 v[104:119], v[40:43], v[88:91], v[104:119]
    v_exp_f32 v74, v74
    v_exp_f32 v75, v75
    ds_read_b128 v[48:51], v146 offset:6400
    v_cvt_pk_bf16_f32 v96, v72, v73
    v_exp_f32 v76, v76
    v_mfma_f32_32x32x16_bf16 v[104:119], v[44:47], v[92:95], v[104:119]
    v_exp_f32 v77, v77
    ds_read_b128 v[52:55], v146 offset:7040
    v_cvt_pk_bf16_f32 v97, v74, v75
    v_exp_f32 v78, v78
    v_mfma_f32_32x32x16_bf16 v[56:71], v[28:31], v[8:11], 0
    v_exp_f32 v79, v79
    v_cvt_pk_bf16_f32 v98, v76, v77
    v_exp_f32 v80, v80
    v_exp_f32 v81, v81
    v_mfma_f32_32x32x16_bf16 v[56:71], v[36:39], v[12:15], v[56:71]
    v_cvt_pk_bf16_f32 v99, v78, v79
    v_exp_f32 v82, v82
    v_exp_f32 v83, v83
    v_cvt_pk_bf16_f32 v100, v80, v81
    v_exp_f32 v84, v84
    v_exp_f32 v85, v85
    v_cvt_pk_bf16_f32 v101, v82, v83
    v_exp_f32 v86, v86
    v_exp_f32 v87, v87
    v_cvt_pk_bf16_f32 v102, v84, v85
    s_nop 0
    v_cvt_pk_bf16_f32 v103, v86, v87
    v_exp_f32 v56, v56
    v_exp_f32 v57, v57
    v_mfma_f32_32x32x16_bf16 v[120:135], v[40:43], v[96:99], v[120:135]
    v_exp_f32 v58, v58
    v_exp_f32 v59, v59
    ds_read_b128 v[24:27], v144 offset:6144
    v_cvt_pk_bf16_f32 v88, v56, v57
    v_exp_f32 v60, v60
    v_mfma_f32_32x32x16_bf16 v[120:135], v[44:47], v[100:103], v[120:135]
    v_exp_f32 v61, v61
    ds_read_b32 v32, v145 offset:768
    v_cvt_pk_bf16_f32 v89, v58, v59
    v_exp_f32 v62, v62
    v_mfma_f32_32x32x16_bf16 v[72:87], v[28:31], v[16:19], 0
    v_exp_f32 v63, v63
    v_cvt_pk_bf16_f32 v90, v60, v61
    v_exp_f32 v64, v64
    v_exp_f32 v65, v65
    v_mfma_f32_32x32x16_bf16 v[72:87], v[36:39], v[20:23], v[72:87]
    v_cvt_pk_bf16_f32 v91, v62, v63
    v_exp_f32 v66, v66
    v_exp_f32 v67, v67
    v_cvt_pk_bf16_f32 v92, v64, v65
    v_exp_f32 v68, v68
    v_exp_f32 v69, v69
    v_cvt_pk_bf16_f32 v93, v66, v67
    v_exp_f32 v70, v70
    v_exp_f32 v71, v71
    v_cvt_pk_bf16_f32 v94, v68, v69
    s_nop 0
    v_cvt_pk_bf16_f32 v95, v70, v71
    v_exp_f32 v72, v72
    v_exp_f32 v73, v73
    s_waitcnt lgkmcnt(0)
    v_mfma_f32_32x32x16_bf16 v[104:119], v[48:51], v[88:91], v[104:119]
    v_exp_f32 v74, v74
    v_exp_f32 v75, v75
    ds_read_b128 v[40:43], v146 offset:7680
    v_cvt_pk_bf16_f32 v96, v72, v73
    v_exp_f32 v76, v76
    v_mfma_f32_32x32x16_bf16 v[104:119], v[52:55], v[92:95], v[104:119]
    v_exp_f32 v77, v77
    ds_read_b128 v[44:47], v146 offset:8320
    v_cvt_pk_bf16_f32 v97, v74, v75
    v_exp_f32 v78, v78
    v_mfma_f32_32x32x16_bf16 v[56:71], v[24:27], v[8:11], 0
    v_exp_f32 v79, v79
    v_cvt_pk_bf16_f32 v98, v76, v77
    v_exp_f32 v80, v80
    v_exp_f32 v81, v81
    v_mfma_f32_32x32x16_bf16 v[56:71], v[32:35], v[12:15], v[56:71]
    v_cvt_pk_bf16_f32 v99, v78, v79
    v_exp_f32 v82, v82
    v_exp_f32 v83, v83
    v_cvt_pk_bf16_f32 v100, v80, v81
    v_exp_f32 v84, v84
    v_exp_f32 v85, v85
    v_cvt_pk_bf16_f32 v101, v82, v83
    v_exp_f32 v86, v86
    v_exp_f32 v87, v87
    v_cvt_pk_bf16_f32 v102, v84, v85
    s_nop 0
    v_cvt_pk_bf16_f32 v103, v86, v87
    v_exp_f32 v56, v56
    v_exp_f32 v57, v57
    v_mfma_f32_32x32x16_bf16 v[120:135], v[48:51], v[96:99], v[120:135]
    v_exp_f32 v58, v58
    v_exp_f32 v59, v59
    ds_read_b128 v[28:31], v144 offset:7168
    v_cvt_pk_bf16_f32 v88, v56, v57
    v_exp_f32 v60, v60
    v_mfma_f32_32x32x16_bf16 v[120:135], v[52:55], v[100:103], v[120:135]
    v_exp_f32 v61, v61
    ds_read_b32 v36, v145 offset:896
    v_cvt_pk_bf16_f32 v89, v58, v59
    v_exp_f32 v62, v62
    v_mfma_f32_32x32x16_bf16 v[72:87], v[24:27], v[16:19], 0
    v_exp_f32 v63, v63
    v_cvt_pk_bf16_f32 v90, v60, v61
    v_exp_f32 v64, v64
    v_exp_f32 v65, v65
    v_mfma_f32_32x32x16_bf16 v[72:87], v[32:35], v[20:23], v[72:87]
    v_cvt_pk_bf16_f32 v91, v62, v63
    v_exp_f32 v66, v66
    v_exp_f32 v67, v67
    v_cvt_pk_bf16_f32 v92, v64, v65
    v_exp_f32 v68, v68
    v_exp_f32 v69, v69
    v_cvt_pk_bf16_f32 v93, v66, v67
    v_exp_f32 v70, v70
    v_exp_f32 v71, v71
    v_cvt_pk_bf16_f32 v94, v68, v69
    s_nop 0
    v_cvt_pk_bf16_f32 v95, v70, v71
    v_exp_f32 v72, v72
    v_exp_f32 v73, v73
    s_waitcnt lgkmcnt(0)
    v_mfma_f32_32x32x16_bf16 v[104:119], v[40:43], v[88:91], v[104:119]
    v_exp_f32 v74, v74
    v_exp_f32 v75, v75
    ds_read_b128 v[48:51], v146 offset:8960
    v_cvt_pk_bf16_f32 v96, v72, v73
    v_exp_f32 v76, v76
    v_mfma_f32_32x32x16_bf16 v[104:119], v[44:47], v[92:95], v[104:119]
    v_exp_f32 v77, v77
    ds_read_b128 v[52:55], v146 offset:9600
    v_cvt_pk_bf16_f32 v97, v74, v75
    v_exp_f32 v78, v78
    v_mfma_f32_32x32x16_bf16 v[56:71], v[28:31], v[8:11], 0
    v_exp_f32 v79, v79
    v_cvt_pk_bf16_f32 v98, v76, v77
    v_exp_f32 v80, v80
    v_exp_f32 v81, v81
    v_mfma_f32_32x32x16_bf16 v[56:71], v[36:39], v[12:15], v[56:71]
    v_cvt_pk_bf16_f32 v99, v78, v79
    v_exp_f32 v82, v82
    v_exp_f32 v83, v83
    v_cvt_pk_bf16_f32 v100, v80, v81
    v_exp_f32 v84, v84
    v_exp_f32 v85, v85
    v_cvt_pk_bf16_f32 v101, v82, v83
    v_exp_f32 v86, v86
    v_exp_f32 v87, v87
    v_cvt_pk_bf16_f32 v102, v84, v85
    s_nop 0
    v_cvt_pk_bf16_f32 v103, v86, v87
    s_waitcnt vmcnt(5)
    s_barrier
    v_exp_f32 v56, v56
    v_exp_f32 v57, v57
    v_mfma_f32_32x32x16_bf16 v[120:135], v[40:43], v[96:99], v[120:135]
    v_exp_f32 v58, v58
    v_exp_f32 v59, v59
    ds_read_b128 v[24:27], v141 offset:0
    v_cvt_pk_bf16_f32 v88, v56, v57
    v_exp_f32 v60, v60
    v_mfma_f32_32x32x16_bf16 v[120:135], v[44:47], v[100:103], v[120:135]
    v_exp_f32 v61, v61
    ds_read_b32 v32, v142 offset:0
    v_cvt_pk_bf16_f32 v89, v58, v59
    v_exp_f32 v62, v62
    v_mfma_f32_32x32x16_bf16 v[72:87], v[28:31], v[16:19], 0
    v_exp_f32 v63, v63
    v_cvt_pk_bf16_f32 v90, v60, v61
    v_exp_f32 v64, v64
    v_exp_f32 v65, v65
    v_mfma_f32_32x32x16_bf16 v[72:87], v[36:39], v[20:23], v[72:87]
    v_cvt_pk_bf16_f32 v91, v62, v63
    v_exp_f32 v66, v66
    v_exp_f32 v67, v67
    v_cvt_pk_bf16_f32 v92, v64, v65
    v_exp_f32 v68, v68
    v_exp_f32 v69, v69
    v_cvt_pk_bf16_f32 v93, v66, v67
    v_exp_f32 v70, v70
    v_exp_f32 v71, v71
    v_cvt_pk_bf16_f32 v94, v68, v69
    s_nop 0
    v_cvt_pk_bf16_f32 v95, v70, v71
    v_exp_f32 v72, v72
    v_exp_f32 v73, v73
    s_waitcnt lgkmcnt(0)
    v_mfma_f32_32x32x16_bf16 v[104:119], v[48:51], v[88:91], v[104:119]
    v_exp_f32 v74, v74
    v_exp_f32 v75, v75
    ds_read_b128 v[40:43], v143 offset:0
    v_cvt_pk_bf16_f32 v96, v72, v73
    v_exp_f32 v76, v76
    v_mfma_f32_32x32x16_bf16 v[104:119], v[52:55], v[92:95], v[104:119]
    v_exp_f32 v77, v77
    ds_read_b128 v[44:47], v143 offset:640
    v_cvt_pk_bf16_f32 v97, v74, v75
    v_exp_f32 v78, v78
    v_mfma_f32_32x32x16_bf16 v[56:71], v[24:27], v[8:11], 0
    v_exp_f32 v79, v79
    s_mov_b32 m0, s53
    s_nop 0
    buffer_load_dwordx4 v1, s[12:15], s51 offen lds
    v_cvt_pk_bf16_f32 v98, v76, v77
    v_exp_f32 v80, v80
    v_exp_f32 v81, v81
    buffer_load_dwordx4 v1, s[12:15], s51 offen offset:1024 lds
    v_mfma_f32_32x32x16_bf16 v[56:71], v[32:35], v[12:15], v[56:71]
    v_cvt_pk_bf16_f32 v99, v78, v79
    v_exp_f32 v82, v82
    v_exp_f32 v83, v83
    buffer_load_dwordx4 v1, s[12:15], s51 offen offset:2048 lds
    v_cvt_pk_bf16_f32 v100, v80, v81
    v_exp_f32 v84, v84
    v_exp_f32 v85, v85
    buffer_load_dwordx4 v1, s[12:15], s51 offen offset:3072 lds
    v_cvt_pk_bf16_f32 v101, v82, v83
    v_exp_f32 v86, v86
    v_exp_f32 v87, v87
    s_add_u32 m0, s53, 4096
    s_add_u32 s36, s51, 4096
    buffer_load_dwordx4 v1, s[12:15], s36 offen lds
    s_add_u32 s51, s51, 20480
    v_cvt_pk_bf16_f32 v102, v84, v85
    s_nop 0
    v_cvt_pk_bf16_f32 v103, v86, v87
    v_mov_b32 v144, v141
    v_mov_b32 v145, v142
    v_mov_b32 v146, v143
    s_sub_u32 s52, s52, 1
    s_cmp_lg_u32 s52, 0
    s_cbranch_scc1 L_aloop_91
    s_waitcnt vmcnt(0) lgkmcnt(0)
    s_nop 1
    v_mfma_f32_32x32x16_bf16 v[120:135], v[48:51], v[96:99], v[120:135]
    v_mfma_f32_32x32x16_bf16 v[120:135], v[52:55], v[100:103], v[120:135]
    s_nop 15
    s_nop 3
    s_mov_b32 s42, 0
L_afin_92:
    s_mov_b32 s44, 0x67800000
    v_mov_b32 v136, v114
    v_mov_b32 v137, v114
    s_nop 1
    v_permlane32_swap_b32 v136, v137
    s_nop 1
    v_mov_b32 v138, v130
    v_mov_b32 v139, v130
    s_nop 1
    v_permlane32_swap_b32 v138, v139
    s_nop 1
    v_cmp_nlt_f32 vcc, v136, s44
    s_mov_b64 s[46:47], vcc
    v_cmp_nlt_f32 vcc, v138, s44
    s_or_b64 vcc, vcc, s[46:47]
    s_cbranch_vccz L_aok_93
    s_cmp_eq_u32 s42, 0
    s_cbranch_scc1 L_afb_94
L_aok_93:
    v_rcp_f32 v136, v136
    s_nop 0
    v_mul_f32 v104, v136, v104
    v_mul_f32 v105, v136, v105
    v_mul_f32 v106, v136, v106
    v_mul_f32 v107, v136, v107
    v_mul_f32 v108, v136, v108
    v_mul_f32 v109, v136, v109
    v_mul_f32 v110, v136, v110
    v_mul_f32 v111, v136, v111
    v_mul_f32 v112, v136, v112
    v_mul_f32 v113, v136, v113
    v_cvt_pk_bf16_f32 v56, v104, v105
    v_cvt_pk_bf16_f32 v57, v106, v107
    v_cvt_pk_bf16_f32 v58, v108, v109
    v_cvt_pk_bf16_f32 v59, v110, v111
    v_cvt_pk_bf16_f32 v60, v112, v113
    v_lshrrev_b32 v5, 4, v2
    v_mul_u32_u24 v5, 4608, v5
    v_and_b32 v142, 15, v0
    v_lshl_add_u32 v5, v142, 4, v5
    s_mul_i32 s43, s34, 36
    v_lshl_add_u32 v142, v3, 2, s43
    v_add_u32 v143, 0, v142
    v_lshrrev_b32 v144, 3, v143
    v_and_b32 v143, 7, v143
    v_lshl_add_u32 v144, v144, 8, v5
    v_lshl_add_u32 v144, v143, 1, v144
    ds_write_b32 v144, v56
    v_add_u32 v143, 2, v142
    v_lshrrev_b32 v144, 3, v143
    v_and_b32 v143, 7, v143
    v_lshl_add_u32 v144, v144, 8, v5
    v_lshl_add_u32 v144, v143, 1, v144
    ds_write_b32 v144, v57
    v_add_u32 v143, 8, v142
    v_lshrrev_b32 v144, 3, v143
    v_and_b32 v143, 7, v143
    v_lshl_add_u32 v144, v144, 8, v5
    v_lshl_add_u32 v144, v143, 1, v144
    ds_write_b32 v144, v58
    v_add_u32 v143, 10, v142
    v_lshrrev_b32 v144, 3, v143
    v_and_b32 v143, 7, v143
    v_lshl_add_u32 v144, v144, 8, v5
    v_lshl_add_u32 v144, v143, 1, v144
    ds_write_b32 v144, v59
    v_add_u32 v143, 16, v142
    v_lshrrev_b32 v144, 3, v143
    v_and_b32 v143, 7, v143
    v_lshl_add_u32 v144, v144, 8, v5
    v_lshl_add_u32 v144, v143, 1, v144
    s_and_saveexec_b64 s[46:47], s[40:41]
    ds_write_b32 v144, v60
    s_mov_b64 exec, s[46:47]
    v_rcp_f32 v138, v138
    s_nop 0
    v_mul_f32 v120, v138, v120
    v_mul_f32 v121, v138, v121
    v_mul_f32 v122, v138, v122
    v_mul_f32 v123, v138, v123
    v_mul_f32 v124, v138, v124
    v_mul_f32 v125, v138, v125
    v_mul_f32 v126, v138, v126
    v_mul_f32 v127, v138, v127
    v_mul_f32 v128, v138, v128
    v_mul_f32 v129, v138, v129
    v_cvt_pk_bf16_f32 v72, v120, v121
    v_cvt_pk_bf16_f32 v73, v122, v123
    v_cvt_pk_bf16_f32 v74, v124, v125
    v_cvt_pk_bf16_f32 v75, v126, v127
    v_cvt_pk_bf16_f32 v76, v128, v129
    v_lshl_add_u32 v142, v3, 2, s43
    v_add_u32 v143, 18, v142
    v_lshrrev_b32 v144, 3, v143
    v_and_b32 v143, 7, v143
    v_lshl_add_u32 v144, v144, 8, v5
    v_lshl_add_u32 v144, v143, 1, v144
    ds_write_b32 v144, v72
    v_add_u32 v143, 20, v142
    v_lshrrev_b32 v144, 3, v143
    v_and_b32 v143, 7, v143
    v_lshl_add_u32 v144, v144, 8, v5
    v_lshl_add_u32 v144, v143, 1, v144
    ds_write_b32 v144, v73
    v_add_u32 v143, 26, v142
    v_lshrrev_b32 v144, 3, v143
    v_and_b32 v143, 7, v143
    v_lshl_add_u32 v144, v144, 8, v5
    v_lshl_add_u32 v144, v143, 1, v144
    ds_write_b32 v144, v74
    v_add_u32 v143, 28, v142
    v_lshrrev_b32 v144, 3, v143
    v_and_b32 v143, 7, v143
    v_lshl_add_u32 v144, v144, 8, v5
    v_lshl_add_u32 v144, v143, 1, v144
    ds_write_b32 v144, v75
    v_add_u32 v143, 34, v142
    v_lshrrev_b32 v144, 3, v143
    v_and_b32 v143, 7, v143
    v_lshl_add_u32 v144, v144, 8, v5
    v_lshl_add_u32 v144, v143, 1, v144
    s_and_saveexec_b64 s[46:47], s[40:41]
    ds_write_b32 v144, v76
    s_mov_b64 exec, s[46:47]
    s_waitcnt lgkmcnt(0)
    s_barrier
    s_lshr_b32 s45, s66, 2
    s_mul_i32 s45, s45, 36864
    s_and_b32 s43, s66, 3
    s_mul_i32 s43, s43, 4608
    s_add_u32 s45, s45, s43
    s_lshl_b32 s43, s34, 10
    s_add_u32 s43, s43, 0
    v_add_u32 v136, s43, v1
    ds_read_b128 v[56:59], v136
    v_cmp_le_u32 vcc, 4608, v136
    v_add_u32 v137, 13824, v136
    s_nop 0
    v_cndmask_b32 v136, v136, v137, vcc
    s_waitcnt lgkmcnt(0)
    buffer_store_dwordx4 v[56:59], v136, s[20:23], s45 offen sc1
    s_nop 1
    s_lshl_b32 s43, s34, 10
    s_add_u32 s43, s43, 4096
    v_add_u32 v136, s43, v1
    ds_read_b128 v[56:59], v136
    v_cmp_le_u32 vcc, 4608, v136
    v_add_u32 v137, 13824, v136
    s_nop 0
    v_cndmask_b32 v136, v136, v137, vcc
    s_waitcnt lgkmcnt(0)
    buffer_store_dwordx4 v[56:59], v136, s[20:23], s45 offen sc1
    s_nop 1
    s_cmp_lg_u32 s34, 0
    s_cbranch_scc1 L_ost_95
    s_lshl_b32 s43, s34, 10
    s_add_u32 s43, s43, 8192
    v_add_u32 v136, s43, v1
    ds_read_b128 v[56:59], v136
    v_cmp_le_u32 vcc, 4608, v136
    v_add_u32 v137, 13824, v136
    s_nop 0
    v_cndmask_b32 v136, v136, v137, vcc
    s_waitcnt lgkmcnt(0)
    buffer_store_dwordx4 v[56:59], v136, s[20:23], s45 offen sc1
    s_nop 1
L_ost_95:
    s_branch L_k3_adone
L_afb_94:
    s_mov_b32 s42, 1
    v_mov_b32 v13, 0
    v_mov_b32 v140, 0xf149f2ca
    v_mov_b32 v21, 0
    v_mov_b32 v141, 0xf149f2ca
    s_mov_b32 s45, 0
L_aml_96:
    s_lshr_b32 s46, s45, 3
    s_mul_i32 s46, s46, 20480
    s_and_b32 s49, s45, 7
    s_lshl_b32 s47, s49, 7
    s_add_u32 s47, s47, s46
    s_mul_i32 s48, s49, 1280
    s_add_u32 s48, s48, s46
    s_lshl_b32 s49, s49, 10
    s_add_u32 s46, s46, s49
    buffer_load_dwordx4 v[24:27], v1, s[12:15], s46 offen
    buffer_load_dword v32, v6, s[12:15], s47 offen
    s_waitcnt vmcnt(0)
    v_mfma_f32_32x32x16_bf16 v[56:71], v[24:27], v[8:11], 0
    v_mfma_f32_32x32x16_bf16 v[56:71], v[32:35], v[12:15], v[56:71]
    v_mfma_f32_32x32x16_bf16 v[72:87], v[24:27], v[16:19], 0
    v_mfma_f32_32x32x16_bf16 v[72:87], v[32:35], v[20:23], v[72:87]
    s_nop 15
    s_nop 3
    v_max3_f32 v140, v140, v56, v57
    v_max3_f32 v140, v140, v58, v59
    v_max3_f32 v140, v140, v60, v61
    v_max3_f32 v140, v140, v62, v63
    v_max3_f32 v140, v140, v64, v65
    v_max3_f32 v140, v140, v66, v67
    v_max3_f32 v140, v140, v68, v69
    v_max3_f32 v140, v140, v70, v71
    v_max3_f32 v141, v141, v72, v73
    v_max3_f32 v141, v141, v74, v75
    v_max3_f32 v141, v141, v76, v77
    v_max3_f32 v141, v141, v78, v79
    v_max3_f32 v141, v141, v80, v81
    v_max3_f32 v141, v141, v82, v83
    v_max3_f32 v141, v141, v84, v85
    v_max3_f32 v141, v141, v86, v87
    s_add_u32 s45, s45, 1
    s_cmp_lt_u32 s45, 64
    s_cbranch_scc1 L_aml_96
    v_mov_b32 v136, v140
    v_mov_b32 v137, v140
    s_nop 1
    v_permlane32_swap_b32 v136, v137
    s_nop 1
    v_max_f32 v140, v136, v137
    v_sub_f32 v140, 0, v140
    v_cvt_pk_bf16_f32 v140, v140, 0
    v_cndmask_b32 v13, 0, v140, s[40:41]
    v_mov_b32 v104, 0
    v_mov_b32 v105, 0
    v_mov_b32 v106, 0
    v_mov_b32 v107, 0
    v_mov_b32 v108, 0
    v_mov_b32 v109, 0
    v_mov_b32 v110, 0
    v_mov_b32 v111, 0
    v_mov_b32 v112, 0
    v_mov_b32 v113, 0
    v_mov_b32 v114, 0
    v_mov_b32 v115, 0
    v_mov_b32 v116, 0
    v_mov_b32 v117, 0
    v_mov_b32 v118, 0
    v_mov_b32 v119, 0
    v_mov_b32 v136, v141
    v_mov_b32 v137, v141
    s_nop 1
    v_permlane32_swap_b32 v136, v137
    s_nop 1
    v_max_f32 v141, v136, v137
    v_sub_f32 v141, 0, v141
    v_cvt_pk_bf16_f32 v141, v141, 0
    v_cndmask_b32 v21, 0, v141, s[40:41]
    v_mov_b32 v120, 0
    v_mov_b32 v121, 0
    v_mov_b32 v122, 0
    v_mov_b32 v123, 0
    v_mov_b32 v124, 0
    v_mov_b32 v125, 0
    v_mov_b32 v126, 0
    v_mov_b32 v127, 0
    v_mov_b32 v128, 0
    v_mov_b32 v129, 0
    v_mov_b32 v130, 0
    v_mov_b32 v131, 0
    v_mov_b32 v132, 0
    v_mov_b32 v133, 0
    v_mov_b32 v134, 0
    v_mov_b32 v135, 0
    s_mov_b32 s45, 0
L_arl_97:
    s_lshr_b32 s46, s45, 3
    s_mul_i32 s46, s46, 20480
    s_and_b32 s49, s45, 7
    s_lshl_b32 s47, s49, 7
    s_add_u32 s47, s47, s46
    s_mul_i32 s48, s49, 1280
    s_add_u32 s48, s48, s46
    s_lshl_b32 s49, s49, 10
    s_add_u32 s46, s46, s49
    buffer_load_dwordx4 v[24:27], v1, s[12:15], s46 offen
    buffer_load_dword v32, v6, s[12:15], s47 offen
    buffer_load_dwordx4 v[40:43], v7, s[12:15], s48 offen
    buffer_load_dwordx4 v[44:47], v7, s[12:15], s48 offen offset:640
    s_waitcnt vmcnt(0)
    v_mfma_f32_32x32x16_bf16 v[56:71], v[24:27], v[8:11], 0
    v_mfma_f32_32x32x16_bf16 v[56:71], v[32:35], v[12:15], v[56:71]
    v_mfma_f32_32x32x16_bf16 v[72:87], v[24:27], v[16:19], 0
    v_mfma_f32_32x32x16_bf16 v[72:87], v[32:35], v[20:23], v[72:87]
    s_nop 15
    s_nop 3
    v_exp_f32 v56, v56
    v_exp_f32 v57, v57
    v_exp_f32 v58, v58
    v_exp_f32 v59, v59
    v_exp_f32 v60, v60
    v_exp_f32 v61, v61
    v_exp_f32 v62, v62
    v_exp_f32 v63, v63
    v_exp_f32 v64, v64
    v_exp_f32 v65, v65
    v_exp_f32 v66, v66
    v_exp_f32 v67, v67
    v_exp_f32 v68, v68
    v_exp_f32 v69, v69
    v_exp_f32 v70, v70
    v_exp_f32 v71, v71
    s_nop 0
    v_cvt_pk_bf16_f32 v88, v56, v57
    v_cvt_pk_bf16_f32 v89, v58, v59
    v_cvt_pk_bf16_f32 v90, v60, v61
    v_cvt_pk_bf16_f32 v91, v62, v63
    v_cvt_pk_bf16_f32 v92, v64, v65
    v_cvt_pk_bf16_f32 v93, v66, v67
    v_cvt_pk_bf16_f32 v94, v68, v69
    v_cvt_pk_bf16_f32 v95, v70, v71
    s_nop 1
    v_mfma_f32_32x32x16_bf16 v[104:119], v[40:43], v[88:91], v[104:119]
    v_mfma_f32_32x32x16_bf16 v[104:119], v[44:47], v[92:95], v[104:119]
    v_exp_f32 v72, v72
    v_exp_f32 v73, v73
    v_exp_f32 v74, v74
    v_exp_f32 v75, v75
    v_exp_f32 v76, v76
    v_exp_f32 v77, v77
    v_exp_f32 v78, v78
    v_exp_f32 v79, v79
    v_exp_f32 v80, v80
    v_exp_f32 v81, v81
    v_exp_f32 v82, v82
    v_exp_f32 v83, v83
    v_exp_f32 v84, v84
    v_exp_f32 v85, v85
    v_exp_f32 v86, v86
    v_exp_f32 v87, v87
    s_nop 0
    v_cvt_pk_bf16_f32 v96, v72, v73
    v_cvt_pk_bf16_f32 v97, v74, v75
    v_cvt_pk_bf16_f32 v98, v76, v77
    v_cvt_pk_bf16_f32 v99, v78, v79
    v_cvt_pk_bf16_f32 v100, v80, v81
    v_cvt_pk_bf16_f32 v101, v82, v83
    v_cvt_pk_bf16_f32 v102, v84, v85
    v_cvt_pk_bf16_f32 v103, v86, v87
    s_nop 1
    v_mfma_f32_32x32x16_bf16 v[120:135], v[40:43], v[96:99], v[120:135]
    v_mfma_f32_32x32x16_bf16 v[120:135], v[44:47], v[100:103], v[120:135]
    s_add_u32 s45, s45, 1
    s_cmp_lt_u32 s45, 64
    s_cbranch_scc1 L_arl_97
    s_nop 15
    s_nop 3
    s_branch L_afin_92
L_k3_adone:
    s_waitcnt vmcnt(0)
    s_barrier
    s_cmp_lg_u32 s34, 0
    s_cbranch_scc1 L_k3_a2
    s_lshr_b32 s3, s66, 2
    s_lshl_b32 s3, s3, 7
    v_mov_b32 v2, 0
    v_mov_b32 v3, 1
    v_cmp_eq_u32 vcc, 0, v0
    s_and_saveexec_b64 s[64:65], vcc
    buffer_atomic_add v3, v2, s[60:63], s3 offen
    s_mov_b64 exec, s[64:65]
L_k3_a2:
    s_cmp_eq_u32 s67, 0
    s_cbranch_scc1 L_k3_end
    s_setprio 0
    s_branch L_k3_next
L_k3_o:
    s_sub_u32 s3, s2, 256
    s_load_dwordx2 s[6:7], s[0:1], 104
    s_load_dwordx2 s[10:11], s[0:1], 88
    s_load_dwordx2 s[8:9], s[0:1], 80
    v_lshrrev_b32 v1, 6, v0
    v_and_b32 v0, 63, v0
    v_readfirstlane_b32 s34, v1
    s_and_b32 s35, s3, 7
    s_lshr_b32 s36, s3, 3
    s_mul_i32 s37, s35, 234
    s_add_u32 s38, s37, 234
    s_lshr_b32 s37, s37, 3
    s_lshr_b32 s38, s38, 3
    s_add_u32 s37, s37, s36
    s_cmp_ge_u32 s37, s38
    s_cbranch_scc1 L_k3_end
    s_mul_i32 s32, s37, 7282
    s_lshr_b32 s32, s32, 16
    s_mul_i32 s33, s32, 9
    s_sub_u32 s33, s37, s33
    s_waitcnt lgkmcnt(0)
    s_movk_i32 s38, 1152
    s_movk_i32 s35, 1152
    s_lshl_b32 s43, s33, 7
    s_mov_b32 s46, s43
    s_add_u32 s12, s6, 33554432
    s_addc_u32 s13, s7, 0
    s_mov_b32 s14, 16777216
    s_mov_b32 s15, 0x00020000
    s_mov_b32 s16, s8
    s_mov_b32 s17, s9
    s_mov_b32 s18, 4718592
    s_mov_b32 s19, 0x00020000
    s_mov_b32 s20, s10
    s_mov_b32 s21, s11
    s_mov_b32 s22, 4718592
    s_mov_b32 s23, 0x00020000
    v_lshrrev_b32 v8, 4, v0
    v_lshlrev_b32 v9, 9, v8
    v_and_b32 v11, 15, v0
    v_lshl_add_u32 v2, v11, 4, v9
    v_lshrrev_b32 v9, 3, v0
    v_mul_lo_u32 v10, v9, s35
    v_lshrrev_b32 v9, 1, v9
    v_lshlrev_b32 v9, 1, v9
    v_and_b32 v11, 7, v0
    v_xor_b32 v9, v9, v11
    v_lshl_add_u32 v3, v9, 4, v10
    s_mul_i32 s39, s34, 20480
    s_mul_i32 s40, s32, 5
    s_lshl_b32 s41, s34, 11
    s_add_u32 s44, s40, 0
    s_lshr_b32 s45, s44, 1
    s_lshl_b32 s45, s45, 18
    s_and_b32 s44, s44, 1
    s_lshl_b32 s44, s44, 8
    s_add_u32 s44, s44, s45
    s_add_u32 s52, s44, s41
    s_add_u32 s44, s40, 1
    s_lshr_b32 s45, s44, 1
    s_lshl_b32 s45, s45, 18
    s_and_b32 s44, s44, 1
    s_lshl_b32 s44, s44, 8
    s_add_u32 s44, s44, s45
    s_add_u32 s53, s44, s41
    s_add_u32 s44, s40, 2
    s_lshr_b32 s45, s44, 1
    s_lshl_b32 s45, s45, 18
    s_and_b32 s44, s44, 1
    s_lshl_b32 s44, s44, 8
    s_add_u32 s44, s44, s45
    s_add_u32 s54, s44, s41
    s_add_u32 s44, s40, 3
    s_lshr_b32 s45, s44, 1
    s_lshl_b32 s45, s45, 18
    s_and_b32 s44, s44, 1
    s_lshl_b32 s44, s44, 8
    s_add_u32 s44, s44, s45
    s_add_u32 s55, s44, s41
    s_add_u32 s44, s40, 4
    s_lshr_b32 s45, s44, 1
    s_lshl_b32 s45, s45, 18
    s_and_b32 s44, s44, 1
    s_lshl_b32 s44, s44, 8
    s_add_u32 s44, s44, s45
    s_add_u32 s56, s44, s41
    s_lshl_b32 s47, s35, 3
    s_lshl_b32 s48, s35, 5
    s_mul_i32 s42, s34, s48
    s_add_u32 s42, s42, s46
    s_mul_i32 s48, s35, 104
    s_add_u32 m0, s39, 0
    s_nop 0
    buffer_load_dwordx4 v3, s[16:19], s42 offen lds
    s_add_u32 s42, s42, s47
    s_add_u32 m0, s39, 1024
    s_nop 0
    buffer_load_dwordx4 v3, s[16:19], s42 offen lds
    s_add_u32 s42, s42, s47
    s_add_u32 m0, s39, 2048
    s_nop 0
    buffer_load_dwordx4 v3, s[16:19], s42 offen lds
    s_add_u32 s42, s42, s47
    s_add_u32 m0, s39, 3072
    s_nop 0
    buffer_load_dwordx4 v3, s[16:19], s42 offen lds
    s_add_u32 s42, s42, s48
    buffer_load_dwordx4 v[48:51], v2, s[12:15], s52 offen
    s_add_u32 s52, s52, 8192
    buffer_load_dwordx4 v[52:55], v2, s[12:15], s53 offen
    s_add_u32 s53, s53, 8192
    buffer_load_dwordx4 v[56:59], v2, s[12:15], s54 offen
    s_add_u32 s54, s54, 8192
    buffer_load_dwordx4 v[60:63], v2, s[12:15], s55 offen
    s_add_u32 s55, s55, 8192
    buffer_load_dwordx4 v[64:67], v2, s[12:15], s56 offen
    s_add_u32 s56, s56, 8192
    s_add_u32 m0, s39, 4096
    s_nop 0
    buffer_load_dwordx4 v3, s[16:19], s42 offen lds
    s_add_u32 s42, s42, s47
    s_add_u32 m0, s39, 5120
    s_nop 0
    buffer_load_dwordx4 v3, s[16:19], s42 offen lds
    s_add_u32 s42, s42, s47
    s_add_u32 m0, s39, 6144
    s_nop 0
    buffer_load_dwordx4 v3, s[16:19], s42 offen lds
    s_add_u32 s42, s42, s47
    s_add_u32 m0, s39, 7168
    s_nop 0
    buffer_load_dwordx4 v3, s[16:19], s42 offen lds
    s_add_u32 s42, s42, s48
    buffer_load_dwordx4 v[68:71], v2, s[12:15], s52 offen
    s_add_u32 s52, s52, 8192
    buffer_load_dwordx4 v[72:75], v2, s[12:15], s53 offen
    s_add_u32 s53, s53, 8192
    buffer_load_dwordx4 v[76:79], v2, s[12:15], s54 offen
    s_add_u32 s54, s54, 8192
    buffer_load_dwordx4 v[80:83], v2, s[12:15], s55 offen
    s_add_u32 s55, s55, 8192
    buffer_load_dwordx4 v[84:87], v2, s[12:15], s56 offen
    s_add_u32 s56, s56, 8192
    s_add_u32 m0, s39, 8192
    s_nop 0
    buffer_load_dwordx4 v3, s[16:19], s42 offen lds
    s_add_u32 s42, s42, s47
    s_add_u32 m0, s39, 9216
    s_nop 0
    buffer_load_dwordx4 v3, s[16:19], s42 offen lds
    s_add_u32 s42, s42, s47
    s_add_u32 m0, s39, 10240
    s_nop 0
    buffer_load_dwordx4 v3, s[16:19], s42 offen lds
    s_add_u32 s42, s42, s47
    s_add_u32 m0, s39, 11264
    s_nop 0
    buffer_load_dwordx4 v3, s[16:19], s42 offen lds
    s_add_u32 s42, s42, s48
    buffer_load_dwordx4 v[88:91], v2, s[12:15], s52 offen
    s_add_u32 s52, s52, 8192
    buffer_load_dwordx4 v[92:95], v2, s[12:15], s53 offen
    s_add_u32 s53, s53, 8192
    buffer_load_dwordx4 v[96:99], v2, s[12:15], s54 offen
    s_add_u32 s54, s54, 8192
    buffer_load_dwordx4 v[100:103], v2, s[12:15], s55 offen
    s_add_u32 s55, s55, 8192
    buffer_load_dwordx4 v[104:107], v2, s[12:15], s56 offen
    s_add_u32 s56, s56, 8192
    s_add_u32 m0, s39, 12288
    s_nop 0
    buffer_load_dwordx4 v3, s[16:19], s42 offen lds
    s_add_u32 s42, s42, s47
    s_add_u32 m0, s39, 13312
    s_nop 0
    buffer_load_dwordx4 v3, s[16:19], s42 offen lds
    s_add_u32 s42, s42, s47
    s_add_u32 m0, s39, 14336
    s_nop 0
    buffer_load_dwordx4 v3, s[16:19], s42 offen lds
    s_add_u32 s42, s42, s47
    s_add_u32 m0, s39, 15360
    s_nop 0
    buffer_load_dwordx4 v3, s[16:19], s42 offen lds
    s_add_u32 s42, s42, s48
    buffer_load_dwordx4 v[108:111], v2, s[12:15], s52 offen
    s_add_u32 s52, s52, 8192
    buffer_load_dwordx4 v[112:115], v2, s[12:15], s53 offen
    s_add_u32 s53, s53, 8192
    buffer_load_dwordx4 v[116:119], v2, s[12:15], s54 offen
    s_add_u32 s54, s54, 8192
    buffer_load_dwordx4 v[120:123], v2, s[12:15], s55 offen
    s_add_u32 s55, s55, 8192
    buffer_load_dwordx4 v[124:127], v2, s[12:15], s56 offen
    s_add_u32 s56, s56, 8192
    v_lshrrev_b32 v10, 2, v0
    v_and_b32 v10, 3, v10
    v_and_b32 v11, 3, v0
    v_lshrrev_b32 v9, 1, v8
    v_lshlrev_b32 v9, 4, v9
    v_and_b32 v15, 1, v8
    v_lshl_add_u32 v9, v15, 2, v9
    v_add_u32 v9, v9, v10
    v_lshlrev_b32 v9, 7, v9
    v_lshl_add_u32 v9, v11, 3, v9
    v_add_u32 v9, s39, v9
    v_lshrrev_b32 v1, 1, v10
    v_lshl_add_u32 v1, v15, 1, v1
    v_lshl_add_u32 v4, v1, 5, v9
    v_xor_b32 v5, 32, v4
    v_xor_b32 v6, 64, v4
    v_xor_b32 v7, 96, v4
    v_accvgpr_write_b32 a0, 0
    v_accvgpr_write_b32 a1, 0
    v_accvgpr_write_b32 a2, 0
    v_accvgpr_write_b32 a3, 0
    v_accvgpr_write_b32 a4, 0
    v_accvgpr_write_b32 a5, 0
    v_accvgpr_write_b32 a6, 0
    v_accvgpr_write_b32 a7, 0
    v_accvgpr_write_b32 a8, 0
    v_accvgpr_write_b32 a9, 0
    v_accvgpr_write_b32 a10, 0
    v_accvgpr_write_b32 a11, 0
    v_accvgpr_write_b32 a12, 0
    v_accvgpr_write_b32 a13, 0
    v_accvgpr_write_b32 a14, 0
    v_accvgpr_write_b32 a15, 0
    v_accvgpr_write_b32 a16, 0
    v_accvgpr_write_b32 a17, 0
    v_accvgpr_write_b32 a18, 0
    v_accvgpr_write_b32 a19, 0
    v_accvgpr_write_b32 a20, 0
    v_accvgpr_write_b32 a21, 0
    v_accvgpr_write_b32 a22, 0
    v_accvgpr_write_b32 a23, 0
    v_accvgpr_write_b32 a24, 0
    v_accvgpr_write_b32 a25, 0
    v_accvgpr_write_b32 a26, 0
    v_accvgpr_write_b32 a27, 0
    v_accvgpr_write_b32 a28, 0
    v_accvgpr_write_b32 a29, 0
    v_accvgpr_write_b32 a30, 0
    v_accvgpr_write_b32 a31, 0
    v_accvgpr_write_b32 a32, 0
    v_accvgpr_write_b32 a33, 0
    v_accvgpr_write_b32 a34, 0
    v_accvgpr_write_b32 a35, 0
    v_accvgpr_write_b32 a36, 0
    v_accvgpr_write_b32 a37, 0
    v_accvgpr_write_b32 a38, 0
    v_accvgpr_write_b32 a39, 0
    v_accvgpr_write_b32 a40, 0
    v_accvgpr_write_b32 a41, 0
    v_accvgpr_write_b32 a42, 0
    v_accvgpr_write_b32 a43, 0
    v_accvgpr_write_b32 a44, 0
    v_accvgpr_write_b32 a45, 0
    v_accvgpr_write_b32 a46, 0
    v_accvgpr_write_b32 a47, 0
    v_accvgpr_write_b32 a48, 0
    v_accvgpr_write_b32 a49, 0
    v_accvgpr_write_b32 a50, 0
    v_accvgpr_write_b32 a51, 0
    v_accvgpr_write_b32 a52, 0
    v_accvgpr_write_b32 a53, 0
    v_accvgpr_write_b32 a54, 0
    v_accvgpr_write_b32 a55, 0
    v_accvgpr_write_b32 a56, 0
    v_accvgpr_write_b32 a57, 0
    v_accvgpr_write_b32 a58, 0
    v_accvgpr_write_b32 a59, 0
    v_accvgpr_write_b32 a60, 0
    v_accvgpr_write_b32 a61, 0
    v_accvgpr_write_b32 a62, 0
    v_accvgpr_write_b32 a63, 0
    v_accvgpr_write_b32 a64, 0
    v_accvgpr_write_b32 a65, 0
    v_accvgpr_write_b32 a66, 0
    v_accvgpr_write_b32 a67, 0
    v_accvgpr_write_b32 a68, 0
    v_accvgpr_write_b32 a69, 0
    v_accvgpr_write_b32 a70, 0
    v_accvgpr_write_b32 a71, 0
    v_accvgpr_write_b32 a72, 0
    v_accvgpr_write_b32 a73, 0
    v_accvgpr_write_b32 a74, 0
    v_accvgpr_write_b32 a75, 0
    v_accvgpr_write_b32 a76, 0
    v_accvgpr_write_b32 a77, 0
    v_accvgpr_write_b32 a78, 0
    v_accvgpr_write_b32 a79, 0
    s_waitcnt vmcnt(27)
    ds_read_b64_tr_b16 v[16:17], v4 offset:0
    ds_read_b64_tr_b16 v[18:19], v4 offset:1024
    ds_read_b64_tr_b16 v[20:21], v5 offset:0
    ds_read_b64_tr_b16 v[22:23], v5 offset:1024
    ds_read_b64_tr_b16 v[24:25], v6 offset:0
    ds_read_b64_tr_b16 v[26:27], v6 offset:1024
    ds_read_b64_tr_b16 v[28:29], v7 offset:0
    ds_read_b64_tr_b16 v[30:31], v7 offset:1024
    s_waitcnt vmcnt(18)
    ds_read_b64_tr_b16 v[32:33], v4 offset:4096
    ds_read_b64_tr_b16 v[34:35], v4 offset:5120
    ds_read_b64_tr_b16 v[36:37], v5 offset:4096
    ds_read_b64_tr_b16 v[38:39], v5 offset:5120
    ds_read_b64_tr_b16 v[40:41], v6 offset:4096
    ds_read_b64_tr_b16 v[42:43], v6 offset:5120
    ds_read_b64_tr_b16 v[44:45], v7 offset:4096
    ds_read_b64_tr_b16 v[46:47], v7 offset:5120
    s_waitcnt lgkmcnt(8)
    v_mfma_f32_16x16x32_bf16 a[0:3], v[16:19], v[48:51], a[0:3]
    v_mfma_f32_16x16x32_bf16 a[16:19], v[16:19], v[52:55], a[16:19]
    s_add_u32 m0, s39, 16384
    s_nop 0
    buffer_load_dwordx4 v3, s[16:19], s42 offen lds
    s_add_u32 s42, s42, s47
    v_mfma_f32_16x16x32_bf16 a[32:35], v[16:19], v[56:59], a[32:35]
    v_mfma_f32_16x16x32_bf16 a[48:51], v[16:19], v[60:63], a[48:51]
    s_add_u32 m0, s39, 17408
    s_nop 0
    buffer_load_dwordx4 v3, s[16:19], s42 offen lds
    s_add_u32 s42, s42, s47
    v_mfma_f32_16x16x32_bf16 a[64:67], v[16:19], v[64:67], a[64:67]
    v_mfma_f32_16x16x32_bf16 a[4:7], v[20:23], v[48:51], a[4:7]
    s_add_u32 m0, s39, 18432
    s_nop 0
    buffer_load_dwordx4 v3, s[16:19], s42 offen lds
    s_add_u32 s42, s42, s47
    v_mfma_f32_16x16x32_bf16 a[20:23], v[20:23], v[52:55], a[20:23]
    v_mfma_f32_16x16x32_bf16 a[36:39], v[20:23], v[56:59], a[36:39]
    s_add_u32 m0, s39, 19456
    s_nop 0
    buffer_load_dwordx4 v3, s[16:19], s42 offen lds
    s_add_u32 s42, s42, s48
    v_mfma_f32_16x16x32_bf16 a[52:55], v[20:23], v[60:63], a[52:55]
    v_mfma_f32_16x16x32_bf16 a[68:71], v[20:23], v[64:67], a[68:71]
    buffer_load_dwordx4 v[128:131], v2, s[12:15], s52 offen
    s_add_u32 s52, s52, 8192
    v_mfma_f32_16x16x32_bf16 a[8:11], v[24:27], v[48:51], a[8:11]
    v_mfma_f32_16x16x32_bf16 a[24:27], v[24:27], v[52:55], a[24:27]
    buffer_load_dwordx4 v[132:135], v2, s[12:15], s53 offen
    s_add_u32 s53, s53, 8192
    v_mfma_f32_16x16x32_bf16 a[40:43], v[24:27], v[56:59], a[40:43]
    v_mfma_f32_16x16x32_bf16 a[56:59], v[24:27], v[60:63], a[56:59]
    buffer_load_dwordx4 v[136:139], v2, s[12:15], s54 offen
    s_add_u32 s54, s54, 8192
    v_mfma_f32_16x16x32_bf16 a[72:75], v[24:27], v[64:67], a[72:75]
    v_mfma_f32_16x16x32_bf16 a[12:15], v[28:31], v[48:51], a[12:15]
    buffer_load_dwordx4 v[140:143], v2, s[12:15], s55 offen
    s_add_u32 s55, s55, 8192
    v_mfma_f32_16x16x32_bf16 a[28:31], v[28:31], v[52:55], a[28:31]
    v_mfma_f32_16x16x32_bf16 a[44:47], v[28:31], v[56:59], a[44:47]
    buffer_load_dwordx4 v[144:147], v2, s[12:15], s56 offen
    s_add_u32 s56, s56, 8192
    v_mfma_f32_16x16x32_bf16 a[60:63], v[28:31], v[60:63], a[60:63]
    v_mfma_f32_16x16x32_bf16 a[76:79], v[28:31], v[64:67], a[76:79]
    s_waitcnt vmcnt(18)
    ds_read_b64_tr_b16 v[16:17], v4 offset:8192
    ds_read_b64_tr_b16 v[18:19], v4 offset:9216
    ds_read_b64_tr_b16 v[20:21], v5 offset:8192
    ds_read_b64_tr_b16 v[22:23], v5 offset:9216
    ds_read_b64_tr_b16 v[24:25], v6 offset:8192
    ds_read_b64_tr_b16 v[26:27], v6 offset:9216
    ds_read_b64_tr_b16 v[28:29], v7 offset:8192
    ds_read_b64_tr_b16 v[30:31], v7 offset:9216
    s_waitcnt lgkmcnt(8)
    v_mfma_f32_16x16x32_bf16 a[0:3], v[32:35], v[68:71], a[0:3]
    v_mfma_f32_16x16x32_bf16 a[16:19], v[32:35], v[72:75], a[16:19]
    s_add_u32 m0, s39, 0
    s_nop 0
    buffer_load_dwordx4 v3, s[16:19], s42 offen lds
    s_add_u32 s42, s42, s47
    v_mfma_f32_16x16x32_bf16 a[32:35], v[32:35], v[76:79], a[32:35]
    v_mfma_f32_16x16x32_bf16 a[48:51], v[32:35], v[80:83], a[48:51]
    s_add_u32 m0, s39, 1024
    s_nop 0
    buffer_load_dwordx4 v3, s[16:19], s42 offen lds
    s_add_u32 s42, s42, s47
    v_mfma_f32_16x16x32_bf16 a[64:67], v[32:35], v[84:87], a[64:67]
    v_mfma_f32_16x16x32_bf16 a[4:7], v[36:39], v[68:71], a[4:7]
    s_add_u32 m0, s39, 2048
    s_nop 0
    buffer_load_dwordx4 v3, s[16:19], s42 offen lds
    s_add_u32 s42, s42, s47
    v_mfma_f32_16x16x32_bf16 a[20:23], v[36:39], v[72:75], a[20:23]
    v_mfma_f32_16x16x32_bf16 a[36:39], v[36:39], v[76:79], a[36:39]
    s_add_u32 m0, s39, 3072
    s_nop 0
    buffer_load_dwordx4 v3, s[16:19], s42 offen lds
    s_add_u32 s42, s42, s48
    v_mfma_f32_16x16x32_bf16 a[52:55], v[36:39], v[80:83], a[52:55]
    v_mfma_f32_16x16x32_bf16 a[68:71], v[36:39], v[84:87], a[68:71]
    buffer_load_dwordx4 v[48:51], v2, s[12:15], s52 offen
    s_add_u32 s52, s52, 8192
    v_mfma_f32_16x16x32_bf16 a[8:11], v[40:43], v[68:71], a[8:11]
    v_mfma_f32_16x16x32_bf16 a[24:27], v[40:43], v[72:75], a[24:27]
    buffer_load_dwordx4 v[52:55], v2, s[12:15], s53 offen
    s_add_u32 s53, s53, 8192
    v_mfma_f32_16x16x32_bf16 a[40:43], v[40:43], v[76:79], a[40:43]
    v_mfma_f32_16x16x32_bf16 a[56:59], v[40:43], v[80:83], a[56:59]
    buffer_load_dwordx4 v[56:59], v2, s[12:15], s54 offen
    s_add_u32 s54, s54, 8192
    v_mfma_f32_16x16x32_bf16 a[72:75], v[40:43], v[84:87], a[72:75]
    v_mfma_f32_16x16x32_bf16 a[12:15], v[44:47], v[68:71], a[12:15]
    buffer_load_dwordx4 v[60:63], v2, s[12:15], s55 offen
    s_add_u32 s55, s55, 8192
    v_mfma_f32_16x16x32_bf16 a[28:31], v[44:47], v[72:75], a[28:31]
    v_mfma_f32_16x16x32_bf16 a[44:47], v[44:47], v[76:79], a[44:47]
    buffer_load_dwordx4 v[64:67], v2, s[12:15], s56 offen
    s_add_u32 s56, s56, 8192
    v_mfma_f32_16x16x32_bf16 a[60:63], v[44:47], v[80:83], a[60:63]
    v_mfma_f32_16x16x32_bf16 a[76:79], v[44:47], v[84:87], a[76:79]
    s_waitcnt vmcnt(18)
    ds_read_b64_tr_b16 v[32:33], v4 offset:12288
    ds_read_b64_tr_b16 v[34:35], v4 offset:13312
    ds_read_b64_tr_b16 v[36:37], v5 offset:12288
    ds_read_b64_tr_b16 v[38:39], v5 offset:13312
    ds_read_b64_tr_b16 v[40:41], v6 offset:12288
    ds_read_b64_tr_b16 v[42:43], v6 offset:13312
    ds_read_b64_tr_b16 v[44:45], v7 offset:12288
    ds_read_b64_tr_b16 v[46:47], v7 offset:13312
    s_waitcnt lgkmcnt(8)
    v_mfma_f32_16x16x32_bf16 a[0:3], v[16:19], v[88:91], a[0:3]
    v_mfma_f32_16x16x32_bf16 a[16:19], v[16:19], v[92:95], a[16:19]
    s_add_u32 m0, s39, 4096
    s_nop 0
    buffer_load_dwordx4 v3, s[16:19], s42 offen lds
    s_add_u32 s42, s42, s47
    v_mfma_f32_16x16x32_bf16 a[32:35], v[16:19], v[96:99], a[32:35]
    v_mfma_f32_16x16x32_bf16 a[48:51], v[16:19], v[100:103], a[48:51]
    s_add_u32 m0, s39, 5120
    s_nop 0
    buffer_load_dwordx4 v3, s[16:19], s42 offen lds
    s_add_u32 s42, s42, s47
    v_mfma_f32_16x16x32_bf16 a[64:67], v[16:19], v[104:107], a[64:67]
    v_mfma_f32_16x16x32_bf16 a[4:7], v[20:23], v[88:91], a[4:7]
    s_add_u32 m0, s39, 6144
    s_nop 0
    buffer_load_dwordx4 v3, s[16:19], s42 offen lds
    s_add_u32 s42, s42, s47
    v_mfma_f32_16x16x32_bf16 a[20:23], v[20:23], v[92:95], a[20:23]
    v_mfma_f32_16x16x32_bf16 a[36:39], v[20:23], v[96:99], a[36:39]
    s_add_u32 m0, s39, 7168
    s_nop 0
    buffer_load_dwordx4 v3, s[16:19], s42 offen lds
    s_add_u32 s42, s42, s48
    v_mfma_f32_16x16x32_bf16 a[52:55], v[20:23], v[100:103], a[52:55]
    v_mfma_f32_16x16x32_bf16 a[68:71], v[20:23], v[104:107], a[68:71]
    buffer_load_dwordx4 v[68:71], v2, s[12:15], s52 offen
    s_add_u32 s52, s52, 8192
    v_mfma_f32_16x16x32_bf16 a[8:11], v[24:27], v[88:91], a[8:11]
    v_mfma_f32_16x16x32_bf16 a[24:27], v[24:27], v[92:95], a[24:27]
    buffer_load_dwordx4 v[72:75], v2, s[12:15], s53 offen
    s_add_u32 s53, s53, 8192
    v_mfma_f32_16x16x32_bf16 a[40:43], v[24:27], v[96:99], a[40:43]
    v_mfma_f32_16x16x32_bf16 a[56:59], v[24:27], v[100:103], a[56:59]
    buffer_load_dwordx4 v[76:79], v2, s[12:15], s54 offen
    s_add_u32 s54, s54, 8192
    v_mfma_f32_16x16x32_bf16 a[72:75], v[24:27], v[104:107], a[72:75]
    v_mfma_f32_16x16x32_bf16 a[12:15], v[28:31], v[88:91], a[12:15]
    buffer_load_dwordx4 v[80:83], v2, s[12:15], s55 offen
    s_add_u32 s55, s55, 8192
    v_mfma_f32_16x16x32_bf16 a[28:31], v[28:31], v[92:95], a[28:31]
    v_mfma_f32_16x16x32_bf16 a[44:47], v[28:31], v[96:99], a[44:47]
    buffer_load_dwordx4 v[84:87], v2, s[12:15], s56 offen
    s_add_u32 s56, s56, 8192
    v_mfma_f32_16x16x32_bf16 a[60:63], v[28:31], v[100:103], a[60:63]
    v_mfma_f32_16x16x32_bf16 a[76:79], v[28:31], v[104:107], a[76:79]
    s_waitcnt vmcnt(18)
    ds_read_b64_tr_b16 v[16:17], v4 offset:16384
    ds_read_b64_tr_b16 v[18:19], v4 offset:17408
    ds_read_b64_tr_b16 v[20:21], v5 offset:16384
    ds_read_b64_tr_b16 v[22:23], v5 offset:17408
    ds_read_b64_tr_b16 v[24:25], v6 offset:16384
    ds_read_b64_tr_b16 v[26:27], v6 offset:17408
    ds_read_b64_tr_b16 v[28:29], v7 offset:16384
    ds_read_b64_tr_b16 v[30:31], v7 offset:17408
    s_waitcnt lgkmcnt(8)
    v_mfma_f32_16x16x32_bf16 a[0:3], v[32:35], v[108:111], a[0:3]
    v_mfma_f32_16x16x32_bf16 a[16:19], v[32:35], v[112:115], a[16:19]
    s_add_u32 m0, s39, 8192
    s_nop 0
    buffer_load_dwordx4 v3, s[16:19], s42 offen lds
    s_add_u32 s42, s42, s47
    v_mfma_f32_16x16x32_bf16 a[32:35], v[32:35], v[116:119], a[32:35]
    v_mfma_f32_16x16x32_bf16 a[48:51], v[32:35], v[120:123], a[48:51]
    s_add_u32 m0, s39, 9216
    s_nop 0
    buffer_load_dwordx4 v3, s[16:19], s42 offen lds
    s_add_u32 s42, s42, s47
    v_mfma_f32_16x16x32_bf16 a[64:67], v[32:35], v[124:127], a[64:67]
    v_mfma_f32_16x16x32_bf16 a[4:7], v[36:39], v[108:111], a[4:7]
    s_add_u32 m0, s39, 10240
    s_nop 0
    buffer_load_dwordx4 v3, s[16:19], s42 offen lds
    s_add_u32 s42, s42, s47
    v_mfma_f32_16x16x32_bf16 a[20:23], v[36:39], v[112:115], a[20:23]
    v_mfma_f32_16x16x32_bf16 a[36:39], v[36:39], v[116:119], a[36:39]
    s_add_u32 m0, s39, 11264
    s_nop 0
    buffer_load_dwordx4 v3, s[16:19], s42 offen lds
    s_add_u32 s42, s42, s48
    v_mfma_f32_16x16x32_bf16 a[52:55], v[36:39], v[120:123], a[52:55]
    v_mfma_f32_16x16x32_bf16 a[68:71], v[36:39], v[124:127], a[68:71]
    buffer_load_dwordx4 v[88:91], v2, s[12:15], s52 offen
    s_add_u32 s52, s52, 8192
    v_mfma_f32_16x16x32_bf16 a[8:11], v[40:43], v[108:111], a[8:11]
    v_mfma_f32_16x16x32_bf16 a[24:27], v[40:43], v[112:115], a[24:27]
    buffer_load_dwordx4 v[92:95], v2, s[12:15], s53 offen
    s_add_u32 s53, s53, 8192
    v_mfma_f32_16x16x32_bf16 a[40:43], v[40:43], v[116:119], a[40:43]
    v_mfma_f32_16x16x32_bf16 a[56:59], v[40:43], v[120:123], a[56:59]
    buffer_load_dwordx4 v[96:99], v2, s[12:15], s54 offen
    s_add_u32 s54, s54, 8192
    v_mfma_f32_16x16x32_bf16 a[72:75], v[40:43], v[124:127], a[72:75]
    v_mfma_f32_16x16x32_bf16 a[12:15], v[44:47], v[108:111], a[12:15]
    buffer_load_dwordx4 v[100:103], v2, s[12:15], s55 offen
    s_add_u32 s55, s55, 8192
    v_mfma_f32_16x16x32_bf16 a[28:31], v[44:47], v[112:115], a[28:31]
    v_mfma_f32_16x16x32_bf16 a[44:47], v[44:47], v[116:119], a[44:47]
    buffer_load_dwordx4 v[104:107], v2, s[12:15], s56 offen
    s_add_u32 s56, s56, 8192
    v_mfma_f32_16x16x32_bf16 a[60:63], v[44:47], v[120:123], a[60:63]
    v_mfma_f32_16x16x32_bf16 a[76:79], v[44:47], v[124:127], a[76:79]
    s_waitcnt vmcnt(18)
    ds_read_b64_tr_b16 v[32:33], v4 offset:0
    ds_read_b64_tr_b16 v[34:35], v4 offset:1024
    ds_read_b64_tr_b16 v[36:37], v5 offset:0
    ds_read_b64_tr_b16 v[38:39], v5 offset:1024
    ds_read_b64_tr_b16 v[40:41], v6 offset:0
    ds_read_b64_tr_b16 v[42:43], v6 offset:1024
    ds_read_b64_tr_b16 v[44:45], v7 offset:0
    ds_read_b64_tr_b16 v[46:47], v7 offset:1024
    s_waitcnt lgkmcnt(8)
    v_mfma_f32_16x16x32_bf16 a[0:3], v[16:19], v[128:131], a[0:3]
    v_mfma_f32_16x16x32_bf16 a[16:19], v[16:19], v[132:135], a[16:19]
    s_add_u32 m0, s39, 12288
    s_nop 0
    buffer_load_dwordx4 v3, s[16:19], s42 offen lds
    s_add_u32 s42, s42, s47
    v_mfma_f32_16x16x32_bf16 a[32:35], v[16:19], v[136:139], a[32:35]
    v_mfma_f32_16x16x32_bf16 a[48:51], v[16:19], v[140:143], a[48:51]
    s_add_u32 m0, s39, 13312
    s_nop 0
    buffer_load_dwordx4 v3, s[16:19], s42 offen lds
    s_add_u32 s42, s42, s47
    v_mfma_f32_16x16x32_bf16 a[64:67], v[16:19], v[144:147], a[64:67]
    v_mfma_f32_16x16x32_bf16 a[4:7], v[20:23], v[128:131], a[4:7]
    s_add_u32 m0, s39, 14336
    s_nop 0
    buffer_load_dwordx4 v3, s[16:19], s42 offen lds
    s_add_u32 s42, s42, s47
    v_mfma_f32_16x16x32_bf16 a[20:23], v[20:23], v[132:135], a[20:23]
    v_mfma_f32_16x16x32_bf16 a[36:39], v[20:23], v[136:139], a[36:39]
    s_add_u32 m0, s39, 15360
    s_nop 0
    buffer_load_dwordx4 v3, s[16:19], s42 offen lds
    s_add_u32 s42, s42, s48
    v_mfma_f32_16x16x32_bf16 a[52:55], v[20:23], v[140:143], a[52:55]
    v_mfma_f32_16x16x32_bf16 a[68:71], v[20:23], v[144:147], a[68:71]
    buffer_load_dwordx4 v[108:111], v2, s[12:15], s52 offen
    s_add_u32 s52, s52, 8192
    v_mfma_f32_16x16x32_bf16 a[8:11], v[24:27], v[128:131], a[8:11]
    v_mfma_f32_16x16x32_bf16 a[24:27], v[24:27], v[132:135], a[24:27]
    buffer_load_dwordx4 v[112:115], v2, s[12:15], s53 offen
    s_add_u32 s53, s53, 8192
    v_mfma_f32_16x16x32_bf16 a[40:43], v[24:27], v[136:139], a[40:43]
    v_mfma_f32_16x16x32_bf16 a[56:59], v[24:27], v[140:143], a[56:59]
    buffer_load_dwordx4 v[116:119], v2, s[12:15], s54 offen
    s_add_u32 s54, s54, 8192
    v_mfma_f32_16x16x32_bf16 a[72:75], v[24:27], v[144:147], a[72:75]
    v_mfma_f32_16x16x32_bf16 a[12:15], v[28:31], v[128:131], a[12:15]
    buffer_load_dwordx4 v[120:123], v2, s[12:15], s55 offen
    s_add_u32 s55, s55, 8192
    v_mfma_f32_16x16x32_bf16 a[28:31], v[28:31], v[132:135], a[28:31]
    v_mfma_f32_16x16x32_bf16 a[44:47], v[28:31], v[136:139], a[44:47]
    buffer_load_dwordx4 v[124:127], v2, s[12:15], s56 offen
    s_add_u32 s56, s56, 8192
    v_mfma_f32_16x16x32_bf16 a[60:63], v[28:31], v[140:143], a[60:63]
    v_mfma_f32_16x16x32_bf16 a[76:79], v[28:31], v[144:147], a[76:79]
    s_waitcnt vmcnt(18)
    ds_read_b64_tr_b16 v[16:17], v4 offset:4096
    ds_read_b64_tr_b16 v[18:19], v4 offset:5120
    ds_read_b64_tr_b16 v[20:21], v5 offset:4096
    ds_read_b64_tr_b16 v[22:23], v5 offset:5120
    ds_read_b64_tr_b16 v[24:25], v6 offset:4096
    ds_read_b64_tr_b16 v[26:27], v6 offset:5120
    ds_read_b64_tr_b16 v[28:29], v7 offset:4096
    ds_read_b64_tr_b16 v[30:31], v7 offset:5120
    s_waitcnt lgkmcnt(8)
    v_mfma_f32_16x16x32_bf16 a[0:3], v[32:35], v[48:51], a[0:3]
    v_mfma_f32_16x16x32_bf16 a[16:19], v[32:35], v[52:55], a[16:19]
    s_add_u32 m0, s39, 16384
    s_nop 0
    buffer_load_dwordx4 v3, s[16:19], s42 offen lds
    s_add_u32 s42, s42, s47
    v_mfma_f32_16x16x32_bf16 a[32:35], v[32:35], v[56:59], a[32:35]
    v_mfma_f32_16x16x32_bf16 a[48:51], v[32:35], v[60:63], a[48:51]
    s_add_u32 m0, s39, 17408
    s_nop 0
    buffer_load_dwordx4 v3, s[16:19], s42 offen lds
    s_add_u32 s42, s42, s47
    v_mfma_f32_16x16x32_bf16 a[64:67], v[32:35], v[64:67], a[64:67]
    v_mfma_f32_16x16x32_bf16 a[4:7], v[36:39], v[48:51], a[4:7]
    s_add_u32 m0, s39, 18432
    s_nop 0
    buffer_load_dwordx4 v3, s[16:19], s42 offen lds
    s_add_u32 s42, s42, s47
    v_mfma_f32_16x16x32_bf16 a[20:23], v[36:39], v[52:55], a[20:23]
    v_mfma_f32_16x16x32_bf16 a[36:39], v[36:39], v[56:59], a[36:39]
    s_add_u32 m0, s39, 19456
    s_nop 0
    buffer_load_dwordx4 v3, s[16:19], s42 offen lds
    s_add_u32 s42, s42, s48
    v_mfma_f32_16x16x32_bf16 a[52:55], v[36:39], v[60:63], a[52:55]
    v_mfma_f32_16x16x32_bf16 a[68:71], v[36:39], v[64:67], a[68:71]
    buffer_load_dwordx4 v[128:131], v2, s[12:15], s52 offen
    s_add_u32 s52, s52, 8192
    v_mfma_f32_16x16x32_bf16 a[8:11], v[40:43], v[48:51], a[8:11]
    v_mfma_f32_16x16x32_bf16 a[24:27], v[40:43], v[52:55], a[24:27]
    buffer_load_dwordx4 v[132:135], v2, s[12:15], s53 offen
    s_add_u32 s53, s53, 8192
    v_mfma_f32_16x16x32_bf16 a[40:43], v[40:43], v[56:59], a[40:43]
    v_mfma_f32_16x16x32_bf16 a[56:59], v[40:43], v[60:63], a[56:59]
    buffer_load_dwordx4 v[136:139], v2, s[12:15], s54 offen
    s_add_u32 s54, s54, 8192
    v_mfma_f32_16x16x32_bf16 a[72:75], v[40:43], v[64:67], a[72:75]
    v_mfma_f32_16x16x32_bf16 a[12:15], v[44:47], v[48:51], a[12:15]
    buffer_load_dwordx4 v[140:143], v2, s[12:15], s55 offen
    s_add_u32 s55, s55, 8192
    v_mfma_f32_16x16x32_bf16 a[28:31], v[44:47], v[52:55], a[28:31]
    v_mfma_f32_16x16x32_bf16 a[44:47], v[44:47], v[56:59], a[44:47]
    buffer_load_dwordx4 v[144:147], v2, s[12:15], s56 offen
    s_add_u32 s56, s56, 8192
    v_mfma_f32_16x16x32_bf16 a[60:63], v[44:47], v[60:63], a[60:63]
    v_mfma_f32_16x16x32_bf16 a[76:79], v[44:47], v[64:67], a[76:79]
    s_waitcnt vmcnt(18)
    ds_read_b64_tr_b16 v[32:33], v4 offset:8192
    ds_read_b64_tr_b16 v[34:35], v4 offset:9216
    ds_read_b64_tr_b16 v[36:37], v5 offset:8192
    ds_read_b64_tr_b16 v[38:39], v5 offset:9216
    ds_read_b64_tr_b16 v[40:41], v6 offset:8192
    ds_read_b64_tr_b16 v[42:43], v6 offset:9216
    ds_read_b64_tr_b16 v[44:45], v7 offset:8192
    ds_read_b64_tr_b16 v[46:47], v7 offset:9216
    s_waitcnt lgkmcnt(8)
    v_mfma_f32_16x16x32_bf16 a[0:3], v[16:19], v[68:71], a[0:3]
    v_mfma_f32_16x16x32_bf16 a[16:19], v[16:19], v[72:75], a[16:19]
    s_add_u32 m0, s39, 0
    s_nop 0
    buffer_load_dwordx4 v3, s[16:19], s42 offen lds
    s_add_u32 s42, s42, s47
    v_mfma_f32_16x16x32_bf16 a[32:35], v[16:19], v[76:79], a[32:35]
    v_mfma_f32_16x16x32_bf16 a[48:51], v[16:19], v[80:83], a[48:51]
    s_add_u32 m0, s39, 1024
    s_nop 0
    buffer_load_dwordx4 v3, s[16:19], s42 offen lds
    s_add_u32 s42, s42, s47
    v_mfma_f32_16x16x32_bf16 a[64:67], v[16:19], v[84:87], a[64:67]
    v_mfma_f32_16x16x32_bf16 a[4:7], v[20:23], v[68:71], a[4:7]
    s_add_u32 m0, s39, 2048
    s_nop 0
    buffer_load_dwordx4 v3, s[16:19], s42 offen lds
    s_add_u32 s42, s42, s47
    v_mfma_f32_16x16x32_bf16 a[20:23], v[20:23], v[72:75], a[20:23]
    v_mfma_f32_16x16x32_bf16 a[36:39], v[20:23], v[76:79], a[36:39]
    s_add_u32 m0, s39, 3072
    s_nop 0
    buffer_load_dwordx4 v3, s[16:19], s42 offen lds
    s_add_u32 s42, s42, s48
    v_mfma_f32_16x16x32_bf16 a[52:55], v[20:23], v[80:83], a[52:55]
    v_mfma_f32_16x16x32_bf16 a[68:71], v[20:23], v[84:87], a[68:71]
    buffer_load_dwordx4 v[48:51], v2, s[12:15], s52 offen
    s_add_u32 s52, s52, 8192
    v_mfma_f32_16x16x32_bf16 a[8:11], v[24:27], v[68:71], a[8:11]
    v_mfma_f32_16x16x32_bf16 a[24:27], v[24:27], v[72:75], a[24:27]
    buffer_load_dwordx4 v[52:55], v2, s[12:15], s53 offen
    s_add_u32 s53, s53, 8192
    v_mfma_f32_16x16x32_bf16 a[40:43], v[24:27], v[76:79], a[40:43]
    v_mfma_f32_16x16x32_bf16 a[56:59], v[24:27], v[80:83], a[56:59]
    buffer_load_dwordx4 v[56:59], v2, s[12:15], s54 offen
    s_add_u32 s54, s54, 8192
    v_mfma_f32_16x16x32_bf16 a[72:75], v[24:27], v[84:87], a[72:75]
    v_mfma_f32_16x16x32_bf16 a[12:15], v[28:31], v[68:71], a[12:15]
    buffer_load_dwordx4 v[60:63], v2, s[12:15], s55 offen
    s_add_u32 s55, s55, 8192
    v_mfma_f32_16x16x32_bf16 a[28:31], v[28:31], v[72:75], a[28:31]
    v_mfma_f32_16x16x32_bf16 a[44:47], v[28:31], v[76:79], a[44:47]
    buffer_load_dwordx4 v[64:67], v2, s[12:15], s56 offen
    s_add_u32 s56, s56, 8192
    v_mfma_f32_16x16x32_bf16 a[60:63], v[28:31], v[80:83], a[60:63]
    v_mfma_f32_16x16x32_bf16 a[76:79], v[28:31], v[84:87], a[76:79]
    s_waitcnt vmcnt(18)
    ds_read_b64_tr_b16 v[16:17], v4 offset:12288
    ds_read_b64_tr_b16 v[18:19], v4 offset:13312
    ds_read_b64_tr_b16 v[20:21], v5 offset:12288
    ds_read_b64_tr_b16 v[22:23], v5 offset:13312
    ds_read_b64_tr_b16 v[24:25], v6 offset:12288
    ds_read_b64_tr_b16 v[26:27], v6 offset:13312
    ds_read_b64_tr_b16 v[28:29], v7 offset:12288
    ds_read_b64_tr_b16 v[30:31], v7 offset:13312
    s_waitcnt lgkmcnt(8)
    v_mfma_f32_16x16x32_bf16 a[0:3], v[32:35], v[88:91], a[0:3]
    v_mfma_f32_16x16x32_bf16 a[16:19], v[32:35], v[92:95], a[16:19]
    s_add_u32 m0, s39, 4096
    s_nop 0
    buffer_load_dwordx4 v3, s[16:19], s42 offen lds
    s_add_u32 s42, s42, s47
    v_mfma_f32_16x16x32_bf16 a[32:35], v[32:35], v[96:99], a[32:35]
    v_mfma_f32_16x16x32_bf16 a[48:51], v[32:35], v[100:103], a[48:51]
    s_add_u32 m0, s39, 5120
    s_nop 0
    buffer_load_dwordx4 v3, s[16:19], s42 offen lds
    s_add_u32 s42, s42, s47
    v_mfma_f32_16x16x32_bf16 a[64:67], v[32:35], v[104:107], a[64:67]
    v_mfma_f32_16x16x32_bf16 a[4:7], v[36:39], v[88:91], a[4:7]
    s_add_u32 m0, s39, 6144
    s_nop 0
    buffer_load_dwordx4 v3, s[16:19], s42 offen lds
    s_add_u32 s42, s42, s47
    v_mfma_f32_16x16x32_bf16 a[20:23], v[36:39], v[92:95], a[20:23]
    v_mfma_f32_16x16x32_bf16 a[36:39], v[36:39], v[96:99], a[36:39]
    s_add_u32 m0, s39, 7168
    s_nop 0
    buffer_load_dwordx4 v3, s[16:19], s42 offen lds
    s_add_u32 s42, s42, s48
    v_mfma_f32_16x16x32_bf16 a[52:55], v[36:39], v[100:103], a[52:55]
    v_mfma_f32_16x16x32_bf16 a[68:71], v[36:39], v[104:107], a[68:71]
    buffer_load_dwordx4 v[68:71], v2, s[12:15], s52 offen
    s_add_u32 s52, s52, 8192
    v_mfma_f32_16x16x32_bf16 a[8:11], v[40:43], v[88:91], a[8:11]
    v_mfma_f32_16x16x32_bf16 a[24:27], v[40:43], v[92:95], a[24:27]
    buffer_load_dwordx4 v[72:75], v2, s[12:15], s53 offen
    s_add_u32 s53, s53, 8192
    v_mfma_f32_16x16x32_bf16 a[40:43], v[40:43], v[96:99], a[40:43]
    v_mfma_f32_16x16x32_bf16 a[56:59], v[40:43], v[100:103], a[56:59]
    buffer_load_dwordx4 v[76:79], v2, s[12:15], s54 offen
    s_add_u32 s54, s54, 8192
    v_mfma_f32_16x16x32_bf16 a[72:75], v[40:43], v[104:107], a[72:75]
    v_mfma_f32_16x16x32_bf16 a[12:15], v[44:47], v[88:91], a[12:15]
    buffer_load_dwordx4 v[80:83], v2, s[12:15], s55 offen
    s_add_u32 s55, s55, 8192
    v_mfma_f32_16x16x32_bf16 a[28:31], v[44:47], v[92:95], a[28:31]
    v_mfma_f32_16x16x32_bf16 a[44:47], v[44:47], v[96:99], a[44:47]
    buffer_load_dwordx4 v[84:87], v2, s[12:15], s56 offen
    s_add_u32 s56, s56, 8192
    v_mfma_f32_16x16x32_bf16 a[60:63], v[44:47], v[100:103], a[60:63]
    v_mfma_f32_16x16x32_bf16 a[76:79], v[44:47], v[104:107], a[76:79]
    s_waitcnt vmcnt(18)
    ds_read_b64_tr_b16 v[32:33], v4 offset:16384
    ds_read_b64_tr_b16 v[34:35], v4 offset:17408
    ds_read_b64_tr_b16 v[36:37], v5 offset:16384
    ds_read_b64_tr_b16 v[38:39], v5 offset:17408
    ds_read_b64_tr_b16 v[40:41], v6 offset:16384
    ds_read_b64_tr_b16 v[42:43], v6 offset:17408
    ds_read_b64_tr_b16 v[44:45], v7 offset:16384
    ds_read_b64_tr_b16 v[46:47], v7 offset:17408
    s_waitcnt lgkmcnt(8)
    v_mfma_f32_16x16x32_bf16 a[0:3], v[16:19], v[108:111], a[0:3]
    v_mfma_f32_16x16x32_bf16 a[16:19], v[16:19], v[112:115], a[16:19]
    s_add_u32 m0, s39, 8192
    s_nop 0
    buffer_load_dwordx4 v3, s[16:19], s42 offen lds
    s_add_u32 s42, s42, s47
    v_mfma_f32_16x16x32_bf16 a[32:35], v[16:19], v[116:119], a[32:35]
    v_mfma_f32_16x16x32_bf16 a[48:51], v[16:19], v[120:123], a[48:51]
    s_add_u32 m0, s39, 9216
    s_nop 0
    buffer_load_dwordx4 v3, s[16:19], s42 offen lds
    s_add_u32 s42, s42, s47
    v_mfma_f32_16x16x32_bf16 a[64:67], v[16:19], v[124:127], a[64:67]
    v_mfma_f32_16x16x32_bf16 a[4:7], v[20:23], v[108:111], a[4:7]
    s_add_u32 m0, s39, 10240
    s_nop 0
    buffer_load_dwordx4 v3, s[16:19], s42 offen lds
    s_add_u32 s42, s42, s47
    v_mfma_f32_16x16x32_bf16 a[20:23], v[20:23], v[112:115], a[20:23]
    v_mfma_f32_16x16x32_bf16 a[36:39], v[20:23], v[116:119], a[36:39]
    s_add_u32 m0, s39, 11264
    s_nop 0
    buffer_load_dwordx4 v3, s[16:19], s42 offen lds
    s_add_u32 s42, s42, s48
    v_mfma_f32_16x16x32_bf16 a[52:55], v[20:23], v[120:123], a[52:55]
    v_mfma_f32_16x16x32_bf16 a[68:71], v[20:23], v[124:127], a[68:71]
    buffer_load_dwordx4 v[88:91], v2, s[12:15], s52 offen
    s_add_u32 s52, s52, 8192
    v_mfma_f32_16x16x32_bf16 a[8:11], v[24:27], v[108:111], a[8:11]
    v_mfma_f32_16x16x32_bf16 a[24:27], v[24:27], v[112:115], a[24:27]
    buffer_load_dwordx4 v[92:95], v2, s[12:15], s53 offen
    s_add_u32 s53, s53, 8192
    v_mfma_f32_16x16x32_bf16 a[40:43], v[24:27], v[116:119], a[40:43]
    v_mfma_f32_16x16x32_bf16 a[56:59], v[24:27], v[120:123], a[56:59]
    buffer_load_dwordx4 v[96:99], v2, s[12:15], s54 offen
    s_add_u32 s54, s54, 8192
    v_mfma_f32_16x16x32_bf16 a[72:75], v[24:27], v[124:127], a[72:75]
    v_mfma_f32_16x16x32_bf16 a[12:15], v[28:31], v[108:111], a[12:15]
    buffer_load_dwordx4 v[100:103], v2, s[12:15], s55 offen
    s_add_u32 s55, s55, 8192
    v_mfma_f32_16x16x32_bf16 a[28:31], v[28:31], v[112:115], a[28:31]
    v_mfma_f32_16x16x32_bf16 a[44:47], v[28:31], v[116:119], a[44:47]
    buffer_load_dwordx4 v[104:107], v2, s[12:15], s56 offen
    s_add_u32 s56, s56, 8192
    v_mfma_f32_16x16x32_bf16 a[60:63], v[28:31], v[120:123], a[60:63]
    v_mfma_f32_16x16x32_bf16 a[76:79], v[28:31], v[124:127], a[76:79]
    s_waitcnt vmcnt(18)
    ds_read_b64_tr_b16 v[16:17], v4 offset:0
    ds_read_b64_tr_b16 v[18:19], v4 offset:1024
    ds_read_b64_tr_b16 v[20:21], v5 offset:0
    ds_read_b64_tr_b16 v[22:23], v5 offset:1024
    ds_read_b64_tr_b16 v[24:25], v6 offset:0
    ds_read_b64_tr_b16 v[26:27], v6 offset:1024
    ds_read_b64_tr_b16 v[28:29], v7 offset:0
    ds_read_b64_tr_b16 v[30:31], v7 offset:1024
    s_waitcnt lgkmcnt(8)
    v_mfma_f32_16x16x32_bf16 a[0:3], v[32:35], v[128:131], a[0:3]
    v_mfma_f32_16x16x32_bf16 a[16:19], v[32:35], v[132:135], a[16:19]
    s_add_u32 m0, s39, 12288
    s_nop 0
    buffer_load_dwordx4 v3, s[16:19], s42 offen lds
    s_add_u32 s42, s42, s47
    v_mfma_f32_16x16x32_bf16 a[32:35], v[32:35], v[136:139], a[32:35]
    v_mfma_f32_16x16x32_bf16 a[48:51], v[32:35], v[140:143], a[48:51]
    s_add_u32 m0, s39, 13312
    s_nop 0
    buffer_load_dwordx4 v3, s[16:19], s42 offen lds
    s_add_u32 s42, s42, s47
    v_mfma_f32_16x16x32_bf16 a[64:67], v[32:35], v[144:147], a[64:67]
    v_mfma_f32_16x16x32_bf16 a[4:7], v[36:39], v[128:131], a[4:7]
    s_add_u32 m0, s39, 14336
    s_nop 0
    buffer_load_dwordx4 v3, s[16:19], s42 offen lds
    s_add_u32 s42, s42, s47
    v_mfma_f32_16x16x32_bf16 a[20:23], v[36:39], v[132:135], a[20:23]
    v_mfma_f32_16x16x32_bf16 a[36:39], v[36:39], v[136:139], a[36:39]
    s_add_u32 m0, s39, 15360
    s_nop 0
    buffer_load_dwordx4 v3, s[16:19], s42 offen lds
    s_add_u32 s42, s42, s48
    v_mfma_f32_16x16x32_bf16 a[52:55], v[36:39], v[140:143], a[52:55]
    v_mfma_f32_16x16x32_bf16 a[68:71], v[36:39], v[144:147], a[68:71]
    buffer_load_dwordx4 v[108:111], v2, s[12:15], s52 offen
    s_add_u32 s52, s52, 8192
    v_mfma_f32_16x16x32_bf16 a[8:11], v[40:43], v[128:131], a[8:11]
    v_mfma_f32_16x16x32_bf16 a[24:27], v[40:43], v[132:135], a[24:27]
    buffer_load_dwordx4 v[112:115], v2, s[12:15], s53 offen
    s_add_u32 s53, s53, 8192
    v_mfma_f32_16x16x32_bf16 a[40:43], v[40:43], v[136:139], a[40:43]
    v_mfma_f32_16x16x32_bf16 a[56:59], v[40:43], v[140:143], a[56:59]
    buffer_load_dwordx4 v[116:119], v2, s[12:15], s54 offen
    s_add_u32 s54, s54, 8192
    v_mfma_f32_16x16x32_bf16 a[72:75], v[40:43], v[144:147], a[72:75]
    v_mfma_f32_16x16x32_bf16 a[12:15], v[44:47], v[128:131], a[12:15]
    buffer_load_dwordx4 v[120:123], v2, s[12:15], s55 offen
    s_add_u32 s55, s55, 8192
    v_mfma_f32_16x16x32_bf16 a[28:31], v[44:47], v[132:135], a[28:31]
    v_mfma_f32_16x16x32_bf16 a[44:47], v[44:47], v[136:139], a[44:47]
    buffer_load_dwordx4 v[124:127], v2, s[12:15], s56 offen
    s_add_u32 s56, s56, 8192
    v_mfma_f32_16x16x32_bf16 a[60:63], v[44:47], v[140:143], a[60:63]
    v_mfma_f32_16x16x32_bf16 a[76:79], v[44:47], v[144:147], a[76:79]
    s_waitcnt vmcnt(18)
    ds_read_b64_tr_b16 v[32:33], v4 offset:4096
    ds_read_b64_tr_b16 v[34:35], v4 offset:5120
    ds_read_b64_tr_b16 v[36:37], v5 offset:4096
    ds_read_b64_tr_b16 v[38:39], v5 offset:5120
    ds_read_b64_tr_b16 v[40:41], v6 offset:4096
    ds_read_b64_tr_b16 v[42:43], v6 offset:5120
    ds_read_b64_tr_b16 v[44:45], v7 offset:4096
    ds_read_b64_tr_b16 v[46:47], v7 offset:5120
    s_waitcnt lgkmcnt(8)
    v_mfma_f32_16x16x32_bf16 a[0:3], v[16:19], v[48:51], a[0:3]
    v_mfma_f32_16x16x32_bf16 a[16:19], v[16:19], v[52:55], a[16:19]
    s_add_u32 m0, s39, 16384
    s_nop 0
    buffer_load_dwordx4 v3, s[16:19], s42 offen lds
    s_add_u32 s42, s42, s47
    v_mfma_f32_16x16x32_bf16 a[32:35], v[16:19], v[56:59], a[32:35]
    v_mfma_f32_16x16x32_bf16 a[48:51], v[16:19], v[60:63], a[48:51]
    s_add_u32 m0, s39, 17408
    s_nop 0
    buffer_load_dwordx4 v3, s[16:19], s42 offen lds
    s_add_u32 s42, s42, s47
    v_mfma_f32_16x16x32_bf16 a[64:67], v[16:19], v[64:67], a[64:67]
    v_mfma_f32_16x16x32_bf16 a[4:7], v[20:23], v[48:51], a[4:7]
    s_add_u32 m0, s39, 18432
    s_nop 0
    buffer_load_dwordx4 v3, s[16:19], s42 offen lds
    s_add_u32 s42, s42, s47
    v_mfma_f32_16x16x32_bf16 a[20:23], v[20:23], v[52:55], a[20:23]
    v_mfma_f32_16x16x32_bf16 a[36:39], v[20:23], v[56:59], a[36:39]
    s_add_u32 m0, s39, 19456
    s_nop 0
    buffer_load_dwordx4 v3, s[16:19], s42 offen lds
    s_add_u32 s42, s42, s48
    v_mfma_f32_16x16x32_bf16 a[52:55], v[20:23], v[60:63], a[52:55]
    v_mfma_f32_16x16x32_bf16 a[68:71], v[20:23], v[64:67], a[68:71]
    buffer_load_dwordx4 v[128:131], v2, s[12:15], s52 offen
    s_add_u32 s52, s52, 8192
    v_mfma_f32_16x16x32_bf16 a[8:11], v[24:27], v[48:51], a[8:11]
    v_mfma_f32_16x16x32_bf16 a[24:27], v[24:27], v[52:55], a[24:27]
    buffer_load_dwordx4 v[132:135], v2, s[12:15], s53 offen
    s_add_u32 s53, s53, 8192
    v_mfma_f32_16x16x32_bf16 a[40:43], v[24:27], v[56:59], a[40:43]
    v_mfma_f32_16x16x32_bf16 a[56:59], v[24:27], v[60:63], a[56:59]
    buffer_load_dwordx4 v[136:139], v2, s[12:15], s54 offen
    s_add_u32 s54, s54, 8192
    v_mfma_f32_16x16x32_bf16 a[72:75], v[24:27], v[64:67], a[72:75]
    v_mfma_f32_16x16x32_bf16 a[12:15], v[28:31], v[48:51], a[12:15]
    buffer_load_dwordx4 v[140:143], v2, s[12:15], s55 offen
    s_add_u32 s55, s55, 8192
    v_mfma_f32_16x16x32_bf16 a[28:31], v[28:31], v[52:55], a[28:31]
    v_mfma_f32_16x16x32_bf16 a[44:47], v[28:31], v[56:59], a[44:47]
    buffer_load_dwordx4 v[144:147], v2, s[12:15], s56 offen
    s_add_u32 s56, s56, 8192
    v_mfma_f32_16x16x32_bf16 a[60:63], v[28:31], v[60:63], a[60:63]
    v_mfma_f32_16x16x32_bf16 a[76:79], v[28:31], v[64:67], a[76:79]
    s_waitcnt vmcnt(18)
    ds_read_b64_tr_b16 v[16:17], v4 offset:8192
    ds_read_b64_tr_b16 v[18:19], v4 offset:9216
    ds_read_b64_tr_b16 v[20:21], v5 offset:8192
    ds_read_b64_tr_b16 v[22:23], v5 offset:9216
    ds_read_b64_tr_b16 v[24:25], v6 offset:8192
    ds_read_b64_tr_b16 v[26:27], v6 offset:9216
    ds_read_b64_tr_b16 v[28:29], v7 offset:8192
    ds_read_b64_tr_b16 v[30:31], v7 offset:9216
    s_waitcnt lgkmcnt(8)
    v_mfma_f32_16x16x32_bf16 a[0:3], v[32:35], v[68:71], a[0:3]
    v_mfma_f32_16x16x32_bf16 a[16:19], v[32:35], v[72:75], a[16:19]
    s_add_u32 m0, s39, 0
    s_nop 0
    buffer_load_dwordx4 v3, s[16:19], s42 offen lds
    s_add_u32 s42, s42, s47
    v_mfma_f32_16x16x32_bf16 a[32:35], v[32:35], v[76:79], a[32:35]
    v_mfma_f32_16x16x32_bf16 a[48:51], v[32:35], v[80:83], a[48:51]
    s_add_u32 m0, s39, 1024
    s_nop 0
    buffer_load_dwordx4 v3, s[16:19], s42 offen lds
    s_add_u32 s42, s42, s47
    v_mfma_f32_16x16x32_bf16 a[64:67], v[32:35], v[84:87], a[64:67]
    v_mfma_f32_16x16x32_bf16 a[4:7], v[36:39], v[68:71], a[4:7]
    s_add_u32 m0, s39, 2048
    s_nop 0
    buffer_load_dwordx4 v3, s[16:19], s42 offen lds
    s_add_u32 s42, s42, s47
    v_mfma_f32_16x16x32_bf16 a[20:23], v[36:39], v[72:75], a[20:23]
    v_mfma_f32_16x16x32_bf16 a[36:39], v[36:39], v[76:79], a[36:39]
    s_add_u32 m0, s39, 3072
    s_nop 0
    buffer_load_dwordx4 v3, s[16:19], s42 offen lds
    s_add_u32 s42, s42, s48
    v_mfma_f32_16x16x32_bf16 a[52:55], v[36:39], v[80:83], a[52:55]
    v_mfma_f32_16x16x32_bf16 a[68:71], v[36:39], v[84:87], a[68:71]
    buffer_load_dwordx4 v[48:51], v2, s[12:15], s52 offen
    s_add_u32 s52, s52, 8192
    v_mfma_f32_16x16x32_bf16 a[8:11], v[40:43], v[68:71], a[8:11]
    v_mfma_f32_16x16x32_bf16 a[24:27], v[40:43], v[72:75], a[24:27]
    buffer_load_dwordx4 v[52:55], v2, s[12:15], s53 offen
    s_add_u32 s53, s53, 8192
    v_mfma_f32_16x16x32_bf16 a[40:43], v[40:43], v[76:79], a[40:43]
    v_mfma_f32_16x16x32_bf16 a[56:59], v[40:43], v[80:83], a[56:59]
    buffer_load_dwordx4 v[56:59], v2, s[12:15], s54 offen
    s_add_u32 s54, s54, 8192
    v_mfma_f32_16x16x32_bf16 a[72:75], v[40:43], v[84:87], a[72:75]
    v_mfma_f32_16x16x32_bf16 a[12:15], v[44:47], v[68:71], a[12:15]
    buffer_load_dwordx4 v[60:63], v2, s[12:15], s55 offen
    s_add_u32 s55, s55, 8192
    v_mfma_f32_16x16x32_bf16 a[28:31], v[44:47], v[72:75], a[28:31]
    v_mfma_f32_16x16x32_bf16 a[44:47], v[44:47], v[76:79], a[44:47]
    buffer_load_dwordx4 v[64:67], v2, s[12:15], s56 offen
    s_add_u32 s56, s56, 8192
    v_mfma_f32_16x16x32_bf16 a[60:63], v[44:47], v[80:83], a[60:63]
    v_mfma_f32_16x16x32_bf16 a[76:79], v[44:47], v[84:87], a[76:79]
    s_waitcnt vmcnt(18)
    ds_read_b64_tr_b16 v[32:33], v4 offset:12288
    ds_read_b64_tr_b16 v[34:35], v4 offset:13312
    ds_read_b64_tr_b16 v[36:37], v5 offset:12288
    ds_read_b64_tr_b16 v[38:39], v5 offset:13312
    ds_read_b64_tr_b16 v[40:41], v6 offset:12288
    ds_read_b64_tr_b16 v[42:43], v6 offset:13312
    ds_read_b64_tr_b16 v[44:45], v7 offset:12288
    ds_read_b64_tr_b16 v[46:47], v7 offset:13312
    s_waitcnt lgkmcnt(8)
    v_mfma_f32_16x16x32_bf16 a[0:3], v[16:19], v[88:91], a[0:3]
    v_mfma_f32_16x16x32_bf16 a[16:19], v[16:19], v[92:95], a[16:19]
    s_add_u32 m0, s39, 4096
    s_nop 0
    buffer_load_dwordx4 v3, s[16:19], s42 offen lds
    s_add_u32 s42, s42, s47
    v_mfma_f32_16x16x32_bf16 a[32:35], v[16:19], v[96:99], a[32:35]
    v_mfma_f32_16x16x32_bf16 a[48:51], v[16:19], v[100:103], a[48:51]
    s_add_u32 m0, s39, 5120
    s_nop 0
    buffer_load_dwordx4 v3, s[16:19], s42 offen lds
    s_add_u32 s42, s42, s47
    v_mfma_f32_16x16x32_bf16 a[64:67], v[16:19], v[104:107], a[64:67]
    v_mfma_f32_16x16x32_bf16 a[4:7], v[20:23], v[88:91], a[4:7]
    s_add_u32 m0, s39, 6144
    s_nop 0
    buffer_load_dwordx4 v3, s[16:19], s42 offen lds
    s_add_u32 s42, s42, s47
    v_mfma_f32_16x16x32_bf16 a[20:23], v[20:23], v[92:95], a[20:23]
    v_mfma_f32_16x16x32_bf16 a[36:39], v[20:23], v[96:99], a[36:39]
    s_add_u32 m0, s39, 7168
    s_nop 0
    buffer_load_dwordx4 v3, s[16:19], s42 offen lds
    s_add_u32 s42, s42, s48
    v_mfma_f32_16x16x32_bf16 a[52:55], v[20:23], v[100:103], a[52:55]
    v_mfma_f32_16x16x32_bf16 a[68:71], v[20:23], v[104:107], a[68:71]
    buffer_load_dwordx4 v[68:71], v2, s[12:15], s52 offen
    s_add_u32 s52, s52, 8192
    v_mfma_f32_16x16x32_bf16 a[8:11], v[24:27], v[88:91], a[8:11]
    v_mfma_f32_16x16x32_bf16 a[24:27], v[24:27], v[92:95], a[24:27]
    buffer_load_dwordx4 v[72:75], v2, s[12:15], s53 offen
    s_add_u32 s53, s53, 8192
    v_mfma_f32_16x16x32_bf16 a[40:43], v[24:27], v[96:99], a[40:43]
    v_mfma_f32_16x16x32_bf16 a[56:59], v[24:27], v[100:103], a[56:59]
    buffer_load_dwordx4 v[76:79], v2, s[12:15], s54 offen
    s_add_u32 s54, s54, 8192
    v_mfma_f32_16x16x32_bf16 a[72:75], v[24:27], v[104:107], a[72:75]
    v_mfma_f32_16x16x32_bf16 a[12:15], v[28:31], v[88:91], a[12:15]
    buffer_load_dwordx4 v[80:83], v2, s[12:15], s55 offen
    s_add_u32 s55, s55, 8192
    v_mfma_f32_16x16x32_bf16 a[28:31], v[28:31], v[92:95], a[28:31]
    v_mfma_f32_16x16x32_bf16 a[44:47], v[28:31], v[96:99], a[44:47]
    buffer_load_dwordx4 v[84:87], v2, s[12:15], s56 offen
    s_add_u32 s56, s56, 8192
    v_mfma_f32_16x16x32_bf16 a[60:63], v[28:31], v[100:103], a[60:63]
    v_mfma_f32_16x16x32_bf16 a[76:79], v[28:31], v[104:107], a[76:79]
    s_waitcnt vmcnt(18)
    ds_read_b64_tr_b16 v[16:17], v4 offset:16384
    ds_read_b64_tr_b16 v[18:19], v4 offset:17408
    ds_read_b64_tr_b16 v[20:21], v5 offset:16384
    ds_read_b64_tr_b16 v[22:23], v5 offset:17408
    ds_read_b64_tr_b16 v[24:25], v6 offset:16384
    ds_read_b64_tr_b16 v[26:27], v6 offset:17408
    ds_read_b64_tr_b16 v[28:29], v7 offset:16384
    ds_read_b64_tr_b16 v[30:31], v7 offset:17408
    s_waitcnt lgkmcnt(8)
    v_mfma_f32_16x16x32_bf16 a[0:3], v[32:35], v[108:111], a[0:3]
    v_mfma_f32_16x16x32_bf16 a[16:19], v[32:35], v[112:115], a[16:19]
    s_add_u32 m0, s39, 8192
    s_nop 0
    buffer_load_dwordx4 v3, s[16:19], s42 offen lds
    s_add_u32 s42, s42, s47
    v_mfma_f32_16x16x32_bf16 a[32:35], v[32:35], v[116:119], a[32:35]
    v_mfma_f32_16x16x32_bf16 a[48:51], v[32:35], v[120:123], a[48:51]
    s_add_u32 m0, s39, 9216
    s_nop 0
    buffer_load_dwordx4 v3, s[16:19], s42 offen lds
    s_add_u32 s42, s42, s47
    v_mfma_f32_16x16x32_bf16 a[64:67], v[32:35], v[124:127], a[64:67]
    v_mfma_f32_16x16x32_bf16 a[4:7], v[36:39], v[108:111], a[4:7]
    s_add_u32 m0, s39, 10240
    s_nop 0
    buffer_load_dwordx4 v3, s[16:19], s42 offen lds
    s_add_u32 s42, s42, s47
    v_mfma_f32_16x16x32_bf16 a[20:23], v[36:39], v[112:115], a[20:23]
    v_mfma_f32_16x16x32_bf16 a[36:39], v[36:39], v[116:119], a[36:39]
    s_add_u32 m0, s39, 11264
    s_nop 0
    buffer_load_dwordx4 v3, s[16:19], s42 offen lds
    s_add_u32 s42, s42, s48
    v_mfma_f32_16x16x32_bf16 a[52:55], v[36:39], v[120:123], a[52:55]
    v_mfma_f32_16x16x32_bf16 a[68:71], v[36:39], v[124:127], a[68:71]
    buffer_load_dwordx4 v[88:91], v2, s[12:15], s52 offen
    s_add_u32 s52, s52, 8192
    v_mfma_f32_16x16x32_bf16 a[8:11], v[40:43], v[108:111], a[8:11]
    v_mfma_f32_16x16x32_bf16 a[24:27], v[40:43], v[112:115], a[24:27]
    buffer_load_dwordx4 v[92:95], v2, s[12:15], s53 offen
    s_add_u32 s53, s53, 8192
    v_mfma_f32_16x16x32_bf16 a[40:43], v[40:43], v[116:119], a[40:43]
    v_mfma_f32_16x16x32_bf16 a[56:59], v[40:43], v[120:123], a[56:59]
    buffer_load_dwordx4 v[96:99], v2, s[12:15], s54 offen
    s_add_u32 s54, s54, 8192
    v_mfma_f32_16x16x32_bf16 a[72:75], v[40:43], v[124:127], a[72:75]
    v_mfma_f32_16x16x32_bf16 a[12:15], v[44:47], v[108:111], a[12:15]
    buffer_load_dwordx4 v[100:103], v2, s[12:15], s55 offen
    s_add_u32 s55, s55, 8192
    v_mfma_f32_16x16x32_bf16 a[28:31], v[44:47], v[112:115], a[28:31]
    v_mfma_f32_16x16x32_bf16 a[44:47], v[44:47], v[116:119], a[44:47]
    buffer_load_dwordx4 v[104:107], v2, s[12:15], s56 offen
    s_add_u32 s56, s56, 8192
    v_mfma_f32_16x16x32_bf16 a[60:63], v[44:47], v[120:123], a[60:63]
    v_mfma_f32_16x16x32_bf16 a[76:79], v[44:47], v[124:127], a[76:79]
    s_waitcnt vmcnt(18)
    ds_read_b64_tr_b16 v[32:33], v4 offset:0
    ds_read_b64_tr_b16 v[34:35], v4 offset:1024
    ds_read_b64_tr_b16 v[36:37], v5 offset:0
    ds_read_b64_tr_b16 v[38:39], v5 offset:1024
    ds_read_b64_tr_b16 v[40:41], v6 offset:0
    ds_read_b64_tr_b16 v[42:43], v6 offset:1024
    ds_read_b64_tr_b16 v[44:45], v7 offset:0
    ds_read_b64_tr_b16 v[46:47], v7 offset:1024
    s_waitcnt lgkmcnt(8)
    v_mfma_f32_16x16x32_bf16 a[0:3], v[16:19], v[128:131], a[0:3]
    v_mfma_f32_16x16x32_bf16 a[16:19], v[16:19], v[132:135], a[16:19]
    s_add_u32 m0, s39, 12288
    s_nop 0
    buffer_load_dwordx4 v3, s[16:19], s42 offen lds
    s_add_u32 s42, s42, s47
    v_mfma_f32_16x16x32_bf16 a[32:35], v[16:19], v[136:139], a[32:35]
    v_mfma_f32_16x16x32_bf16 a[48:51], v[16:19], v[140:143], a[48:51]
    s_add_u32 m0, s39, 13312
    s_nop 0
    buffer_load_dwordx4 v3, s[16:19], s42 offen lds
    s_add_u32 s42, s42, s47
    v_mfma_f32_16x16x32_bf16 a[64:67], v[16:19], v[144:147], a[64:67]
    v_mfma_f32_16x16x32_bf16 a[4:7], v[20:23], v[128:131], a[4:7]
    s_add_u32 m0, s39, 14336
    s_nop 0
    buffer_load_dwordx4 v3, s[16:19], s42 offen lds
    s_add_u32 s42, s42, s47
    v_mfma_f32_16x16x32_bf16 a[20:23], v[20:23], v[132:135], a[20:23]
    v_mfma_f32_16x16x32_bf16 a[36:39], v[20:23], v[136:139], a[36:39]
    s_add_u32 m0, s39, 15360
    s_nop 0
    buffer_load_dwordx4 v3, s[16:19], s42 offen lds
    s_add_u32 s42, s42, s48
    v_mfma_f32_16x16x32_bf16 a[52:55], v[20:23], v[140:143], a[52:55]
    v_mfma_f32_16x16x32_bf16 a[68:71], v[20:23], v[144:147], a[68:71]
    buffer_load_dwordx4 v[108:111], v2, s[12:15], s52 offen
    s_add_u32 s52, s52, 8192
    v_mfma_f32_16x16x32_bf16 a[8:11], v[24:27], v[128:131], a[8:11]
    v_mfma_f32_16x16x32_bf16 a[24:27], v[24:27], v[132:135], a[24:27]
    buffer_load_dwordx4 v[112:115], v2, s[12:15], s53 offen
    s_add_u32 s53, s53, 8192
    v_mfma_f32_16x16x32_bf16 a[40:43], v[24:27], v[136:139], a[40:43]
    v_mfma_f32_16x16x32_bf16 a[56:59], v[24:27], v[140:143], a[56:59]
    buffer_load_dwordx4 v[116:119], v2, s[12:15], s54 offen
    s_add_u32 s54, s54, 8192
    v_mfma_f32_16x16x32_bf16 a[72:75], v[24:27], v[144:147], a[72:75]
    v_mfma_f32_16x16x32_bf16 a[12:15], v[28:31], v[128:131], a[12:15]
    buffer_load_dwordx4 v[120:123], v2, s[12:15], s55 offen
    s_add_u32 s55, s55, 8192
    v_mfma_f32_16x16x32_bf16 a[28:31], v[28:31], v[132:135], a[28:31]
    v_mfma_f32_16x16x32_bf16 a[44:47], v[28:31], v[136:139], a[44:47]
    buffer_load_dwordx4 v[124:127], v2, s[12:15], s56 offen
    s_add_u32 s56, s56, 8192
    v_mfma_f32_16x16x32_bf16 a[60:63], v[28:31], v[140:143], a[60:63]
    v_mfma_f32_16x16x32_bf16 a[76:79], v[28:31], v[144:147], a[76:79]
    s_waitcnt vmcnt(18)
    ds_read_b64_tr_b16 v[16:17], v4 offset:4096
    ds_read_b64_tr_b16 v[18:19], v4 offset:5120
    ds_read_b64_tr_b16 v[20:21], v5 offset:4096
    ds_read_b64_tr_b16 v[22:23], v5 offset:5120
    ds_read_b64_tr_b16 v[24:25], v6 offset:4096
    ds_read_b64_tr_b16 v[26:27], v6 offset:5120
    ds_read_b64_tr_b16 v[28:29], v7 offset:4096
    ds_read_b64_tr_b16 v[30:31], v7 offset:5120
    s_waitcnt lgkmcnt(8)
    v_mfma_f32_16x16x32_bf16 a[0:3], v[32:35], v[48:51], a[0:3]
    v_mfma_f32_16x16x32_bf16 a[16:19], v[32:35], v[52:55], a[16:19]
    s_add_u32 m0, s39, 16384
    s_nop 0
    buffer_load_dwordx4 v3, s[16:19], s42 offen lds
    s_add_u32 s42, s42, s47
    v_mfma_f32_16x16x32_bf16 a[32:35], v[32:35], v[56:59], a[32:35]
    v_mfma_f32_16x16x32_bf16 a[48:51], v[32:35], v[60:63], a[48:51]
    s_add_u32 m0, s39, 17408
    s_nop 0
    buffer_load_dwordx4 v3, s[16:19], s42 offen lds
    s_add_u32 s42, s42, s47
    v_mfma_f32_16x16x32_bf16 a[64:67], v[32:35], v[64:67], a[64:67]
    v_mfma_f32_16x16x32_bf16 a[4:7], v[36:39], v[48:51], a[4:7]
    s_add_u32 m0, s39, 18432
    s_nop 0
    buffer_load_dwordx4 v3, s[16:19], s42 offen lds
    s_add_u32 s42, s42, s47
    v_mfma_f32_16x16x32_bf16 a[20:23], v[36:39], v[52:55], a[20:23]
    v_mfma_f32_16x16x32_bf16 a[36:39], v[36:39], v[56:59], a[36:39]
    s_add_u32 m0, s39, 19456
    s_nop 0
    buffer_load_dwordx4 v3, s[16:19], s42 offen lds
    s_add_u32 s42, s42, s48
    v_mfma_f32_16x16x32_bf16 a[52:55], v[36:39], v[60:63], a[52:55]
    v_mfma_f32_16x16x32_bf16 a[68:71], v[36:39], v[64:67], a[68:71]
    buffer_load_dwordx4 v[128:131], v2, s[12:15], s52 offen
    s_add_u32 s52, s52, 8192
    v_mfma_f32_16x16x32_bf16 a[8:11], v[40:43], v[48:51], a[8:11]
    v_mfma_f32_16x16x32_bf16 a[24:27], v[40:43], v[52:55], a[24:27]
    buffer_load_dwordx4 v[132:135], v2, s[12:15], s53 offen
    s_add_u32 s53, s53, 8192
    v_mfma_f32_16x16x32_bf16 a[40:43], v[40:43], v[56:59], a[40:43]
    v_mfma_f32_16x16x32_bf16 a[56:59], v[40:43], v[60:63], a[56:59]
    buffer_load_dwordx4 v[136:139], v2, s[12:15], s54 offen
    s_add_u32 s54, s54, 8192
    v_mfma_f32_16x16x32_bf16 a[72:75], v[40:43], v[64:67], a[72:75]
    v_mfma_f32_16x16x32_bf16 a[12:15], v[44:47], v[48:51], a[12:15]
    buffer_load_dwordx4 v[140:143], v2, s[12:15], s55 offen
    s_add_u32 s55, s55, 8192
    v_mfma_f32_16x16x32_bf16 a[28:31], v[44:47], v[52:55], a[28:31]
    v_mfma_f32_16x16x32_bf16 a[44:47], v[44:47], v[56:59], a[44:47]
    buffer_load_dwordx4 v[144:147], v2, s[12:15], s56 offen
    s_add_u32 s56, s56, 8192
    v_mfma_f32_16x16x32_bf16 a[60:63], v[44:47], v[60:63], a[60:63]
    v_mfma_f32_16x16x32_bf16 a[76:79], v[44:47], v[64:67], a[76:79]
    s_waitcnt vmcnt(18)
    ds_read_b64_tr_b16 v[32:33], v4 offset:8192
    ds_read_b64_tr_b16 v[34:35], v4 offset:9216
    ds_read_b64_tr_b16 v[36:37], v5 offset:8192
    ds_read_b64_tr_b16 v[38:39], v5 offset:9216
    ds_read_b64_tr_b16 v[40:41], v6 offset:8192
    ds_read_b64_tr_b16 v[42:43], v6 offset:9216
    ds_read_b64_tr_b16 v[44:45], v7 offset:8192
    ds_read_b64_tr_b16 v[46:47], v7 offset:9216
    s_waitcnt lgkmcnt(8)
    v_mfma_f32_16x16x32_bf16 a[0:3], v[16:19], v[68:71], a[0:3]
    v_mfma_f32_16x16x32_bf16 a[16:19], v[16:19], v[72:75], a[16:19]
    s_add_u32 m0, s39, 0
    s_nop 0
    buffer_load_dwordx4 v3, s[16:19], s42 offen lds
    s_add_u32 s42, s42, s47
    v_mfma_f32_16x16x32_bf16 a[32:35], v[16:19], v[76:79], a[32:35]
    v_mfma_f32_16x16x32_bf16 a[48:51], v[16:19], v[80:83], a[48:51]
    s_add_u32 m0, s39, 1024
    s_nop 0
    buffer_load_dwordx4 v3, s[16:19], s42 offen lds
    s_add_u32 s42, s42, s47
    v_mfma_f32_16x16x32_bf16 a[64:67], v[16:19], v[84:87], a[64:67]
    v_mfma_f32_16x16x32_bf16 a[4:7], v[20:23], v[68:71], a[4:7]
    s_add_u32 m0, s39, 2048
    s_nop 0
    buffer_load_dwordx4 v3, s[16:19], s42 offen lds
    s_add_u32 s42, s42, s47
    v_mfma_f32_16x16x32_bf16 a[20:23], v[20:23], v[72:75], a[20:23]
    v_mfma_f32_16x16x32_bf16 a[36:39], v[20:23], v[76:79], a[36:39]
    s_add_u32 m0, s39, 3072
    s_nop 0
    buffer_load_dwordx4 v3, s[16:19], s42 offen lds
    s_add_u32 s42, s42, s48
    v_mfma_f32_16x16x32_bf16 a[52:55], v[20:23], v[80:83], a[52:55]
    v_mfma_f32_16x16x32_bf16 a[68:71], v[20:23], v[84:87], a[68:71]
    buffer_load_dwordx4 v[48:51], v2, s[12:15], s52 offen
    s_add_u32 s52, s52, 8192
    v_mfma_f32_16x16x32_bf16 a[8:11], v[24:27], v[68:71], a[8:11]
    v_mfma_f32_16x16x32_bf16 a[24:27], v[24:27], v[72:75], a[24:27]
    buffer_load_dwordx4 v[52:55], v2, s[12:15], s53 offen
    s_add_u32 s53, s53, 8192
    v_mfma_f32_16x16x32_bf16 a[40:43], v[24:27], v[76:79], a[40:43]
    v_mfma_f32_16x16x32_bf16 a[56:59], v[24:27], v[80:83], a[56:59]
    buffer_load_dwordx4 v[56:59], v2, s[12:15], s54 offen
    s_add_u32 s54, s54, 8192
    v_mfma_f32_16x16x32_bf16 a[72:75], v[24:27], v[84:87], a[72:75]
    v_mfma_f32_16x16x32_bf16 a[12:15], v[28:31], v[68:71], a[12:15]
    buffer_load_dwordx4 v[60:63], v2, s[12:15], s55 offen
    s_add_u32 s55, s55, 8192
    v_mfma_f32_16x16x32_bf16 a[28:31], v[28:31], v[72:75], a[28:31]
    v_mfma_f32_16x16x32_bf16 a[44:47], v[28:31], v[76:79], a[44:47]
    buffer_load_dwordx4 v[64:67], v2, s[12:15], s56 offen
    s_add_u32 s56, s56, 8192
    v_mfma_f32_16x16x32_bf16 a[60:63], v[28:31], v[80:83], a[60:63]
    v_mfma_f32_16x16x32_bf16 a[76:79], v[28:31], v[84:87], a[76:79]
    s_waitcnt vmcnt(18)
    ds_read_b64_tr_b16 v[16:17], v4 offset:12288
    ds_read_b64_tr_b16 v[18:19], v4 offset:13312
    ds_read_b64_tr_b16 v[20:21], v5 offset:12288
    ds_read_b64_tr_b16 v[22:23], v5 offset:13312
    ds_read_b64_tr_b16 v[24:25], v6 offset:12288
    ds_read_b64_tr_b16 v[26:27], v6 offset:13312
    ds_read_b64_tr_b16 v[28:29], v7 offset:12288
    ds_read_b64_tr_b16 v[30:31], v7 offset:13312
    s_waitcnt lgkmcnt(8)
    v_mfma_f32_16x16x32_bf16 a[0:3], v[32:35], v[88:91], a[0:3]
    v_mfma_f32_16x16x32_bf16 a[16:19], v[32:35], v[92:95], a[16:19]
    s_add_u32 m0, s39, 4096
    s_nop 0
    buffer_load_dwordx4 v3, s[16:19], s42 offen lds
    s_add_u32 s42, s42, s47
    v_mfma_f32_16x16x32_bf16 a[32:35], v[32:35], v[96:99], a[32:35]
    v_mfma_f32_16x16x32_bf16 a[48:51], v[32:35], v[100:103], a[48:51]
    s_add_u32 m0, s39, 5120
    s_nop 0
    buffer_load_dwordx4 v3, s[16:19], s42 offen lds
    s_add_u32 s42, s42, s47
    v_mfma_f32_16x16x32_bf16 a[64:67], v[32:35], v[104:107], a[64:67]
    v_mfma_f32_16x16x32_bf16 a[4:7], v[36:39], v[88:91], a[4:7]
    s_add_u32 m0, s39, 6144
    s_nop 0
    buffer_load_dwordx4 v3, s[16:19], s42 offen lds
    s_add_u32 s42, s42, s47
    v_mfma_f32_16x16x32_bf16 a[20:23], v[36:39], v[92:95], a[20:23]
    v_mfma_f32_16x16x32_bf16 a[36:39], v[36:39], v[96:99], a[36:39]
    s_add_u32 m0, s39, 7168
    s_nop 0
    buffer_load_dwordx4 v3, s[16:19], s42 offen lds
    s_add_u32 s42, s42, s48
    v_mfma_f32_16x16x32_bf16 a[52:55], v[36:39], v[100:103], a[52:55]
    v_mfma_f32_16x16x32_bf16 a[68:71], v[36:39], v[104:107], a[68:71]
    buffer_load_dwordx4 v[68:71], v2, s[12:15], s52 offen
    s_add_u32 s52, s52, 8192
    v_mfma_f32_16x16x32_bf16 a[8:11], v[40:43], v[88:91], a[8:11]
    v_mfma_f32_16x16x32_bf16 a[24:27], v[40:43], v[92:95], a[24:27]
    buffer_load_dwordx4 v[72:75], v2, s[12:15], s53 offen
    s_add_u32 s53, s53, 8192
    v_mfma_f32_16x16x32_bf16 a[40:43], v[40:43], v[96:99], a[40:43]
    v_mfma_f32_16x16x32_bf16 a[56:59], v[40:43], v[100:103], a[56:59]
    buffer_load_dwordx4 v[76:79], v2, s[12:15], s54 offen
    s_add_u32 s54, s54, 8192
    v_mfma_f32_16x16x32_bf16 a[72:75], v[40:43], v[104:107], a[72:75]
    v_mfma_f32_16x16x32_bf16 a[12:15], v[44:47], v[88:91], a[12:15]
    buffer_load_dwordx4 v[80:83], v2, s[12:15], s55 offen
    s_add_u32 s55, s55, 8192
    v_mfma_f32_16x16x32_bf16 a[28:31], v[44:47], v[92:95], a[28:31]
    v_mfma_f32_16x16x32_bf16 a[44:47], v[44:47], v[96:99], a[44:47]
    buffer_load_dwordx4 v[84:87], v2, s[12:15], s56 offen
    s_add_u32 s56, s56, 8192
    v_mfma_f32_16x16x32_bf16 a[60:63], v[44:47], v[100:103], a[60:63]
    v_mfma_f32_16x16x32_bf16 a[76:79], v[44:47], v[104:107], a[76:79]
    s_waitcnt vmcnt(18)
    ds_read_b64_tr_b16 v[32:33], v4 offset:16384
    ds_read_b64_tr_b16 v[34:35], v4 offset:17408
    ds_read_b64_tr_b16 v[36:37], v5 offset:16384
    ds_read_b64_tr_b16 v[38:39], v5 offset:17408
    ds_read_b64_tr_b16 v[40:41], v6 offset:16384
    ds_read_b64_tr_b16 v[42:43], v6 offset:17408
    ds_read_b64_tr_b16 v[44:45], v7 offset:16384
    ds_read_b64_tr_b16 v[46:47], v7 offset:17408
    s_waitcnt lgkmcnt(8)
    v_mfma_f32_16x16x32_bf16 a[0:3], v[16:19], v[108:111], a[0:3]
    v_mfma_f32_16x16x32_bf16 a[16:19], v[16:19], v[112:115], a[16:19]
    s_add_u32 m0, s39, 8192
    s_nop 0
    buffer_load_dwordx4 v3, s[16:19], s42 offen lds
    s_add_u32 s42, s42, s47
    v_mfma_f32_16x16x32_bf16 a[32:35], v[16:19], v[116:119], a[32:35]
    v_mfma_f32_16x16x32_bf16 a[48:51], v[16:19], v[120:123], a[48:51]
    s_add_u32 m0, s39, 9216
    s_nop 0
    buffer_load_dwordx4 v3, s[16:19], s42 offen lds
    s_add_u32 s42, s42, s47
    v_mfma_f32_16x16x32_bf16 a[64:67], v[16:19], v[124:127], a[64:67]
    v_mfma_f32_16x16x32_bf16 a[4:7], v[20:23], v[108:111], a[4:7]
    s_add_u32 m0, s39, 10240
    s_nop 0
    buffer_load_dwordx4 v3, s[16:19], s42 offen lds
    s_add_u32 s42, s42, s47
    v_mfma_f32_16x16x32_bf16 a[20:23], v[20:23], v[112:115], a[20:23]
    v_mfma_f32_16x16x32_bf16 a[36:39], v[20:23], v[116:119], a[36:39]
    s_add_u32 m0, s39, 11264
    s_nop 0
    buffer_load_dwordx4 v3, s[16:19], s42 offen lds
    s_add_u32 s42, s42, s48
    v_mfma_f32_16x16x32_bf16 a[52:55], v[20:23], v[120:123], a[52:55]
    v_mfma_f32_16x16x32_bf16 a[68:71], v[20:23], v[124:127], a[68:71]
    buffer_load_dwordx4 v[88:91], v2, s[12:15], s52 offen
    s_add_u32 s52, s52, 8192
    v_mfma_f32_16x16x32_bf16 a[8:11], v[24:27], v[108:111], a[8:11]
    v_mfma_f32_16x16x32_bf16 a[24:27], v[24:27], v[112:115], a[24:27]
    buffer_load_dwordx4 v[92:95], v2, s[12:15], s53 offen
    s_add_u32 s53, s53, 8192
    v_mfma_f32_16x16x32_bf16 a[40:43], v[24:27], v[116:119], a[40:43]
    v_mfma_f32_16x16x32_bf16 a[56:59], v[24:27], v[120:123], a[56:59]
    buffer_load_dwordx4 v[96:99], v2, s[12:15], s54 offen
    s_add_u32 s54, s54, 8192
    v_mfma_f32_16x16x32_bf16 a[72:75], v[24:27], v[124:127], a[72:75]
    v_mfma_f32_16x16x32_bf16 a[12:15], v[28:31], v[108:111], a[12:15]
    buffer_load_dwordx4 v[100:103], v2, s[12:15], s55 offen
    s_add_u32 s55, s55, 8192
    v_mfma_f32_16x16x32_bf16 a[28:31], v[28:31], v[112:115], a[28:31]
    v_mfma_f32_16x16x32_bf16 a[44:47], v[28:31], v[116:119], a[44:47]
    buffer_load_dwordx4 v[104:107], v2, s[12:15], s56 offen
    s_add_u32 s56, s56, 8192
    v_mfma_f32_16x16x32_bf16 a[60:63], v[28:31], v[120:123], a[60:63]
    v_mfma_f32_16x16x32_bf16 a[76:79], v[28:31], v[124:127], a[76:79]
    s_waitcnt vmcnt(18)
    ds_read_b64_tr_b16 v[16:17], v4 offset:0
    ds_read_b64_tr_b16 v[18:19], v4 offset:1024
    ds_read_b64_tr_b16 v[20:21], v5 offset:0
    ds_read_b64_tr_b16 v[22:23], v5 offset:1024
    ds_read_b64_tr_b16 v[24:25], v6 offset:0
    ds_read_b64_tr_b16 v[26:27], v6 offset:1024
    ds_read_b64_tr_b16 v[28:29], v7 offset:0
    ds_read_b64_tr_b16 v[30:31], v7 offset:1024
    s_waitcnt lgkmcnt(8)
    v_mfma_f32_16x16x32_bf16 a[0:3], v[32:35], v[128:131], a[0:3]
    v_mfma_f32_16x16x32_bf16 a[16:19], v[32:35], v[132:135], a[16:19]
    s_add_u32 m0, s39, 12288
    s_nop 0
    buffer_load_dwordx4 v3, s[16:19], s42 offen lds
    s_add_u32 s42, s42, s47
    v_mfma_f32_16x16x32_bf16 a[32:35], v[32:35], v[136:139], a[32:35]
    v_mfma_f32_16x16x32_bf16 a[48:51], v[32:35], v[140:143], a[48:51]
    s_add_u32 m0, s39, 13312
    s_nop 0
    buffer_load_dwordx4 v3, s[16:19], s42 offen lds
    s_add_u32 s42, s42, s47
    v_mfma_f32_16x16x32_bf16 a[64:67], v[32:35], v[144:147], a[64:67]
    v_mfma_f32_16x16x32_bf16 a[4:7], v[36:39], v[128:131], a[4:7]
    s_add_u32 m0, s39, 14336
    s_nop 0
    buffer_load_dwordx4 v3, s[16:19], s42 offen lds
    s_add_u32 s42, s42, s47
    v_mfma_f32_16x16x32_bf16 a[20:23], v[36:39], v[132:135], a[20:23]
    v_mfma_f32_16x16x32_bf16 a[36:39], v[36:39], v[136:139], a[36:39]
    s_add_u32 m0, s39, 15360
    s_nop 0
    buffer_load_dwordx4 v3, s[16:19], s42 offen lds
    s_add_u32 s42, s42, s48
    v_mfma_f32_16x16x32_bf16 a[52:55], v[36:39], v[140:143], a[52:55]
    v_mfma_f32_16x16x32_bf16 a[68:71], v[36:39], v[144:147], a[68:71]
    buffer_load_dwordx4 v[108:111], v2, s[12:15], s52 offen
    s_add_u32 s52, s52, 8192
    v_mfma_f32_16x16x32_bf16 a[8:11], v[40:43], v[128:131], a[8:11]
    v_mfma_f32_16x16x32_bf16 a[24:27], v[40:43], v[132:135], a[24:27]
    buffer_load_dwordx4 v[112:115], v2, s[12:15], s53 offen
    s_add_u32 s53, s53, 8192
    v_mfma_f32_16x16x32_bf16 a[40:43], v[40:43], v[136:139], a[40:43]
    v_mfma_f32_16x16x32_bf16 a[56:59], v[40:43], v[140:143], a[56:59]
    buffer_load_dwordx4 v[116:119], v2, s[12:15], s54 offen
    s_add_u32 s54, s54, 8192
    v_mfma_f32_16x16x32_bf16 a[72:75], v[40:43], v[144:147], a[72:75]
    v_mfma_f32_16x16x32_bf16 a[12:15], v[44:47], v[128:131], a[12:15]
    buffer_load_dwordx4 v[120:123], v2, s[12:15], s55 offen
    s_add_u32 s55, s55, 8192
    v_mfma_f32_16x16x32_bf16 a[28:31], v[44:47], v[132:135], a[28:31]
    v_mfma_f32_16x16x32_bf16 a[44:47], v[44:47], v[136:139], a[44:47]
    buffer_load_dwordx4 v[124:127], v2, s[12:15], s56 offen
    s_add_u32 s56, s56, 8192
    v_mfma_f32_16x16x32_bf16 a[60:63], v[44:47], v[140:143], a[60:63]
    v_mfma_f32_16x16x32_bf16 a[76:79], v[44:47], v[144:147], a[76:79]
    s_waitcnt vmcnt(18)
    ds_read_b64_tr_b16 v[32:33], v4 offset:4096
    ds_read_b64_tr_b16 v[34:35], v4 offset:5120
    ds_read_b64_tr_b16 v[36:37], v5 offset:4096
    ds_read_b64_tr_b16 v[38:39], v5 offset:5120
    ds_read_b64_tr_b16 v[40:41], v6 offset:4096
    ds_read_b64_tr_b16 v[42:43], v6 offset:5120
    ds_read_b64_tr_b16 v[44:45], v7 offset:4096
    ds_read_b64_tr_b16 v[46:47], v7 offset:5120
    s_waitcnt lgkmcnt(8)
    v_mfma_f32_16x16x32_bf16 a[0:3], v[16:19], v[48:51], a[0:3]
    v_mfma_f32_16x16x32_bf16 a[16:19], v[16:19], v[52:55], a[16:19]
    s_add_u32 m0, s39, 16384
    s_nop 0
    buffer_load_dwordx4 v3, s[16:19], s42 offen lds
    s_add_u32 s42, s42, s47
    v_mfma_f32_16x16x32_bf16 a[32:35], v[16:19], v[56:59], a[32:35]
    v_mfma_f32_16x16x32_bf16 a[48:51], v[16:19], v[60:63], a[48:51]
    s_add_u32 m0, s39, 17408
    s_nop 0
    buffer_load_dwordx4 v3, s[16:19], s42 offen lds
    s_add_u32 s42, s42, s47
    v_mfma_f32_16x16x32_bf16 a[64:67], v[16:19], v[64:67], a[64:67]
    v_mfma_f32_16x16x32_bf16 a[4:7], v[20:23], v[48:51], a[4:7]
    s_add_u32 m0, s39, 18432
    s_nop 0
    buffer_load_dwordx4 v3, s[16:19], s42 offen lds
    s_add_u32 s42, s42, s47
    v_mfma_f32_16x16x32_bf16 a[20:23], v[20:23], v[52:55], a[20:23]
    v_mfma_f32_16x16x32_bf16 a[36:39], v[20:23], v[56:59], a[36:39]
    s_add_u32 m0, s39, 19456
    s_nop 0
    buffer_load_dwordx4 v3, s[16:19], s42 offen lds
    s_add_u32 s42, s42, s48
    v_mfma_f32_16x16x32_bf16 a[52:55], v[20:23], v[60:63], a[52:55]
    v_mfma_f32_16x16x32_bf16 a[68:71], v[20:23], v[64:67], a[68:71]
    buffer_load_dwordx4 v[128:131], v2, s[12:15], s52 offen
    s_add_u32 s52, s52, 8192
    v_mfma_f32_16x16x32_bf16 a[8:11], v[24:27], v[48:51], a[8:11]
    v_mfma_f32_16x16x32_bf16 a[24:27], v[24:27], v[52:55], a[24:27]
    buffer_load_dwordx4 v[132:135], v2, s[12:15], s53 offen
    s_add_u32 s53, s53, 8192
    v_mfma_f32_16x16x32_bf16 a[40:43], v[24:27], v[56:59], a[40:43]
    v_mfma_f32_16x16x32_bf16 a[56:59], v[24:27], v[60:63], a[56:59]
    buffer_load_dwordx4 v[136:139], v2, s[12:15], s54 offen
    s_add_u32 s54, s54, 8192
    v_mfma_f32_16x16x32_bf16 a[72:75], v[24:27], v[64:67], a[72:75]
    v_mfma_f32_16x16x32_bf16 a[12:15], v[28:31], v[48:51], a[12:15]
    buffer_load_dwordx4 v[140:143], v2, s[12:15], s55 offen
    s_add_u32 s55, s55, 8192
    v_mfma_f32_16x16x32_bf16 a[28:31], v[28:31], v[52:55], a[28:31]
    v_mfma_f32_16x16x32_bf16 a[44:47], v[28:31], v[56:59], a[44:47]
    buffer_load_dwordx4 v[144:147], v2, s[12:15], s56 offen
    s_add_u32 s56, s56, 8192
    v_mfma_f32_16x16x32_bf16 a[60:63], v[28:31], v[60:63], a[60:63]
    v_mfma_f32_16x16x32_bf16 a[76:79], v[28:31], v[64:67], a[76:79]
    s_waitcnt vmcnt(18)
    ds_read_b64_tr_b16 v[16:17], v4 offset:8192
    ds_read_b64_tr_b16 v[18:19], v4 offset:9216
    ds_read_b64_tr_b16 v[20:21], v5 offset:8192
    ds_read_b64_tr_b16 v[22:23], v5 offset:9216
    ds_read_b64_tr_b16 v[24:25], v6 offset:8192
    ds_read_b64_tr_b16 v[26:27], v6 offset:9216
    ds_read_b64_tr_b16 v[28:29], v7 offset:8192
    ds_read_b64_tr_b16 v[30:31], v7 offset:9216
    s_waitcnt lgkmcnt(8)
    v_mfma_f32_16x16x32_bf16 a[0:3], v[32:35], v[68:71], a[0:3]
    v_mfma_f32_16x16x32_bf16 a[16:19], v[32:35], v[72:75], a[16:19]
    s_add_u32 m0, s39, 0
    s_nop 0
    buffer_load_dwordx4 v3, s[16:19], s42 offen lds
    s_add_u32 s42, s42, s47
    v_mfma_f32_16x16x32_bf16 a[32:35], v[32:35], v[76:79], a[32:35]
    v_mfma_f32_16x16x32_bf16 a[48:51], v[32:35], v[80:83], a[48:51]
    s_add_u32 m0, s39, 1024
    s_nop 0
    buffer_load_dwordx4 v3, s[16:19], s42 offen lds
    s_add_u32 s42, s42, s47
    v_mfma_f32_16x16x32_bf16 a[64:67], v[32:35], v[84:87], a[64:67]
    v_mfma_f32_16x16x32_bf16 a[4:7], v[36:39], v[68:71], a[4:7]
    s_add_u32 m0, s39, 2048
    s_nop 0
    buffer_load_dwordx4 v3, s[16:19], s42 offen lds
    s_add_u32 s42, s42, s47
    v_mfma_f32_16x16x32_bf16 a[20:23], v[36:39], v[72:75], a[20:23]
    v_mfma_f32_16x16x32_bf16 a[36:39], v[36:39], v[76:79], a[36:39]
    s_add_u32 m0, s39, 3072
    s_nop 0
    buffer_load_dwordx4 v3, s[16:19], s42 offen lds
    s_add_u32 s42, s42, s48
    v_mfma_f32_16x16x32_bf16 a[52:55], v[36:39], v[80:83], a[52:55]
    v_mfma_f32_16x16x32_bf16 a[68:71], v[36:39], v[84:87], a[68:71]
    buffer_load_dwordx4 v[48:51], v2, s[12:15], s52 offen
    s_add_u32 s52, s52, 8192
    v_mfma_f32_16x16x32_bf16 a[8:11], v[40:43], v[68:71], a[8:11]
    v_mfma_f32_16x16x32_bf16 a[24:27], v[40:43], v[72:75], a[24:27]
    buffer_load_dwordx4 v[52:55], v2, s[12:15], s53 offen
    s_add_u32 s53, s53, 8192
    v_mfma_f32_16x16x32_bf16 a[40:43], v[40:43], v[76:79], a[40:43]
    v_mfma_f32_16x16x32_bf16 a[56:59], v[40:43], v[80:83], a[56:59]
    buffer_load_dwordx4 v[56:59], v2, s[12:15], s54 offen
    s_add_u32 s54, s54, 8192
    v_mfma_f32_16x16x32_bf16 a[72:75], v[40:43], v[84:87], a[72:75]
    v_mfma_f32_16x16x32_bf16 a[12:15], v[44:47], v[68:71], a[12:15]
    buffer_load_dwordx4 v[60:63], v2, s[12:15], s55 offen
    s_add_u32 s55, s55, 8192
    v_mfma_f32_16x16x32_bf16 a[28:31], v[44:47], v[72:75], a[28:31]
    v_mfma_f32_16x16x32_bf16 a[44:47], v[44:47], v[76:79], a[44:47]
    buffer_load_dwordx4 v[64:67], v2, s[12:15], s56 offen
    s_add_u32 s56, s56, 8192
    v_mfma_f32_16x16x32_bf16 a[60:63], v[44:47], v[80:83], a[60:63]
    v_mfma_f32_16x16x32_bf16 a[76:79], v[44:47], v[84:87], a[76:79]
    s_waitcnt vmcnt(18)
    ds_read_b64_tr_b16 v[32:33], v4 offset:12288
    ds_read_b64_tr_b16 v[34:35], v4 offset:13312
    ds_read_b64_tr_b16 v[36:37], v5 offset:12288
    ds_read_b64_tr_b16 v[38:39], v5 offset:13312
    ds_read_b64_tr_b16 v[40:41], v6 offset:12288
    ds_read_b64_tr_b16 v[42:43], v6 offset:13312
    ds_read_b64_tr_b16 v[44:45], v7 offset:12288
    ds_read_b64_tr_b16 v[46:47], v7 offset:13312
    s_waitcnt lgkmcnt(8)
    v_mfma_f32_16x16x32_bf16 a[0:3], v[16:19], v[88:91], a[0:3]
    v_mfma_f32_16x16x32_bf16 a[16:19], v[16:19], v[92:95], a[16:19]
    s_add_u32 m0, s39, 4096
    s_nop 0
    buffer_load_dwordx4 v3, s[16:19], s42 offen lds
    s_add_u32 s42, s42, s47
    v_mfma_f32_16x16x32_bf16 a[32:35], v[16:19], v[96:99], a[32:35]
    v_mfma_f32_16x16x32_bf16 a[48:51], v[16:19], v[100:103], a[48:51]
    s_add_u32 m0, s39, 5120
    s_nop 0
    buffer_load_dwordx4 v3, s[16:19], s42 offen lds
    s_add_u32 s42, s42, s47
    v_mfma_f32_16x16x32_bf16 a[64:67], v[16:19], v[104:107], a[64:67]
    v_mfma_f32_16x16x32_bf16 a[4:7], v[20:23], v[88:91], a[4:7]
    s_add_u32 m0, s39, 6144
    s_nop 0
    buffer_load_dwordx4 v3, s[16:19], s42 offen lds
    s_add_u32 s42, s42, s47
    v_mfma_f32_16x16x32_bf16 a[20:23], v[20:23], v[92:95], a[20:23]
    v_mfma_f32_16x16x32_bf16 a[36:39], v[20:23], v[96:99], a[36:39]
    s_add_u32 m0, s39, 7168
    s_nop 0
    buffer_load_dwordx4 v3, s[16:19], s42 offen lds
    s_add_u32 s42, s42, s48
    v_mfma_f32_16x16x32_bf16 a[52:55], v[20:23], v[100:103], a[52:55]
    v_mfma_f32_16x16x32_bf16 a[68:71], v[20:23], v[104:107], a[68:71]
    buffer_load_dwordx4 v[68:71], v2, s[12:15], s52 offen
    s_add_u32 s52, s52, 8192
    v_mfma_f32_16x16x32_bf16 a[8:11], v[24:27], v[88:91], a[8:11]
    v_mfma_f32_16x16x32_bf16 a[24:27], v[24:27], v[92:95], a[24:27]
    buffer_load_dwordx4 v[72:75], v2, s[12:15], s53 offen
    s_add_u32 s53, s53, 8192
    v_mfma_f32_16x16x32_bf16 a[40:43], v[24:27], v[96:99], a[40:43]
    v_mfma_f32_16x16x32_bf16 a[56:59], v[24:27], v[100:103], a[56:59]
    buffer_load_dwordx4 v[76:79], v2, s[12:15], s54 offen
    s_add_u32 s54, s54, 8192
    v_mfma_f32_16x16x32_bf16 a[72:75], v[24:27], v[104:107], a[72:75]
    v_mfma_f32_16x16x32_bf16 a[12:15], v[28:31], v[88:91], a[12:15]
    buffer_load_dwordx4 v[80:83], v2, s[12:15], s55 offen
    s_add_u32 s55, s55, 8192
    v_mfma_f32_16x16x32_bf16 a[28:31], v[28:31], v[92:95], a[28:31]
    v_mfma_f32_16x16x32_bf16 a[44:47], v[28:31], v[96:99], a[44:47]
    buffer_load_dwordx4 v[84:87], v2, s[12:15], s56 offen
    s_add_u32 s56, s56, 8192
    v_mfma_f32_16x16x32_bf16 a[60:63], v[28:31], v[100:103], a[60:63]
    v_mfma_f32_16x16x32_bf16 a[76:79], v[28:31], v[104:107], a[76:79]
    s_waitcnt vmcnt(18)
    ds_read_b64_tr_b16 v[16:17], v4 offset:16384
    ds_read_b64_tr_b16 v[18:19], v4 offset:17408
    ds_read_b64_tr_b16 v[20:21], v5 offset:16384
    ds_read_b64_tr_b16 v[22:23], v5 offset:17408
    ds_read_b64_tr_b16 v[24:25], v6 offset:16384
    ds_read_b64_tr_b16 v[26:27], v6 offset:17408
    ds_read_b64_tr_b16 v[28:29], v7 offset:16384
    ds_read_b64_tr_b16 v[30:31], v7 offset:17408
    s_waitcnt lgkmcnt(8)
    v_mfma_f32_16x16x32_bf16 a[0:3], v[32:35], v[108:111], a[0:3]
    v_mfma_f32_16x16x32_bf16 a[16:19], v[32:35], v[112:115], a[16:19]
    s_add_u32 m0, s39, 8192
    s_nop 0
    buffer_load_dwordx4 v3, s[16:19], s42 offen lds
    s_add_u32 s42, s42, s47
    v_mfma_f32_16x16x32_bf16 a[32:35], v[32:35], v[116:119], a[32:35]
    v_mfma_f32_16x16x32_bf16 a[48:51], v[32:35], v[120:123], a[48:51]
    s_add_u32 m0, s39, 9216
    s_nop 0
    buffer_load_dwordx4 v3, s[16:19], s42 offen lds
    s_add_u32 s42, s42, s47
    v_mfma_f32_16x16x32_bf16 a[64:67], v[32:35], v[124:127], a[64:67]
    v_mfma_f32_16x16x32_bf16 a[4:7], v[36:39], v[108:111], a[4:7]
    s_add_u32 m0, s39, 10240
    s_nop 0
    buffer_load_dwordx4 v3, s[16:19], s42 offen lds
    s_add_u32 s42, s42, s47
    v_mfma_f32_16x16x32_bf16 a[20:23], v[36:39], v[112:115], a[20:23]
    v_mfma_f32_16x16x32_bf16 a[36:39], v[36:39], v[116:119], a[36:39]
    s_add_u32 m0, s39, 11264
    s_nop 0
    buffer_load_dwordx4 v3, s[16:19], s42 offen lds
    s_add_u32 s42, s42, s48
    v_mfma_f32_16x16x32_bf16 a[52:55], v[36:39], v[120:123], a[52:55]
    v_mfma_f32_16x16x32_bf16 a[68:71], v[36:39], v[124:127], a[68:71]
    buffer_load_dwordx4 v[88:91], v2, s[12:15], s52 offen
    s_add_u32 s52, s52, 8192
    v_mfma_f32_16x16x32_bf16 a[8:11], v[40:43], v[108:111], a[8:11]
    v_mfma_f32_16x16x32_bf16 a[24:27], v[40:43], v[112:115], a[24:27]
    buffer_load_dwordx4 v[92:95], v2, s[12:15], s53 offen
    s_add_u32 s53, s53, 8192
    v_mfma_f32_16x16x32_bf16 a[40:43], v[40:43], v[116:119], a[40:43]
    v_mfma_f32_16x16x32_bf16 a[56:59], v[40:43], v[120:123], a[56:59]
    buffer_load_dwordx4 v[96:99], v2, s[12:15], s54 offen
    s_add_u32 s54, s54, 8192
    v_mfma_f32_16x16x32_bf16 a[72:75], v[40:43], v[124:127], a[72:75]
    v_mfma_f32_16x16x32_bf16 a[12:15], v[44:47], v[108:111], a[12:15]
    buffer_load_dwordx4 v[100:103], v2, s[12:15], s55 offen
    s_add_u32 s55, s55, 8192
    v_mfma_f32_16x16x32_bf16 a[28:31], v[44:47], v[112:115], a[28:31]
    v_mfma_f32_16x16x32_bf16 a[44:47], v[44:47], v[116:119], a[44:47]
    buffer_load_dwordx4 v[104:107], v2, s[12:15], s56 offen
    s_add_u32 s56, s56, 8192
    v_mfma_f32_16x16x32_bf16 a[60:63], v[44:47], v[120:123], a[60:63]
    v_mfma_f32_16x16x32_bf16 a[76:79], v[44:47], v[124:127], a[76:79]
    s_waitcnt vmcnt(18)
    ds_read_b64_tr_b16 v[32:33], v4 offset:0
    ds_read_b64_tr_b16 v[34:35], v4 offset:1024
    ds_read_b64_tr_b16 v[36:37], v5 offset:0
    ds_read_b64_tr_b16 v[38:39], v5 offset:1024
    ds_read_b64_tr_b16 v[40:41], v6 offset:0
    ds_read_b64_tr_b16 v[42:43], v6 offset:1024
    ds_read_b64_tr_b16 v[44:45], v7 offset:0
    ds_read_b64_tr_b16 v[46:47], v7 offset:1024
    s_waitcnt lgkmcnt(8)
    v_mfma_f32_16x16x32_bf16 a[0:3], v[16:19], v[128:131], a[0:3]
    v_mfma_f32_16x16x32_bf16 a[16:19], v[16:19], v[132:135], a[16:19]
    s_add_u32 m0, s39, 12288
    s_nop 0
    buffer_load_dwordx4 v3, s[16:19], s42 offen lds
    s_add_u32 s42, s42, s47
    v_mfma_f32_16x16x32_bf16 a[32:35], v[16:19], v[136:139], a[32:35]
    v_mfma_f32_16x16x32_bf16 a[48:51], v[16:19], v[140:143], a[48:51]
    s_add_u32 m0, s39, 13312
    s_nop 0
    buffer_load_dwordx4 v3, s[16:19], s42 offen lds
    s_add_u32 s42, s42, s47
    v_mfma_f32_16x16x32_bf16 a[64:67], v[16:19], v[144:147], a[64:67]
    v_mfma_f32_16x16x32_bf16 a[4:7], v[20:23], v[128:131], a[4:7]
    s_add_u32 m0, s39, 14336
    s_nop 0
    buffer_load_dwordx4 v3, s[16:19], s42 offen lds
    s_add_u32 s42, s42, s47
    v_mfma_f32_16x16x32_bf16 a[20:23], v[20:23], v[132:135], a[20:23]
    v_mfma_f32_16x16x32_bf16 a[36:39], v[20:23], v[136:139], a[36:39]
    s_add_u32 m0, s39, 15360
    s_nop 0
    buffer_load_dwordx4 v3, s[16:19], s42 offen lds
    s_add_u32 s42, s42, s48
    v_mfma_f32_16x16x32_bf16 a[52:55], v[20:23], v[140:143], a[52:55]
    v_mfma_f32_16x16x32_bf16 a[68:71], v[20:23], v[144:147], a[68:71]
    buffer_load_dwordx4 v[108:111], v2, s[12:15], s52 offen
    s_add_u32 s52, s52, 8192
    v_mfma_f32_16x16x32_bf16 a[8:11], v[24:27], v[128:131], a[8:11]
    v_mfma_f32_16x16x32_bf16 a[24:27], v[24:27], v[132:135], a[24:27]
    buffer_load_dwordx4 v[112:115], v2, s[12:15], s53 offen
    s_add_u32 s53, s53, 8192
    v_mfma_f32_16x16x32_bf16 a[40:43], v[24:27], v[136:139], a[40:43]
    v_mfma_f32_16x16x32_bf16 a[56:59], v[24:27], v[140:143], a[56:59]
    buffer_load_dwordx4 v[116:119], v2, s[12:15], s54 offen
    s_add_u32 s54, s54, 8192
    v_mfma_f32_16x16x32_bf16 a[72:75], v[24:27], v[144:147], a[72:75]
    v_mfma_f32_16x16x32_bf16 a[12:15], v[28:31], v[128:131], a[12:15]
    buffer_load_dwordx4 v[120:123], v2, s[12:15], s55 offen
    s_add_u32 s55, s55, 8192
    v_mfma_f32_16x16x32_bf16 a[28:31], v[28:31], v[132:135], a[28:31]
    v_mfma_f32_16x16x32_bf16 a[44:47], v[28:31], v[136:139], a[44:47]
    buffer_load_dwordx4 v[124:127], v2, s[12:15], s56 offen
    s_add_u32 s56, s56, 8192
    v_mfma_f32_16x16x32_bf16 a[60:63], v[28:31], v[140:143], a[60:63]
    v_mfma_f32_16x16x32_bf16 a[76:79], v[28:31], v[144:147], a[76:79]
    s_waitcnt vmcnt(18)
    ds_read_b64_tr_b16 v[16:17], v4 offset:4096
    ds_read_b64_tr_b16 v[18:19], v4 offset:5120
    ds_read_b64_tr_b16 v[20:21], v5 offset:4096
    ds_read_b64_tr_b16 v[22:23], v5 offset:5120
    ds_read_b64_tr_b16 v[24:25], v6 offset:4096
    ds_read_b64_tr_b16 v[26:27], v6 offset:5120
    ds_read_b64_tr_b16 v[28:29], v7 offset:4096
    ds_read_b64_tr_b16 v[30:31], v7 offset:5120
    s_waitcnt lgkmcnt(8)
    v_mfma_f32_16x16x32_bf16 a[0:3], v[32:35], v[48:51], a[0:3]
    v_mfma_f32_16x16x32_bf16 a[16:19], v[32:35], v[52:55], a[16:19]
    s_add_u32 m0, s39, 16384
    s_nop 0
    buffer_load_dwordx4 v3, s[16:19], s42 offen lds
    s_add_u32 s42, s42, s47
    v_mfma_f32_16x16x32_bf16 a[32:35], v[32:35], v[56:59], a[32:35]
    v_mfma_f32_16x16x32_bf16 a[48:51], v[32:35], v[60:63], a[48:51]
    s_add_u32 m0, s39, 17408
    s_nop 0
    buffer_load_dwordx4 v3, s[16:19], s42 offen lds
    s_add_u32 s42, s42, s47
    v_mfma_f32_16x16x32_bf16 a[64:67], v[32:35], v[64:67], a[64:67]
    v_mfma_f32_16x16x32_bf16 a[4:7], v[36:39], v[48:51], a[4:7]
    s_add_u32 m0, s39, 18432
    s_nop 0
    buffer_load_dwordx4 v3, s[16:19], s42 offen lds
    s_add_u32 s42, s42, s47
    v_mfma_f32_16x16x32_bf16 a[20:23], v[36:39], v[52:55], a[20:23]
    v_mfma_f32_16x16x32_bf16 a[36:39], v[36:39], v[56:59], a[36:39]
    s_add_u32 m0, s39, 19456
    s_nop 0
    buffer_load_dwordx4 v3, s[16:19], s42 offen lds
    s_add_u32 s42, s42, s48
    v_mfma_f32_16x16x32_bf16 a[52:55], v[36:39], v[60:63], a[52:55]
    v_mfma_f32_16x16x32_bf16 a[68:71], v[36:39], v[64:67], a[68:71]
    buffer_load_dwordx4 v[128:131], v2, s[12:15], s52 offen
    s_add_u32 s52, s52, 8192
    v_mfma_f32_16x16x32_bf16 a[8:11], v[40:43], v[48:51], a[8:11]
    v_mfma_f32_16x16x32_bf16 a[24:27], v[40:43], v[52:55], a[24:27]
    buffer_load_dwordx4 v[132:135], v2, s[12:15], s53 offen
    s_add_u32 s53, s53, 8192
    v_mfma_f32_16x16x32_bf16 a[40:43], v[40:43], v[56:59], a[40:43]
    v_mfma_f32_16x16x32_bf16 a[56:59], v[40:43], v[60:63], a[56:59]
    buffer_load_dwordx4 v[136:139], v2, s[12:15], s54 offen
    s_add_u32 s54, s54, 8192
    v_mfma_f32_16x16x32_bf16 a[72:75], v[40:43], v[64:67], a[72:75]
    v_mfma_f32_16x16x32_bf16 a[12:15], v[44:47], v[48:51], a[12:15]
    buffer_load_dwordx4 v[140:143], v2, s[12:15], s55 offen
    s_add_u32 s55, s55, 8192
    v_mfma_f32_16x16x32_bf16 a[28:31], v[44:47], v[52:55], a[28:31]
    v_mfma_f32_16x16x32_bf16 a[44:47], v[44:47], v[56:59], a[44:47]
    buffer_load_dwordx4 v[144:147], v2, s[12:15], s56 offen
    s_add_u32 s56, s56, 8192
    v_mfma_f32_16x16x32_bf16 a[60:63], v[44:47], v[60:63], a[60:63]
    v_mfma_f32_16x16x32_bf16 a[76:79], v[44:47], v[64:67], a[76:79]
    s_waitcnt vmcnt(18)
    ds_read_b64_tr_b16 v[32:33], v4 offset:8192
    ds_read_b64_tr_b16 v[34:35], v4 offset:9216
    ds_read_b64_tr_b16 v[36:37], v5 offset:8192
    ds_read_b64_tr_b16 v[38:39], v5 offset:9216
    ds_read_b64_tr_b16 v[40:41], v6 offset:8192
    ds_read_b64_tr_b16 v[42:43], v6 offset:9216
    ds_read_b64_tr_b16 v[44:45], v7 offset:8192
    ds_read_b64_tr_b16 v[46:47], v7 offset:9216
    s_waitcnt lgkmcnt(8)
    v_mfma_f32_16x16x32_bf16 a[0:3], v[16:19], v[68:71], a[0:3]
    v_mfma_f32_16x16x32_bf16 a[16:19], v[16:19], v[72:75], a[16:19]
    s_add_u32 m0, s39, 0
    s_nop 0
    buffer_load_dwordx4 v3, s[16:19], s42 offen lds
    s_add_u32 s42, s42, s47
    v_mfma_f32_16x16x32_bf16 a[32:35], v[16:19], v[76:79], a[32:35]
    v_mfma_f32_16x16x32_bf16 a[48:51], v[16:19], v[80:83], a[48:51]
    s_add_u32 m0, s39, 1024
    s_nop 0
    buffer_load_dwordx4 v3, s[16:19], s42 offen lds
    s_add_u32 s42, s42, s47
    v_mfma_f32_16x16x32_bf16 a[64:67], v[16:19], v[84:87], a[64:67]
    v_mfma_f32_16x16x32_bf16 a[4:7], v[20:23], v[68:71], a[4:7]
    s_add_u32 m0, s39, 2048
    s_nop 0
    buffer_load_dwordx4 v3, s[16:19], s42 offen lds
    s_add_u32 s42, s42, s47
    v_mfma_f32_16x16x32_bf16 a[20:23], v[20:23], v[72:75], a[20:23]
    v_mfma_f32_16x16x32_bf16 a[36:39], v[20:23], v[76:79], a[36:39]
    s_add_u32 m0, s39, 3072
    s_nop 0
    buffer_load_dwordx4 v3, s[16:19], s42 offen lds
    s_add_u32 s42, s42, s48
    v_mfma_f32_16x16x32_bf16 a[52:55], v[20:23], v[80:83], a[52:55]
    v_mfma_f32_16x16x32_bf16 a[68:71], v[20:23], v[84:87], a[68:71]
    buffer_load_dwordx4 v[48:51], v2, s[12:15], s52 offen
    s_add_u32 s52, s52, 8192
    v_mfma_f32_16x16x32_bf16 a[8:11], v[24:27], v[68:71], a[8:11]
    v_mfma_f32_16x16x32_bf16 a[24:27], v[24:27], v[72:75], a[24:27]
    buffer_load_dwordx4 v[52:55], v2, s[12:15], s53 offen
    s_add_u32 s53, s53, 8192
    v_mfma_f32_16x16x32_bf16 a[40:43], v[24:27], v[76:79], a[40:43]
    v_mfma_f32_16x16x32_bf16 a[56:59], v[24:27], v[80:83], a[56:59]
    buffer_load_dwordx4 v[56:59], v2, s[12:15], s54 offen
    s_add_u32 s54, s54, 8192
    v_mfma_f32_16x16x32_bf16 a[72:75], v[24:27], v[84:87], a[72:75]
    v_mfma_f32_16x16x32_bf16 a[12:15], v[28:31], v[68:71], a[12:15]
    buffer_load_dwordx4 v[60:63], v2, s[12:15], s55 offen
    s_add_u32 s55, s55, 8192
    v_mfma_f32_16x16x32_bf16 a[28:31], v[28:31], v[72:75], a[28:31]
    v_mfma_f32_16x16x32_bf16 a[44:47], v[28:31], v[76:79], a[44:47]
    buffer_load_dwordx4 v[64:67], v2, s[12:15], s56 offen
    s_add_u32 s56, s56, 8192
    v_mfma_f32_16x16x32_bf16 a[60:63], v[28:31], v[80:83], a[60:63]
    v_mfma_f32_16x16x32_bf16 a[76:79], v[28:31], v[84:87], a[76:79]
    s_waitcnt vmcnt(18)
    ds_read_b64_tr_b16 v[16:17], v4 offset:12288
    ds_read_b64_tr_b16 v[18:19], v4 offset:13312
    ds_read_b64_tr_b16 v[20:21], v5 offset:12288
    ds_read_b64_tr_b16 v[22:23], v5 offset:13312
    ds_read_b64_tr_b16 v[24:25], v6 offset:12288
    ds_read_b64_tr_b16 v[26:27], v6 offset:13312
    ds_read_b64_tr_b16 v[28:29], v7 offset:12288
    ds_read_b64_tr_b16 v[30:31], v7 offset:13312
    s_waitcnt lgkmcnt(8)
    v_mfma_f32_16x16x32_bf16 a[0:3], v[32:35], v[88:91], a[0:3]
    v_mfma_f32_16x16x32_bf16 a[16:19], v[32:35], v[92:95], a[16:19]
    s_add_u32 m0, s39, 4096
    s_nop 0
    buffer_load_dwordx4 v3, s[16:19], s42 offen lds
    s_add_u32 s42, s42, s47
    v_mfma_f32_16x16x32_bf16 a[32:35], v[32:35], v[96:99], a[32:35]
    v_mfma_f32_16x16x32_bf16 a[48:51], v[32:35], v[100:103], a[48:51]
    s_add_u32 m0, s39, 5120
    s_nop 0
    buffer_load_dwordx4 v3, s[16:19], s42 offen lds
    s_add_u32 s42, s42, s47
    v_mfma_f32_16x16x32_bf16 a[64:67], v[32:35], v[104:107], a[64:67]
    v_mfma_f32_16x16x32_bf16 a[4:7], v[36:39], v[88:91], a[4:7]
    s_add_u32 m0, s39, 6144
    s_nop 0
    buffer_load_dwordx4 v3, s[16:19], s42 offen lds
    s_add_u32 s42, s42, s47
    v_mfma_f32_16x16x32_bf16 a[20:23], v[36:39], v[92:95], a[20:23]
    v_mfma_f32_16x16x32_bf16 a[36:39], v[36:39], v[96:99], a[36:39]
    s_add_u32 m0, s39, 7168
    s_nop 0
    buffer_load_dwordx4 v3, s[16:19], s42 offen lds
    s_add_u32 s42, s42, s48
    v_mfma_f32_16x16x32_bf16 a[52:55], v[36:39], v[100:103], a[52:55]
    v_mfma_f32_16x16x32_bf16 a[68:71], v[36:39], v[104:107], a[68:71]
    buffer_load_dwordx4 v[68:71], v2, s[12:15], s52 offen
    s_add_u32 s52, s52, 8192
    v_mfma_f32_16x16x32_bf16 a[8:11], v[40:43], v[88:91], a[8:11]
    v_mfma_f32_16x16x32_bf16 a[24:27], v[40:43], v[92:95], a[24:27]
    buffer_load_dwordx4 v[72:75], v2, s[12:15], s53 offen
    s_add_u32 s53, s53, 8192
    v_mfma_f32_16x16x32_bf16 a[40:43], v[40:43], v[96:99], a[40:43]
    v_mfma_f32_16x16x32_bf16 a[56:59], v[40:43], v[100:103], a[56:59]
    buffer_load_dwordx4 v[76:79], v2, s[12:15], s54 offen
    s_add_u32 s54, s54, 8192
    v_mfma_f32_16x16x32_bf16 a[72:75], v[40:43], v[104:107], a[72:75]
    v_mfma_f32_16x16x32_bf16 a[12:15], v[44:47], v[88:91], a[12:15]
    buffer_load_dwordx4 v[80:83], v2, s[12:15], s55 offen
    s_add_u32 s55, s55, 8192
    v_mfma_f32_16x16x32_bf16 a[28:31], v[44:47], v[92:95], a[28:31]
    v_mfma_f32_16x16x32_bf16 a[44:47], v[44:47], v[96:99], a[44:47]
    buffer_load_dwordx4 v[84:87], v2, s[12:15], s56 offen
    s_add_u32 s56, s56, 8192
    v_mfma_f32_16x16x32_bf16 a[60:63], v[44:47], v[100:103], a[60:63]
    v_mfma_f32_16x16x32_bf16 a[76:79], v[44:47], v[104:107], a[76:79]
    s_waitcnt vmcnt(18)
    ds_read_b64_tr_b16 v[32:33], v4 offset:16384
    ds_read_b64_tr_b16 v[34:35], v4 offset:17408
    ds_read_b64_tr_b16 v[36:37], v5 offset:16384
    ds_read_b64_tr_b16 v[38:39], v5 offset:17408
    ds_read_b64_tr_b16 v[40:41], v6 offset:16384
    ds_read_b64_tr_b16 v[42:43], v6 offset:17408
    ds_read_b64_tr_b16 v[44:45], v7 offset:16384
    ds_read_b64_tr_b16 v[46:47], v7 offset:17408
    s_waitcnt lgkmcnt(8)
    v_mfma_f32_16x16x32_bf16 a[0:3], v[16:19], v[108:111], a[0:3]
    v_mfma_f32_16x16x32_bf16 a[16:19], v[16:19], v[112:115], a[16:19]
    v_mfma_f32_16x16x32_bf16 a[32:35], v[16:19], v[116:119], a[32:35]
    v_mfma_f32_16x16x32_bf16 a[48:51], v[16:19], v[120:123], a[48:51]
    v_mfma_f32_16x16x32_bf16 a[64:67], v[16:19], v[124:127], a[64:67]
    v_mfma_f32_16x16x32_bf16 a[4:7], v[20:23], v[108:111], a[4:7]
    v_mfma_f32_16x16x32_bf16 a[20:23], v[20:23], v[112:115], a[20:23]
    v_mfma_f32_16x16x32_bf16 a[36:39], v[20:23], v[116:119], a[36:39]
    v_mfma_f32_16x16x32_bf16 a[52:55], v[20:23], v[120:123], a[52:55]
    v_mfma_f32_16x16x32_bf16 a[68:71], v[20:23], v[124:127], a[68:71]
    v_mfma_f32_16x16x32_bf16 a[8:11], v[24:27], v[108:111], a[8:11]
    v_mfma_f32_16x16x32_bf16 a[24:27], v[24:27], v[112:115], a[24:27]
    v_mfma_f32_16x16x32_bf16 a[40:43], v[24:27], v[116:119], a[40:43]
    v_mfma_f32_16x16x32_bf16 a[56:59], v[24:27], v[120:123], a[56:59]
    v_mfma_f32_16x16x32_bf16 a[72:75], v[24:27], v[124:127], a[72:75]
    v_mfma_f32_16x16x32_bf16 a[12:15], v[28:31], v[108:111], a[12:15]
    v_mfma_f32_16x16x32_bf16 a[28:31], v[28:31], v[112:115], a[28:31]
    v_mfma_f32_16x16x32_bf16 a[44:47], v[28:31], v[116:119], a[44:47]
    v_mfma_f32_16x16x32_bf16 a[60:63], v[28:31], v[120:123], a[60:63]
    v_mfma_f32_16x16x32_bf16 a[76:79], v[28:31], v[124:127], a[76:79]
    s_waitcnt vmcnt(9)
    ds_read_b64_tr_b16 v[16:17], v4 offset:0
    ds_read_b64_tr_b16 v[18:19], v4 offset:1024
    ds_read_b64_tr_b16 v[20:21], v5 offset:0
    ds_read_b64_tr_b16 v[22:23], v5 offset:1024
    ds_read_b64_tr_b16 v[24:25], v6 offset:0
    ds_read_b64_tr_b16 v[26:27], v6 offset:1024
    ds_read_b64_tr_b16 v[28:29], v7 offset:0
    ds_read_b64_tr_b16 v[30:31], v7 offset:1024
    s_waitcnt lgkmcnt(8)
    v_mfma_f32_16x16x32_bf16 a[0:3], v[32:35], v[128:131], a[0:3]
    v_mfma_f32_16x16x32_bf16 a[16:19], v[32:35], v[132:135], a[16:19]
    v_mfma_f32_16x16x32_bf16 a[32:35], v[32:35], v[136:139], a[32:35]
    v_mfma_f32_16x16x32_bf16 a[48:51], v[32:35], v[140:143], a[48:51]
    v_mfma_f32_16x16x32_bf16 a[64:67], v[32:35], v[144:147], a[64:67]
    v_mfma_f32_16x16x32_bf16 a[4:7], v[36:39], v[128:131], a[4:7]
    v_mfma_f32_16x16x32_bf16 a[20:23], v[36:39], v[132:135], a[20:23]
    v_mfma_f32_16x16x32_bf16 a[36:39], v[36:39], v[136:139], a[36:39]
    v_mfma_f32_16x16x32_bf16 a[52:55], v[36:39], v[140:143], a[52:55]
    v_mfma_f32_16x16x32_bf16 a[68:71], v[36:39], v[144:147], a[68:71]
    v_mfma_f32_16x16x32_bf16 a[8:11], v[40:43], v[128:131], a[8:11]
    v_mfma_f32_16x16x32_bf16 a[24:27], v[40:43], v[132:135], a[24:27]
    v_mfma_f32_16x16x32_bf16 a[40:43], v[40:43], v[136:139], a[40:43]
    v_mfma_f32_16x16x32_bf16 a[56:59], v[40:43], v[140:143], a[56:59]
    v_mfma_f32_16x16x32_bf16 a[72:75], v[40:43], v[144:147], a[72:75]
    v_mfma_f32_16x16x32_bf16 a[12:15], v[44:47], v[128:131], a[12:15]
    v_mfma_f32_16x16x32_bf16 a[28:31], v[44:47], v[132:135], a[28:31]
    v_mfma_f32_16x16x32_bf16 a[44:47], v[44:47], v[136:139], a[44:47]
    v_mfma_f32_16x16x32_bf16 a[60:63], v[44:47], v[140:143], a[60:63]
    v_mfma_f32_16x16x32_bf16 a[76:79], v[44:47], v[144:147], a[76:79]
    s_waitcnt vmcnt(0)
    ds_read_b64_tr_b16 v[32:33], v4 offset:4096
    ds_read_b64_tr_b16 v[34:35], v4 offset:5120
    ds_read_b64_tr_b16 v[36:37], v5 offset:4096
    ds_read_b64_tr_b16 v[38:39], v5 offset:5120
    ds_read_b64_tr_b16 v[40:41], v6 offset:4096
    ds_read_b64_tr_b16 v[42:43], v6 offset:5120
    ds_read_b64_tr_b16 v[44:45], v7 offset:4096
    ds_read_b64_tr_b16 v[46:47], v7 offset:5120
    s_waitcnt lgkmcnt(8)
    v_mfma_f32_16x16x32_bf16 a[0:3], v[16:19], v[48:51], a[0:3]
    v_mfma_f32_16x16x32_bf16 a[16:19], v[16:19], v[52:55], a[16:19]
    v_mfma_f32_16x16x32_bf16 a[32:35], v[16:19], v[56:59], a[32:35]
    v_mfma_f32_16x16x32_bf16 a[48:51], v[16:19], v[60:63], a[48:51]
    v_mfma_f32_16x16x32_bf16 a[64:67], v[16:19], v[64:67], a[64:67]
    v_mfma_f32_16x16x32_bf16 a[4:7], v[20:23], v[48:51], a[4:7]
    v_mfma_f32_16x16x32_bf16 a[20:23], v[20:23], v[52:55], a[20:23]
    v_mfma_f32_16x16x32_bf16 a[36:39], v[20:23], v[56:59], a[36:39]
    v_mfma_f32_16x16x32_bf16 a[52:55], v[20:23], v[60:63], a[52:55]
    v_mfma_f32_16x16x32_bf16 a[68:71], v[20:23], v[64:67], a[68:71]
    v_mfma_f32_16x16x32_bf16 a[8:11], v[24:27], v[48:51], a[8:11]
    v_mfma_f32_16x16x32_bf16 a[24:27], v[24:27], v[52:55], a[24:27]
    v_mfma_f32_16x16x32_bf16 a[40:43], v[24:27], v[56:59], a[40:43]
    v_mfma_f32_16x16x32_bf16 a[56:59], v[24:27], v[60:63], a[56:59]
    v_mfma_f32_16x16x32_bf16 a[72:75], v[24:27], v[64:67], a[72:75]
    v_mfma_f32_16x16x32_bf16 a[12:15], v[28:31], v[48:51], a[12:15]
    v_mfma_f32_16x16x32_bf16 a[28:31], v[28:31], v[52:55], a[28:31]
    v_mfma_f32_16x16x32_bf16 a[44:47], v[28:31], v[56:59], a[44:47]
    v_mfma_f32_16x16x32_bf16 a[60:63], v[28:31], v[60:63], a[60:63]
    v_mfma_f32_16x16x32_bf16 a[76:79], v[28:31], v[64:67], a[76:79]
    s_waitcnt lgkmcnt(0)
    v_mfma_f32_16x16x32_bf16 a[0:3], v[32:35], v[68:71], a[0:3]
    v_mfma_f32_16x16x32_bf16 a[16:19], v[32:35], v[72:75], a[16:19]
    v_mfma_f32_16x16x32_bf16 a[32:35], v[32:35], v[76:79], a[32:35]
    v_mfma_f32_16x16x32_bf16 a[48:51], v[32:35], v[80:83], a[48:51]
    v_mfma_f32_16x16x32_bf16 a[64:67], v[32:35], v[84:87], a[64:67]
    v_mfma_f32_16x16x32_bf16 a[4:7], v[36:39], v[68:71], a[4:7]
    v_mfma_f32_16x16x32_bf16 a[20:23], v[36:39], v[72:75], a[20:23]
    v_mfma_f32_16x16x32_bf16 a[36:39], v[36:39], v[76:79], a[36:39]
    v_mfma_f32_16x16x32_bf16 a[52:55], v[36:39], v[80:83], a[52:55]
    v_mfma_f32_16x16x32_bf16 a[68:71], v[36:39], v[84:87], a[68:71]
    v_mfma_f32_16x16x32_bf16 a[8:11], v[40:43], v[68:71], a[8:11]
    v_mfma_f32_16x16x32_bf16 a[24:27], v[40:43], v[72:75], a[24:27]
    v_mfma_f32_16x16x32_bf16 a[40:43], v[40:43], v[76:79], a[40:43]
    v_mfma_f32_16x16x32_bf16 a[56:59], v[40:43], v[80:83], a[56:59]
    v_mfma_f32_16x16x32_bf16 a[72:75], v[40:43], v[84:87], a[72:75]
    v_mfma_f32_16x16x32_bf16 a[12:15], v[44:47], v[68:71], a[12:15]
    v_mfma_f32_16x16x32_bf16 a[28:31], v[44:47], v[72:75], a[28:31]
    v_mfma_f32_16x16x32_bf16 a[44:47], v[44:47], v[76:79], a[44:47]
    v_mfma_f32_16x16x32_bf16 a[60:63], v[44:47], v[80:83], a[60:63]
    v_mfma_f32_16x16x32_bf16 a[76:79], v[44:47], v[84:87], a[76:79]
    s_nop 15
    v_lshlrev_b32 v1, 4, v0
    v_add_u32 v13, s39, v1
    ds_write_b128 v13, a[0:3] offset:0
    ds_write_b128 v13, a[4:7] offset:1024
    ds_write_b128 v13, a[8:11] offset:2048
    ds_write_b128 v13, a[12:15] offset:3072
    ds_write_b128 v13, a[16:19] offset:4096
    ds_write_b128 v13, a[20:23] offset:5120
    ds_write_b128 v13, a[24:27] offset:6144
    ds_write_b128 v13, a[28:31] offset:7168
    ds_write_b128 v13, a[32:35] offset:8192
    ds_write_b128 v13, a[36:39] offset:9216
    ds_write_b128 v13, a[40:43] offset:10240
    ds_write_b128 v13, a[44:47] offset:11264
    ds_write_b128 v13, a[48:51] offset:12288
    ds_write_b128 v13, a[52:55] offset:13312
    ds_write_b128 v13, a[56:59] offset:14336
    ds_write_b128 v13, a[60:63] offset:15360
    ds_write_b128 v13, a[64:67] offset:16384
    ds_write_b128 v13, a[68:71] offset:17408
    ds_write_b128 v13, a[72:75] offset:18432
    ds_write_b128 v13, a[76:79] offset:19456
    s_waitcnt lgkmcnt(0)
    s_barrier
    s_lshl_b32 s44, s34, 10
    v_add_u32 v12, s44, v1
    v_add_u32 v13, 40960, v12
    ds_read_b128 v[16:19], v12 offset:0
    ds_read_b128 v[20:23], v12 offset:20480
    ds_read_b128 v[24:27], v13 offset:0
    ds_read_b128 v[28:31], v13 offset:20480
    ds_read_b128 v[32:35], v12 offset:4096
    ds_read_b128 v[36:39], v12 offset:24576
    ds_read_b128 v[40:43], v13 offset:4096
    ds_read_b128 v[44:47], v13 offset:24576
    ds_read_b128 v[48:51], v12 offset:8192
    ds_read_b128 v[52:55], v12 offset:28672
    ds_read_b128 v[56:59], v13 offset:8192
    ds_read_b128 v[60:63], v13 offset:28672
    ds_read_b128 v[64:67], v12 offset:12288
    ds_read_b128 v[68:71], v12 offset:32768
    ds_read_b128 v[72:75], v13 offset:12288
    ds_read_b128 v[76:79], v13 offset:32768
    ds_read_b128 v[80:83], v12 offset:16384
    ds_read_b128 v[84:87], v12 offset:36864
    ds_read_b128 v[88:91], v13 offset:16384
    ds_read_b128 v[92:95], v13 offset:36864
    s_waitcnt lgkmcnt(0)
    v_add_f32 v16, v16, v20
    v_add_f32 v24, v24, v28
    v_add_f32 v16, v16, v24
    v_add_f32 v17, v17, v21
    v_add_f32 v25, v25, v29
    v_add_f32 v17, v17, v25
    v_add_f32 v18, v18, v22
    v_add_f32 v26, v26, v30
    v_add_f32 v18, v18, v26
    v_add_f32 v19, v19, v23
    v_add_f32 v27, v27, v31
    v_add_f32 v19, v19, v27
    v_add_f32 v32, v32, v36
    v_add_f32 v40, v40, v44
    v_add_f32 v32, v32, v40
    v_add_f32 v33, v33, v37
    v_add_f32 v41, v41, v45
    v_add_f32 v33, v33, v41
    v_add_f32 v34, v34, v38
    v_add_f32 v42, v42, v46
    v_add_f32 v34, v34, v42
    v_add_f32 v35, v35, v39
    v_add_f32 v43, v43, v47
    v_add_f32 v35, v35, v43
    v_add_f32 v48, v48, v52
    v_add_f32 v56, v56, v60
    v_add_f32 v48, v48, v56
    v_add_f32 v49, v49, v53
    v_add_f32 v57, v57, v61
    v_add_f32 v49, v49, v57
    v_add_f32 v50, v50, v54
    v_add_f32 v58, v58, v62
    v_add_f32 v50, v50, v58
    v_add_f32 v51, v51, v55
    v_add_f32 v59, v59, v63
    v_add_f32 v51, v51, v59
    v_add_f32 v64, v64, v68
    v_add_f32 v72, v72, v76
    v_add_f32 v64, v64, v72
    v_add_f32 v65, v65, v69
    v_add_f32 v73, v73, v77
    v_add_f32 v65, v65, v73
    v_add_f32 v66, v66, v70
    v_add_f32 v74, v74, v78
    v_add_f32 v66, v66, v74
    v_add_f32 v67, v67, v71
    v_add_f32 v75, v75, v79
    v_add_f32 v67, v67, v75
    v_add_f32 v80, v80, v84
    v_add_f32 v88, v88, v92
    v_add_f32 v80, v80, v88
    v_add_f32 v81, v81, v85
    v_add_f32 v89, v89, v93
    v_add_f32 v81, v81, v89
    v_add_f32 v82, v82, v86
    v_add_f32 v90, v90, v94
    v_add_f32 v82, v82, v90
    v_add_f32 v83, v83, v87
    v_add_f32 v91, v91, v95
    v_add_f32 v83, v83, v91
    s_mul_i32 s44, s32, 80
    v_and_b32 v9, 15, v0
    v_add_u32 v9, s44, v9
    s_movk_i32 s45, 2304
    v_mul_lo_u32 v9, v9, s45
    v_lshl_add_u32 v9, v8, 3, v9
    s_lshl_b32 s44, s34, 5
    s_add_u32 s43, s43, s44
    v_cvt_pk_bf16_f32 v100, v16, v17
    v_cvt_pk_bf16_f32 v101, v18, v19
    s_add_u32 s44, s43, 1152
    buffer_store_dwordx2 v[100:101], v9, s[20:23], s44 offen
    v_cvt_pk_bf16_f32 v102, v32, v33
    v_cvt_pk_bf16_f32 v103, v34, v35
    s_add_u32 s44, s43, 38016
    buffer_store_dwordx2 v[102:103], v9, s[20:23], s44 offen
    v_cvt_pk_bf16_f32 v104, v48, v49
    v_cvt_pk_bf16_f32 v105, v50, v51
    s_add_u32 s44, s43, 74880
    buffer_store_dwordx2 v[104:105], v9, s[20:23], s44 offen
    v_cvt_pk_bf16_f32 v106, v64, v65
    v_cvt_pk_bf16_f32 v107, v66, v67
    s_add_u32 s44, s43, 111744
    buffer_store_dwordx2 v[106:107], v9, s[20:23], s44 offen
    v_cvt_pk_bf16_f32 v108, v80, v81
    v_cvt_pk_bf16_f32 v109, v82, v83
    s_add_u32 s44, s43, 148608
    buffer_store_dwordx2 v[108:109], v9, s[20:23], s44 offen
    s_branch L_k3_next
L_k3_next:
    s_mov_b64 exec, -1
    s_waitcnt lgkmcnt(0)
    s_barrier
    s_sub_u32 s3, s2, 256
    v_lshl_add_u32 v0, s34, 6, v0
    s_load_dwordx2 s[6:7], s[0:1], 104
    s_load_dwordx2 s[10:11], s[0:1], 88
    s_load_dwordx2 s[8:9], s[0:1], 32
    v_lshrrev_b32 v1, 6, v0
    v_and_b32 v0, 63, v0
    v_readfirstlane_b32 s34, v1
    s_and_b32 s35, s3, 7
    s_lshr_b32 s36, s3, 3
    s_mul_i32 s37, s35, 234
    s_add_u32 s38, s37, 234
    s_lshr_b32 s37, s37, 3
    s_lshr_b32 s38, s38, 3
    s_add_u32 s37, s37, s36
    s_cmp_ge_u32 s37, s38
    s_cbranch_scc1 L_k3_end
    s_mul_i32 s32, s37, 7282
    s_lshr_b32 s32, s32, 16
    s_mul_i32 s33, s32, 9
    s_sub_u32 s33, s37, s33
    s_waitcnt lgkmcnt(0)
    s_movk_i32 s38, 1152
    s_movk_i32 s35, 1152
    s_lshl_b32 s43, s33, 7
    s_mov_b32 s46, s43
    s_add_u32 s12, s6, 55574528
    s_addc_u32 s13, s7, 0
    s_mov_b32 s14, 2359296
    s_mov_b32 s15, 0x00020000
    s_mov_b32 s16, s8
    s_mov_b32 s17, s9
    s_mov_b32 s18, 663552
    s_mov_b32 s19, 0x00020000
    s_mov_b32 s20, s10
    s_mov_b32 s21, s11
    s_mov_b32 s22, 4718592
    s_mov_b32 s23, 0x00020000
    v_lshrrev_b32 v8, 4, v0
    v_lshlrev_b32 v2, 4, v0
    v_lshrrev_b32 v9, 3, v0
    v_mul_lo_u32 v10, v9, s35
    v_lshrrev_b32 v9, 1, v9
    v_lshlrev_b32 v9, 1, v9
    v_and_b32 v11, 7, v0
    v_xor_b32 v9, v9, v11
    v_lshl_add_u32 v3, v9, 4, v10
    s_mul_i32 s39, s34, 20480
    s_mul_i32 s40, s32, 92160
    s_lshl_b32 s41, s34, 10
    s_add_u32 s40, s40, s41
    s_add_u32 s52, s40, 0
    s_add_u32 s53, s40, 18432
    s_add_u32 s54, s40, 36864
    s_add_u32 s55, s40, 55296
    s_add_u32 s56, s40, 73728
    s_lshl_b32 s47, s35, 3
    s_lshl_b32 s48, s35, 5
    s_mul_i32 s42, s34, s48
    s_add_u32 s42, s42, s46
    s_mul_i32 s48, s35, 104
    s_add_u32 m0, s39, 0
    s_nop 0
    buffer_load_dwordx4 v3, s[16:19], s42 offen lds
    s_add_u32 s42, s42, s47
    s_add_u32 m0, s39, 1024
    s_nop 0
    buffer_load_dwordx4 v3, s[16:19], s42 offen lds
    s_add_u32 s42, s42, s47
    s_add_u32 m0, s39, 2048
    s_nop 0
    buffer_load_dwordx4 v3, s[16:19], s42 offen lds
    s_add_u32 s42, s42, s47
    s_add_u32 m0, s39, 3072
    s_nop 0
    buffer_load_dwordx4 v3, s[16:19], s42 offen lds
    s_add_u32 s42, s42, s48
    s_add_u32 m0, s39, 4096
    s_nop 0
    buffer_load_dwordx4 v3, s[16:19], s42 offen lds
    s_add_u32 s42, s42, s47
    s_add_u32 m0, s39, 5120
    s_nop 0
    buffer_load_dwordx4 v3, s[16:19], s42 offen lds
    s_add_u32 s42, s42, s47
    s_add_u32 m0, s39, 6144
    s_nop 0
    buffer_load_dwordx4 v3, s[16:19], s42 offen lds
    s_add_u32 s42, s42, s47
    s_add_u32 m0, s39, 7168
    s_nop 0
    buffer_load_dwordx4 v3, s[16:19], s42 offen lds
    s_add_u32 s42, s42, s48
    s_add_u32 m0, s39, 8192
    s_nop 0
    buffer_load_dwordx4 v3, s[16:19], s42 offen lds
    s_add_u32 s42, s42, s47
    s_add_u32 m0, s39, 9216
    s_nop 0
    buffer_load_dwordx4 v3, s[16:19], s42 offen lds
    s_add_u32 s42, s42, s47
    s_add_u32 m0, s39, 10240
    s_nop 0
    buffer_load_dwordx4 v3, s[16:19], s42 offen lds
    s_add_u32 s42, s42, s47
    s_add_u32 m0, s39, 11264
    s_nop 0
    buffer_load_dwordx4 v3, s[16:19], s42 offen lds
    s_add_u32 s42, s42, s48
    s_add_u32 m0, s39, 12288
    s_nop 0
    buffer_load_dwordx4 v3, s[16:19], s42 offen lds
    s_add_u32 s42, s42, s47
    s_add_u32 m0, s39, 13312
    s_nop 0
    buffer_load_dwordx4 v3, s[16:19], s42 offen lds
    s_add_u32 s42, s42, s47
    s_add_u32 m0, s39, 14336
    s_nop 0
    buffer_load_dwordx4 v3, s[16:19], s42 offen lds
    s_add_u32 s42, s42, s47
    s_add_u32 m0, s39, 15360
    s_nop 0
    buffer_load_dwordx4 v3, s[16:19], s42 offen lds
    s_add_u32 s42, s42, s48
    s_cmp_lg_u32 s34, 0
    s_cbranch_scc1 L_pdone_99
    s_mul_i32 s44, s32, 80
    s_lshr_b32 s45, s44, 5
    s_add_u32 s44, s44, 79
    s_lshr_b32 s44, s44, 5
    s_min_u32 s44, s44, 63
    v_and_b32 v9, 3, v0
    v_add_u32 v9, s45, v9
    v_min_u32 v9, s44, v9
    v_lshlrev_b32 v9, 7, v9
L_poll_98:
    buffer_load_dword v10, v9, s[60:63], 0 offen sc1
    s_waitcnt vmcnt(0)
    v_and_b32 v11, 0xff, v10
    v_cmp_ne_u32 vcc, 4, v11
    s_cbranch_vccz L_pdone_99
    v_lshrrev_b32 v11, 16, v10
    v_cmp_ne_u32 vcc, 15, v11
    s_cbranch_vccnz L_k3_steal
    s_sleep 4
    s_branch L_poll_98
L_pdone_99:
    v_mov_b32 v9, 0
    v_mov_b32 v10, -1
    s_cmp_lg_u32 s34, 0
    s_cbranch_scc1 L_k3_sync
    ds_write_b32 v9, v10 offset:16384
    s_waitcnt lgkmcnt(0)
L_k3_sync:
    s_barrier
    ds_read_b32 v10, v9 offset:16384
    s_waitcnt vmcnt(0) lgkmcnt(0)
    v_readfirstlane_b32 s66, v10
    s_barrier
    s_cmp_lg_u32 s66, -1
    s_cbranch_scc1 L_k3_runsteal
    s_add_u32 m0, s39, 16384
    s_nop 0
    buffer_load_dwordx4 v3, s[16:19], s42 offen lds
    s_add_u32 s42, s42, s47
    s_add_u32 m0, s39, 17408
    s_nop 0
    buffer_load_dwordx4 v3, s[16:19], s42 offen lds
    s_add_u32 s42, s42, s47
    s_add_u32 m0, s39, 18432
    s_nop 0
    buffer_load_dwordx4 v3, s[16:19], s42 offen lds
    s_add_u32 s42, s42, s47
    s_add_u32 m0, s39, 19456
    s_nop 0
    buffer_load_dwordx4 v3, s[16:19], s42 offen lds
    s_add_u32 s42, s42, s48
    buffer_load_dwordx4 v[48:51], v2, s[12:15], s52 offen sc1
    s_add_u32 s52, s52, 4096
    buffer_load_dwordx4 v[52:55], v2, s[12:15], s53 offen sc1
    s_add_u32 s53, s53, 4096
    buffer_load_dwordx4 v[56:59], v2, s[12:15], s54 offen sc1
    s_add_u32 s54, s54, 4096
    buffer_load_dwordx4 v[60:63], v2, s[12:15], s55 offen sc1
    s_add_u32 s55, s55, 4096
    buffer_load_dwordx4 v[64:67], v2, s[12:15], s56 offen sc1
    s_add_u32 s56, s56, 4096
    buffer_load_dwordx4 v[68:71], v2, s[12:15], s52 offen sc1
    s_add_u32 s52, s52, 4096
    buffer_load_dwordx4 v[72:75], v2, s[12:15], s53 offen sc1
    s_add_u32 s53, s53, 4096
    buffer_load_dwordx4 v[76:79], v2, s[12:15], s54 offen sc1
    s_add_u32 s54, s54, 4096
    buffer_load_dwordx4 v[80:83], v2, s[12:15], s55 offen sc1
    s_add_u32 s55, s55, 4096
    buffer_load_dwordx4 v[84:87], v2, s[12:15], s56 offen sc1
    s_add_u32 s56, s56, 4096
    buffer_load_dwordx4 v[88:91], v2, s[12:15], s52 offen sc1
    s_add_u32 s52, s52, 4096
    buffer_load_dwordx4 v[92:95], v2, s[12:15], s53 offen sc1
    s_add_u32 s53, s53, 4096
    buffer_load_dwordx4 v[96:99], v2, s[12:15], s54 offen sc1
    s_add_u32 s54, s54, 4096
    buffer_load_dwordx4 v[100:103], v2, s[12:15], s55 offen sc1
    s_add_u32 s55, s55, 4096
    buffer_load_dwordx4 v[104:107], v2, s[12:15], s56 offen sc1
    s_add_u32 s56, s56, 4096
    buffer_load_dwordx4 v[108:111], v2, s[12:15], s52 offen sc1
    s_add_u32 s52, s52, 4096
    buffer_load_dwordx4 v[112:115], v2, s[12:15], s53 offen sc1
    s_add_u32 s53, s53, 4096
    buffer_load_dwordx4 v[116:119], v2, s[12:15], s54 offen sc1
    s_add_u32 s54, s54, 4096
    buffer_load_dwordx4 v[120:123], v2, s[12:15], s55 offen sc1
    s_add_u32 s55, s55, 4096
    buffer_load_dwordx4 v[124:127], v2, s[12:15], s56 offen sc1
    s_add_u32 s56, s56, 4096
    buffer_load_dwordx4 v[128:131], v2, s[12:15], s52 offen sc1
    s_add_u32 s52, s52, 4096
    buffer_load_dwordx4 v[132:135], v2, s[12:15], s53 offen sc1
    s_add_u32 s53, s53, 4096
    buffer_load_dwordx4 v[136:139], v2, s[12:15], s54 offen sc1
    s_add_u32 s54, s54, 4096
    buffer_load_dwordx4 v[140:143], v2, s[12:15], s55 offen sc1
    s_add_u32 s55, s55, 4096
    buffer_load_dwordx4 v[144:147], v2, s[12:15], s56 offen sc1
    s_add_u32 s56, s56, 4096
    v_lshrrev_b32 v10, 2, v0
    v_and_b32 v10, 3, v10
    v_and_b32 v11, 3, v0
    v_lshl_add_u32 v9, v8, 3, v10
    v_lshlrev_b32 v9, 7, v9
    v_lshl_add_u32 v9, v11, 3, v9
    v_add_u32 v9, s39, v9
    v_lshrrev_b32 v1, 1, v10
    v_lshl_add_u32 v4, v1, 5, v9
    v_xor_b32 v5, 32, v4
    v_xor_b32 v6, 64, v4
    v_xor_b32 v7, 96, v4
    v_accvgpr_write_b32 a0, 0
    v_accvgpr_write_b32 a1, 0
    v_accvgpr_write_b32 a2, 0
    v_accvgpr_write_b32 a3, 0
    v_accvgpr_write_b32 a4, 0
    v_accvgpr_write_b32 a5, 0
    v_accvgpr_write_b32 a6, 0
    v_accvgpr_write_b32 a7, 0
    v_accvgpr_write_b32 a8, 0
    v_accvgpr_write_b32 a9, 0
    v_accvgpr_write_b32 a10, 0
    v_accvgpr_write_b32 a11, 0
    v_accvgpr_write_b32 a12, 0
    v_accvgpr_write_b32 a13, 0
    v_accvgpr_write_b32 a14, 0
    v_accvgpr_write_b32 a15, 0
    v_accvgpr_write_b32 a16, 0
    v_accvgpr_write_b32 a17, 0
    v_accvgpr_write_b32 a18, 0
    v_accvgpr_write_b32 a19, 0
    v_accvgpr_write_b32 a20, 0
    v_accvgpr_write_b32 a21, 0
    v_accvgpr_write_b32 a22, 0
    v_accvgpr_write_b32 a23, 0
    v_accvgpr_write_b32 a24, 0
    v_accvgpr_write_b32 a25, 0
    v_accvgpr_write_b32 a26, 0
    v_accvgpr_write_b32 a27, 0
    v_accvgpr_write_b32 a28, 0
    v_accvgpr_write_b32 a29, 0
    v_accvgpr_write_b32 a30, 0
    v_accvgpr_write_b32 a31, 0
    v_accvgpr_write_b32 a32, 0
    v_accvgpr_write_b32 a33, 0
    v_accvgpr_write_b32 a34, 0
    v_accvgpr_write_b32 a35, 0
    v_accvgpr_write_b32 a36, 0
    v_accvgpr_write_b32 a37, 0
    v_accvgpr_write_b32 a38, 0
    v_accvgpr_write_b32 a39, 0
    v_accvgpr_write_b32 a40, 0
    v_accvgpr_write_b32 a41, 0
    v_accvgpr_write_b32 a42, 0
    v_accvgpr_write_b32 a43, 0
    v_accvgpr_write_b32 a44, 0
    v_accvgpr_write_b32 a45, 0
    v_accvgpr_write_b32 a46, 0
    v_accvgpr_write_b32 a47, 0
    v_accvgpr_write_b32 a48, 0
    v_accvgpr_write_b32 a49, 0
    v_accvgpr_write_b32 a50, 0
    v_accvgpr_write_b32 a51, 0
    v_accvgpr_write_b32 a52, 0
    v_accvgpr_write_b32 a53, 0
    v_accvgpr_write_b32 a54, 0
    v_accvgpr_write_b32 a55, 0
    v_accvgpr_write_b32 a56, 0
    v_accvgpr_write_b32 a57, 0
    v_accvgpr_write_b32 a58, 0
    v_accvgpr_write_b32 a59, 0
    v_accvgpr_write_b32 a60, 0
    v_accvgpr_write_b32 a61, 0
    v_accvgpr_write_b32 a62, 0
    v_accvgpr_write_b32 a63, 0
    v_accvgpr_write_b32 a64, 0
    v_accvgpr_write_b32 a65, 0
    v_accvgpr_write_b32 a66, 0
    v_accvgpr_write_b32 a67, 0
    v_accvgpr_write_b32 a68, 0
    v_accvgpr_write_b32 a69, 0
    v_accvgpr_write_b32 a70, 0
    v_accvgpr_write_b32 a71, 0
    v_accvgpr_write_b32 a72, 0
    v_accvgpr_write_b32 a73, 0
    v_accvgpr_write_b32 a74, 0
    v_accvgpr_write_b32 a75, 0
    v_accvgpr_write_b32 a76, 0
    v_accvgpr_write_b32 a77, 0
    v_accvgpr_write_b32 a78, 0
    v_accvgpr_write_b32 a79, 0
    ds_read_b64_tr_b16 v[16:17], v4 offset:0
    ds_read_b64_tr_b16 v[18:19], v6 offset:512
    ds_read_b64_tr_b16 v[20:21], v5 offset:0
    ds_read_b64_tr_b16 v[22:23], v7 offset:512
    ds_read_b64_tr_b16 v[24:25], v6 offset:0
    ds_read_b64_tr_b16 v[26:27], v4 offset:512
    ds_read_b64_tr_b16 v[28:29], v7 offset:0
    ds_read_b64_tr_b16 v[30:31], v5 offset:512
    ds_read_b64_tr_b16 v[32:33], v4 offset:4096
    ds_read_b64_tr_b16 v[34:35], v6 offset:4608
    ds_read_b64_tr_b16 v[36:37], v5 offset:4096
    ds_read_b64_tr_b16 v[38:39], v7 offset:4608
    ds_read_b64_tr_b16 v[40:41], v6 offset:4096
    ds_read_b64_tr_b16 v[42:43], v4 offset:4608
    ds_read_b64_tr_b16 v[44:45], v7 offset:4096
    ds_read_b64_tr_b16 v[46:47], v5 offset:4608
    s_waitcnt lgkmcnt(8)
    s_waitcnt vmcnt(20)
    v_mfma_f32_16x16x32_bf16 a[0:3], v[16:19], v[48:51], a[0:3]
    v_mfma_f32_16x16x32_bf16 a[16:19], v[16:19], v[52:55], a[16:19]
    v_mfma_f32_16x16x32_bf16 a[32:35], v[16:19], v[56:59], a[32:35]
    v_mfma_f32_16x16x32_bf16 a[48:51], v[16:19], v[60:63], a[48:51]
    v_mfma_f32_16x16x32_bf16 a[64:67], v[16:19], v[64:67], a[64:67]
    v_mfma_f32_16x16x32_bf16 a[4:7], v[20:23], v[48:51], a[4:7]
    v_mfma_f32_16x16x32_bf16 a[20:23], v[20:23], v[52:55], a[20:23]
    v_mfma_f32_16x16x32_bf16 a[36:39], v[20:23], v[56:59], a[36:39]
    v_mfma_f32_16x16x32_bf16 a[52:55], v[20:23], v[60:63], a[52:55]
    v_mfma_f32_16x16x32_bf16 a[68:71], v[20:23], v[64:67], a[68:71]
    v_mfma_f32_16x16x32_bf16 a[8:11], v[24:27], v[48:51], a[8:11]
    v_mfma_f32_16x16x32_bf16 a[24:27], v[24:27], v[52:55], a[24:27]
    v_mfma_f32_16x16x32_bf16 a[40:43], v[24:27], v[56:59], a[40:43]
    v_mfma_f32_16x16x32_bf16 a[56:59], v[24:27], v[60:63], a[56:59]
    v_mfma_f32_16x16x32_bf16 a[72:75], v[24:27], v[64:67], a[72:75]
    v_mfma_f32_16x16x32_bf16 a[12:15], v[28:31], v[48:51], a[12:15]
    v_mfma_f32_16x16x32_bf16 a[28:31], v[28:31], v[52:55], a[28:31]
    v_mfma_f32_16x16x32_bf16 a[44:47], v[28:31], v[56:59], a[44:47]
    v_mfma_f32_16x16x32_bf16 a[60:63], v[28:31], v[60:63], a[60:63]
    v_mfma_f32_16x16x32_bf16 a[76:79], v[28:31], v[64:67], a[76:79]
    ds_read_b64_tr_b16 v[16:17], v4 offset:8192
    ds_read_b64_tr_b16 v[18:19], v6 offset:8704
    ds_read_b64_tr_b16 v[20:21], v5 offset:8192
    ds_read_b64_tr_b16 v[22:23], v7 offset:8704
    ds_read_b64_tr_b16 v[24:25], v6 offset:8192
    ds_read_b64_tr_b16 v[26:27], v4 offset:8704
    ds_read_b64_tr_b16 v[28:29], v7 offset:8192
    ds_read_b64_tr_b16 v[30:31], v5 offset:8704
    s_waitcnt lgkmcnt(8)
    s_waitcnt vmcnt(15)
    v_mfma_f32_16x16x32_bf16 a[0:3], v[32:35], v[68:71], a[0:3]
    v_mfma_f32_16x16x32_bf16 a[16:19], v[32:35], v[72:75], a[16:19]
    v_mfma_f32_16x16x32_bf16 a[32:35], v[32:35], v[76:79], a[32:35]
    v_mfma_f32_16x16x32_bf16 a[48:51], v[32:35], v[80:83], a[48:51]
    v_mfma_f32_16x16x32_bf16 a[64:67], v[32:35], v[84:87], a[64:67]
    v_mfma_f32_16x16x32_bf16 a[4:7], v[36:39], v[68:71], a[4:7]
    v_mfma_f32_16x16x32_bf16 a[20:23], v[36:39], v[72:75], a[20:23]
    v_mfma_f32_16x16x32_bf16 a[36:39], v[36:39], v[76:79], a[36:39]
    v_mfma_f32_16x16x32_bf16 a[52:55], v[36:39], v[80:83], a[52:55]
    v_mfma_f32_16x16x32_bf16 a[68:71], v[36:39], v[84:87], a[68:71]
    v_mfma_f32_16x16x32_bf16 a[8:11], v[40:43], v[68:71], a[8:11]
    v_mfma_f32_16x16x32_bf16 a[24:27], v[40:43], v[72:75], a[24:27]
    v_mfma_f32_16x16x32_bf16 a[40:43], v[40:43], v[76:79], a[40:43]
    v_mfma_f32_16x16x32_bf16 a[56:59], v[40:43], v[80:83], a[56:59]
    v_mfma_f32_16x16x32_bf16 a[72:75], v[40:43], v[84:87], a[72:75]
    v_mfma_f32_16x16x32_bf16 a[12:15], v[44:47], v[68:71], a[12:15]
    v_mfma_f32_16x16x32_bf16 a[28:31], v[44:47], v[72:75], a[28:31]
    v_mfma_f32_16x16x32_bf16 a[44:47], v[44:47], v[76:79], a[44:47]
    v_mfma_f32_16x16x32_bf16 a[60:63], v[44:47], v[80:83], a[60:63]
    v_mfma_f32_16x16x32_bf16 a[76:79], v[44:47], v[84:87], a[76:79]
    ds_read_b64_tr_b16 v[32:33], v4 offset:12288
    ds_read_b64_tr_b16 v[34:35], v6 offset:12800
    ds_read_b64_tr_b16 v[36:37], v5 offset:12288
    ds_read_b64_tr_b16 v[38:39], v7 offset:12800
    ds_read_b64_tr_b16 v[40:41], v6 offset:12288
    ds_read_b64_tr_b16 v[42:43], v4 offset:12800
    ds_read_b64_tr_b16 v[44:45], v7 offset:12288
    ds_read_b64_tr_b16 v[46:47], v5 offset:12800
    s_waitcnt lgkmcnt(8)
    s_waitcnt vmcnt(10)
    v_mfma_f32_16x16x32_bf16 a[0:3], v[16:19], v[88:91], a[0:3]
    v_mfma_f32_16x16x32_bf16 a[16:19], v[16:19], v[92:95], a[16:19]
    v_mfma_f32_16x16x32_bf16 a[32:35], v[16:19], v[96:99], a[32:35]
    v_mfma_f32_16x16x32_bf16 a[48:51], v[16:19], v[100:103], a[48:51]
    v_mfma_f32_16x16x32_bf16 a[64:67], v[16:19], v[104:107], a[64:67]
    v_mfma_f32_16x16x32_bf16 a[4:7], v[20:23], v[88:91], a[4:7]
    v_mfma_f32_16x16x32_bf16 a[20:23], v[20:23], v[92:95], a[20:23]
    v_mfma_f32_16x16x32_bf16 a[36:39], v[20:23], v[96:99], a[36:39]
    v_mfma_f32_16x16x32_bf16 a[52:55], v[20:23], v[100:103], a[52:55]
    v_mfma_f32_16x16x32_bf16 a[68:71], v[20:23], v[104:107], a[68:71]
    v_mfma_f32_16x16x32_bf16 a[8:11], v[24:27], v[88:91], a[8:11]
    v_mfma_f32_16x16x32_bf16 a[24:27], v[24:27], v[92:95], a[24:27]
    v_mfma_f32_16x16x32_bf16 a[40:43], v[24:27], v[96:99], a[40:43]
    v_mfma_f32_16x16x32_bf16 a[56:59], v[24:27], v[100:103], a[56:59]
    v_mfma_f32_16x16x32_bf16 a[72:75], v[24:27], v[104:107], a[72:75]
    v_mfma_f32_16x16x32_bf16 a[12:15], v[28:31], v[88:91], a[12:15]
    v_mfma_f32_16x16x32_bf16 a[28:31], v[28:31], v[92:95], a[28:31]
    v_mfma_f32_16x16x32_bf16 a[44:47], v[28:31], v[96:99], a[44:47]
    v_mfma_f32_16x16x32_bf16 a[60:63], v[28:31], v[100:103], a[60:63]
    v_mfma_f32_16x16x32_bf16 a[76:79], v[28:31], v[104:107], a[76:79]
    ds_read_b64_tr_b16 v[16:17], v4 offset:16384
    ds_read_b64_tr_b16 v[18:19], v6 offset:16896
    ds_read_b64_tr_b16 v[20:21], v5 offset:16384
    ds_read_b64_tr_b16 v[22:23], v7 offset:16896
    ds_read_b64_tr_b16 v[24:25], v6 offset:16384
    ds_read_b64_tr_b16 v[26:27], v4 offset:16896
    ds_read_b64_tr_b16 v[28:29], v7 offset:16384
    ds_read_b64_tr_b16 v[30:31], v5 offset:16896
    s_waitcnt lgkmcnt(8)
    s_waitcnt vmcnt(5)
    v_mfma_f32_16x16x32_bf16 a[0:3], v[32:35], v[108:111], a[0:3]
    v_mfma_f32_16x16x32_bf16 a[16:19], v[32:35], v[112:115], a[16:19]
    v_mfma_f32_16x16x32_bf16 a[32:35], v[32:35], v[116:119], a[32:35]
    v_mfma_f32_16x16x32_bf16 a[48:51], v[32:35], v[120:123], a[48:51]
    v_mfma_f32_16x16x32_bf16 a[64:67], v[32:35], v[124:127], a[64:67]
    v_mfma_f32_16x16x32_bf16 a[4:7], v[36:39], v[108:111], a[4:7]
    v_mfma_f32_16x16x32_bf16 a[20:23], v[36:39], v[112:115], a[20:23]
    v_mfma_f32_16x16x32_bf16 a[36:39], v[36:39], v[116:119], a[36:39]
    v_mfma_f32_16x16x32_bf16 a[52:55], v[36:39], v[120:123], a[52:55]
    v_mfma_f32_16x16x32_bf16 a[68:71], v[36:39], v[124:127], a[68:71]
    v_mfma_f32_16x16x32_bf16 a[8:11], v[40:43], v[108:111], a[8:11]
    v_mfma_f32_16x16x32_bf16 a[24:27], v[40:43], v[112:115], a[24:27]
    v_mfma_f32_16x16x32_bf16 a[40:43], v[40:43], v[116:119], a[40:43]
    v_mfma_f32_16x16x32_bf16 a[56:59], v[40:43], v[120:123], a[56:59]
    v_mfma_f32_16x16x32_bf16 a[72:75], v[40:43], v[124:127], a[72:75]
    v_mfma_f32_16x16x32_bf16 a[12:15], v[44:47], v[108:111], a[12:15]
    v_mfma_f32_16x16x32_bf16 a[28:31], v[44:47], v[112:115], a[28:31]
    v_mfma_f32_16x16x32_bf16 a[44:47], v[44:47], v[116:119], a[44:47]
    v_mfma_f32_16x16x32_bf16 a[60:63], v[44:47], v[120:123], a[60:63]
    v_mfma_f32_16x16x32_bf16 a[76:79], v[44:47], v[124:127], a[76:79]
    s_waitcnt lgkmcnt(0)
    s_waitcnt vmcnt(0)
    s_cmp_ge_u32 s34, 2
    s_cbranch_scc1 L_sk5_100
    v_mfma_f32_16x16x32_bf16 a[0:3], v[16:19], v[128:131], a[0:3]
    v_mfma_f32_16x16x32_bf16 a[16:19], v[16:19], v[132:135], a[16:19]
    v_mfma_f32_16x16x32_bf16 a[32:35], v[16:19], v[136:139], a[32:35]
    v_mfma_f32_16x16x32_bf16 a[48:51], v[16:19], v[140:143], a[48:51]
    v_mfma_f32_16x16x32_bf16 a[64:67], v[16:19], v[144:147], a[64:67]
    v_mfma_f32_16x16x32_bf16 a[4:7], v[20:23], v[128:131], a[4:7]
    v_mfma_f32_16x16x32_bf16 a[20:23], v[20:23], v[132:135], a[20:23]
    v_mfma_f32_16x16x32_bf16 a[36:39], v[20:23], v[136:139], a[36:39]
    v_mfma_f32_16x16x32_bf16 a[52:55], v[20:23], v[140:143], a[52:55]
    v_mfma_f32_16x16x32_bf16 a[68:71], v[20:23], v[144:147], a[68:71]
    v_mfma_f32_16x16x32_bf16 a[8:11], v[24:27], v[128:131], a[8:11]
    v_mfma_f32_16x16x32_bf16 a[24:27], v[24:27], v[132:135], a[24:27]
    v_mfma_f32_16x16x32_bf16 a[40:43], v[24:27], v[136:139], a[40:43]
    v_mfma_f32_16x16x32_bf16 a[56:59], v[24:27], v[140:143], a[56:59]
    v_mfma_f32_16x16x32_bf16 a[72:75], v[24:27], v[144:147], a[72:75]
    v_mfma_f32_16x16x32_bf16 a[12:15], v[28:31], v[128:131], a[12:15]
    v_mfma_f32_16x16x32_bf16 a[28:31], v[28:31], v[132:135], a[28:31]
    v_mfma_f32_16x16x32_bf16 a[44:47], v[28:31], v[136:139], a[44:47]
    v_mfma_f32_16x16x32_bf16 a[60:63], v[28:31], v[140:143], a[60:63]
    v_mfma_f32_16x16x32_bf16 a[76:79], v[28:31], v[144:147], a[76:79]
L_sk5_100:
    s_nop 15
    v_lshlrev_b32 v1, 4, v0
    v_add_u32 v13, s39, v1
    ds_write_b128 v13, a[0:3] offset:0
    ds_write_b128 v13, a[4:7] offset:1024
    ds_write_b128 v13, a[8:11] offset:2048
    ds_write_b128 v13, a[12:15] offset:3072
    ds_write_b128 v13, a[16:19] offset:4096
    ds_write_b128 v13, a[20:23] offset:5120
    ds_write_b128 v13, a[24:27] offset:6144
    ds_write_b128 v13, a[28:31] offset:7168
    ds_write_b128 v13, a[32:35] offset:8192
    ds_write_b128 v13, a[36:39] offset:9216
    ds_write_b128 v13, a[40:43] offset:10240
    ds_write_b128 v13, a[44:47] offset:11264
    ds_write_b128 v13, a[48:51] offset:12288
    ds_write_b128 v13, a[52:55] offset:13312
    ds_write_b128 v13, a[56:59] offset:14336
    ds_write_b128 v13, a[60:63] offset:15360
    ds_write_b128 v13, a[64:67] offset:16384
    ds_write_b128 v13, a[68:71] offset:17408
    ds_write_b128 v13, a[72:75] offset:18432
    ds_write_b128 v13, a[76:79] offset:19456
    s_waitcnt lgkmcnt(0)
    s_barrier
    s_lshl_b32 s44, s34, 10
    v_add_u32 v12, s44, v1
    v_add_u32 v13, 40960, v12
    ds_read_b128 v[16:19], v12 offset:0
    ds_read_b128 v[20:23], v12 offset:20480
    ds_read_b128 v[24:27], v13 offset:0
    ds_read_b128 v[28:31], v13 offset:20480
    ds_read_b128 v[32:35], v12 offset:4096
    ds_read_b128 v[36:39], v12 offset:24576
    ds_read_b128 v[40:43], v13 offset:4096
    ds_read_b128 v[44:47], v13 offset:24576
    ds_read_b128 v[48:51], v12 offset:8192
    ds_read_b128 v[52:55], v12 offset:28672
    ds_read_b128 v[56:59], v13 offset:8192
    ds_read_b128 v[60:63], v13 offset:28672
    ds_read_b128 v[64:67], v12 offset:12288
    ds_read_b128 v[68:71], v12 offset:32768
    ds_read_b128 v[72:75], v13 offset:12288
    ds_read_b128 v[76:79], v13 offset:32768
    ds_read_b128 v[80:83], v12 offset:16384
    ds_read_b128 v[84:87], v12 offset:36864
    ds_read_b128 v[88:91], v13 offset:16384
    ds_read_b128 v[92:95], v13 offset:36864
    s_waitcnt lgkmcnt(0)
    v_add_f32 v16, v16, v20
    v_add_f32 v24, v24, v28
    v_add_f32 v16, v16, v24
    v_add_f32 v17, v17, v21
    v_add_f32 v25, v25, v29
    v_add_f32 v17, v17, v25
    v_add_f32 v18, v18, v22
    v_add_f32 v26, v26, v30
    v_add_f32 v18, v18, v26
    v_add_f32 v19, v19, v23
    v_add_f32 v27, v27, v31
    v_add_f32 v19, v19, v27
    v_add_f32 v32, v32, v36
    v_add_f32 v40, v40, v44
    v_add_f32 v32, v32, v40
    v_add_f32 v33, v33, v37
    v_add_f32 v41, v41, v45
    v_add_f32 v33, v33, v41
    v_add_f32 v34, v34, v38
    v_add_f32 v42, v42, v46
    v_add_f32 v34, v34, v42
    v_add_f32 v35, v35, v39
    v_add_f32 v43, v43, v47
    v_add_f32 v35, v35, v43
    v_add_f32 v48, v48, v52
    v_add_f32 v56, v56, v60
    v_add_f32 v48, v48, v56
    v_add_f32 v49, v49, v53
    v_add_f32 v57, v57, v61
    v_add_f32 v49, v49, v57
    v_add_f32 v50, v50, v54
    v_add_f32 v58, v58, v62
    v_add_f32 v50, v50, v58
    v_add_f32 v51, v51, v55
    v_add_f32 v59, v59, v63
    v_add_f32 v51, v51, v59
    v_add_f32 v64, v64, v68
    v_add_f32 v72, v72, v76
    v_add_f32 v64, v64, v72
    v_add_f32 v65, v65, v69
    v_add_f32 v73, v73, v77
    v_add_f32 v65, v65, v73
    v_add_f32 v66, v66, v70
    v_add_f32 v74, v74, v78
    v_add_f32 v66, v66, v74
    v_add_f32 v67, v67, v71
    v_add_f32 v75, v75, v79
    v_add_f32 v67, v67, v75
    v_add_f32 v80, v80, v84
    v_add_f32 v88, v88, v92
    v_add_f32 v80, v80, v88
    v_add_f32 v81, v81, v85
    v_add_f32 v89, v89, v93
    v_add_f32 v81, v81, v89
    v_add_f32 v82, v82, v86
    v_add_f32 v90, v90, v94
    v_add_f32 v82, v82, v90
    v_add_f32 v83, v83, v87
    v_add_f32 v91, v91, v95
    v_add_f32 v83, v83, v91
    s_mul_i32 s44, s32, 80
    v_and_b32 v9, 15, v0
    v_add_u32 v9, s44, v9
    s_movk_i32 s45, 2304
    v_mul_lo_u32 v9, v9, s45
    v_lshl_add_u32 v9, v8, 3, v9
    s_lshl_b32 s44, s34, 5
    s_add_u32 s43, s43, s44
    v_cvt_pk_bf16_f32 v100, v16, v17
    v_cvt_pk_bf16_f32 v101, v18, v19
    s_add_u32 s44, s43, 0
    buffer_store_dwordx2 v[100:101], v9, s[20:23], s44 offen
    v_cvt_pk_bf16_f32 v102, v32, v33
    v_cvt_pk_bf16_f32 v103, v34, v35
    s_add_u32 s44, s43, 36864
    buffer_store_dwordx2 v[102:103], v9, s[20:23], s44 offen
    v_cvt_pk_bf16_f32 v104, v48, v49
    v_cvt_pk_bf16_f32 v105, v50, v51
    s_add_u32 s44, s43, 73728
    buffer_store_dwordx2 v[104:105], v9, s[20:23], s44 offen
    v_cvt_pk_bf16_f32 v106, v64, v65
    v_cvt_pk_bf16_f32 v107, v66, v67
    s_add_u32 s44, s43, 110592
    buffer_store_dwordx2 v[106:107], v9, s[20:23], s44 offen
    v_cvt_pk_bf16_f32 v108, v80, v81
    v_cvt_pk_bf16_f32 v109, v82, v83
    s_add_u32 s44, s43, 147456
    buffer_store_dwordx2 v[108:109], v9, s[20:23], s44 offen
    s_branch L_k3_end
L_k3_steal:
    s_ff1_i32_b64 s68, vcc
    s_nop 3
    v_readlane_b32 s69, v10, s68
    v_readlane_b32 s70, v9, s68
    s_lshr_b32 s69, s69, 16
    s_not_b32 s69, s69
    s_and_b32 s69, s69, 15
    s_ff1_i32_b32 s69, s69
    s_lshl_b32 s71, 0x10000, s69
    v_mov_b32 v11, s71
    v_mov_b32 v12, 0
    v_cmp_eq_u32 vcc, 0, v0
    s_and_saveexec_b64 s[64:65], vcc
    buffer_atomic_or v11, v12, s[60:63], s70 offen sc0
    s_waitcnt vmcnt(0)
    s_mov_b64 exec, s[64:65]
    v_readfirstlane_b32 s72, v11
    s_and_b32 s72, s72, s71
    s_cmp_lg_u32 s72, 0
    s_cbranch_scc1 L_poll_98
    s_lshr_b32 s70, s70, 5
    s_add_u32 s70, s70, s69
    v_mov_b32 v9, 0
    v_mov_b32 v10, s70
    ds_write_b32 v9, v10 offset:16384
    s_waitcnt lgkmcnt(0)
    s_branch L_k3_sync
L_k3_runsteal:
    s_mov_b32 s67, 1
    v_mov_b32 v147, 0
    s_mov_b32 s68, 0
    v_lshl_add_u32 v0, s34, 6, v0
    s_branch L_k3_abody
L_k3_end:
    s_endpgm
.section .rodata,"a"
.p2align 6
.amdhsa_kernel k2b_kernel
  .amdhsa_next_free_vgpr 512
  .amdhsa_next_free_sgpr 102
  .amdhsa_accum_offset 256
  .amdhsa_group_segment_fixed_size 0
  .amdhsa_kernarg_size 112
  .amdhsa_user_sgpr_count 2
  .amdhsa_user_sgpr_kernarg_segment_ptr 1
  .amdhsa_system_sgpr_workgroup_id_x 1
.end_amdhsa_kernel
.p2align 6
.amdhsa_kernel k3_kernel
  .amdhsa_next_free_vgpr 228
  .amdhsa_next_free_sgpr 102
  .amdhsa_accum_offset 148
  .amdhsa_group_segment_fixed_size 0
  .amdhsa_kernarg_size 112
  .amdhsa_user_sgpr_count 2
  .amdhsa_user_sgpr_kernarg_segment_ptr 1
  .amdhsa_system_sgpr_workgroup_id_x 1
.end_amdhsa_kernel
```
